```python
import torch

def _softmax(x, axis=-1):
    return torch.softmax(x, dim=axis)
def _gelu(x):
    return torch.nn.functional.gelu(x, approximate="tanh")
def _silu(x):
    return torch.nn.functional.silu(x)
def _sigmoid(x):
    return torch.sigmoid(x)
def _layernorm(x, axis=-1, eps=1e-5):
    m = x.mean(dim=axis, keepdim=True)
    v = x.var(dim=axis, keepdim=True, unbiased=False)
    return (x - m) / torch.sqrt(v + eps)
def _scatter_add(tgt, idx, src, axis=0):
    return tgt.clone().index_add_(axis, idx, src)
def _segment_sum(src, seg, n):
    out = torch.zeros((n,) + src.shape[1:], dtype=src.dtype)
    return out.index_add_(0, seg, src)
def _pad(x, pw):
    flat = tuple(v for pair in reversed(pw) for v in pair)
    return torch.nn.functional.pad(x, flat)

kernel_name = 'concat_heads__ssm_conv_s5__compressed_kv_cla__prompt'

def setup_inputs():

    _w = (lambda a: (lambda t: t.to(torch.bfloat16) if t.is_floating_point() else t)(torch.as_tensor(a)))
    def _A_setup():
        B, S, D = 1, 2048, 512
        P = D
        Lambda_re = -0.5 * (lambda _x: torch.exp(torch.as_tensor(_x)))((lambda *s: torch.randn(*s, dtype=torch.bfloat16) * 0.2)(P))
        Lambda_im = (lambda *s: torch.randn(*s, dtype=torch.bfloat16) * 0.4)(P) * 1.0
        B_re = (lambda *s: torch.randn(*s, dtype=torch.bfloat16) * 0.2)(P, D) * (D ** -0.5)
        B_im = (lambda *s: torch.randn(*s, dtype=torch.bfloat16) * 0.2)(P, D) * (D ** -0.5)
        C_re = (lambda *s: torch.randn(*s, dtype=torch.bfloat16) * 0.2)(D, P) * (P ** -0.5)
        C_im = (lambda *s: torch.randn(*s, dtype=torch.bfloat16) * 0.2)(D, P) * (P ** -0.5)
        log_dt = (lambda *s: torch.randn(*s, dtype=torch.bfloat16) * 0.2)(P) * 0.3 - 2.0
        Dskip = (lambda *s: torch.randn(*s, dtype=torch.bfloat16) * 0.05)(D)
        return {
            "x": _w((lambda *s: torch.randn(*s, dtype=torch.bfloat16) * 0.05)(B, S, D)),
            "Lambda_re": _w(Lambda_re),
            "Lambda_im": _w(Lambda_im),
            "B_re": _w(B_re),
            "B_im": _w(B_im),
            "C_re": _w(C_re),
            "C_im": _w(C_im),
            "log_dt": _w(log_dt),
            "Dskip": _w(Dskip),
        }
    _A_in = _A_setup()

    def _B_setup():
        B, H, Sq, Sk, D, M = 1, 32, 2048, 2048, 128, 512
        Dc = 4 * D
        return {
            "x": _w((lambda *s: torch.randn(*s, dtype=torch.bfloat16) * 3.2)(B, Sq, M)),
            "c_kv": _w((lambda *s: torch.randn(*s, dtype=torch.bfloat16) * 0.1)(B, Sk, Dc)),
            "w_q": _w((lambda *s: torch.randn(*s, dtype=torch.bfloat16) * 6.4)(M, H, D) * (M ** -0.5)),
            "w_uk": _w((lambda *s: torch.randn(*s, dtype=torch.bfloat16) * 6.4)(Dc, H, D) * (Dc ** -0.5)),
            "w_uv": _w((lambda *s: torch.randn(*s, dtype=torch.bfloat16) * 0.1)(Dc, H, D) * (Dc ** -0.5)),
            "w_o": _w((lambda *s: torch.randn(*s, dtype=torch.bfloat16) * 0.1)(H, D, M) * ((H * D) ** -0.5)),
        }
    _B_in = _B_setup()

    return {
        "A_x": _A_in["x"],
        "A_Lambda_re": _A_in["Lambda_re"],
        "A_Lambda_im": _A_in["Lambda_im"],
        "A_B_re": _A_in["B_re"],
        "A_B_im": _A_in["B_im"],
        "A_C_re": _A_in["C_re"],
        "A_C_im": _A_in["C_im"],
        "A_log_dt": _A_in["log_dt"],
        "A_Dskip": _A_in["Dskip"],
        "B_x": _B_in["x"],
        "B_c_kv": _B_in["c_kv"],
        "B_w_q": _B_in["w_q"],
        "B_w_uk": _B_in["w_uk"],
        "B_w_uv": _B_in["w_uv"],
        "B_w_o": _B_in["w_o"],
    }

def reference(A_x, A_Lambda_re, A_Lambda_im, A_B_re, A_B_im, A_C_re, A_C_im, A_log_dt, A_Dskip, B_x, B_c_kv, B_w_q, B_w_uk, B_w_uv, B_w_o):
    def _A_ref(x, Lambda_re, Lambda_im, B_re, B_im, C_re, C_im, log_dt, Dskip):
        Bsz, L, H = x.shape
        Lam = Lambda_re + 1j * Lambda_im
        Bmat = B_re + 1j * B_im
        Cmat = C_re + 1j * C_im
        dt = torch.exp(log_dt)
        Lam_bar = torch.exp(dt * Lam)
        B_bar = ((Lam_bar - 1.0) / Lam)[:, None] * Bmat
        Bu = torch.einsum("bld,pd->blp", x + 0j, B_bar)
        h = torch.zeros_like(Bu[:, 0, :])
        hs = []
        for t in range(L):
            h = Lam_bar[None, :] * h + Bu[:, t, :]
            hs.append(h)
        hseq = torch.stack(hs, 1)
        y = 2.0 * torch.einsum("blp,dp->bld", hseq, Cmat).real + x * Dskip[None, None, :]
        return y

    def _B_ref(x, c_kv, w_q, w_uk, w_uv, w_o):
        B, Sq, M = x.shape[0], x.shape[1], x.shape[2]
        Sk = c_kv.shape[1]
        H, D = w_q.shape[1], w_q.shape[2]
        q = torch.einsum("bqm,mhd->bhqd", x, w_q)
        k = torch.einsum("bkc,chd->bhkd", c_kv, w_uk)
        v = torch.einsum("bkc,chd->bhkd", c_kv, w_uv)
        scores = torch.einsum("bhqd,bhkd->bhqk", q, k) * (D ** -0.5)
        off = Sk - Sq
        qi = torch.arange(Sq)[:, None]
        kj = torch.arange(Sk)[None, :]
        cmask = kj <= (qi + off)
        scores = torch.where(cmask[None, None], scores, -1e9)
        p = _softmax(scores, axis=-1)
        ctx = torch.einsum("bhqk,bhkd->bhqd", p, v)
        return torch.einsum("bhqd,hdm->bqm", ctx, w_o)

    a = _A_ref(A_x, A_Lambda_re, A_Lambda_im, A_B_re, A_B_im, A_C_re, A_C_im, A_log_dt, A_Dskip)
    b = _B_ref(B_x, B_c_kv, B_w_q, B_w_uk, B_w_uv, B_w_o)
    return torch.concatenate([a, b], axis=-1)
```

```asm
; @launch grid=(256,1,1) block=(256,1,1) lds=163840
.amdgcn_target "amdgcn-amd-amdhsa--gfx950"
.text
.globl concat_heads__ssm_conv_s5__compressed_kv_cla__prompt_kernel
.p2align 8
.type concat_heads__ssm_conv_s5__compressed_kv_cla__prompt_kernel,@function
concat_heads__ssm_conv_s5__compressed_kv_cla__prompt_kernel:
s_cmp_ge_u32 s2, 256
s_cbranch_scc1 L_end
s_load_dwordx16 s[20:35], s[0:1], 64
s_load_dwordx16 s[4:19], s[0:1], 0
s_load_dwordx4 s[36:39], s[0:1], 128
s_getpc_b64 s[80:81]
L_pc:
s_lshr_b32 s91, s2, 3
v_lshrrev_b32 v8, 5, v0
v_lshlrev_b32 v8, 5, v8
v_add_lshl_u32 v8, v8, s91, 7
global_load_dword v126, v8, s[80:81]
v_lshrrev_b32 v8, 6, v0
v_and_b32 v1, 63, v0
v_readfirstlane_b32 s3, v8
v_lshrrev_b32 v3, 4, v1
v_lshrrev_b32 v8, 3, v1
v_and_b32 v9, 7, v1
v_xor_b32 v10, v9, v3
v_lshlrev_b32 v10, 4, v10
v_lshl_add_u32 v63, v8, 10, v10
v_xor_b32 v11, 64, v63
v_add_u32 v26, 0, v63
v_add_u32 v27, 7168, v11
v_add_u32 v28, 14336, v63
v_add_u32 v29, 21504, v11
v_add_u32 v30, 524288, v63
v_add_u32 v31, 531456, v11
v_add_u32 v32, 538624, v63
v_add_u32 v33, 545792, v11
s_and_b32 s77, s91, 7
s_lshl_b32 s86, s3, 13
s_lshl_b32 s87, s3, 12
s_and_b32 s83, s3, 1
s_lshl_b32 s83, s83, 4
s_add_u32 s84, s83, s77
s_lshl_b32 s84, s84, 1
s_lshr_b32 s82, s3, 1
s_add_u32 s84, s84, s82
s_lshl_b32 s84, s84, 15
v_and_b32 v14, 15, v1
v_lshlrev_b32 v12, 1, v3
v_xor_b32 v12, v12, v14
v_lshlrev_b32 v12, 4, v12
v_lshl_add_u32 v12, v3, 13, v12
s_lshl_b32 s82, s3, 17
v_add_u32 v34, s82, v12
v_xor_b32 v12, 128, v34
v_add_u32 v35, 31744, v34
v_add_u32 v36, 63488, v12
v_add_u32 v37, 95232, v12
s_and_b32 s94, s2, 7
s_lshr_b32 s82, s91, 3
s_lshl_b32 s76, s94, 2
s_add_u32 s76, s76, s82
s_lshl_b32 s85, s76, 8
s_mov_b32 s50, 0x200000
s_mov_b32 s51, 0x20000
s_mov_b32 s54, 0x400000
s_mov_b32 s55, 0x20000
s_mov_b32 s58, 0x400000
s_mov_b32 s59, 0x20000
s_waitcnt lgkmcnt(0)
s_mov_b32 s48, s24
s_and_b32 s49, s25, 0xffff
s_add_u32 m0, s86, 65536
s_nop 0
buffer_load_dwordx4 v26, s[48:51], s84 offen offset:0 lds
buffer_load_dwordx4 v27, s[48:51], s84 offen offset:1024 lds
buffer_load_dwordx4 v28, s[48:51], s84 offen offset:2048 lds
buffer_load_dwordx4 v29, s[48:51], s84 offen offset:3072 lds
s_add_u32 m0, s86, 69632
s_nop 0
buffer_load_dwordx4 v30, s[48:51], s84 offen offset:0 lds
buffer_load_dwordx4 v31, s[48:51], s84 offen offset:1024 lds
buffer_load_dwordx4 v32, s[48:51], s84 offen offset:2048 lds
buffer_load_dwordx4 v33, s[48:51], s84 offen offset:3072 lds
s_mov_b32 s52, s28
s_and_b32 s53, s29, 0xffff
s_add_u32 m0, s87, 98304
s_nop 0
buffer_load_dwordx4 v34, s[52:55], s85 offen offset:0 lds
buffer_load_dwordx4 v35, s[52:55], s85 offen offset:1024 lds
buffer_load_dwordx4 v36, s[52:55], s85 offen offset:2048 lds
buffer_load_dwordx4 v37, s[52:55], s85 offen offset:3072 lds
v_lshlrev_b32 v9, 28, v8
v_lshl_add_u32 v4, v1, 7, v9
v_and_b32 v9, 4, v1
v_lshl_add_u32 v7, v9, 7, v4
v_lshlrev_b32 v2, 4, v1
s_and_b32 s82, s91, 1
s_lshl_b32 s78, s94, 1
s_add_u32 s78, s78, s82
s_lshr_b32 s79, s2, 4
s_mov_b32 s92, s85
s_lshl_b32 s82, s79, 5
s_add_u32 s82, s82, s83
v_add_u32 v18, s82, v14
v_lshlrev_b32 v18, 1, v18
s_lshr_b32 s88, s91, 1
s_lshl_b32 s88, s88, 15
s_add_u32 s88, s88, s86
s_lshl_b32 s82, s94, 10
s_add_u32 s88, s88, s82
s_lshl_b32 s93, s2, 2
s_add_u32 s93, s93, s3
s_lshl_b32 s94, s94, 5
s_add_u32 s94, s94, s91
s_lshl_b32 s94, s94, 2
s_add_u32 s94, s94, s3
s_lshl_b32 s94, s94, 11
s_bitcmp1_b32 s91, 0
s_cselect_b32 s80, s30, s28
s_cselect_b32 s81, s31, s29
s_mov_b32 s64, s80
s_and_b32 s65, s81, 0xffff
s_mov_b32 s66, 0x400000
s_mov_b32 s67, 0x20000
s_lshl_b32 s91, s93, 11
s_cmp_ge_u32 s3, 2
s_cselect_b32 s80, s12, s10
s_cselect_b32 s81, s13, s11
s_mov_b32 s44, s80
s_and_b32 s45, s81, 0xffff
s_mov_b32 s46, 0x80000
s_mov_b32 s47, 0x20000
s_bitcmp1_b32 s2, 4
s_cselect_b32 s80, s16, s14
s_cselect_b32 s81, s17, s15
s_mov_b32 s68, s80
s_and_b32 s69, s81, 0xffff
s_mov_b32 s70, 0x80000
s_mov_b32 s71, 0x20000
s_mov_b32 s60, s38
s_and_b32 s61, s39, 0xffff
s_mov_b32 s62, 0x4a00000
s_mov_b32 s63, 0x20000
s_getreg_b32 s16, hwreg(HW_REG_XCC_ID, 0, 4)
s_add_u32 s16, s16, 1
s_lshl_b32 s0, s76, 5
s_add_u32 s0, s0, s77
s_lshl_b32 s0, s0, 2
s_add_u32 s0, s0, 59834368
s_lshl_b32 s1, s3, 11
v_lshrrev_b32 v17, 1, v1
v_and_b32 v0, 1, v1
v_lshlrev_b32 v0, 4, v0
v_lshl_add_u32 v0, v17, 7, v0
s_cmp_lg_u32 s93, 3
s_cbranch_scc1 L_noclr
v_mov_b32 v20, 0
v_mov_b32 v21, 0
v_mov_b32 v22, 0
v_mov_b32 v23, 0
s_mov_b32 s82, 59834368
buffer_store_dwordx4 v[20:23], v0, s[60:63], s82 offen sc1
s_add_u32 s82, s82, 4096
buffer_store_dwordx4 v[20:23], v0, s[60:63], s82 offen sc1
s_add_u32 s82, s82, 4096
buffer_store_dwordx4 v[20:23], v0, s[60:63], s82 offen sc1
s_add_u32 s82, s82, 4096
buffer_store_dwordx4 v[20:23], v0, s[60:63], s82 offen sc1
s_add_u32 s82, s82, 4096
buffer_store_dwordx4 v[20:23], v0, s[60:63], s82 offen sc1
s_add_u32 s82, s82, 4096
v_lshlrev_b32 v17, 7, v1
buffer_store_dwordx4 v[20:23], v17, s[60:63], s82 offen sc1
s_add_u32 s82, s82, 8192
buffer_store_dwordx4 v[20:23], v0, s[60:63], s82 offen sc1
L_noclr:
v_lshrrev_b32 v12, 2, v8
v_lshlrev_b32 v12, 4, v12
v_and_b32 v13, 3, v8
v_add_u32 v12, v12, v13
s_lshr_b32 s82, s3, 1
s_lshl_b32 s82, s82, 6
s_and_b32 s83, s3, 1
s_lshl_b32 s83, s83, 3
s_add_u32 s82, s82, s83
v_add_u32 v12, s82, v12
v_lshl_add_u32 v44, v12, 10, v10
v_xor_b32 v12, 64, v44
v_add_u32 v45, 31744, v12
v_add_u32 v46, 2048, v44
v_add_u32 v47, 33792, v12
s_lshl_b32 s83, s83, 11
v_add_u32 v48, s83, v63
s_add_u32 s83, s83, 7168
v_add_u32 v49, s83, v11
s_lshl_b32 s89, s78, 17
s_lshl_b32 s90, s79, 15
v_lshrrev_b32 v5, 1, v14
v_xor_b32 v5, v5, v3
v_lshlrev_b32 v5, 4, v5
v_lshl_add_u32 v5, v14, 7, v5
s_and_b32 s82, s3, 1
s_lshl_b32 s83, s82, 14
s_add_u32 s83, s83, 0x10000
v_add_u32 v38, s83, v5
v_xor_b32 v39, 64, v38
s_lshr_b32 s83, s3, 1
s_lshl_b32 s83, s83, 13
v_add_u32 v50, s83, v5
v_xor_b32 v51, 64, v50
s_lshl_b32 s83, s82, 11
v_add_u32 v54, s83, v5
v_xor_b32 v55, 64, v54
v_add_u32 v52, 0x20000, v50
v_add_u32 v53, 0x20000, v51
v_add_u32 v56, 0x20000, v54
v_add_u32 v57, 0x20000, v55
v_bfe_u32 v12, v1, 2, 2
v_and_b32 v13, 1, v3
v_lshl_add_u32 v13, v13, 2, v12
v_lshl_add_u32 v25, v3, 3, v12
v_lshlrev_b32 v25, 8, v25
v_lshl_add_u32 v25, v13, 5, v25
v_and_b32 v15, 3, v1
v_lshl_add_u32 v25, v15, 3, v25
s_lshr_b32 s83, s3, 1
s_lshl_b32 s83, s83, 7
v_xor_b32 v17, s83, v25
v_add_u32 v17, 98304, v17
v_xor_b32 v40, 0, v17
v_xor_b32 v41, 32, v17
v_xor_b32 v42, 64, v17
v_xor_b32 v43, 96, v17
v_lshlrev_b32 v24, 3, v14
s_lshr_b32 s82, s3, 1
s_lshl_b32 s82, s82, 2
v_add_u32 v62, s82, v3
s_mov_b32 s56, s30
s_and_b32 s57, s31, 0xffff
s_add_u32 m0, s87, 114688
s_nop 0
buffer_load_dwordx4 v34, s[56:59], s85 offen offset:0 lds
buffer_load_dwordx4 v35, s[56:59], s85 offen offset:1024 lds
buffer_load_dwordx4 v36, s[56:59], s85 offen offset:2048 lds
buffer_load_dwordx4 v37, s[56:59], s85 offen offset:3072 lds
global_load_ushort v108, v18, s[6:7]
global_load_ushort v109, v18, s[8:9]
global_load_ushort v110, v18, s[18:19]
s_mov_b32 s40, s4
s_and_b32 s41, s5, 0xffff
s_mov_b32 s42, 0x200000
s_mov_b32 s43, 0x20000
buffer_load_dword v127, v7, s[40:43], s94 offen
s_bitcmp1_b32 s2, 7
s_cselect_b32 s80, s12, s10
s_cselect_b32 s81, s13, s11
s_mov_b32 s72, s80
s_and_b32 s73, s81, 0xffff
s_mov_b32 s74, 0x80000
s_mov_b32 s75, 0x20000
s_and_b32 s83, s93, 511
s_lshl_b32 s83, s83, 10
buffer_load_dword v127, v4, s[72:75], s83 offen
s_add_u32 m0, s87, 0
s_nop 0
buffer_load_dwordx4 v44, s[40:43], s89 offen offset:0 lds
buffer_load_dwordx4 v45, s[40:43], s89 offen offset:1024 lds
buffer_load_dwordx4 v46, s[40:43], s89 offen offset:2048 lds
buffer_load_dwordx4 v47, s[40:43], s89 offen offset:3072 lds
s_add_u32 m0, s1, 16384
s_nop 0
buffer_load_dwordx4 v48, s[44:47], s90 offen offset:0 lds
buffer_load_dwordx4 v49, s[44:47], s90 offen offset:1024 lds
s_add_u32 s89, s89, 128
s_add_u32 s90, s90, 128
s_add_u32 s88, s88, 524288
buffer_load_dword v127, v4, s[64:67], s88 offen
s_mov_b32 s48, s24
s_and_b32 s49, s25, 0xffff
buffer_load_dword v127, v7, s[48:51], s91 offen
s_waitcnt vmcnt(10)
v_lshlrev_b32 v108, 16, v108
v_lshlrev_b32 v109, 16, v109
v_lshlrev_b32 v110, 16, v110
v_mul_f32 v110, 0x3fb8aa3b, v110
v_exp_f32 v110, v110
s_nop 0
v_cvt_pk_bf16_f32 v110, v110, v110
v_lshlrev_b32 v110, 16, v110
v_mul_f32 v112, v110, v108
v_mul_f32 v113, v110, v109
v_mul_f32 v112, 0x3fb8aa3b, v112
v_mul_f32 v113, 0x3e22f983, v113
v_exp_f32 v112, v112
v_rndne_f32 v114, v113
v_sub_f32 v113, v113, v114
v_cos_f32 v114, v113
v_sin_f32 v115, v113
s_nop 0
v_mul_f32 v96, v112, v114
v_mul_f32 v97, v112, v115
v_add_f32 v112, -1.0, v96
v_mul_f32 v113, v108, v108
v_fma_f32 v113, v109, v109, v113
v_rcp_f32 v113, v113
v_mul_f32 v114, v112, v108
v_fma_f32 v114, v97, v109, v114
v_mul_f32 v115, v97, v108
v_fma_f32 v115, -v112, v109, v115
v_add_f32 v113, v113, v113
v_mul_f32 v102, v114, v113
v_mul_f32 v103, v115, v113
s_add_u32 s84, s84, 128
s_add_u32 s85, s85, 524288
s_waitcnt vmcnt(13) lgkmcnt(0)
s_barrier
ds_read_b128 a[128:131], v38 offset:0
ds_read_b128 a[132:135], v39 offset:0
ds_read_b64_tr_b16 a[160:161], v40 offset:16384
ds_read_b64_tr_b16 a[162:163], v40 offset:17408
ds_read_b64_tr_b16 a[164:165], v40 offset:24576
ds_read_b64_tr_b16 a[166:167], v40 offset:25600
ds_read_b64_tr_b16 a[168:169], v41 offset:16384
ds_read_b64_tr_b16 a[170:171], v41 offset:17408
ds_read_b64_tr_b16 a[172:173], v41 offset:24576
ds_read_b64_tr_b16 a[174:175], v41 offset:25600
ds_read_b64_tr_b16 a[176:177], v42 offset:16384
ds_read_b64_tr_b16 a[178:179], v42 offset:17408
ds_read_b64_tr_b16 a[180:181], v42 offset:24576
ds_read_b64_tr_b16 a[182:183], v42 offset:25600
ds_read_b64_tr_b16 a[184:185], v43 offset:16384
ds_read_b64_tr_b16 a[186:187], v43 offset:17408
ds_read_b64_tr_b16 a[188:189], v43 offset:24576
ds_read_b64_tr_b16 a[190:191], v43 offset:25600
ds_read_b128 a[136:139], v38 offset:2048
ds_read_b128 a[140:143], v39 offset:2048
ds_read_b128 a[144:147], v38 offset:4096
ds_read_b128 a[148:151], v39 offset:4096
ds_read_b128 a[152:155], v38 offset:6144
ds_read_b128 a[156:159], v39 offset:6144
s_waitcnt lgkmcnt(15)
v_mfma_f32_16x16x32_bf16 v[128:131], a[128:131], a[160:163], 0
s_waitcnt lgkmcnt(0)
v_mul_f32 v112, v96, v96
v_mul_f32 v113, v96, v97
v_mfma_f32_16x16x32_bf16 v[128:131], a[132:135], a[164:167], v[128:131]
s_add_u32 m0, s87, 24576
ds_read_b128 a[192:195], v38 offset:8192
v_fma_f32 v112, -v97, v97, v112
v_mfma_f32_16x16x32_bf16 v[132:135], a[128:131], a[168:171], 0
buffer_load_dwordx4 v44, s[40:43], s89 offen offset:0 lds
v_mfma_f32_16x16x32_bf16 v[132:135], a[132:135], a[172:175], v[132:135]
ds_read_b128 a[196:199], v39 offset:8192
v_fma_f32 v113, v97, v96, v113
v_mfma_f32_16x16x32_bf16 v[136:139], a[128:131], a[176:179], 0
buffer_load_dwordx4 v45, s[40:43], s89 offen offset:1024 lds
v_mfma_f32_16x16x32_bf16 v[136:139], a[132:135], a[180:183], v[136:139]
ds_read_b128 a[200:203], v38 offset:10240
v_mul_f32 v114, v112, v112
v_mfma_f32_16x16x32_bf16 v[140:143], a[128:131], a[184:187], 0
v_mul_f32 v115, v112, v113
v_fma_f32 v114, -v113, v113, v114
v_mfma_f32_16x16x32_bf16 v[140:143], a[132:135], a[188:191], v[140:143]
ds_read_b128 a[204:207], v39 offset:10240
v_fma_f32 v115, v113, v112, v115
v_mfma_f32_16x16x32_bf16 v[144:147], a[136:139], a[160:163], 0
buffer_load_dwordx4 v46, s[40:43], s89 offen offset:2048 lds
v_mfma_f32_16x16x32_bf16 v[144:147], a[140:143], a[164:167], v[144:147]
ds_read_b128 a[208:211], v38 offset:12288
v_mul_f32 v112, v114, v114
v_mfma_f32_16x16x32_bf16 v[148:151], a[136:139], a[168:171], 0
buffer_load_dwordx4 v47, s[40:43], s89 offen offset:3072 lds
v_mfma_f32_16x16x32_bf16 v[148:151], a[140:143], a[172:175], v[148:151]
ds_read_b128 a[212:215], v39 offset:12288
v_mul_f32 v113, v114, v115
v_mfma_f32_16x16x32_bf16 v[152:155], a[136:139], a[176:179], 0
v_fma_f32 v112, -v115, v115, v112
v_fma_f32 v113, v115, v114, v113
v_mfma_f32_16x16x32_bf16 v[152:155], a[140:143], a[180:183], v[152:155]
s_add_u32 m0, s1, 40960
ds_read_b128 a[216:219], v38 offset:14336
v_mul_f32 v98, v112, v112
v_mfma_f32_16x16x32_bf16 v[156:159], a[136:139], a[184:187], 0
buffer_load_dwordx4 v48, s[44:47], s90 offen offset:0 lds
v_mfma_f32_16x16x32_bf16 v[156:159], a[140:143], a[188:191], v[156:159]
ds_read_b128 a[220:223], v39 offset:14336
v_mul_f32 v99, v112, v113
v_mfma_f32_16x16x32_bf16 v[160:163], a[144:147], a[160:163], 0
buffer_load_dwordx4 v49, s[44:47], s90 offen offset:1024 lds
v_mfma_f32_16x16x32_bf16 v[160:163], a[148:151], a[164:167], v[160:163]
s_add_u32 s89, s89, 128
s_add_u32 s90, s90, 128
ds_read_b64_tr_b16 a[224:225], v40 offset:0
v_fma_f32 v98, -v113, v113, v98
v_mfma_f32_16x16x32_bf16 v[164:167], a[144:147], a[168:171], 0
v_fma_f32 v99, v113, v112, v99
v_mul_f32 v116, v98, v98
v_mfma_f32_16x16x32_bf16 v[164:167], a[148:151], a[172:175], v[164:167]
s_add_u32 m0, s87, 131072
ds_read_b64_tr_b16 a[226:227], v40 offset:1024
v_mul_f32 v117, v98, v99
v_mfma_f32_16x16x32_bf16 v[168:171], a[144:147], a[176:179], 0
buffer_load_dwordx4 v44, s[40:43], s89 offen offset:0 lds
v_mfma_f32_16x16x32_bf16 v[168:171], a[148:151], a[180:183], v[168:171]
ds_read_b64_tr_b16 a[228:229], v40 offset:8192
v_fma_f32 v116, -v99, v99, v116
v_mfma_f32_16x16x32_bf16 v[172:175], a[144:147], a[184:187], 0
buffer_load_dwordx4 v45, s[40:43], s89 offen offset:1024 lds
v_mfma_f32_16x16x32_bf16 v[172:175], a[148:151], a[188:191], v[172:175]
ds_read_b64_tr_b16 a[230:231], v40 offset:9216
v_fma_f32 v117, v99, v98, v117
v_mfma_f32_16x16x32_bf16 v[176:179], a[152:155], a[160:163], 0
v_mul_f32 v118, v116, v116
v_mul_f32 v119, v116, v117
v_mfma_f32_16x16x32_bf16 v[176:179], a[156:159], a[164:167], v[176:179]
ds_read_b64_tr_b16 a[232:233], v41 offset:0
v_fma_f32 v118, -v117, v117, v118
v_mfma_f32_16x16x32_bf16 v[180:183], a[152:155], a[168:171], 0
buffer_load_dwordx4 v46, s[40:43], s89 offen offset:2048 lds
v_mfma_f32_16x16x32_bf16 v[180:183], a[156:159], a[172:175], v[180:183]
ds_read_b64_tr_b16 a[234:235], v41 offset:1024
v_fma_f32 v119, v117, v116, v119
v_mfma_f32_16x16x32_bf16 v[184:187], a[152:155], a[176:179], 0
buffer_load_dwordx4 v47, s[40:43], s89 offen offset:3072 lds
v_mfma_f32_16x16x32_bf16 v[184:187], a[156:159], a[180:183], v[184:187]
ds_read_b64_tr_b16 a[236:237], v41 offset:8192
v_mul_f32 v100, v118, v118
v_mfma_f32_16x16x32_bf16 v[188:191], a[152:155], a[184:187], 0
s_waitcnt lgkmcnt(2)
v_mul_f32 v101, v118, v119
v_fma_f32 v100, -v119, v119, v100
v_mfma_f32_16x16x32_bf16 v[188:191], a[156:159], a[188:191], v[188:191]
s_add_u32 m0, s1, 147456
ds_read_b64_tr_b16 a[238:239], v41 offset:9216
v_fma_f32 v101, v119, v118, v101
v_mfma_f32_16x16x32_bf16 v[192:195], a[192:195], a[160:163], 0
buffer_load_dwordx4 v48, s[44:47], s90 offen offset:0 lds
v_mfma_f32_16x16x32_bf16 v[192:195], a[196:199], a[164:167], v[192:195]
ds_read_b64_tr_b16 a[240:241], v42 offset:0
v_and_b32 v8, 1, v62
v_mfma_f32_16x16x32_bf16 v[196:199], a[192:195], a[168:171], 0
buffer_load_dwordx4 v49, s[44:47], s90 offen offset:1024 lds
v_mfma_f32_16x16x32_bf16 v[196:199], a[196:199], a[172:175], v[196:199]
s_add_u32 s89, s89, 128
s_add_u32 s90, s90, 128
ds_read_b64_tr_b16 a[242:243], v42 offset:1024
v_cmp_ne_u32 vcc, 0, v8
v_mfma_f32_16x16x32_bf16 v[200:203], a[192:195], a[176:179], 0
v_mov_b32 v9, 1.0
v_mov_b32 v10, 0
v_mfma_f32_16x16x32_bf16 v[200:203], a[196:199], a[180:183], v[200:203]
s_add_u32 m0, s87, 49152
ds_read_b64_tr_b16 a[244:245], v42 offset:8192
v_cndmask_b32 v112, v9, v98, vcc
v_mfma_f32_16x16x32_bf16 v[204:207], a[192:195], a[184:187], 0
buffer_load_dwordx4 v44, s[40:43], s89 offen offset:0 lds
v_mfma_f32_16x16x32_bf16 v[204:207], a[196:199], a[188:191], v[204:207]
ds_read_b64_tr_b16 a[246:247], v42 offset:9216
v_cndmask_b32 v113, v10, v99, vcc
v_mfma_f32_16x16x32_bf16 v[208:211], a[200:203], a[160:163], 0
buffer_load_dwordx4 v45, s[40:43], s89 offen offset:1024 lds
v_mfma_f32_16x16x32_bf16 v[208:211], a[204:207], a[164:167], v[208:211]
ds_read_b64_tr_b16 a[248:249], v43 offset:0
v_and_b32 v8, 2, v62
v_mfma_f32_16x16x32_bf16 v[212:215], a[200:203], a[168:171], 0
v_cmp_ne_u32 vcc, 0, v8
v_and_b32 v8, 4, v62
v_mfma_f32_16x16x32_bf16 v[212:215], a[204:207], a[172:175], v[212:215]
ds_read_b64_tr_b16 a[250:251], v43 offset:1024
v_cndmask_b32 v116, v9, v116, vcc
v_mfma_f32_16x16x32_bf16 v[216:219], a[200:203], a[176:179], 0
buffer_load_dwordx4 v46, s[40:43], s89 offen offset:2048 lds
v_mfma_f32_16x16x32_bf16 v[216:219], a[204:207], a[180:183], v[216:219]
ds_read_b64_tr_b16 a[252:253], v43 offset:8192
v_cndmask_b32 v117, v10, v117, vcc
v_mfma_f32_16x16x32_bf16 v[220:223], a[200:203], a[184:187], 0
buffer_load_dwordx4 v47, s[40:43], s89 offen offset:3072 lds
v_mfma_f32_16x16x32_bf16 v[220:223], a[204:207], a[188:191], v[220:223]
ds_read_b64_tr_b16 a[254:255], v43 offset:9216
v_cmp_ne_u32 vcc, 0, v8
v_mfma_f32_16x16x32_bf16 v[224:227], a[208:211], a[160:163], 0
v_mul_f32 v114, v112, v116
v_mul_f32 v115, v112, v117
v_mfma_f32_16x16x32_bf16 v[224:227], a[212:215], a[164:167], v[224:227]
s_add_u32 m0, s1, 155648
v_fma_f32 v114, -v113, v117, v114
v_fma_f32 v115, v113, v116, v115
v_mfma_f32_16x16x32_bf16 v[228:231], a[208:211], a[168:171], 0
buffer_load_dwordx4 v48, s[44:47], s90 offen offset:0 lds
v_mfma_f32_16x16x32_bf16 v[228:231], a[212:215], a[172:175], v[228:231]
v_cndmask_b32 v118, v9, v118, vcc
v_cndmask_b32 v119, v10, v119, vcc
v_mfma_f32_16x16x32_bf16 v[232:235], a[208:211], a[176:179], 0
buffer_load_dwordx4 v49, s[44:47], s90 offen offset:1024 lds
v_mfma_f32_16x16x32_bf16 v[232:235], a[212:215], a[180:183], v[232:235]
s_add_u32 s89, s89, 128
s_add_u32 s90, s90, 128
v_mul_f32 v106, v114, v118
v_mul_f32 v107, v114, v119
v_mfma_f32_16x16x32_bf16 v[236:239], a[208:211], a[184:187], 0
v_fma_f32 v106, -v115, v119, v106
v_fma_f32 v107, v115, v118, v107
v_mfma_f32_16x16x32_bf16 v[236:239], a[212:215], a[188:191], v[236:239]
v_lshrrev_b32 v7, 3, v1
v_lshlrev_b32 v7, 28, v7
v_mfma_f32_16x16x32_bf16 v[240:243], a[216:219], a[160:163], 0
v_lshl_add_u32 v7, v1, 7, v7
v_lshrrev_b32 v4, 3, v1
v_mfma_f32_16x16x32_bf16 v[240:243], a[220:223], a[164:167], v[240:243]
v_mul_u32_u24 v4, 7168, v4
v_add_u32 v4, v4, v7
v_mfma_f32_16x16x32_bf16 v[244:247], a[216:219], a[168:171], 0
v_lshrrev_b32 v124, 2, v1
v_lshl_add_u32 v7, v124, 9, v7
v_mfma_f32_16x16x32_bf16 v[244:247], a[220:223], a[172:175], v[244:247]
s_lshl_b32 s82, s76, 3
s_add_u32 s82, s82, s77
s_lshr_b32 s82, s82, 0
v_mfma_f32_16x16x32_bf16 v[248:251], a[216:219], a[176:179], 0
s_lshl_b32 s82, s82, 2
s_add_u32 s82, s82, s3
s_lshl_b32 s82, s82, 11
v_mfma_f32_16x16x32_bf16 v[248:251], a[220:223], a[180:183], v[248:251]
s_lshl_b32 s88, s82, 2
s_and_b32 s88, s88, 0xfffff
s_lshr_b32 s81, s76, 2
v_mfma_f32_16x16x32_bf16 v[252:255], a[216:219], a[184:187], 0
s_waitcnt lgkmcnt(0)
s_lshl_b32 s81, s81, 10
s_add_u32 s88, s88, s81
v_mfma_f32_16x16x32_bf16 v[252:255], a[220:223], a[188:191], v[252:255]
s_barrier
v_mfma_f32_16x16x32_bf16 a[0:3], a[224:227], a[128:131], 0
s_bitcmp1_b32 s76, 1
s_cselect_b32 s64, s56, s52
s_cselect_b32 s65, s57, s53
v_mfma_f32_16x16x32_bf16 a[0:3], a[228:231], a[132:135], a[0:3]
s_add_u32 m0, s86, 65536
s_or_b32 s88, s88, 524288
v_mfma_f32_16x16x32_bf16 a[4:7], a[232:235], a[128:131], 0
buffer_load_dwordx4 v26, s[48:51], s84 offen offset:0 lds
v_mfma_f32_16x16x32_bf16 a[4:7], a[236:239], a[132:135], a[4:7]
buffer_load_dword v127, v7, s[40:43], s82 offen offset:512
v_mfma_f32_16x16x32_bf16 a[8:11], a[240:243], a[128:131], 0
s_add_u32 s88, s88, 524288
v_mfma_f32_16x16x32_bf16 a[8:11], a[244:247], a[132:135], a[8:11]
buffer_load_dword v127, v4, s[64:67], s88 offen
v_mfma_f32_16x16x32_bf16 a[12:15], a[248:251], a[128:131], 0
buffer_load_dwordx4 v27, s[48:51], s84 offen offset:1024 lds
v_mfma_f32_16x16x32_bf16 a[12:15], a[252:255], a[132:135], a[12:15]
s_add_u32 s88, s88, 524288
v_mfma_f32_16x16x32_bf16 a[16:19], a[224:227], a[136:139], 0
v_mfma_f32_16x16x32_bf16 a[16:19], a[228:231], a[140:143], a[16:19]
v_mfma_f32_16x16x32_bf16 a[20:23], a[232:235], a[136:139], 0
buffer_load_dwordx4 v28, s[48:51], s84 offen offset:2048 lds
v_mfma_f32_16x16x32_bf16 a[20:23], a[236:239], a[140:143], a[20:23]
v_mfma_f32_16x16x32_bf16 a[24:27], a[240:243], a[136:139], 0
v_mfma_f32_16x16x32_bf16 a[24:27], a[244:247], a[140:143], a[24:27]
v_mfma_f32_16x16x32_bf16 a[28:31], a[248:251], a[136:139], 0
buffer_load_dwordx4 v29, s[48:51], s84 offen offset:3072 lds
v_mfma_f32_16x16x32_bf16 a[28:31], a[252:255], a[140:143], a[28:31]
v_mfma_f32_16x16x32_bf16 a[32:35], a[224:227], a[144:147], 0
v_mfma_f32_16x16x32_bf16 a[32:35], a[228:231], a[148:151], a[32:35]
s_add_u32 m0, s86, 69632
v_mfma_f32_16x16x32_bf16 a[36:39], a[232:235], a[144:147], 0
buffer_load_dwordx4 v30, s[48:51], s84 offen offset:0 lds
v_mfma_f32_16x16x32_bf16 a[36:39], a[236:239], a[148:151], a[36:39]
v_mfma_f32_16x16x32_bf16 a[40:43], a[240:243], a[144:147], 0
v_mfma_f32_16x16x32_bf16 a[40:43], a[244:247], a[148:151], a[40:43]
v_mfma_f32_16x16x32_bf16 a[44:47], a[248:251], a[144:147], 0
buffer_load_dwordx4 v31, s[48:51], s84 offen offset:1024 lds
v_mfma_f32_16x16x32_bf16 a[44:47], a[252:255], a[148:151], a[44:47]
s_waitcnt vmcnt(20)
v_mfma_f32_16x16x32_bf16 a[48:51], a[224:227], a[152:155], 0
s_barrier
v_mfma_f32_16x16x32_bf16 a[48:51], a[228:231], a[156:159], a[48:51]
ds_read_b128 v[108:111], v54 offset:16384
v_mfma_f32_16x16x32_bf16 a[52:55], a[232:235], a[152:155], 0
buffer_load_dwordx4 v32, s[48:51], s84 offen offset:2048 lds
v_mfma_f32_16x16x32_bf16 a[52:55], a[236:239], a[156:159], a[52:55]
ds_read_b128 v[112:115], v54 offset:20480
v_mfma_f32_16x16x32_bf16 a[56:59], a[240:243], a[152:155], 0
ds_read_b128 a[176:179], v50 offset:0
v_mfma_f32_16x16x32_bf16 a[56:59], a[244:247], a[156:159], a[56:59]
ds_read_b128 a[180:183], v50 offset:2048
v_mfma_f32_16x16x32_bf16 a[60:63], a[248:251], a[152:155], 0
buffer_load_dwordx4 v33, s[48:51], s84 offen offset:3072 lds
v_mfma_f32_16x16x32_bf16 a[60:63], a[252:255], a[156:159], a[60:63]
ds_read_b128 a[184:187], v50 offset:4096
v_mfma_f32_16x16x32_bf16 a[64:67], a[224:227], a[192:195], 0
ds_read_b128 a[188:191], v50 offset:6144
v_mfma_f32_16x16x32_bf16 a[64:67], a[228:231], a[196:199], a[64:67]
s_add_u32 m0, s87, 98304
ds_read_b128 v[16:19], v55 offset:16384
v_mfma_f32_16x16x32_bf16 a[68:71], a[232:235], a[192:195], 0
buffer_load_dwordx4 v34, s[52:55], s85 offen offset:0 lds
v_mfma_f32_16x16x32_bf16 a[68:71], a[236:239], a[196:199], a[68:71]
ds_read_b128 v[20:23], v55 offset:20480
v_mfma_f32_16x16x32_bf16 a[72:75], a[240:243], a[192:195], 0
ds_read_b128 v[116:119], v51 offset:0
v_mfma_f32_16x16x32_bf16 a[72:75], a[244:247], a[196:199], a[72:75]
ds_read_b128 v[120:123], v51 offset:2048
v_mfma_f32_16x16x32_bf16 a[76:79], a[248:251], a[192:195], 0
buffer_load_dwordx4 v35, s[52:55], s85 offen offset:1024 lds
v_mfma_f32_16x16x32_bf16 a[76:79], a[252:255], a[196:199], a[76:79]
ds_read_b128 v[8:11], v51 offset:4096
v_mfma_f32_16x16x32_bf16 a[80:83], a[224:227], a[200:203], 0
ds_read_b128 v[12:15], v51 offset:6144
v_mfma_f32_16x16x32_bf16 a[80:83], a[228:231], a[204:207], a[80:83]
ds_read_b128 a[144:147], v54 offset:40960
v_mfma_f32_16x16x32_bf16 a[84:87], a[232:235], a[200:203], 0
buffer_load_dwordx4 v36, s[52:55], s85 offen offset:2048 lds
v_mfma_f32_16x16x32_bf16 a[84:87], a[236:239], a[204:207], a[84:87]
ds_read_b128 a[148:151], v54 offset:45056
v_mfma_f32_16x16x32_bf16 a[88:91], a[240:243], a[200:203], 0
ds_read_b128 a[128:131], v50 offset:24576
v_mfma_f32_16x16x32_bf16 a[88:91], a[244:247], a[204:207], a[88:91]
ds_read_b128 a[132:135], v50 offset:26624
v_mfma_f32_16x16x32_bf16 a[92:95], a[248:251], a[200:203], 0
buffer_load_dwordx4 v37, s[52:55], s85 offen offset:3072 lds
v_mfma_f32_16x16x32_bf16 a[92:95], a[252:255], a[204:207], a[92:95]
ds_read_b128 a[136:139], v50 offset:28672
v_mfma_f32_16x16x32_bf16 a[96:99], a[224:227], a[208:211], 0
ds_read_b128 a[140:143], v50 offset:30720
v_mfma_f32_16x16x32_bf16 a[96:99], a[228:231], a[212:215], a[96:99]
s_add_u32 m0, s87, 114688
ds_read_b128 a[168:171], v55 offset:40960
v_mfma_f32_16x16x32_bf16 a[100:103], a[232:235], a[208:211], 0
buffer_load_dwordx4 v34, s[56:59], s85 offen offset:0 lds
v_mfma_f32_16x16x32_bf16 a[100:103], a[236:239], a[212:215], a[100:103]
ds_read_b128 a[172:175], v55 offset:45056
v_mfma_f32_16x16x32_bf16 a[104:107], a[240:243], a[208:211], 0
ds_read_b128 a[152:155], v51 offset:24576
v_mfma_f32_16x16x32_bf16 a[104:107], a[244:247], a[212:215], a[104:107]
ds_read_b128 a[156:159], v51 offset:26624
v_mfma_f32_16x16x32_bf16 a[108:111], a[248:251], a[208:211], 0
buffer_load_dwordx4 v35, s[56:59], s85 offen offset:1024 lds
v_mfma_f32_16x16x32_bf16 a[108:111], a[252:255], a[212:215], a[108:111]
ds_read_b128 a[160:163], v51 offset:28672
v_mfma_f32_16x16x32_bf16 a[112:115], a[224:227], a[216:219], 0
buffer_load_dwordx4 v36, s[56:59], s85 offen offset:2048 lds
v_mfma_f32_16x16x32_bf16 a[112:115], a[228:231], a[220:223], a[112:115]
ds_read_b128 a[164:167], v51 offset:30720
v_mfma_f32_16x16x32_bf16 a[116:119], a[232:235], a[216:219], 0
buffer_load_dwordx4 v37, s[56:59], s85 offen offset:3072 lds
v_mfma_f32_16x16x32_bf16 a[116:119], a[236:239], a[220:223], a[116:119]
s_add_u32 s84, s84, 128
v_mfma_f32_16x16x32_bf16 a[120:123], a[240:243], a[216:219], 0
s_add_u32 s85, s85, 524288
v_mfma_f32_16x16x32_bf16 a[120:123], a[244:247], a[220:223], a[120:123]
v_mfma_f32_16x16x32_bf16 a[124:127], a[248:251], a[216:219], 0
s_waitcnt vmcnt(18) lgkmcnt(0)
v_mfma_f32_16x16x32_bf16 a[124:127], a[252:255], a[220:223], a[124:127]
s_barrier
v_mfma_f32_16x16x32_bf16 v[64:67], a[176:179], v[108:111], 0
ds_read_b128 a[208:211], v56 offset:16384
v_mfma_f32_16x16x32_bf16 v[64:67], v[116:119], v[16:19], v[64:67]
ds_read_b128 a[212:215], v56 offset:20480
v_mfma_f32_16x16x32_bf16 v[68:71], a[176:179], v[112:115], 0
ds_read_b128 a[192:195], v52 offset:0
v_mfma_f32_16x16x32_bf16 v[68:71], v[116:119], v[20:23], v[68:71]
ds_read_b128 a[196:199], v52 offset:2048
v_mfma_f32_16x16x32_bf16 v[72:75], a[180:183], v[108:111], 0
ds_read_b128 a[200:203], v52 offset:4096
v_mfma_f32_16x16x32_bf16 v[72:75], v[120:123], v[16:19], v[72:75]
ds_read_b128 a[204:207], v52 offset:6144
v_mfma_f32_16x16x32_bf16 v[76:79], a[180:183], v[112:115], 0
ds_read_b128 a[232:235], v57 offset:16384
v_mfma_f32_16x16x32_bf16 v[76:79], v[120:123], v[20:23], v[76:79]
ds_read_b128 a[236:239], v57 offset:20480
v_mfma_f32_16x16x32_bf16 v[80:83], a[184:187], v[108:111], 0
ds_read_b128 a[216:219], v53 offset:0
v_mfma_f32_16x16x32_bf16 v[80:83], v[8:11], v[16:19], v[80:83]
ds_read_b128 a[220:223], v53 offset:2048
v_mfma_f32_16x16x32_bf16 v[84:87], a[184:187], v[112:115], 0
ds_read_b128 a[224:227], v53 offset:4096
v_mfma_f32_16x16x32_bf16 v[84:87], v[8:11], v[20:23], v[84:87]
s_add_u32 m0, s87, 0
ds_read_b128 a[228:231], v53 offset:6144
v_mfma_f32_16x16x32_bf16 v[88:91], a[188:191], v[108:111], 0
buffer_load_dwordx4 v44, s[40:43], s89 offen offset:0 lds
v_mfma_f32_16x16x32_bf16 v[88:91], v[12:15], v[16:19], v[88:91]
s_cmp_lg_u32 s93, 3
s_cbranch_scc1 L_noini
v_mov_b32 v124, 0
v_mov_b32 v125, 1
s_mov_b64 exec, 1
global_store_dword v124, v125, s[36:37] sc1
s_mov_b64 exec, -1
L_noini:
v_mfma_f32_16x16x32_bf16 v[92:95], a[188:191], v[112:115], 0
s_mov_b32 s72, s26
s_and_b32 s73, s27, 0xffff
s_mov_b32 s74, 0x400000
v_mfma_f32_16x16x32_bf16 v[92:95], v[12:15], v[20:23], v[92:95]
s_mov_b32 s75, 0x20000
ds_read_b128 v[108:111], v56 offset:24576
v_mfma_f32_16x16x32_bf16 v[64:67], a[128:131], a[144:147], v[64:67]
ds_read_b128 v[112:115], v56 offset:28672
v_mfma_f32_16x16x32_bf16 v[64:67], a[152:155], a[168:171], v[64:67]
ds_read_b128 a[240:243], v50 offset:49152
v_mfma_f32_16x16x32_bf16 v[68:71], a[128:131], a[148:151], v[68:71]
ds_read_b128 a[244:247], v50 offset:51200
v_mfma_f32_16x16x32_bf16 v[68:71], a[152:155], a[172:175], v[68:71]
buffer_load_dwordx4 v45, s[40:43], s89 offen offset:1024 lds
v_mfma_f32_16x16x32_bf16 v[72:75], a[132:135], a[144:147], v[72:75]
ds_read_b128 a[248:251], v50 offset:53248
v_mfma_f32_16x16x32_bf16 v[72:75], a[156:159], a[168:171], v[72:75]
ds_read_b128 a[252:255], v50 offset:55296
v_mfma_f32_16x16x32_bf16 v[76:79], a[132:135], a[148:151], v[76:79]
ds_read_b128 v[16:19], v57 offset:24576
v_mfma_f32_16x16x32_bf16 v[76:79], a[156:159], a[172:175], v[76:79]
ds_read_b128 v[20:23], v57 offset:28672
v_mfma_f32_16x16x32_bf16 v[80:83], a[136:139], a[144:147], v[80:83]
ds_read_b128 v[116:119], v51 offset:49152
v_mfma_f32_16x16x32_bf16 v[80:83], a[160:163], a[168:171], v[80:83]
ds_read_b128 v[120:123], v51 offset:51200
v_mfma_f32_16x16x32_bf16 v[84:87], a[136:139], a[148:151], v[84:87]
ds_read_b128 v[8:11], v51 offset:53248
v_mfma_f32_16x16x32_bf16 v[84:87], a[160:163], a[172:175], v[84:87]
buffer_load_dwordx4 v46, s[40:43], s89 offen offset:2048 lds
v_mfma_f32_16x16x32_bf16 v[88:91], a[140:143], a[144:147], v[88:91]
ds_read_b128 v[12:15], v51 offset:55296
v_mfma_f32_16x16x32_bf16 v[88:91], a[164:167], a[168:171], v[88:91]
v_mfma_f32_16x16x32_bf16 v[92:95], a[140:143], a[148:151], v[92:95]
s_waitcnt vmcnt(3) lgkmcnt(0)
v_mfma_f32_16x16x32_bf16 v[92:95], a[164:167], a[172:175], v[92:95]
s_barrier
v_mfma_f32_16x16x32_bf16 v[64:67], a[192:195], a[208:211], v[64:67]
ds_read_b128 a[128:131], v38 offset:0
v_mfma_f32_16x16x32_bf16 v[64:67], a[216:219], a[232:235], v[64:67]
ds_read_b128 a[132:135], v39 offset:0
v_mfma_f32_16x16x32_bf16 v[68:71], a[192:195], a[212:215], v[68:71]
ds_read_b64_tr_b16 a[160:161], v40 offset:16384
v_mfma_f32_16x16x32_bf16 v[68:71], a[216:219], a[236:239], v[68:71]
ds_read_b64_tr_b16 a[162:163], v40 offset:17408
v_mfma_f32_16x16x32_bf16 v[72:75], a[196:199], a[208:211], v[72:75]
ds_read_b64_tr_b16 a[164:165], v40 offset:24576
v_mfma_f32_16x16x32_bf16 v[72:75], a[220:223], a[232:235], v[72:75]
ds_read_b64_tr_b16 a[166:167], v40 offset:25600
v_mfma_f32_16x16x32_bf16 v[76:79], a[196:199], a[212:215], v[76:79]
ds_read_b64_tr_b16 a[168:169], v41 offset:16384
v_mfma_f32_16x16x32_bf16 v[76:79], a[220:223], a[236:239], v[76:79]
ds_read_b64_tr_b16 a[170:171], v41 offset:17408
v_mfma_f32_16x16x32_bf16 v[80:83], a[200:203], a[208:211], v[80:83]
buffer_load_dwordx4 v47, s[40:43], s89 offen offset:3072 lds
v_mfma_f32_16x16x32_bf16 v[80:83], a[224:227], a[232:235], v[80:83]
ds_read_b64_tr_b16 a[172:173], v41 offset:24576
v_mfma_f32_16x16x32_bf16 v[84:87], a[200:203], a[212:215], v[84:87]
ds_read_b64_tr_b16 a[174:175], v41 offset:25600
v_mfma_f32_16x16x32_bf16 v[84:87], a[224:227], a[236:239], v[84:87]
ds_read_b64_tr_b16 a[176:177], v42 offset:16384
v_mfma_f32_16x16x32_bf16 v[88:91], a[204:207], a[208:211], v[88:91]
ds_read_b64_tr_b16 a[178:179], v42 offset:17408
v_mfma_f32_16x16x32_bf16 v[88:91], a[228:231], a[232:235], v[88:91]
ds_read_b64_tr_b16 a[180:181], v42 offset:24576
v_mfma_f32_16x16x32_bf16 v[92:95], a[204:207], a[212:215], v[92:95]
ds_read_b64_tr_b16 a[182:183], v42 offset:25600
v_mfma_f32_16x16x32_bf16 v[92:95], a[228:231], a[236:239], v[92:95]
ds_read_b64_tr_b16 a[184:185], v43 offset:16384
v_mfma_f32_16x16x32_bf16 v[64:67], a[240:243], v[108:111], v[64:67]
s_add_u32 m0, s1, 16384
ds_read_b64_tr_b16 a[186:187], v43 offset:17408
v_mfma_f32_16x16x32_bf16 v[64:67], v[116:119], v[16:19], v[64:67]
buffer_load_dwordx4 v48, s[44:47], s90 offen offset:0 lds
v_mfma_f32_16x16x32_bf16 v[68:71], a[240:243], v[112:115], v[68:71]
ds_read_b64_tr_b16 a[188:189], v43 offset:24576
v_mfma_f32_16x16x32_bf16 v[68:71], v[116:119], v[20:23], v[68:71]
ds_read_b64_tr_b16 a[190:191], v43 offset:25600
v_mfma_f32_16x16x32_bf16 v[72:75], a[244:247], v[108:111], v[72:75]
ds_read_b128 a[136:139], v38 offset:2048
v_mfma_f32_16x16x32_bf16 v[72:75], v[120:123], v[16:19], v[72:75]
ds_read_b128 a[140:143], v39 offset:2048
v_mfma_f32_16x16x32_bf16 v[76:79], a[244:247], v[112:115], v[76:79]
ds_read_b128 a[144:147], v38 offset:4096
v_mfma_f32_16x16x32_bf16 v[76:79], v[120:123], v[20:23], v[76:79]
ds_read_b128 a[148:151], v39 offset:4096
v_mfma_f32_16x16x32_bf16 v[80:83], a[248:251], v[108:111], v[80:83]
ds_read_b128 a[152:155], v38 offset:6144
v_mfma_f32_16x16x32_bf16 v[80:83], v[8:11], v[16:19], v[80:83]
ds_read_b128 a[156:159], v39 offset:6144
v_mfma_f32_16x16x32_bf16 v[84:87], a[248:251], v[112:115], v[84:87]
v_mfma_f32_16x16x32_bf16 v[84:87], v[8:11], v[20:23], v[84:87]
buffer_load_dwordx4 v49, s[44:47], s90 offen offset:1024 lds
v_mfma_f32_16x16x32_bf16 v[88:91], a[252:255], v[108:111], v[88:91]
s_add_u32 s89, s89, 128
s_add_u32 s90, s90, 128
v_mfma_f32_16x16x32_bf16 v[88:91], v[12:15], v[16:19], v[88:91]
s_add_u32 m0, s87, 24576
v_mfma_f32_16x16x32_bf16 v[92:95], a[252:255], v[112:115], v[92:95]
buffer_load_dwordx4 v44, s[40:43], s89 offen offset:0 lds
v_mfma_f32_16x16x32_bf16 v[92:95], v[12:15], v[20:23], v[92:95]
s_waitcnt lgkmcnt(0)
v_mfma_f32_16x16x32_bf16 v[128:131], a[128:131], a[160:163], v[128:131]
buffer_load_dwordx4 v45, s[40:43], s89 offen offset:1024 lds
v_mfma_f32_16x16x32_bf16 v[128:131], a[132:135], a[164:167], v[128:131]
ds_read_b128 a[192:195], v38 offset:8192
v_mfma_f32_16x16x32_bf16 v[132:135], a[128:131], a[168:171], v[132:135]
buffer_load_dwordx4 v46, s[40:43], s89 offen offset:2048 lds
v_mfma_f32_16x16x32_bf16 v[132:135], a[132:135], a[172:175], v[132:135]
ds_read_b128 a[196:199], v39 offset:8192
v_mfma_f32_16x16x32_bf16 v[136:139], a[128:131], a[176:179], v[136:139]
buffer_load_dwordx4 v47, s[40:43], s89 offen offset:3072 lds
v_mfma_f32_16x16x32_bf16 v[136:139], a[132:135], a[180:183], v[136:139]
s_add_u32 m0, s1, 40960
ds_read_b128 a[200:203], v38 offset:10240
v_mfma_f32_16x16x32_bf16 v[140:143], a[128:131], a[184:187], v[140:143]
buffer_load_dwordx4 v48, s[44:47], s90 offen offset:0 lds
v_mfma_f32_16x16x32_bf16 v[140:143], a[132:135], a[188:191], v[140:143]
ds_read_b128 a[204:207], v39 offset:10240
v_mfma_f32_16x16x32_bf16 v[144:147], a[136:139], a[160:163], v[144:147]
buffer_load_dwordx4 v49, s[44:47], s90 offen offset:1024 lds
v_mfma_f32_16x16x32_bf16 v[144:147], a[140:143], a[164:167], v[144:147]
s_add_u32 s89, s89, 128
s_add_u32 s90, s90, 128
ds_read_b128 a[208:211], v38 offset:12288
v_mfma_f32_16x16x32_bf16 v[148:151], a[136:139], a[168:171], v[148:151]
v_mfma_f32_16x16x32_bf16 v[148:151], a[140:143], a[172:175], v[148:151]
s_add_u32 m0, s87, 131072
ds_read_b128 a[212:215], v39 offset:12288
v_mfma_f32_16x16x32_bf16 v[152:155], a[136:139], a[176:179], v[152:155]
buffer_load_dwordx4 v44, s[40:43], s89 offen offset:0 lds
v_mfma_f32_16x16x32_bf16 v[152:155], a[140:143], a[180:183], v[152:155]
ds_read_b128 a[216:219], v38 offset:14336
v_mfma_f32_16x16x32_bf16 v[156:159], a[136:139], a[184:187], v[156:159]
buffer_load_dwordx4 v45, s[40:43], s89 offen offset:1024 lds
v_mfma_f32_16x16x32_bf16 v[156:159], a[140:143], a[188:191], v[156:159]
ds_read_b128 a[220:223], v39 offset:14336
v_mfma_f32_16x16x32_bf16 v[160:163], a[144:147], a[160:163], v[160:163]
buffer_load_dwordx4 v46, s[40:43], s89 offen offset:2048 lds
v_mfma_f32_16x16x32_bf16 v[160:163], a[148:151], a[164:167], v[160:163]
ds_read_b64_tr_b16 a[224:225], v40 offset:0
v_mfma_f32_16x16x32_bf16 v[164:167], a[144:147], a[168:171], v[164:167]
buffer_load_dwordx4 v47, s[40:43], s89 offen offset:3072 lds
v_mfma_f32_16x16x32_bf16 v[164:167], a[148:151], a[172:175], v[164:167]
s_add_u32 m0, s1, 147456
ds_read_b64_tr_b16 a[226:227], v40 offset:1024
v_mfma_f32_16x16x32_bf16 v[168:171], a[144:147], a[176:179], v[168:171]
buffer_load_dwordx4 v48, s[44:47], s90 offen offset:0 lds
v_mfma_f32_16x16x32_bf16 v[168:171], a[148:151], a[180:183], v[168:171]
ds_read_b64_tr_b16 a[228:229], v40 offset:8192
v_mfma_f32_16x16x32_bf16 v[172:175], a[144:147], a[184:187], v[172:175]
buffer_load_dwordx4 v49, s[44:47], s90 offen offset:1024 lds
v_mfma_f32_16x16x32_bf16 v[172:175], a[148:151], a[188:191], v[172:175]
s_add_u32 s89, s89, 128
s_add_u32 s90, s90, 128
ds_read_b64_tr_b16 a[230:231], v40 offset:9216
v_mfma_f32_16x16x32_bf16 v[176:179], a[152:155], a[160:163], v[176:179]
v_mfma_f32_16x16x32_bf16 v[176:179], a[156:159], a[164:167], v[176:179]
s_add_u32 m0, s87, 49152
ds_read_b64_tr_b16 a[232:233], v41 offset:0
v_mfma_f32_16x16x32_bf16 v[180:183], a[152:155], a[168:171], v[180:183]
buffer_load_dwordx4 v44, s[40:43], s89 offen offset:0 lds
v_mfma_f32_16x16x32_bf16 v[180:183], a[156:159], a[172:175], v[180:183]
ds_read_b64_tr_b16 a[234:235], v41 offset:1024
v_mfma_f32_16x16x32_bf16 v[184:187], a[152:155], a[176:179], v[184:187]
buffer_load_dwordx4 v45, s[40:43], s89 offen offset:1024 lds
v_mfma_f32_16x16x32_bf16 v[184:187], a[156:159], a[180:183], v[184:187]
ds_read_b64_tr_b16 a[236:237], v41 offset:8192
v_mfma_f32_16x16x32_bf16 v[188:191], a[152:155], a[184:187], v[188:191]
buffer_load_dwordx4 v46, s[40:43], s89 offen offset:2048 lds
v_mfma_f32_16x16x32_bf16 v[188:191], a[156:159], a[188:191], v[188:191]
s_waitcnt lgkmcnt(1)
ds_read_b64_tr_b16 a[238:239], v41 offset:9216
v_mfma_f32_16x16x32_bf16 v[192:195], a[192:195], a[160:163], v[192:195]
buffer_load_dwordx4 v47, s[40:43], s89 offen offset:3072 lds
v_mfma_f32_16x16x32_bf16 v[192:195], a[196:199], a[164:167], v[192:195]
s_add_u32 m0, s1, 155648
ds_read_b64_tr_b16 a[240:241], v42 offset:0
v_mfma_f32_16x16x32_bf16 v[196:199], a[192:195], a[168:171], v[196:199]
buffer_load_dwordx4 v48, s[44:47], s90 offen offset:0 lds
v_mfma_f32_16x16x32_bf16 v[196:199], a[196:199], a[172:175], v[196:199]
ds_read_b64_tr_b16 a[242:243], v42 offset:1024
v_mfma_f32_16x16x32_bf16 v[200:203], a[192:195], a[176:179], v[200:203]
buffer_load_dwordx4 v49, s[44:47], s90 offen offset:1024 lds
v_mfma_f32_16x16x32_bf16 v[200:203], a[196:199], a[180:183], v[200:203]
s_add_u32 s89, s89, 128
s_add_u32 s90, s90, 128
ds_read_b64_tr_b16 a[244:245], v42 offset:8192
v_mfma_f32_16x16x32_bf16 v[204:207], a[192:195], a[184:187], v[204:207]
v_mfma_f32_16x16x32_bf16 v[204:207], a[196:199], a[188:191], v[204:207]
ds_read_b64_tr_b16 a[246:247], v42 offset:9216
v_mfma_f32_16x16x32_bf16 v[208:211], a[200:203], a[160:163], v[208:211]
buffer_load_dword v127, v4, s[64:67], s88 offen
v_mfma_f32_16x16x32_bf16 v[208:211], a[204:207], a[164:167], v[208:211]
ds_read_b64_tr_b16 a[248:249], v43 offset:0
v_mfma_f32_16x16x32_bf16 v[212:215], a[200:203], a[168:171], v[212:215]
buffer_load_dword v127, v7, s[48:51], s82 offen offset:512
v_mfma_f32_16x16x32_bf16 v[212:215], a[204:207], a[172:175], v[212:215]
s_add_u32 s88, s88, 524288
ds_read_b64_tr_b16 a[250:251], v43 offset:1024
v_mfma_f32_16x16x32_bf16 v[216:219], a[200:203], a[176:179], v[216:219]
buffer_load_dword v127, v4, s[64:67], s88 offen
v_mfma_f32_16x16x32_bf16 v[216:219], a[204:207], a[180:183], v[216:219]
s_add_u32 s88, s88, 524288
ds_read_b64_tr_b16 a[252:253], v43 offset:8192
v_mfma_f32_16x16x32_bf16 v[220:223], a[200:203], a[184:187], v[220:223]
v_mfma_f32_16x16x32_bf16 v[220:223], a[204:207], a[188:191], v[220:223]
ds_read_b64_tr_b16 a[254:255], v43 offset:9216
v_mfma_f32_16x16x32_bf16 v[224:227], a[208:211], a[160:163], v[224:227]
v_mfma_f32_16x16x32_bf16 v[224:227], a[212:215], a[164:167], v[224:227]
v_mfma_f32_16x16x32_bf16 v[228:231], a[208:211], a[168:171], v[228:231]
v_mfma_f32_16x16x32_bf16 v[228:231], a[212:215], a[172:175], v[228:231]
v_mfma_f32_16x16x32_bf16 v[232:235], a[208:211], a[176:179], v[232:235]
v_mfma_f32_16x16x32_bf16 v[232:235], a[212:215], a[180:183], v[232:235]
v_mfma_f32_16x16x32_bf16 v[236:239], a[208:211], a[184:187], v[236:239]
v_mfma_f32_16x16x32_bf16 v[236:239], a[212:215], a[188:191], v[236:239]
v_mfma_f32_16x16x32_bf16 v[240:243], a[216:219], a[160:163], v[240:243]
v_mfma_f32_16x16x32_bf16 v[240:243], a[220:223], a[164:167], v[240:243]
v_mfma_f32_16x16x32_bf16 v[244:247], a[216:219], a[168:171], v[244:247]
v_mfma_f32_16x16x32_bf16 v[244:247], a[220:223], a[172:175], v[244:247]
v_mfma_f32_16x16x32_bf16 v[248:251], a[216:219], a[176:179], v[248:251]
v_mfma_f32_16x16x32_bf16 v[248:251], a[220:223], a[180:183], v[248:251]
v_mfma_f32_16x16x32_bf16 v[252:255], a[216:219], a[184:187], v[252:255]
s_waitcnt vmcnt(15) lgkmcnt(0)
v_mfma_f32_16x16x32_bf16 v[252:255], a[220:223], a[188:191], v[252:255]
s_barrier
v_mfma_f32_16x16x32_bf16 a[0:3], a[224:227], a[128:131], a[0:3]
v_mfma_f32_16x16x32_bf16 a[0:3], a[228:231], a[132:135], a[0:3]
s_add_u32 m0, s86, 65536
ds_read_b128 v[108:111], v54 offset:16384
v_mfma_f32_16x16x32_bf16 a[4:7], a[232:235], a[128:131], a[4:7]
buffer_load_dwordx4 v26, s[48:51], s84 offen offset:0 lds
v_mfma_f32_16x16x32_bf16 a[4:7], a[236:239], a[132:135], a[4:7]
ds_read_b128 v[112:115], v54 offset:20480
v_mfma_f32_16x16x32_bf16 a[8:11], a[240:243], a[128:131], a[8:11]
v_mfma_f32_16x16x32_bf16 a[8:11], a[244:247], a[132:135], a[8:11]
ds_read_b128 a[176:179], v50 offset:0
v_mfma_f32_16x16x32_bf16 a[12:15], a[248:251], a[128:131], a[12:15]
buffer_load_dwordx4 v27, s[48:51], s84 offen offset:1024 lds
v_mfma_f32_16x16x32_bf16 a[12:15], a[252:255], a[132:135], a[12:15]
ds_read_b128 a[180:183], v50 offset:2048
v_mfma_f32_16x16x32_bf16 a[16:19], a[224:227], a[136:139], a[16:19]
v_mfma_f32_16x16x32_bf16 a[16:19], a[228:231], a[140:143], a[16:19]
ds_read_b128 a[184:187], v50 offset:4096
v_mfma_f32_16x16x32_bf16 a[20:23], a[232:235], a[136:139], a[20:23]
buffer_load_dwordx4 v28, s[48:51], s84 offen offset:2048 lds
v_mfma_f32_16x16x32_bf16 a[20:23], a[236:239], a[140:143], a[20:23]
ds_read_b128 a[188:191], v50 offset:6144
v_mfma_f32_16x16x32_bf16 a[24:27], a[240:243], a[136:139], a[24:27]
v_mfma_f32_16x16x32_bf16 a[24:27], a[244:247], a[140:143], a[24:27]
ds_read_b128 v[16:19], v55 offset:16384
v_mfma_f32_16x16x32_bf16 a[28:31], a[248:251], a[136:139], a[28:31]
buffer_load_dwordx4 v29, s[48:51], s84 offen offset:3072 lds
v_mfma_f32_16x16x32_bf16 a[28:31], a[252:255], a[140:143], a[28:31]
ds_read_b128 v[20:23], v55 offset:20480
v_mfma_f32_16x16x32_bf16 a[32:35], a[224:227], a[144:147], a[32:35]
v_mfma_f32_16x16x32_bf16 a[32:35], a[228:231], a[148:151], a[32:35]
s_add_u32 m0, s86, 69632
ds_read_b128 v[116:119], v51 offset:0
v_mfma_f32_16x16x32_bf16 a[36:39], a[232:235], a[144:147], a[36:39]
buffer_load_dwordx4 v30, s[48:51], s84 offen offset:0 lds
v_mfma_f32_16x16x32_bf16 a[36:39], a[236:239], a[148:151], a[36:39]
ds_read_b128 v[120:123], v51 offset:2048
v_mfma_f32_16x16x32_bf16 a[40:43], a[240:243], a[144:147], a[40:43]
v_mfma_f32_16x16x32_bf16 a[40:43], a[244:247], a[148:151], a[40:43]
ds_read_b128 v[8:11], v51 offset:4096
v_mfma_f32_16x16x32_bf16 a[44:47], a[248:251], a[144:147], a[44:47]
buffer_load_dwordx4 v31, s[48:51], s84 offen offset:1024 lds
v_mfma_f32_16x16x32_bf16 a[44:47], a[252:255], a[148:151], a[44:47]
ds_read_b128 v[12:15], v51 offset:6144
v_mfma_f32_16x16x32_bf16 a[48:51], a[224:227], a[152:155], a[48:51]
v_mfma_f32_16x16x32_bf16 a[48:51], a[228:231], a[156:159], a[48:51]
ds_read_b128 a[144:147], v54 offset:40960
v_mfma_f32_16x16x32_bf16 a[52:55], a[232:235], a[152:155], a[52:55]
buffer_load_dwordx4 v32, s[48:51], s84 offen offset:2048 lds
v_mfma_f32_16x16x32_bf16 a[52:55], a[236:239], a[156:159], a[52:55]
ds_read_b128 a[148:151], v54 offset:45056
v_mfma_f32_16x16x32_bf16 a[56:59], a[240:243], a[152:155], a[56:59]
v_mfma_f32_16x16x32_bf16 a[56:59], a[244:247], a[156:159], a[56:59]
ds_read_b128 a[128:131], v50 offset:24576
v_mfma_f32_16x16x32_bf16 a[60:63], a[248:251], a[152:155], a[60:63]
buffer_load_dwordx4 v33, s[48:51], s84 offen offset:3072 lds
v_mfma_f32_16x16x32_bf16 a[60:63], a[252:255], a[156:159], a[60:63]
ds_read_b128 a[132:135], v50 offset:26624
v_mfma_f32_16x16x32_bf16 a[64:67], a[224:227], a[192:195], a[64:67]
v_mfma_f32_16x16x32_bf16 a[64:67], a[228:231], a[196:199], a[64:67]
s_add_u32 m0, s87, 98304
ds_read_b128 a[136:139], v50 offset:28672
v_mfma_f32_16x16x32_bf16 a[68:71], a[232:235], a[192:195], a[68:71]
buffer_load_dwordx4 v34, s[52:55], s85 offen offset:0 lds
v_mfma_f32_16x16x32_bf16 a[68:71], a[236:239], a[196:199], a[68:71]
ds_read_b128 a[140:143], v50 offset:30720
v_mfma_f32_16x16x32_bf16 a[72:75], a[240:243], a[192:195], a[72:75]
v_mfma_f32_16x16x32_bf16 a[72:75], a[244:247], a[196:199], a[72:75]
ds_read_b128 a[168:171], v55 offset:40960
v_mfma_f32_16x16x32_bf16 a[76:79], a[248:251], a[192:195], a[76:79]
buffer_load_dwordx4 v35, s[52:55], s85 offen offset:1024 lds
v_mfma_f32_16x16x32_bf16 a[76:79], a[252:255], a[196:199], a[76:79]
ds_read_b128 a[172:175], v55 offset:45056
v_mfma_f32_16x16x32_bf16 a[80:83], a[224:227], a[200:203], a[80:83]
v_mfma_f32_16x16x32_bf16 a[80:83], a[228:231], a[204:207], a[80:83]
ds_read_b128 a[152:155], v51 offset:24576
v_mfma_f32_16x16x32_bf16 a[84:87], a[232:235], a[200:203], a[84:87]
buffer_load_dwordx4 v36, s[52:55], s85 offen offset:2048 lds
v_mfma_f32_16x16x32_bf16 a[84:87], a[236:239], a[204:207], a[84:87]
ds_read_b128 a[156:159], v51 offset:26624
v_mfma_f32_16x16x32_bf16 a[88:91], a[240:243], a[200:203], a[88:91]
v_mfma_f32_16x16x32_bf16 a[88:91], a[244:247], a[204:207], a[88:91]
ds_read_b128 a[160:163], v51 offset:28672
v_mfma_f32_16x16x32_bf16 a[92:95], a[248:251], a[200:203], a[92:95]
buffer_load_dwordx4 v37, s[52:55], s85 offen offset:3072 lds
v_mfma_f32_16x16x32_bf16 a[92:95], a[252:255], a[204:207], a[92:95]
ds_read_b128 a[164:167], v51 offset:30720
v_mfma_f32_16x16x32_bf16 a[96:99], a[224:227], a[208:211], a[96:99]
v_mfma_f32_16x16x32_bf16 a[96:99], a[228:231], a[212:215], a[96:99]
s_add_u32 m0, s87, 114688
v_mfma_f32_16x16x32_bf16 a[100:103], a[232:235], a[208:211], a[100:103]
buffer_load_dwordx4 v34, s[56:59], s85 offen offset:0 lds
v_mfma_f32_16x16x32_bf16 a[100:103], a[236:239], a[212:215], a[100:103]
v_mfma_f32_16x16x32_bf16 a[104:107], a[240:243], a[208:211], a[104:107]
v_mfma_f32_16x16x32_bf16 a[104:107], a[244:247], a[212:215], a[104:107]
v_mfma_f32_16x16x32_bf16 a[108:111], a[248:251], a[208:211], a[108:111]
buffer_load_dwordx4 v35, s[56:59], s85 offen offset:1024 lds
v_mfma_f32_16x16x32_bf16 a[108:111], a[252:255], a[212:215], a[108:111]
v_mfma_f32_16x16x32_bf16 a[112:115], a[224:227], a[216:219], a[112:115]
buffer_load_dwordx4 v36, s[56:59], s85 offen offset:2048 lds
v_mfma_f32_16x16x32_bf16 a[112:115], a[228:231], a[220:223], a[112:115]
v_mfma_f32_16x16x32_bf16 a[116:119], a[232:235], a[216:219], a[116:119]
buffer_load_dwordx4 v37, s[56:59], s85 offen offset:3072 lds
v_mfma_f32_16x16x32_bf16 a[116:119], a[236:239], a[220:223], a[116:119]
s_add_u32 s84, s84, 128
v_mfma_f32_16x16x32_bf16 a[120:123], a[240:243], a[216:219], a[120:123]
s_add_u32 s85, s85, 524288
v_mfma_f32_16x16x32_bf16 a[120:123], a[244:247], a[220:223], a[120:123]
v_mfma_f32_16x16x32_bf16 a[124:127], a[248:251], a[216:219], a[124:127]
s_waitcnt vmcnt(19) lgkmcnt(0)
v_mfma_f32_16x16x32_bf16 a[124:127], a[252:255], a[220:223], a[124:127]
s_barrier
v_mfma_f32_16x16x32_bf16 v[64:67], a[176:179], v[108:111], v[64:67]
ds_read_b128 a[208:211], v56 offset:16384
v_mfma_f32_16x16x32_bf16 v[64:67], v[116:119], v[16:19], v[64:67]
ds_read_b128 a[212:215], v56 offset:20480
v_mfma_f32_16x16x32_bf16 v[68:71], a[176:179], v[112:115], v[68:71]
ds_read_b128 a[192:195], v52 offset:0
v_mfma_f32_16x16x32_bf16 v[68:71], v[116:119], v[20:23], v[68:71]
ds_read_b128 a[196:199], v52 offset:2048
v_mfma_f32_16x16x32_bf16 v[72:75], a[180:183], v[108:111], v[72:75]
ds_read_b128 a[200:203], v52 offset:4096
v_mfma_f32_16x16x32_bf16 v[72:75], v[120:123], v[16:19], v[72:75]
ds_read_b128 a[204:207], v52 offset:6144
v_mfma_f32_16x16x32_bf16 v[76:79], a[180:183], v[112:115], v[76:79]
ds_read_b128 a[232:235], v57 offset:16384
v_mfma_f32_16x16x32_bf16 v[76:79], v[120:123], v[20:23], v[76:79]
ds_read_b128 a[236:239], v57 offset:20480
v_mfma_f32_16x16x32_bf16 v[80:83], a[184:187], v[108:111], v[80:83]
ds_read_b128 a[216:219], v53 offset:0
v_mfma_f32_16x16x32_bf16 v[80:83], v[8:11], v[16:19], v[80:83]
ds_read_b128 a[220:223], v53 offset:2048
v_mfma_f32_16x16x32_bf16 v[84:87], a[184:187], v[112:115], v[84:87]
ds_read_b128 a[224:227], v53 offset:4096
v_mfma_f32_16x16x32_bf16 v[84:87], v[8:11], v[20:23], v[84:87]
s_add_u32 m0, s86, 0
ds_read_b128 a[228:231], v53 offset:6144
v_mfma_f32_16x16x32_bf16 v[88:91], a[188:191], v[108:111], v[88:91]
buffer_load_dwordx4 v26, s[48:51], s84 offen offset:0 lds
v_mfma_f32_16x16x32_bf16 v[88:91], v[12:15], v[16:19], v[88:91]
v_mfma_f32_16x16x32_bf16 v[92:95], a[188:191], v[112:115], v[92:95]
v_mfma_f32_16x16x32_bf16 v[92:95], v[12:15], v[20:23], v[92:95]
ds_read_b128 v[108:111], v56 offset:24576
v_mfma_f32_16x16x32_bf16 v[64:67], a[128:131], a[144:147], v[64:67]
ds_read_b128 v[112:115], v56 offset:28672
v_mfma_f32_16x16x32_bf16 v[64:67], a[152:155], a[168:171], v[64:67]
ds_read_b128 a[240:243], v50 offset:49152
v_mfma_f32_16x16x32_bf16 v[68:71], a[128:131], a[148:151], v[68:71]
ds_read_b128 a[244:247], v50 offset:51200
v_mfma_f32_16x16x32_bf16 v[68:71], a[152:155], a[172:175], v[68:71]
buffer_load_dwordx4 v27, s[48:51], s84 offen offset:1024 lds
v_mfma_f32_16x16x32_bf16 v[72:75], a[132:135], a[144:147], v[72:75]
ds_read_b128 a[248:251], v50 offset:53248
v_mfma_f32_16x16x32_bf16 v[72:75], a[156:159], a[168:171], v[72:75]
ds_read_b128 a[252:255], v50 offset:55296
v_mfma_f32_16x16x32_bf16 v[76:79], a[132:135], a[148:151], v[76:79]
ds_read_b128 v[16:19], v57 offset:24576
v_mfma_f32_16x16x32_bf16 v[76:79], a[156:159], a[172:175], v[76:79]
ds_read_b128 v[20:23], v57 offset:28672
v_mfma_f32_16x16x32_bf16 v[80:83], a[136:139], a[144:147], v[80:83]
ds_read_b128 v[116:119], v51 offset:49152
v_mfma_f32_16x16x32_bf16 v[80:83], a[160:163], a[168:171], v[80:83]
ds_read_b128 v[120:123], v51 offset:51200
v_mfma_f32_16x16x32_bf16 v[84:87], a[136:139], a[148:151], v[84:87]
ds_read_b128 v[8:11], v51 offset:53248
v_mfma_f32_16x16x32_bf16 v[84:87], a[160:163], a[172:175], v[84:87]
buffer_load_dwordx4 v28, s[48:51], s84 offen offset:2048 lds
v_mfma_f32_16x16x32_bf16 v[88:91], a[140:143], a[144:147], v[88:91]
ds_read_b128 v[12:15], v51 offset:55296
v_mfma_f32_16x16x32_bf16 v[88:91], a[164:167], a[168:171], v[88:91]
v_mfma_f32_16x16x32_bf16 v[92:95], a[140:143], a[148:151], v[92:95]
s_waitcnt vmcnt(3) lgkmcnt(0)
v_mfma_f32_16x16x32_bf16 v[92:95], a[164:167], a[172:175], v[92:95]
s_barrier
v_mfma_f32_16x16x32_bf16 v[64:67], a[192:195], a[208:211], v[64:67]
ds_read_b128 a[128:131], v38 offset:0
v_mfma_f32_16x16x32_bf16 v[64:67], a[216:219], a[232:235], v[64:67]
ds_read_b128 a[132:135], v39 offset:0
v_mfma_f32_16x16x32_bf16 v[68:71], a[192:195], a[212:215], v[68:71]
ds_read_b64_tr_b16 a[160:161], v40 offset:16384
v_mfma_f32_16x16x32_bf16 v[68:71], a[216:219], a[236:239], v[68:71]
ds_read_b64_tr_b16 a[162:163], v40 offset:17408
v_mfma_f32_16x16x32_bf16 v[72:75], a[196:199], a[208:211], v[72:75]
ds_read_b64_tr_b16 a[164:165], v40 offset:24576
v_mfma_f32_16x16x32_bf16 v[72:75], a[220:223], a[232:235], v[72:75]
ds_read_b64_tr_b16 a[166:167], v40 offset:25600
v_mfma_f32_16x16x32_bf16 v[76:79], a[196:199], a[212:215], v[76:79]
ds_read_b64_tr_b16 a[168:169], v41 offset:16384
v_mfma_f32_16x16x32_bf16 v[76:79], a[220:223], a[236:239], v[76:79]
ds_read_b64_tr_b16 a[170:171], v41 offset:17408
v_mfma_f32_16x16x32_bf16 v[80:83], a[200:203], a[208:211], v[80:83]
buffer_load_dwordx4 v29, s[48:51], s84 offen offset:3072 lds
v_mfma_f32_16x16x32_bf16 v[80:83], a[224:227], a[232:235], v[80:83]
ds_read_b64_tr_b16 a[172:173], v41 offset:24576
v_mfma_f32_16x16x32_bf16 v[84:87], a[200:203], a[212:215], v[84:87]
ds_read_b64_tr_b16 a[174:175], v41 offset:25600
v_mfma_f32_16x16x32_bf16 v[84:87], a[224:227], a[236:239], v[84:87]
ds_read_b64_tr_b16 a[176:177], v42 offset:16384
v_mfma_f32_16x16x32_bf16 v[88:91], a[204:207], a[208:211], v[88:91]
ds_read_b64_tr_b16 a[178:179], v42 offset:17408
v_mfma_f32_16x16x32_bf16 v[88:91], a[228:231], a[232:235], v[88:91]
ds_read_b64_tr_b16 a[180:181], v42 offset:24576
v_mfma_f32_16x16x32_bf16 v[92:95], a[204:207], a[212:215], v[92:95]
ds_read_b64_tr_b16 a[182:183], v42 offset:25600
v_mfma_f32_16x16x32_bf16 v[92:95], a[228:231], a[236:239], v[92:95]
ds_read_b64_tr_b16 a[184:185], v43 offset:16384
v_mfma_f32_16x16x32_bf16 v[64:67], a[240:243], v[108:111], v[64:67]
s_add_u32 m0, s86, 4096
ds_read_b64_tr_b16 a[186:187], v43 offset:17408
v_mfma_f32_16x16x32_bf16 v[64:67], v[116:119], v[16:19], v[64:67]
buffer_load_dwordx4 v30, s[48:51], s84 offen offset:0 lds
v_mfma_f32_16x16x32_bf16 v[68:71], a[240:243], v[112:115], v[68:71]
ds_read_b64_tr_b16 a[188:189], v43 offset:24576
v_mfma_f32_16x16x32_bf16 v[68:71], v[116:119], v[20:23], v[68:71]
ds_read_b64_tr_b16 a[190:191], v43 offset:25600
v_mfma_f32_16x16x32_bf16 v[72:75], a[244:247], v[108:111], v[72:75]
ds_read_b128 a[136:139], v38 offset:2048
v_mfma_f32_16x16x32_bf16 v[72:75], v[120:123], v[16:19], v[72:75]
ds_read_b128 a[140:143], v39 offset:2048
v_mfma_f32_16x16x32_bf16 v[76:79], a[244:247], v[112:115], v[76:79]
ds_read_b128 a[144:147], v38 offset:4096
v_mfma_f32_16x16x32_bf16 v[76:79], v[120:123], v[20:23], v[76:79]
ds_read_b128 a[148:151], v39 offset:4096
v_mfma_f32_16x16x32_bf16 v[80:83], a[248:251], v[108:111], v[80:83]
ds_read_b128 a[152:155], v38 offset:6144
v_mfma_f32_16x16x32_bf16 v[80:83], v[8:11], v[16:19], v[80:83]
ds_read_b128 a[156:159], v39 offset:6144
v_mfma_f32_16x16x32_bf16 v[84:87], a[248:251], v[112:115], v[84:87]
v_mfma_f32_16x16x32_bf16 v[84:87], v[8:11], v[20:23], v[84:87]
buffer_load_dwordx4 v31, s[48:51], s84 offen offset:1024 lds
v_mfma_f32_16x16x32_bf16 v[88:91], a[252:255], v[108:111], v[88:91]
v_mfma_f32_16x16x32_bf16 v[88:91], v[12:15], v[16:19], v[88:91]
v_mfma_f32_16x16x32_bf16 v[92:95], a[252:255], v[112:115], v[92:95]
buffer_load_dwordx4 v32, s[48:51], s84 offen offset:2048 lds
v_mfma_f32_16x16x32_bf16 v[92:95], v[12:15], v[20:23], v[92:95]
s_waitcnt lgkmcnt(0)
v_mfma_f32_16x16x32_bf16 v[128:131], a[128:131], a[160:163], v[128:131]
buffer_load_dwordx4 v33, s[48:51], s84 offen offset:3072 lds
v_mfma_f32_16x16x32_bf16 v[128:131], a[132:135], a[164:167], v[128:131]
ds_read_b128 a[192:195], v38 offset:8192
v_mfma_f32_16x16x32_bf16 v[132:135], a[128:131], a[168:171], v[132:135]
v_mfma_f32_16x16x32_bf16 v[132:135], a[132:135], a[172:175], v[132:135]
s_add_u32 m0, s87, 32768
ds_read_b128 a[196:199], v39 offset:8192
v_mfma_f32_16x16x32_bf16 v[136:139], a[128:131], a[176:179], v[136:139]
buffer_load_dwordx4 v34, s[52:55], s85 offen offset:0 lds
v_mfma_f32_16x16x32_bf16 v[136:139], a[132:135], a[180:183], v[136:139]
ds_read_b128 a[200:203], v38 offset:10240
v_fma_f32 v112, v96, v64, v65
v_mfma_f32_16x16x32_bf16 v[140:143], a[128:131], a[184:187], v[140:143]
v_fma_f32 v113, v96, v68, v69
v_fma_f32 v112, -v97, v68, v112
v_mfma_f32_16x16x32_bf16 v[140:143], a[132:135], a[188:191], v[140:143]
ds_read_b128 a[204:207], v39 offset:10240
v_fma_f32 v113, v97, v64, v113
v_mfma_f32_16x16x32_bf16 v[144:147], a[136:139], a[160:163], v[144:147]
buffer_load_dwordx4 v35, s[52:55], s85 offen offset:1024 lds
v_mfma_f32_16x16x32_bf16 v[144:147], a[140:143], a[164:167], v[144:147]
ds_read_b128 a[208:211], v38 offset:12288
v_fma_f32 v114, v96, v112, v66
v_mfma_f32_16x16x32_bf16 v[148:151], a[136:139], a[168:171], v[148:151]
v_fma_f32 v115, v96, v113, v70
v_fma_f32 v114, -v97, v113, v114
v_mfma_f32_16x16x32_bf16 v[148:151], a[140:143], a[172:175], v[148:151]
ds_read_b128 a[212:215], v39 offset:12288
v_fma_f32 v115, v97, v112, v115
v_mfma_f32_16x16x32_bf16 v[152:155], a[136:139], a[176:179], v[152:155]
buffer_load_dwordx4 v36, s[52:55], s85 offen offset:2048 lds
v_mfma_f32_16x16x32_bf16 v[152:155], a[140:143], a[180:183], v[152:155]
ds_read_b128 a[216:219], v38 offset:14336
v_fma_f32 v112, v96, v114, v67
v_mfma_f32_16x16x32_bf16 v[156:159], a[136:139], a[184:187], v[156:159]
v_fma_f32 v113, v96, v115, v71
v_fma_f32 v112, -v97, v115, v112
v_mfma_f32_16x16x32_bf16 v[156:159], a[140:143], a[188:191], v[156:159]
ds_read_b128 a[220:223], v39 offset:14336
v_fma_f32 v113, v97, v114, v113
v_mfma_f32_16x16x32_bf16 v[160:163], a[144:147], a[160:163], v[160:163]
buffer_load_dwordx4 v37, s[52:55], s85 offen offset:3072 lds
v_mfma_f32_16x16x32_bf16 v[160:163], a[148:151], a[164:167], v[160:163]
ds_read_b64_tr_b16 a[224:225], v40 offset:0
v_fma_f32 v114, v96, v112, v72
v_mfma_f32_16x16x32_bf16 v[164:167], a[144:147], a[168:171], v[164:167]
v_fma_f32 v115, v96, v113, v76
v_fma_f32 v114, -v97, v113, v114
v_mfma_f32_16x16x32_bf16 v[164:167], a[148:151], a[172:175], v[164:167]
s_add_u32 m0, s87, 49152
ds_read_b64_tr_b16 a[226:227], v40 offset:1024
v_fma_f32 v115, v97, v112, v115
v_mfma_f32_16x16x32_bf16 v[168:171], a[144:147], a[176:179], v[168:171]
buffer_load_dwordx4 v34, s[56:59], s85 offen offset:0 lds
v_mfma_f32_16x16x32_bf16 v[168:171], a[148:151], a[180:183], v[168:171]
ds_read_b64_tr_b16 a[228:229], v40 offset:8192
v_fma_f32 v112, v96, v114, v73
v_mfma_f32_16x16x32_bf16 v[172:175], a[144:147], a[184:187], v[172:175]
v_fma_f32 v113, v96, v115, v77
v_fma_f32 v112, -v97, v115, v112
v_mfma_f32_16x16x32_bf16 v[172:175], a[148:151], a[188:191], v[172:175]
ds_read_b64_tr_b16 a[230:231], v40 offset:9216
v_fma_f32 v113, v97, v114, v113
v_mfma_f32_16x16x32_bf16 v[176:179], a[152:155], a[160:163], v[176:179]
buffer_load_dwordx4 v35, s[56:59], s85 offen offset:1024 lds
v_mfma_f32_16x16x32_bf16 v[176:179], a[156:159], a[164:167], v[176:179]
ds_read_b64_tr_b16 a[232:233], v41 offset:0
v_fma_f32 v114, v96, v112, v74
v_mfma_f32_16x16x32_bf16 v[180:183], a[152:155], a[168:171], v[180:183]
v_fma_f32 v115, v96, v113, v78
v_fma_f32 v114, -v97, v113, v114
v_mfma_f32_16x16x32_bf16 v[180:183], a[156:159], a[172:175], v[180:183]
ds_read_b64_tr_b16 a[234:235], v41 offset:1024
v_fma_f32 v115, v97, v112, v115
v_mfma_f32_16x16x32_bf16 v[184:187], a[152:155], a[176:179], v[184:187]
buffer_load_dwordx4 v36, s[56:59], s85 offen offset:2048 lds
v_mfma_f32_16x16x32_bf16 v[184:187], a[156:159], a[180:183], v[184:187]
ds_read_b64_tr_b16 a[236:237], v41 offset:8192
v_fma_f32 v112, v96, v114, v75
v_mfma_f32_16x16x32_bf16 v[188:191], a[152:155], a[184:187], v[188:191]
v_fma_f32 v113, v96, v115, v79
v_fma_f32 v112, -v97, v115, v112
v_mfma_f32_16x16x32_bf16 v[188:191], a[156:159], a[188:191], v[188:191]
s_waitcnt lgkmcnt(1)
ds_read_b64_tr_b16 a[238:239], v41 offset:9216
v_fma_f32 v113, v97, v114, v113
v_mfma_f32_16x16x32_bf16 v[192:195], a[192:195], a[160:163], v[192:195]
buffer_load_dwordx4 v37, s[56:59], s85 offen offset:3072 lds
v_mfma_f32_16x16x32_bf16 v[192:195], a[196:199], a[164:167], v[192:195]
s_add_u32 s84, s84, 128
s_add_u32 s85, s85, 524288
ds_read_b64_tr_b16 a[240:241], v42 offset:0
v_fma_f32 v114, v96, v112, v80
v_mfma_f32_16x16x32_bf16 v[196:199], a[192:195], a[168:171], v[196:199]
v_fma_f32 v115, v96, v113, v84
v_fma_f32 v114, -v97, v113, v114
v_mfma_f32_16x16x32_bf16 v[196:199], a[196:199], a[172:175], v[196:199]
ds_read_b64_tr_b16 a[242:243], v42 offset:1024
v_fma_f32 v115, v97, v112, v115
v_mfma_f32_16x16x32_bf16 v[200:203], a[192:195], a[176:179], v[200:203]
buffer_load_dword v127, v4, s[64:67], s88 offen
v_mfma_f32_16x16x32_bf16 v[200:203], a[196:199], a[180:183], v[200:203]
s_add_u32 s88, s88, 524288
ds_read_b64_tr_b16 a[244:245], v42 offset:8192
s_and_b32 s18, s3, 1
v_mfma_f32_16x16x32_bf16 v[204:207], a[192:195], a[184:187], v[204:207]
buffer_load_dword v127, v4, s[64:67], s88 offen
v_mfma_f32_16x16x32_bf16 v[204:207], a[196:199], a[188:191], v[204:207]
s_add_u32 s88, s88, 524288
ds_read_b64_tr_b16 a[246:247], v42 offset:9216
s_lshl_b32 s18, s18, 7
v_mfma_f32_16x16x32_bf16 v[208:211], a[200:203], a[160:163], v[208:211]
buffer_load_dword v127, v4, s[64:67], s88 offen
v_mfma_f32_16x16x32_bf16 v[208:211], a[204:207], a[164:167], v[208:211]
s_add_u32 s19, s18, 131072
ds_read_b64_tr_b16 a[248:249], v43 offset:0
v_add_u32 v8, s19, v24
v_mfma_f32_16x16x32_bf16 v[212:215], a[200:203], a[168:171], v[212:215]
s_getpc_b64 s[64:65]
Lpc_srd:
s_sub_u32 s64, s64, Lpc_srd-L_pc
s_subb_u32 s65, s65, 0
v_mfma_f32_16x16x32_bf16 v[212:215], a[204:207], a[172:175], v[212:215]
s_and_b32 s65, s65, 0xffff
ds_read_b64_tr_b16 a[250:251], v43 offset:1024
s_mov_b32 s66, L_text_end-L_pc
v_mfma_f32_16x16x32_bf16 v[216:219], a[200:203], a[176:179], v[216:219]
s_mov_b32 s67, 0x20000
s_lshr_b32 s95, s2, 3
s_lshl_b32 s95, s95, 2
v_mfma_f32_16x16x32_bf16 v[216:219], a[204:207], a[180:183], v[216:219]
s_add_u32 s95, s95, s3
ds_read_b64_tr_b16 a[252:253], v43 offset:8192
s_lshl_b32 s95, s95, 7
v_mfma_f32_16x16x32_bf16 v[220:223], a[200:203], a[184:187], v[220:223]
s_lshl_b32 s81, s93, 7
v_lshl_add_u32 v9, v62, 8, v8
s_lshl_b32 s91, s79, 8
v_mfma_f32_16x16x32_bf16 v[220:223], a[204:207], a[188:191], v[220:223]
s_add_u32 s91, s91, s18
ds_read_b64_tr_b16 a[254:255], v43 offset:9216
v_fma_f32 v112, v96, v114, v81
v_mfma_f32_16x16x32_bf16 v[224:227], a[208:211], a[160:163], v[224:227]
buffer_load_dword v126, off, s[64:67], s81
v_mfma_f32_16x16x32_bf16 v[224:227], a[212:215], a[164:167], v[224:227]
v_fma_f32 v113, v96, v115, v85
v_fma_f32 v112, -v97, v115, v112
v_mfma_f32_16x16x32_bf16 v[228:231], a[208:211], a[168:171], v[228:231]
v_fma_f32 v113, v97, v114, v113
v_fma_f32 v114, v96, v112, v82
v_mfma_f32_16x16x32_bf16 v[228:231], a[212:215], a[172:175], v[228:231]
v_fma_f32 v115, v96, v113, v86
v_fma_f32 v114, -v97, v113, v114
v_mfma_f32_16x16x32_bf16 v[232:235], a[208:211], a[176:179], v[232:235]
v_xor_b32 v38, 0x10000, v38
v_fma_f32 v115, v97, v112, v115
v_mfma_f32_16x16x32_bf16 v[232:235], a[212:215], a[180:183], v[232:235]
v_xor_b32 v39, 0x10000, v39
v_fma_f32 v112, v96, v114, v83
v_mfma_f32_16x16x32_bf16 v[236:239], a[208:211], a[184:187], v[236:239]
v_xor_b32 v40, 0x10000, v40
v_fma_f32 v113, v96, v115, v87
v_mfma_f32_16x16x32_bf16 v[236:239], a[212:215], a[188:191], v[236:239]
v_xor_b32 v41, 0x10000, v41
v_fma_f32 v112, -v97, v115, v112
v_mfma_f32_16x16x32_bf16 v[240:243], a[216:219], a[160:163], v[240:243]
v_xor_b32 v42, 0x10000, v42
v_fma_f32 v113, v97, v114, v113
v_mfma_f32_16x16x32_bf16 v[240:243], a[220:223], a[164:167], v[240:243]
v_xor_b32 v43, 0x10000, v43
v_fma_f32 v114, v96, v112, v88
v_mfma_f32_16x16x32_bf16 v[244:247], a[216:219], a[168:171], v[244:247]
v_fma_f32 v115, v96, v113, v92
v_fma_f32 v114, -v97, v113, v114
v_mfma_f32_16x16x32_bf16 v[244:247], a[220:223], a[172:175], v[244:247]
v_fma_f32 v115, v97, v112, v115
v_fma_f32 v112, v96, v114, v89
v_mfma_f32_16x16x32_bf16 v[248:251], a[216:219], a[176:179], v[248:251]
v_fma_f32 v113, v96, v115, v93
v_fma_f32 v112, -v97, v115, v112
v_mfma_f32_16x16x32_bf16 v[248:251], a[220:223], a[180:183], v[248:251]
v_fma_f32 v113, v97, v114, v113
v_fma_f32 v114, v96, v112, v90
v_fma_f32 v115, v96, v113, v94
v_fma_f32 v114, -v97, v113, v114
v_fma_f32 v115, v97, v112, v115
v_fma_f32 v112, v96, v114, v91
v_fma_f32 v113, v96, v115, v95
v_fma_f32 v112, -v97, v115, v112
v_fma_f32 v113, v97, v114, v113
ds_write_b64 v9, v[112:113]
v_mfma_f32_16x16x32_bf16 v[252:255], a[216:219], a[184:187], v[252:255]
s_waitcnt vmcnt(4) lgkmcnt(0)
v_mfma_f32_16x16x32_bf16 v[252:255], a[220:223], a[188:191], v[252:255]
s_barrier
v_mfma_f32_16x16x32_bf16 a[0:3], a[224:227], a[128:131], a[0:3]
ds_read_b64 v[108:109], v8 offset:0
v_mfma_f32_16x16x32_bf16 a[0:3], a[228:231], a[132:135], a[0:3]
s_add_u32 m0, s86, 65536
ds_read_b64_tr_b16 a[160:161], v40 offset:16384
v_mfma_f32_16x16x32_bf16 a[4:7], a[232:235], a[128:131], a[4:7]
buffer_load_dwordx4 v26, s[48:51], s84 offen offset:0 lds
v_mfma_f32_16x16x32_bf16 a[4:7], a[236:239], a[132:135], a[4:7]
ds_read_b64_tr_b16 a[162:163], v40 offset:17408
v_mfma_f32_16x16x32_bf16 a[8:11], a[240:243], a[128:131], a[8:11]
ds_read_b64 v[110:111], v8 offset:256
v_mfma_f32_16x16x32_bf16 a[8:11], a[244:247], a[132:135], a[8:11]
ds_read_b64_tr_b16 a[164:165], v40 offset:24576
v_mfma_f32_16x16x32_bf16 a[12:15], a[248:251], a[128:131], a[12:15]
buffer_load_dwordx4 v27, s[48:51], s84 offen offset:1024 lds
v_mfma_f32_16x16x32_bf16 a[12:15], a[252:255], a[132:135], a[12:15]
ds_read_b64_tr_b16 a[166:167], v40 offset:25600
v_mfma_f32_16x16x32_bf16 a[16:19], a[224:227], a[136:139], a[16:19]
ds_read_b64 v[112:113], v8 offset:512
v_mfma_f32_16x16x32_bf16 a[16:19], a[228:231], a[140:143], a[16:19]
ds_read_b64_tr_b16 a[168:169], v41 offset:16384
v_mfma_f32_16x16x32_bf16 a[20:23], a[232:235], a[136:139], a[20:23]
buffer_load_dwordx4 v28, s[48:51], s84 offen offset:2048 lds
v_mfma_f32_16x16x32_bf16 a[20:23], a[236:239], a[140:143], a[20:23]
ds_read_b64_tr_b16 a[170:171], v41 offset:17408
v_mfma_f32_16x16x32_bf16 a[24:27], a[240:243], a[136:139], a[24:27]
ds_read_b64 v[114:115], v8 offset:768
v_mfma_f32_16x16x32_bf16 a[24:27], a[244:247], a[140:143], a[24:27]
ds_read_b64_tr_b16 a[172:173], v41 offset:24576
v_mfma_f32_16x16x32_bf16 a[28:31], a[248:251], a[136:139], a[28:31]
buffer_load_dwordx4 v29, s[48:51], s84 offen offset:3072 lds
v_mfma_f32_16x16x32_bf16 a[28:31], a[252:255], a[140:143], a[28:31]
ds_read_b64_tr_b16 a[174:175], v41 offset:25600
v_mfma_f32_16x16x32_bf16 a[32:35], a[224:227], a[144:147], a[32:35]
ds_read_b64 v[116:117], v8 offset:1024
v_mfma_f32_16x16x32_bf16 a[32:35], a[228:231], a[148:151], a[32:35]
s_add_u32 m0, s86, 69632
ds_read_b64_tr_b16 a[176:177], v42 offset:16384
v_mfma_f32_16x16x32_bf16 a[36:39], a[232:235], a[144:147], a[36:39]
buffer_load_dwordx4 v30, s[48:51], s84 offen offset:0 lds
v_mfma_f32_16x16x32_bf16 a[36:39], a[236:239], a[148:151], a[36:39]
ds_read_b64_tr_b16 a[178:179], v42 offset:17408
v_mfma_f32_16x16x32_bf16 a[40:43], a[240:243], a[144:147], a[40:43]
ds_read_b64 v[118:119], v8 offset:1280
v_mfma_f32_16x16x32_bf16 a[40:43], a[244:247], a[148:151], a[40:43]
ds_read_b64_tr_b16 a[180:181], v42 offset:24576
v_mfma_f32_16x16x32_bf16 a[44:47], a[248:251], a[144:147], a[44:47]
buffer_load_dwordx4 v31, s[48:51], s84 offen offset:1024 lds
v_mfma_f32_16x16x32_bf16 a[44:47], a[252:255], a[148:151], a[44:47]
ds_read_b64_tr_b16 a[182:183], v42 offset:25600
v_mfma_f32_16x16x32_bf16 a[48:51], a[224:227], a[152:155], a[48:51]
ds_read_b64 v[120:121], v8 offset:1536
v_mfma_f32_16x16x32_bf16 a[48:51], a[228:231], a[156:159], a[48:51]
ds_read_b64_tr_b16 a[184:185], v43 offset:16384
v_mfma_f32_16x16x32_bf16 a[52:55], a[232:235], a[152:155], a[52:55]
buffer_load_dwordx4 v32, s[48:51], s84 offen offset:2048 lds
v_mfma_f32_16x16x32_bf16 a[52:55], a[236:239], a[156:159], a[52:55]
ds_read_b64_tr_b16 a[186:187], v43 offset:17408
v_mfma_f32_16x16x32_bf16 a[56:59], a[240:243], a[152:155], a[56:59]
ds_read_b64 v[122:123], v8 offset:1792
v_mov_b32 v104, 0
v_mfma_f32_16x16x32_bf16 a[56:59], a[244:247], a[156:159], a[56:59]
ds_read_b64_tr_b16 a[188:189], v43 offset:24576
v_mov_b32 v105, 0
v_mfma_f32_16x16x32_bf16 a[60:63], a[248:251], a[152:155], a[60:63]
buffer_load_dwordx4 v33, s[48:51], s84 offen offset:3072 lds
v_mfma_f32_16x16x32_bf16 a[60:63], a[252:255], a[156:159], a[60:63]
ds_read_b64_tr_b16 a[190:191], v43 offset:25600
v_mfma_f32_16x16x32_bf16 a[64:67], a[224:227], a[192:195], a[64:67]
s_add_u32 s44, s60, 59768832
s_addc_u32 s45, s61, 0
v_mfma_f32_16x16x32_bf16 a[64:67], a[228:231], a[196:199], a[64:67]
s_add_u32 m0, s87, 98304
ds_read_b128 a[128:131], v38 offset:0
s_mov_b32 s46, 0x10000
v_mfma_f32_16x16x32_bf16 a[68:71], a[232:235], a[192:195], a[68:71]
buffer_load_dwordx4 v34, s[52:55], s85 offen offset:0 lds
v_mfma_f32_16x16x32_bf16 a[68:71], a[236:239], a[196:199], a[68:71]
s_lshl_b32 s18, s78, 12
ds_read_b128 a[132:135], v39 offset:0
s_add_u32 s18, s18, s91
v_mfma_f32_16x16x32_bf16 a[72:75], a[240:243], a[192:195], a[72:75]
s_waitcnt lgkmcnt(4)
v_fma_f32 v110, v98, v108, v110
v_fma_f32 v111, v98, v109, v111
v_mfma_f32_16x16x32_bf16 a[72:75], a[244:247], a[196:199], a[72:75]
ds_read_b128 a[136:139], v38 offset:2048
v_fma_f32 v110, -v99, v109, v110
v_mfma_f32_16x16x32_bf16 a[76:79], a[248:251], a[192:195], a[76:79]
buffer_load_dwordx4 v35, s[52:55], s85 offen offset:1024 lds
v_mfma_f32_16x16x32_bf16 a[76:79], a[252:255], a[196:199], a[76:79]
ds_read_b128 a[140:143], v39 offset:2048
v_fma_f32 v111, v99, v108, v111
v_mfma_f32_16x16x32_bf16 a[80:83], a[224:227], a[200:203], a[80:83]
v_fma_f32 v112, v98, v110, v112
v_fma_f32 v113, v98, v111, v113
v_mfma_f32_16x16x32_bf16 a[80:83], a[228:231], a[204:207], a[80:83]
ds_read_b128 a[144:147], v38 offset:4096
v_fma_f32 v112, -v99, v111, v112
v_mfma_f32_16x16x32_bf16 a[84:87], a[232:235], a[200:203], a[84:87]
buffer_load_dwordx4 v36, s[52:55], s85 offen offset:2048 lds
v_mfma_f32_16x16x32_bf16 a[84:87], a[236:239], a[204:207], a[84:87]
ds_read_b128 a[148:151], v39 offset:4096
v_fma_f32 v113, v99, v110, v113
v_mfma_f32_16x16x32_bf16 a[88:91], a[240:243], a[200:203], a[88:91]
v_fma_f32 v114, v98, v112, v114
v_fma_f32 v115, v98, v113, v115
v_mfma_f32_16x16x32_bf16 a[88:91], a[244:247], a[204:207], a[88:91]
ds_read_b128 a[152:155], v38 offset:6144
v_fma_f32 v114, -v99, v113, v114
v_mfma_f32_16x16x32_bf16 a[92:95], a[248:251], a[200:203], a[92:95]
buffer_load_dwordx4 v37, s[52:55], s85 offen offset:3072 lds
v_mfma_f32_16x16x32_bf16 a[92:95], a[252:255], a[204:207], a[92:95]
ds_read_b128 a[156:159], v39 offset:6144
v_fma_f32 v115, v99, v112, v115
v_mfma_f32_16x16x32_bf16 a[96:99], a[224:227], a[208:211], a[96:99]
v_fma_f32 v116, v98, v114, v116
v_fma_f32 v117, v98, v115, v117
v_mfma_f32_16x16x32_bf16 a[96:99], a[228:231], a[212:215], a[96:99]
s_add_u32 m0, s87, 114688
v_fma_f32 v116, -v99, v115, v116
v_fma_f32 v117, v99, v114, v117
v_mfma_f32_16x16x32_bf16 a[100:103], a[232:235], a[208:211], a[100:103]
buffer_load_dwordx4 v34, s[56:59], s85 offen offset:0 lds
v_mfma_f32_16x16x32_bf16 a[100:103], a[236:239], a[212:215], a[100:103]
v_fma_f32 v118, v98, v116, v118
v_fma_f32 v119, v98, v117, v119
v_mfma_f32_16x16x32_bf16 a[104:107], a[240:243], a[208:211], a[104:107]
v_fma_f32 v118, -v99, v117, v118
v_fma_f32 v119, v99, v116, v119
v_mfma_f32_16x16x32_bf16 a[104:107], a[244:247], a[212:215], a[104:107]
v_fma_f32 v120, v98, v118, v120
v_fma_f32 v121, v98, v119, v121
v_mfma_f32_16x16x32_bf16 a[108:111], a[248:251], a[208:211], a[108:111]
buffer_load_dwordx4 v35, s[56:59], s85 offen offset:1024 lds
v_mfma_f32_16x16x32_bf16 a[108:111], a[252:255], a[212:215], a[108:111]
v_fma_f32 v120, -v99, v119, v120
v_fma_f32 v121, v99, v118, v121
v_mfma_f32_16x16x32_bf16 a[112:115], a[224:227], a[216:219], a[112:115]
v_fma_f32 v122, v98, v120, v122
v_fma_f32 v123, v98, v121, v123
v_mfma_f32_16x16x32_bf16 a[112:115], a[228:231], a[220:223], a[112:115]
v_fma_f32 v122, -v99, v121, v122
v_fma_f32 v123, v99, v120, v123
v_mfma_f32_16x16x32_bf16 a[116:119], a[232:235], a[216:219], a[116:119]
buffer_load_dwordx4 v36, s[56:59], s85 offen offset:2048 lds
v_mfma_f32_16x16x32_bf16 a[116:119], a[236:239], a[220:223], a[116:119]
s_cmp_ge_u32 s3, 2
s_cbranch_scc1 L_noE
s_mov_b64 exec, 0xffff
buffer_store_dwordx2 v[122:123], v24, s[44:47], s18 offen sc1
s_mov_b64 exec, -1
L_noE:
v_mfma_f32_16x16x32_bf16 a[120:123], a[240:243], a[216:219], a[120:123]
v_mov_b32 v10, 0
v_mfma_f32_16x16x32_bf16 a[120:123], a[244:247], a[220:223], a[120:123]
global_load_dword v13, v10, s[36:37] sc1
v_mfma_f32_16x16x32_bf16 a[124:127], a[248:251], a[216:219], a[124:127]
buffer_load_dwordx4 v37, s[56:59], s85 offen offset:3072 lds
v_mfma_f32_16x16x32_bf16 a[124:127], a[252:255], a[220:223], a[124:127]
s_add_u32 s84, s84, 128
v_cmp_eq_u32 vcc, 1, v62
s_waitcnt lgkmcnt(0)
v_mfma_f32_16x16x32_bf16 v[128:131], a[128:131], a[160:163], v[128:131]
s_add_u32 s85, s85, 524288
v_mfma_f32_16x16x32_bf16 v[128:131], a[132:135], a[164:167], v[128:131]
ds_read_b128 a[192:195], v38 offset:8192
v_cndmask_b32 v104, v104, v108, vcc
v_mfma_f32_16x16x32_bf16 v[132:135], a[128:131], a[168:171], v[132:135]
v_cndmask_b32 v105, v105, v109, vcc
v_cmp_eq_u32 vcc, 2, v62
v_mfma_f32_16x16x32_bf16 v[132:135], a[132:135], a[172:175], v[132:135]
ds_read_b128 a[196:199], v39 offset:8192
v_mfma_f32_16x16x32_bf16 v[136:139], a[128:131], a[176:179], v[136:139]
v_cndmask_b32 v104, v104, v110, vcc
v_cndmask_b32 v105, v105, v111, vcc
v_mfma_f32_16x16x32_bf16 v[136:139], a[132:135], a[180:183], v[136:139]
ds_read_b128 a[200:203], v38 offset:10240
v_cmp_eq_u32 vcc, 3, v62
v_mfma_f32_16x16x32_bf16 v[140:143], a[128:131], a[184:187], v[140:143]
v_mfma_f32_16x16x32_bf16 v[140:143], a[132:135], a[188:191], v[140:143]
ds_read_b128 a[204:207], v39 offset:10240
v_cndmask_b32 v104, v104, v112, vcc
v_mfma_f32_16x16x32_bf16 v[144:147], a[136:139], a[160:163], v[144:147]
v_lshrrev_b32 v7, 3, v1
v_lshlrev_b32 v7, 28, v7
v_mfma_f32_16x16x32_bf16 v[144:147], a[140:143], a[164:167], v[144:147]
ds_read_b128 a[208:211], v38 offset:12288
v_lshl_add_u32 v7, v1, 7, v7
v_mfma_f32_16x16x32_bf16 v[148:151], a[136:139], a[168:171], v[148:151]
v_lshrrev_b32 v4, 3, v1
v_mul_u32_u24 v4, 7168, v4
v_mfma_f32_16x16x32_bf16 v[148:151], a[140:143], a[172:175], v[148:151]
ds_read_b128 a[212:215], v39 offset:12288
v_add_u32 v4, v4, v7
v_mfma_f32_16x16x32_bf16 v[152:155], a[136:139], a[176:179], v[152:155]
v_lshrrev_b32 v124, 2, v1
v_lshl_add_u32 v7, v124, 9, v7
v_mfma_f32_16x16x32_bf16 v[152:155], a[140:143], a[180:183], v[152:155]
s_lshl_b32 s82, s76, 3
ds_read_b128 a[216:219], v38 offset:14336
s_add_u32 s82, s82, s77
v_mfma_f32_16x16x32_bf16 v[156:159], a[136:139], a[184:187], v[156:159]
s_lshr_b32 s82, s82, 0
s_lshl_b32 s82, s82, 2
s_add_u32 s82, s82, s3
v_mfma_f32_16x16x32_bf16 v[156:159], a[140:143], a[188:191], v[156:159]
s_lshl_b32 s82, s82, 11
ds_read_b128 a[220:223], v39 offset:14336
s_lshl_b32 s88, s82, 2
v_mfma_f32_16x16x32_bf16 v[160:163], a[144:147], a[160:163], v[160:163]
s_and_b32 s88, s88, 0xfffff
s_lshr_b32 s81, s76, 2
s_lshl_b32 s81, s81, 10
v_mfma_f32_16x16x32_bf16 v[160:163], a[148:151], a[164:167], v[160:163]
s_add_u32 s88, s88, s81
ds_read_b64_tr_b16 a[224:225], v40 offset:0
s_add_u32 s1, s82, 2097152
v_mfma_f32_16x16x32_bf16 v[164:167], a[144:147], a[168:171], v[164:167]
v_cndmask_b32 v105, v105, v113, vcc
v_cmp_eq_u32 vcc, 4, v62
v_mfma_f32_16x16x32_bf16 v[164:167], a[148:151], a[172:175], v[164:167]
ds_read_b64_tr_b16 a[226:227], v40 offset:1024
v_mfma_f32_16x16x32_bf16 v[168:171], a[144:147], a[176:179], v[168:171]
v_cndmask_b32 v104, v104, v114, vcc
v_cndmask_b32 v105, v105, v115, vcc
v_mfma_f32_16x16x32_bf16 v[168:171], a[148:151], a[180:183], v[168:171]
ds_read_b64_tr_b16 a[228:229], v40 offset:8192
v_cmp_eq_u32 vcc, 5, v62
v_mfma_f32_16x16x32_bf16 v[172:175], a[144:147], a[184:187], v[172:175]
v_mfma_f32_16x16x32_bf16 v[172:175], a[148:151], a[188:191], v[172:175]
ds_read_b64_tr_b16 a[230:231], v40 offset:9216
v_cndmask_b32 v104, v104, v116, vcc
v_mfma_f32_16x16x32_bf16 v[176:179], a[152:155], a[160:163], v[176:179]
v_cndmask_b32 v105, v105, v117, vcc
v_cmp_eq_u32 vcc, 6, v62
v_mfma_f32_16x16x32_bf16 v[176:179], a[156:159], a[164:167], v[176:179]
ds_read_b64_tr_b16 a[232:233], v41 offset:0
v_mfma_f32_16x16x32_bf16 v[180:183], a[152:155], a[168:171], v[180:183]
v_cndmask_b32 v104, v104, v118, vcc
v_cndmask_b32 v105, v105, v119, vcc
v_mfma_f32_16x16x32_bf16 v[180:183], a[156:159], a[172:175], v[180:183]
ds_read_b64_tr_b16 a[234:235], v41 offset:1024
v_cmp_eq_u32 vcc, 7, v62
v_mfma_f32_16x16x32_bf16 v[184:187], a[152:155], a[176:179], v[184:187]
v_mfma_f32_16x16x32_bf16 v[184:187], a[156:159], a[180:183], v[184:187]
ds_read_b64_tr_b16 a[236:237], v41 offset:8192
v_cndmask_b32 v104, v104, v120, vcc
v_mfma_f32_16x16x32_bf16 v[188:191], a[152:155], a[184:187], v[188:191]
s_waitcnt lgkmcnt(2)
v_cndmask_b32 v105, v105, v121, vcc
s_lshr_b32 s18, s2, 5
v_mfma_f32_16x16x32_bf16 v[188:191], a[156:159], a[188:191], v[188:191]
s_lshl_b32 s18, s18, 2
ds_read_b64_tr_b16 a[238:239], v41 offset:9216
s_add_u32 s18, s18, s3
v_mfma_f32_16x16x32_bf16 v[192:195], a[192:195], a[160:163], v[192:195]
s_lshl_b32 s18, s18, 14
s_and_b32 s19, s2, 15
s_lshl_b32 s19, s19, 6
v_mfma_f32_16x16x32_bf16 v[192:195], a[196:199], a[164:167], v[192:195]
s_add_u32 s18, s18, s19
ds_read_b64_tr_b16 a[240:241], v42 offset:0
v_lshlrev_b32 v14, 7, v24
v_mfma_f32_16x16x32_bf16 v[196:199], a[192:195], a[168:171], v[196:199]
v_lshl_add_u32 v14, v3, 4, v14
v_mfma_f32_16x16x32_bf16 v[196:199], a[196:199], a[172:175], v[196:199]
ds_read_b64_tr_b16 a[242:243], v42 offset:1024
v_mfma_f32_16x16x32_bf16 v[200:203], a[192:195], a[176:179], v[200:203]
buffer_load_dwordx4 v[20:23], v14, s[68:71], s18 offen
v_mfma_f32_16x16x32_bf16 v[200:203], a[196:199], a[180:183], v[200:203]
ds_read_b64_tr_b16 a[244:245], v42 offset:8192
v_mfma_f32_16x16x32_bf16 v[204:207], a[192:195], a[184:187], v[204:207]
v_mfma_f32_16x16x32_bf16 v[204:207], a[196:199], a[188:191], v[204:207]
ds_read_b64_tr_b16 a[246:247], v42 offset:9216
v_mfma_f32_16x16x32_bf16 v[208:211], a[200:203], a[160:163], v[208:211]
v_mfma_f32_16x16x32_bf16 v[208:211], a[204:207], a[164:167], v[208:211]
ds_read_b64_tr_b16 a[248:249], v43 offset:0
v_mfma_f32_16x16x32_bf16 v[212:215], a[200:203], a[168:171], v[212:215]
v_mfma_f32_16x16x32_bf16 v[212:215], a[204:207], a[172:175], v[212:215]
ds_read_b64_tr_b16 a[250:251], v43 offset:1024
v_mfma_f32_16x16x32_bf16 v[216:219], a[200:203], a[176:179], v[216:219]
v_mfma_f32_16x16x32_bf16 v[216:219], a[204:207], a[180:183], v[216:219]
ds_read_b64_tr_b16 a[252:253], v43 offset:8192
v_mfma_f32_16x16x32_bf16 v[220:223], a[200:203], a[184:187], v[220:223]
v_mfma_f32_16x16x32_bf16 v[220:223], a[204:207], a[188:191], v[220:223]
ds_read_b64_tr_b16 a[254:255], v43 offset:9216
v_mfma_f32_16x16x32_bf16 v[224:227], a[208:211], a[160:163], v[224:227]
v_mfma_f32_16x16x32_bf16 v[224:227], a[212:215], a[164:167], v[224:227]
v_mfma_f32_16x16x32_bf16 v[228:231], a[208:211], a[168:171], v[228:231]
v_mfma_f32_16x16x32_bf16 v[228:231], a[212:215], a[172:175], v[228:231]
v_mfma_f32_16x16x32_bf16 v[232:235], a[208:211], a[176:179], v[232:235]
v_xor_b32 v38, 0x10000, v38
v_mfma_f32_16x16x32_bf16 v[232:235], a[212:215], a[180:183], v[232:235]
v_xor_b32 v39, 0x10000, v39
v_mfma_f32_16x16x32_bf16 v[236:239], a[208:211], a[184:187], v[236:239]
v_xor_b32 v40, 0x10000, v40
v_mfma_f32_16x16x32_bf16 v[236:239], a[212:215], a[188:191], v[236:239]
v_xor_b32 v41, 0x10000, v41
v_mfma_f32_16x16x32_bf16 v[240:243], a[216:219], a[160:163], v[240:243]
v_xor_b32 v42, 0x10000, v42
v_mfma_f32_16x16x32_bf16 v[240:243], a[220:223], a[164:167], v[240:243]
Lcp11:
s_add_u32 s9, s95, Lcp11-L_pc+3072
v_xor_b32 v43, 0x10000, v43
v_mfma_f32_16x16x32_bf16 v[244:247], a[216:219], a[168:171], v[244:247]
buffer_load_dword v126, off, s[64:67], s9
v_mfma_f32_16x16x32_bf16 v[244:247], a[220:223], a[172:175], v[244:247]
v_mfma_f32_16x16x32_bf16 v[248:251], a[216:219], a[176:179], v[248:251]
v_mfma_f32_16x16x32_bf16 v[248:251], a[220:223], a[180:183], v[248:251]
v_mfma_f32_16x16x32_bf16 v[252:255], a[216:219], a[184:187], v[252:255]
s_waitcnt vmcnt(2) lgkmcnt(0)
v_mfma_f32_16x16x32_bf16 v[252:255], a[220:223], a[188:191], v[252:255]
s_barrier
v_mfma_f32_16x16x32_bf16 a[0:3], a[224:227], a[128:131], a[0:3]
v_cmp_eq_u32 vcc, 0, v13
v_mfma_f32_16x16x32_bf16 a[0:3], a[228:231], a[132:135], a[0:3]
s_add_u32 m0, s86, 0
ds_read_b64_tr_b16 a[160:161], v40 offset:16384
v_mfma_f32_16x16x32_bf16 a[4:7], a[232:235], a[128:131], a[4:7]
buffer_load_dwordx4 v26, s[48:51], s84 offen offset:0 lds
v_mfma_f32_16x16x32_bf16 a[4:7], a[236:239], a[132:135], a[4:7]
ds_read_b64_tr_b16 a[162:163], v40 offset:17408
v_mfma_f32_16x16x32_bf16 a[8:11], a[240:243], a[128:131], a[8:11]
s_cbranch_vccnz L_spinI
L_goI:
s_cmp_lg_u32 s3, 0
s_cbranch_scc1 Lpub1
s_add_u32 s16, s16, 256
s_mov_b64 exec, 1
v_mov_b32 v11, s16
buffer_store_dword v11, off, s[60:63], s0 sc1
s_mov_b64 exec, -1
s_add_u32 s0, s0, 4096
Lpub1:
v_mfma_f32_16x16x32_bf16 a[8:11], a[244:247], a[132:135], a[8:11]
s_mov_b32 s68, s22
ds_read_b64_tr_b16 a[164:165], v40 offset:24576
s_and_b32 s69, s23, 0xffff
v_mfma_f32_16x16x32_bf16 a[12:15], a[248:251], a[128:131], a[12:15]
buffer_load_dwordx4 v27, s[48:51], s84 offen offset:1024 lds
v_mfma_f32_16x16x32_bf16 a[12:15], a[252:255], a[132:135], a[12:15]
s_mov_b32 s70, 0x200000
ds_read_b64_tr_b16 a[166:167], v40 offset:25600
s_mov_b32 s71, 0x20000
v_mfma_f32_16x16x32_bf16 a[16:19], a[224:227], a[136:139], a[16:19]
v_min_u32 v11, s78, v1
v_lshrrev_b32 v10, 1, v11
v_mfma_f32_16x16x32_bf16 a[16:19], a[228:231], a[140:143], a[16:19]
ds_read_b64_tr_b16 a[168:169], v41 offset:16384
v_lshlrev_b32 v10, 9, v10
v_mfma_f32_16x16x32_bf16 a[20:23], a[232:235], a[136:139], a[20:23]
buffer_load_dwordx4 v28, s[48:51], s84 offen offset:2048 lds
v_mfma_f32_16x16x32_bf16 a[20:23], a[236:239], a[140:143], a[20:23]
ds_read_b64_tr_b16 a[170:171], v41 offset:17408
v_and_b32 v11, 1, v11
v_mfma_f32_16x16x32_bf16 a[24:27], a[240:243], a[136:139], a[24:27]
v_lshl_add_u32 v10, v11, 2, v10
s_lshr_b32 s18, s79, 2
v_mfma_f32_16x16x32_bf16 a[24:27], a[244:247], a[140:143], a[24:27]
s_lshl_b32 s18, s18, 7
ds_read_b64_tr_b16 a[172:173], v41 offset:24576
s_and_b32 s19, s79, 3
v_mfma_f32_16x16x32_bf16 a[28:31], a[248:251], a[136:139], a[28:31]
buffer_load_dwordx4 v29, s[48:51], s84 offen offset:3072 lds
v_mfma_f32_16x16x32_bf16 a[28:31], a[252:255], a[140:143], a[28:31]
s_lshl_b32 s19, s19, 3
ds_read_b64_tr_b16 a[174:175], v41 offset:25600
s_add_u32 s18, s18, s19
v_mfma_f32_16x16x32_bf16 a[32:35], a[224:227], a[144:147], a[32:35]
v_add_u32 v10, s18, v10
v_mfma_f32_16x16x32_bf16 a[32:35], a[228:231], a[148:151], a[32:35]
s_add_u32 m0, s86, 4096
ds_read_b64_tr_b16 a[176:177], v42 offset:16384
v_mfma_f32_16x16x32_bf16 a[36:39], a[232:235], a[144:147], a[36:39]
buffer_load_dwordx4 v30, s[48:51], s84 offen offset:0 lds
v_mfma_f32_16x16x32_bf16 a[36:39], a[236:239], a[148:151], a[36:39]
ds_read_b64_tr_b16 a[178:179], v42 offset:17408
v_mfma_f32_16x16x32_bf16 a[40:43], a[240:243], a[144:147], a[40:43]
v_mfma_f32_16x16x32_bf16 a[40:43], a[244:247], a[148:151], a[40:43]
ds_read_b64_tr_b16 a[180:181], v42 offset:24576
v_mfma_f32_16x16x32_bf16 a[44:47], a[248:251], a[144:147], a[44:47]
buffer_load_dwordx4 v31, s[48:51], s84 offen offset:1024 lds
v_mfma_f32_16x16x32_bf16 a[44:47], a[252:255], a[148:151], a[44:47]
ds_read_b64_tr_b16 a[182:183], v42 offset:25600
v_mfma_f32_16x16x32_bf16 a[48:51], a[224:227], a[152:155], a[48:51]
v_mfma_f32_16x16x32_bf16 a[48:51], a[228:231], a[156:159], a[48:51]
ds_read_b64_tr_b16 a[184:185], v43 offset:16384
v_mfma_f32_16x16x32_bf16 a[52:55], a[232:235], a[152:155], a[52:55]
buffer_load_dwordx4 v32, s[48:51], s84 offen offset:2048 lds
v_mfma_f32_16x16x32_bf16 a[52:55], a[236:239], a[156:159], a[52:55]
ds_read_b64_tr_b16 a[186:187], v43 offset:17408
v_mfma_f32_16x16x32_bf16 a[56:59], a[240:243], a[152:155], a[56:59]
v_mfma_f32_16x16x32_bf16 a[56:59], a[244:247], a[156:159], a[56:59]
ds_read_b64_tr_b16 a[188:189], v43 offset:24576
v_mfma_f32_16x16x32_bf16 a[60:63], a[248:251], a[152:155], a[60:63]
buffer_load_dwordx4 v33, s[48:51], s84 offen offset:3072 lds
v_mfma_f32_16x16x32_bf16 a[60:63], a[252:255], a[156:159], a[60:63]
ds_read_b64_tr_b16 a[190:191], v43 offset:25600
v_mfma_f32_16x16x32_bf16 a[64:67], a[224:227], a[192:195], a[64:67]
v_mfma_f32_16x16x32_bf16 a[64:67], a[228:231], a[196:199], a[64:67]
s_add_u32 m0, s87, 32768
ds_read_b128 a[128:131], v38 offset:0
v_mfma_f32_16x16x32_bf16 a[68:71], a[232:235], a[192:195], a[68:71]
buffer_load_dwordx4 v34, s[52:55], s85 offen offset:0 lds
v_mfma_f32_16x16x32_bf16 a[68:71], a[236:239], a[196:199], a[68:71]
ds_read_b128 a[132:135], v39 offset:0
v_mfma_f32_16x16x32_bf16 a[72:75], a[240:243], a[192:195], a[72:75]
v_mfma_f32_16x16x32_bf16 a[72:75], a[244:247], a[196:199], a[72:75]
ds_read_b128 a[136:139], v38 offset:2048
v_mfma_f32_16x16x32_bf16 a[76:79], a[248:251], a[192:195], a[76:79]
buffer_load_dwordx4 v35, s[52:55], s85 offen offset:1024 lds
v_mfma_f32_16x16x32_bf16 a[76:79], a[252:255], a[196:199], a[76:79]
ds_read_b128 a[140:143], v39 offset:2048
v_mfma_f32_16x16x32_bf16 a[80:83], a[224:227], a[200:203], a[80:83]
v_mfma_f32_16x16x32_bf16 a[80:83], a[228:231], a[204:207], a[80:83]
ds_read_b128 a[144:147], v38 offset:4096
v_mfma_f32_16x16x32_bf16 a[84:87], a[232:235], a[200:203], a[84:87]
buffer_load_dwordx4 v36, s[52:55], s85 offen offset:2048 lds
v_mfma_f32_16x16x32_bf16 a[84:87], a[236:239], a[204:207], a[84:87]
ds_read_b128 a[148:151], v39 offset:4096
v_mfma_f32_16x16x32_bf16 a[88:91], a[240:243], a[200:203], a[88:91]
v_mfma_f32_16x16x32_bf16 a[88:91], a[244:247], a[204:207], a[88:91]
ds_read_b128 a[152:155], v38 offset:6144
v_mfma_f32_16x16x32_bf16 a[92:95], a[248:251], a[200:203], a[92:95]
buffer_load_dwordx4 v37, s[52:55], s85 offen offset:3072 lds
v_mfma_f32_16x16x32_bf16 a[92:95], a[252:255], a[204:207], a[92:95]
ds_read_b128 a[156:159], v39 offset:6144
v_mfma_f32_16x16x32_bf16 a[96:99], a[224:227], a[208:211], a[96:99]
v_mfma_f32_16x16x32_bf16 a[96:99], a[228:231], a[212:215], a[96:99]
s_add_u32 m0, s87, 49152
v_mfma_f32_16x16x32_bf16 a[100:103], a[232:235], a[208:211], a[100:103]
buffer_load_dwordx4 v34, s[56:59], s85 offen offset:0 lds
v_mfma_f32_16x16x32_bf16 a[100:103], a[236:239], a[212:215], a[100:103]
v_mfma_f32_16x16x32_bf16 a[104:107], a[240:243], a[208:211], a[104:107]
v_mfma_f32_16x16x32_bf16 a[104:107], a[244:247], a[212:215], a[104:107]
v_mfma_f32_16x16x32_bf16 a[108:111], a[248:251], a[208:211], a[108:111]
buffer_load_dwordx4 v35, s[56:59], s85 offen offset:1024 lds
v_mfma_f32_16x16x32_bf16 a[108:111], a[252:255], a[212:215], a[108:111]
v_mfma_f32_16x16x32_bf16 a[112:115], a[224:227], a[216:219], a[112:115]
v_mfma_f32_16x16x32_bf16 a[112:115], a[228:231], a[220:223], a[112:115]
v_mfma_f32_16x16x32_bf16 a[116:119], a[232:235], a[216:219], a[116:119]
buffer_load_dwordx4 v36, s[56:59], s85 offen offset:2048 lds
v_mfma_f32_16x16x32_bf16 a[116:119], a[236:239], a[220:223], a[116:119]
v_mfma_f32_16x16x32_bf16 a[120:123], a[240:243], a[216:219], a[120:123]
s_waitcnt vmcnt(16)
s_lshl_b32 s18, s93, 10
s_add_u32 s18, s18, 58720256
v_mfma_f32_16x16x32_bf16 a[120:123], a[244:247], a[220:223], a[120:123]
buffer_store_dwordx4 v[20:23], v2, s[60:63], s18 offen sc1
v_mfma_f32_16x16x32_bf16 a[124:127], a[248:251], a[216:219], a[124:127]
buffer_load_dwordx4 v37, s[56:59], s85 offen offset:3072 lds
v_mfma_f32_16x16x32_bf16 a[124:127], a[252:255], a[220:223], a[124:127]
s_add_u32 s84, s84, 128
s_sub_u32 s8, 15, s77
s_lshl_b32 s80, s3, 14
s_waitcnt lgkmcnt(0)
v_mfma_f32_16x16x32_bf16 v[128:131], a[128:131], a[160:163], v[128:131]
s_add_u32 s85, s85, 524288
s_lshl_b32 s18, s8, 17
s_add_u32 s18, s18, s80
v_mfma_f32_16x16x32_bf16 v[128:131], a[132:135], a[164:167], v[128:131]
s_lshl_b32 s19, s77, 17
ds_read_b128 a[192:195], v38 offset:8192
s_add_u32 s19, s19, s80
v_mfma_f32_16x16x32_bf16 v[132:135], a[128:131], a[168:171], v[132:135]
buffer_load_dword v127, v7, s[68:71], s82 offen
v_mfma_f32_16x16x32_bf16 v[132:135], a[132:135], a[172:175], v[132:135]
ds_read_b128 a[196:199], v39 offset:8192
v_xor_b32 v20, 64, v63
v_mfma_f32_16x16x32_bf16 v[136:139], a[128:131], a[176:179], v[136:139]
buffer_load_dword v127, v4, s[72:75], s88 offen
v_mfma_f32_16x16x32_bf16 v[136:139], a[132:135], a[180:183], v[136:139]
s_add_u32 s88, s88, 1048576
ds_read_b128 a[200:203], v38 offset:10240
v_add_u32 v44, s18, v63
v_mfma_f32_16x16x32_bf16 v[140:143], a[128:131], a[184:187], v[140:143]
v_add_u32 v45, s18, v20
v_add_u32 v45, 7168, v45
v_mfma_f32_16x16x32_bf16 v[140:143], a[132:135], a[188:191], v[140:143]
ds_read_b128 a[204:207], v39 offset:10240
v_add_u32 v46, s18, v63
v_mfma_f32_16x16x32_bf16 v[144:147], a[136:139], a[160:163], v[144:147]
v_add_u32 v46, 63488, v46
v_add_u32 v47, s18, v20
v_mfma_f32_16x16x32_bf16 v[144:147], a[140:143], a[164:167], v[144:147]
ds_read_b128 a[208:211], v38 offset:12288
v_add_u32 v47, 70656, v47
v_mfma_f32_16x16x32_bf16 v[148:151], a[136:139], a[168:171], v[148:151]
v_add_u32 v48, s19, v63
v_add_u32 v49, s19, v20
v_mfma_f32_16x16x32_bf16 v[148:151], a[140:143], a[172:175], v[148:151]
ds_read_b128 a[212:215], v39 offset:12288
v_add_u32 v49, 7168, v49
v_mfma_f32_16x16x32_bf16 v[152:155], a[136:139], a[176:179], v[152:155]
v_add_u32 v50, s19, v63
v_add_u32 v50, 63488, v50
v_mfma_f32_16x16x32_bf16 v[152:155], a[140:143], a[180:183], v[152:155]
ds_read_b128 a[216:219], v38 offset:14336
v_add_u32 v51, s19, v20
v_mfma_f32_16x16x32_bf16 v[156:159], a[136:139], a[184:187], v[156:159]
v_add_u32 v51, 70656, v51
s_add_u32 s18, s86, 98304
v_mfma_f32_16x16x32_bf16 v[156:159], a[140:143], a[188:191], v[156:159]
ds_read_b128 a[220:223], v39 offset:14336
v_add_u32 v52, s18, v5
v_mfma_f32_16x16x32_bf16 v[160:163], a[144:147], a[160:163], v[160:163]
v_xor_b32 v53, 64, v52
s_mov_b32 s89, 0
v_mfma_f32_16x16x32_bf16 v[160:163], a[148:151], a[164:167], v[160:163]
ds_read_b64_tr_b16 a[224:225], v40 offset:0
v_add_u32 v54, 49152, v25
v_mfma_f32_16x16x32_bf16 v[164:167], a[144:147], a[168:171], v[164:167]
v_xor_b32 v55, 32, v54
v_xor_b32 v56, 64, v54
v_mfma_f32_16x16x32_bf16 v[164:167], a[148:151], a[172:175], v[164:167]
ds_read_b64_tr_b16 a[226:227], v40 offset:1024
v_xor_b32 v57, 96, v54
v_mfma_f32_16x16x32_bf16 v[168:171], a[144:147], a[176:179], v[168:171]
v_xor_b32 v58, 128, v54
v_xor_b32 v59, 160, v54
v_mfma_f32_16x16x32_bf16 v[168:171], a[148:151], a[180:183], v[168:171]
ds_read_b64_tr_b16 a[228:229], v40 offset:8192
v_xor_b32 v60, 192, v54
v_mfma_f32_16x16x32_bf16 v[172:175], a[144:147], a[184:187], v[172:175]
v_xor_b32 v61, 224, v54
v_mul_f32 v12, v103, v64
v_mfma_f32_16x16x32_bf16 v[172:175], a[148:151], a[188:191], v[172:175]
ds_read_b64_tr_b16 a[230:231], v40 offset:9216
v_mul_f32 v64, v102, v64
v_mfma_f32_16x16x32_bf16 v[176:179], a[152:155], a[160:163], v[176:179]
v_fma_f32 v64, -v103, v68, v64
v_fma_f32 v68, v102, v68, v12
v_mfma_f32_16x16x32_bf16 v[176:179], a[156:159], a[164:167], v[176:179]
ds_read_b64_tr_b16 a[232:233], v41 offset:0
v_mul_f32 v12, v103, v65
v_mfma_f32_16x16x32_bf16 v[180:183], a[152:155], a[168:171], v[180:183]
v_mul_f32 v65, v102, v65
v_fma_f32 v65, -v103, v69, v65
v_mfma_f32_16x16x32_bf16 v[180:183], a[156:159], a[172:175], v[180:183]
ds_read_b64_tr_b16 a[234:235], v41 offset:1024
v_fma_f32 v69, v102, v69, v12
v_mfma_f32_16x16x32_bf16 v[184:187], a[152:155], a[176:179], v[184:187]
v_mul_f32 v12, v103, v66
v_mul_f32 v66, v102, v66
v_mfma_f32_16x16x32_bf16 v[184:187], a[156:159], a[180:183], v[184:187]
ds_read_b64_tr_b16 a[236:237], v41 offset:8192
v_fma_f32 v66, -v103, v70, v66
v_mfma_f32_16x16x32_bf16 v[188:191], a[152:155], a[184:187], v[188:191]
v_fma_f32 v70, v102, v70, v12
v_mul_f32 v12, v103, v67
v_mfma_f32_16x16x32_bf16 v[188:191], a[156:159], a[188:191], v[188:191]
s_waitcnt lgkmcnt(1)
ds_read_b64_tr_b16 a[238:239], v41 offset:9216
v_mul_f32 v67, v102, v67
v_mfma_f32_16x16x32_bf16 v[192:195], a[192:195], a[160:163], v[192:195]
v_fma_f32 v67, -v103, v71, v67
v_fma_f32 v71, v102, v71, v12
v_mfma_f32_16x16x32_bf16 v[192:195], a[196:199], a[164:167], v[192:195]
ds_read_b64_tr_b16 a[240:241], v42 offset:0
v_mul_f32 v12, v103, v72
v_mfma_f32_16x16x32_bf16 v[196:199], a[192:195], a[168:171], v[196:199]
v_mul_f32 v72, v102, v72
v_fma_f32 v72, -v103, v76, v72
v_mfma_f32_16x16x32_bf16 v[196:199], a[196:199], a[172:175], v[196:199]
ds_read_b64_tr_b16 a[242:243], v42 offset:1024
v_fma_f32 v76, v102, v76, v12
v_mfma_f32_16x16x32_bf16 v[200:203], a[192:195], a[176:179], v[200:203]
v_mul_f32 v12, v103, v73
v_mul_f32 v73, v102, v73
v_mfma_f32_16x16x32_bf16 v[200:203], a[196:199], a[180:183], v[200:203]
ds_read_b64_tr_b16 a[244:245], v42 offset:8192
v_fma_f32 v73, -v103, v77, v73
v_mfma_f32_16x16x32_bf16 v[204:207], a[192:195], a[184:187], v[204:207]
v_fma_f32 v77, v102, v77, v12
v_mul_f32 v12, v103, v74
v_mfma_f32_16x16x32_bf16 v[204:207], a[196:199], a[188:191], v[204:207]
ds_read_b64_tr_b16 a[246:247], v42 offset:9216
v_mul_f32 v74, v102, v74
v_mfma_f32_16x16x32_bf16 v[208:211], a[200:203], a[160:163], v[208:211]
v_fma_f32 v74, -v103, v78, v74
v_fma_f32 v78, v102, v78, v12
v_mfma_f32_16x16x32_bf16 v[208:211], a[204:207], a[164:167], v[208:211]
ds_read_b64_tr_b16 a[248:249], v43 offset:0
v_mul_f32 v12, v103, v75
v_mfma_f32_16x16x32_bf16 v[212:215], a[200:203], a[168:171], v[212:215]
v_mul_f32 v75, v102, v75
v_fma_f32 v75, -v103, v79, v75
v_mfma_f32_16x16x32_bf16 v[212:215], a[204:207], a[172:175], v[212:215]
ds_read_b64_tr_b16 a[250:251], v43 offset:1024
v_fma_f32 v79, v102, v79, v12
v_mfma_f32_16x16x32_bf16 v[216:219], a[200:203], a[176:179], v[216:219]
v_mul_f32 v12, v103, v80
v_mul_f32 v80, v102, v80
v_mfma_f32_16x16x32_bf16 v[216:219], a[204:207], a[180:183], v[216:219]
ds_read_b64_tr_b16 a[252:253], v43 offset:8192
v_fma_f32 v80, -v103, v84, v80
v_mfma_f32_16x16x32_bf16 v[220:223], a[200:203], a[184:187], v[220:223]
v_fma_f32 v84, v102, v84, v12
v_mul_f32 v12, v103, v81
v_mfma_f32_16x16x32_bf16 v[220:223], a[204:207], a[188:191], v[220:223]
ds_read_b64_tr_b16 a[254:255], v43 offset:9216
v_mul_f32 v81, v102, v81
v_mfma_f32_16x16x32_bf16 v[224:227], a[208:211], a[160:163], v[224:227]
v_fma_f32 v81, -v103, v85, v81
v_fma_f32 v85, v102, v85, v12
v_mfma_f32_16x16x32_bf16 v[224:227], a[212:215], a[164:167], v[224:227]
v_mul_f32 v12, v103, v82
v_mul_f32 v82, v102, v82
v_mfma_f32_16x16x32_bf16 v[228:231], a[208:211], a[168:171], v[228:231]
v_fma_f32 v82, -v103, v86, v82
v_fma_f32 v86, v102, v86, v12
v_mfma_f32_16x16x32_bf16 v[228:231], a[212:215], a[172:175], v[228:231]
v_mul_f32 v12, v103, v83
v_mul_f32 v83, v102, v83
v_mfma_f32_16x16x32_bf16 v[232:235], a[208:211], a[176:179], v[232:235]
v_xor_b32 v38, 0x10000, v38
v_fma_f32 v83, -v103, v87, v83
v_mfma_f32_16x16x32_bf16 v[232:235], a[212:215], a[180:183], v[232:235]
v_xor_b32 v39, 0x10000, v39
v_fma_f32 v87, v102, v87, v12
v_mfma_f32_16x16x32_bf16 v[236:239], a[208:211], a[184:187], v[236:239]
v_xor_b32 v40, 0x10000, v40
v_mul_f32 v12, v103, v88
v_mfma_f32_16x16x32_bf16 v[236:239], a[212:215], a[188:191], v[236:239]
v_xor_b32 v41, 0x10000, v41
v_mul_f32 v88, v102, v88
v_mfma_f32_16x16x32_bf16 v[240:243], a[216:219], a[160:163], v[240:243]
v_xor_b32 v42, 0x10000, v42
v_fma_f32 v88, -v103, v92, v88
v_mfma_f32_16x16x32_bf16 v[240:243], a[220:223], a[164:167], v[240:243]
v_xor_b32 v43, 0x10000, v43
v_fma_f32 v92, v102, v92, v12
v_mfma_f32_16x16x32_bf16 v[244:247], a[216:219], a[168:171], v[244:247]
v_mul_f32 v12, v103, v89
v_mul_f32 v89, v102, v89
v_mfma_f32_16x16x32_bf16 v[244:247], a[220:223], a[172:175], v[244:247]
v_fma_f32 v89, -v103, v93, v89
v_fma_f32 v93, v102, v93, v12
v_mfma_f32_16x16x32_bf16 v[248:251], a[216:219], a[176:179], v[248:251]
v_mul_f32 v12, v103, v90
v_mul_f32 v90, v102, v90
v_mfma_f32_16x16x32_bf16 v[248:251], a[220:223], a[180:183], v[248:251]
v_fma_f32 v90, -v103, v94, v90
v_fma_f32 v94, v102, v94, v12
v_mfma_f32_16x16x32_bf16 v[252:255], a[216:219], a[184:187], v[252:255]
s_waitcnt vmcnt(2) lgkmcnt(0)
v_mul_f32 v12, v103, v91
v_mul_f32 v91, v102, v91
v_mfma_f32_16x16x32_bf16 v[252:255], a[220:223], a[188:191], v[252:255]
s_barrier
v_mfma_f32_16x16x32_bf16 a[0:3], a[224:227], a[128:131], a[0:3]
v_fma_f32 v91, -v103, v95, v91
v_fma_f32 v95, v102, v95, v12
v_mfma_f32_16x16x32_bf16 a[0:3], a[228:231], a[132:135], a[0:3]
s_add_u32 m0, s86, 65536
ds_read_b64_tr_b16 a[160:161], v40 offset:16384
v_mul_f32 v112, v100, v100
v_mfma_f32_16x16x32_bf16 a[4:7], a[232:235], a[128:131], a[4:7]
buffer_load_dwordx4 v26, s[48:51], s84 offen offset:0 lds
v_mfma_f32_16x16x32_bf16 a[4:7], a[236:239], a[132:135], a[4:7]
ds_read_b64_tr_b16 a[162:163], v40 offset:17408
v_mul_f32 v113, v100, v101
v_mfma_f32_16x16x32_bf16 a[8:11], a[240:243], a[128:131], a[8:11]
v_fma_f32 v112, -v101, v101, v112
v_fma_f32 v113, v101, v100, v113
v_mfma_f32_16x16x32_bf16 a[8:11], a[244:247], a[132:135], a[8:11]
ds_read_b64_tr_b16 a[164:165], v40 offset:24576
v_mul_f32 v116, v112, v112
v_mfma_f32_16x16x32_bf16 a[12:15], a[248:251], a[128:131], a[12:15]
buffer_load_dwordx4 v27, s[48:51], s84 offen offset:1024 lds
v_mfma_f32_16x16x32_bf16 a[12:15], a[252:255], a[132:135], a[12:15]
ds_read_b64_tr_b16 a[166:167], v40 offset:25600
v_mul_f32 v117, v112, v113
v_mfma_f32_16x16x32_bf16 a[16:19], a[224:227], a[136:139], a[16:19]
v_fma_f32 v116, -v113, v113, v116
v_fma_f32 v117, v113, v112, v117
v_mfma_f32_16x16x32_bf16 a[16:19], a[228:231], a[140:143], a[16:19]
ds_read_b64_tr_b16 a[168:169], v41 offset:16384
v_mul_f32 v118, v116, v116
v_mfma_f32_16x16x32_bf16 a[20:23], a[232:235], a[136:139], a[20:23]
buffer_load_dwordx4 v28, s[48:51], s84 offen offset:2048 lds
v_mfma_f32_16x16x32_bf16 a[20:23], a[236:239], a[140:143], a[20:23]
ds_read_b64_tr_b16 a[170:171], v41 offset:17408
v_mul_f32 v119, v116, v117
v_mfma_f32_16x16x32_bf16 a[24:27], a[240:243], a[136:139], a[24:27]
v_fma_f32 v118, -v117, v117, v118
v_fma_f32 v119, v117, v116, v119
v_mfma_f32_16x16x32_bf16 a[24:27], a[244:247], a[140:143], a[24:27]
s_sub_u32 s18, s78, 4
ds_read_b64_tr_b16 a[172:173], v41 offset:24576
s_lshl_b32 s18, s18, 12
v_mfma_f32_16x16x32_bf16 a[28:31], a[248:251], a[136:139], a[28:31]
buffer_load_dwordx4 v29, s[48:51], s84 offen offset:3072 lds
v_mfma_f32_16x16x32_bf16 a[28:31], a[252:255], a[140:143], a[28:31]
s_add_u32 s18, s18, s91
ds_read_b64_tr_b16 a[174:175], v41 offset:25600
v_add_u32 v16, s18, v24
v_mfma_f32_16x16x32_bf16 a[32:35], a[224:227], a[144:147], a[32:35]
v_lshlrev_b32 v17, 14, v3
v_sub_u32 v16, v16, v17
v_mfma_f32_16x16x32_bf16 a[32:35], a[228:231], a[148:151], a[32:35]
s_add_u32 m0, s86, 69632
ds_read_b64_tr_b16 a[176:177], v42 offset:16384
v_add_u32 v17, 4096, v16
v_mfma_f32_16x16x32_bf16 a[36:39], a[232:235], a[144:147], a[36:39]
buffer_load_dwordx4 v30, s[48:51], s84 offen offset:0 lds
v_mfma_f32_16x16x32_bf16 a[36:39], a[236:239], a[148:151], a[36:39]
ds_read_b64_tr_b16 a[178:179], v42 offset:17408
v_add_u32 v18, 8192, v16
v_mfma_f32_16x16x32_bf16 a[40:43], a[240:243], a[144:147], a[40:43]
v_add_u32 v19, 12288, v16
v_and_b32 v14, 7, v1
v_mfma_f32_16x16x32_bf16 a[40:43], a[244:247], a[148:151], a[40:43]
ds_read_b64_tr_b16 a[180:181], v42 offset:24576
v_bfe_u32 v15, v1, 3, 2
v_mfma_f32_16x16x32_bf16 a[44:47], a[248:251], a[144:147], a[44:47]
buffer_load_dwordx4 v31, s[48:51], s84 offen offset:1024 lds
v_mfma_f32_16x16x32_bf16 a[44:47], a[252:255], a[148:151], a[44:47]
ds_read_b64_tr_b16 a[182:183], v42 offset:25600
v_lshlrev_b32 v14, 2, v14
v_mfma_f32_16x16x32_bf16 a[48:51], a[224:227], a[152:155], a[48:51]
v_lshl_add_u32 v14, v15, 7, v14
s_lshr_b32 s18, s76, 2
v_mfma_f32_16x16x32_bf16 a[48:51], a[228:231], a[156:159], a[48:51]
s_lshl_b32 s18, s18, 9
ds_read_b64_tr_b16 a[184:185], v43 offset:16384
v_add_u32 v14, s18, v14
v_mfma_f32_16x16x32_bf16 a[52:55], a[232:235], a[152:155], a[52:55]
buffer_load_dwordx4 v32, s[48:51], s84 offen offset:2048 lds
v_mfma_f32_16x16x32_bf16 a[52:55], a[236:239], a[156:159], a[52:55]
ds_read_b64_tr_b16 a[186:187], v43 offset:17408
v_and_b32 v112, 3, v1
v_mfma_f32_16x16x32_bf16 a[56:59], a[240:243], a[152:155], a[56:59]
v_bfe_u32 v113, v1, 3, 1
v_lshl_add_u32 v112, v113, 2, v112
v_mfma_f32_16x16x32_bf16 a[56:59], a[244:247], a[156:159], a[56:59]
ds_read_b64_tr_b16 a[188:189], v43 offset:24576
v_xor_b32 v62, v112, v62
v_mfma_f32_16x16x32_bf16 a[60:63], a[248:251], a[152:155], a[60:63]
buffer_load_dwordx4 v33, s[48:51], s84 offen offset:3072 lds
v_mfma_f32_16x16x32_bf16 a[60:63], a[252:255], a[156:159], a[60:63]
ds_read_b64_tr_b16 a[190:191], v43 offset:25600
v_lshlrev_b32 v62, 5, v62
v_mfma_f32_16x16x32_bf16 a[64:67], a[224:227], a[192:195], a[64:67]
v_lshl_add_u32 v62, v24, 5, v62
s_and_b32 s18, s3, 1
v_mfma_f32_16x16x32_bf16 a[64:67], a[228:231], a[196:199], a[64:67]
s_add_u32 m0, s87, 98304
ds_read_b128 a[128:131], v38 offset:0
s_lshl_b32 s18, s18, 12
v_mfma_f32_16x16x32_bf16 a[68:71], a[232:235], a[192:195], a[68:71]
buffer_load_dwordx4 v34, s[52:55], s85 offen offset:0 lds
v_mfma_f32_16x16x32_bf16 a[68:71], a[236:239], a[196:199], a[68:71]
s_add_u32 s18, s18, 32768
ds_read_b128 a[132:135], v39 offset:0
v_add_u32 v62, s18, v62
v_mfma_f32_16x16x32_bf16 a[72:75], a[240:243], a[192:195], a[72:75]
s_lshl_b32 s18, s3, 6
v_xor_b32 v63, s18, v25
v_add_u32 v63, 32768, v63
v_mfma_f32_16x16x32_bf16 a[72:75], a[244:247], a[196:199], a[72:75]
ds_read_b128 a[136:139], v38 offset:2048
v_xor_b32 v24, 32, v63
v_mfma_f32_16x16x32_bf16 a[76:79], a[248:251], a[192:195], a[76:79]
buffer_load_dwordx4 v35, s[52:55], s85 offen offset:1024 lds
v_mfma_f32_16x16x32_bf16 a[76:79], a[252:255], a[196:199], a[76:79]
s_lshl_b32 s91, s78, 1
ds_read_b128 a[140:143], v39 offset:2048
s_lshr_b32 s18, s3, 1
v_mfma_f32_16x16x32_bf16 a[80:83], a[224:227], a[200:203], a[80:83]
s_add_u32 s91, s91, s18
s_lshl_b32 s91, s91, 5
s_add_u32 s91, s91, s79
v_mfma_f32_16x16x32_bf16 a[80:83], a[228:231], a[204:207], a[80:83]
s_lshl_b32 s91, s91, 12
ds_read_b128 a[144:147], v38 offset:4096
s_and_b32 s18, s3, 1
v_mfma_f32_16x16x32_bf16 a[84:87], a[232:235], a[200:203], a[84:87]
buffer_load_dwordx4 v36, s[52:55], s85 offen offset:2048 lds
v_mfma_f32_16x16x32_bf16 a[84:87], a[236:239], a[204:207], a[84:87]
s_lshl_b32 s18, s18, 11
ds_read_b128 a[148:151], v39 offset:4096
s_add_u32 s91, s91, s18
v_mfma_f32_16x16x32_bf16 a[88:91], a[240:243], a[200:203], a[88:91]
s_add_u32 s91, s91, 50331648
s_lshl_b32 s18, s77, 15
s_lshl_b32 s19, s76, 20
v_mfma_f32_16x16x32_bf16 a[88:91], a[244:247], a[204:207], a[88:91]
s_add_u32 s18, s18, s19
ds_read_b128 a[152:155], v38 offset:6144
s_lshr_b32 s19, s3, 1
v_mfma_f32_16x16x32_bf16 a[92:95], a[248:251], a[200:203], a[92:95]
buffer_load_dwordx4 v37, s[52:55], s85 offen offset:3072 lds
v_mfma_f32_16x16x32_bf16 a[92:95], a[252:255], a[204:207], a[92:95]
s_lshl_b32 s93, s19, 11
ds_read_b128 a[156:159], v39 offset:6144
s_add_u32 s93, s93, s18
v_mfma_f32_16x16x32_bf16 a[96:99], a[224:227], a[208:211], a[96:99]
s_lshl_b32 s94, s19, 13
s_add_u32 s94, s94, s18
s_add_u32 s94, s94, 16384
v_mfma_f32_16x16x32_bf16 a[96:99], a[228:231], a[212:215], a[96:99]
s_add_u32 m0, s87, 114688
s_and_b32 s19, s3, 1
s_lshl_b32 s18, s19, 13
v_mfma_f32_16x16x32_bf16 a[100:103], a[232:235], a[208:211], a[100:103]
buffer_load_dwordx4 v34, s[56:59], s85 offen offset:0 lds
v_mfma_f32_16x16x32_bf16 a[100:103], a[236:239], a[212:215], a[100:103]
s_add_u32 s93, s93, s18
s_lshl_b32 s18, s19, 10
s_add_u32 s94, s94, s18
v_mfma_f32_16x16x32_bf16 a[104:107], a[240:243], a[208:211], a[104:107]
s_mov_b32 s19, 59834368
v_mfma_f32_16x16x32_bf16 a[104:107], a[244:247], a[212:215], a[104:107]
buffer_load_dword v13, v10, s[60:63], s19 offen sc1
v_mfma_f32_16x16x32_bf16 a[108:111], a[248:251], a[208:211], a[108:111]
buffer_load_dwordx4 v35, s[56:59], s85 offen offset:1024 lds
v_mfma_f32_16x16x32_bf16 a[108:111], a[252:255], a[212:215], a[108:111]
v_mfma_f32_16x16x32_bf16 a[112:115], a[224:227], a[216:219], a[112:115]
v_mfma_f32_16x16x32_bf16 a[112:115], a[228:231], a[220:223], a[112:115]
v_mfma_f32_16x16x32_bf16 a[116:119], a[232:235], a[216:219], a[116:119]
buffer_load_dwordx4 v36, s[56:59], s85 offen offset:2048 lds
v_mfma_f32_16x16x32_bf16 a[116:119], a[236:239], a[220:223], a[116:119]
v_mfma_f32_16x16x32_bf16 a[120:123], a[240:243], a[216:219], a[120:123]
v_mfma_f32_16x16x32_bf16 a[120:123], a[244:247], a[220:223], a[120:123]
s_waitcnt lgkmcnt(0)
v_mfma_f32_16x16x32_bf16 a[124:127], a[248:251], a[216:219], a[124:127]
buffer_load_dwordx4 v37, s[56:59], s85 offen offset:3072 lds
v_mfma_f32_16x16x32_bf16 a[124:127], a[252:255], a[220:223], a[124:127]
s_add_u32 s84, s84, 128
v_mfma_f32_16x16x32_bf16 v[128:131], a[128:131], a[160:163], v[128:131]
s_add_u32 s85, s85, 524288
v_mfma_f32_16x16x32_bf16 v[128:131], a[132:135], a[164:167], v[128:131]
ds_read_b128 a[192:195], v38 offset:8192
v_mfma_f32_16x16x32_bf16 v[132:135], a[128:131], a[168:171], v[132:135]
buffer_load_dword v127, v4, s[72:75], s88 offen
v_mfma_f32_16x16x32_bf16 v[132:135], a[132:135], a[172:175], v[132:135]
s_add_u32 s88, s88, 1048576
ds_read_b128 a[196:199], v39 offset:8192
v_mfma_f32_16x16x32_bf16 v[136:139], a[128:131], a[176:179], v[136:139]
buffer_load_dword v127, v7, s[68:71], s82 offen offset:512
v_mfma_f32_16x16x32_bf16 v[136:139], a[132:135], a[180:183], v[136:139]
ds_read_b128 a[200:203], v38 offset:10240
v_mfma_f32_16x16x32_bf16 v[140:143], a[128:131], a[184:187], v[140:143]
v_mfma_f32_16x16x32_bf16 v[140:143], a[132:135], a[188:191], v[140:143]
ds_read_b128 a[204:207], v39 offset:10240
v_mfma_f32_16x16x32_bf16 v[144:147], a[136:139], a[160:163], v[144:147]
v_mfma_f32_16x16x32_bf16 v[144:147], a[140:143], a[164:167], v[144:147]
ds_read_b128 a[208:211], v38 offset:12288
v_mfma_f32_16x16x32_bf16 v[148:151], a[136:139], a[168:171], v[148:151]
v_mfma_f32_16x16x32_bf16 v[148:151], a[140:143], a[172:175], v[148:151]
ds_read_b128 a[212:215], v39 offset:12288
v_mfma_f32_16x16x32_bf16 v[152:155], a[136:139], a[176:179], v[152:155]
v_mfma_f32_16x16x32_bf16 v[152:155], a[140:143], a[180:183], v[152:155]
ds_read_b128 a[216:219], v38 offset:14336
v_mfma_f32_16x16x32_bf16 v[156:159], a[136:139], a[184:187], v[156:159]
v_mfma_f32_16x16x32_bf16 v[156:159], a[140:143], a[188:191], v[156:159]
ds_read_b128 a[220:223], v39 offset:14336
v_mfma_f32_16x16x32_bf16 v[160:163], a[144:147], a[160:163], v[160:163]
v_mfma_f32_16x16x32_bf16 v[160:163], a[148:151], a[164:167], v[160:163]
ds_read_b64_tr_b16 a[224:225], v40 offset:0
v_mfma_f32_16x16x32_bf16 v[164:167], a[144:147], a[168:171], v[164:167]
v_mfma_f32_16x16x32_bf16 v[164:167], a[148:151], a[172:175], v[164:167]
ds_read_b64_tr_b16 a[226:227], v40 offset:1024
v_mfma_f32_16x16x32_bf16 v[168:171], a[144:147], a[176:179], v[168:171]
v_mfma_f32_16x16x32_bf16 v[168:171], a[148:151], a[180:183], v[168:171]
ds_read_b64_tr_b16 a[228:229], v40 offset:8192
v_mfma_f32_16x16x32_bf16 v[172:175], a[144:147], a[184:187], v[172:175]
v_mfma_f32_16x16x32_bf16 v[172:175], a[148:151], a[188:191], v[172:175]
ds_read_b64_tr_b16 a[230:231], v40 offset:9216
v_mfma_f32_16x16x32_bf16 v[176:179], a[152:155], a[160:163], v[176:179]
v_mfma_f32_16x16x32_bf16 v[176:179], a[156:159], a[164:167], v[176:179]
ds_read_b64_tr_b16 a[232:233], v41 offset:0
v_mfma_f32_16x16x32_bf16 v[180:183], a[152:155], a[168:171], v[180:183]
v_mfma_f32_16x16x32_bf16 v[180:183], a[156:159], a[172:175], v[180:183]
ds_read_b64_tr_b16 a[234:235], v41 offset:1024
v_mfma_f32_16x16x32_bf16 v[184:187], a[152:155], a[176:179], v[184:187]
v_mfma_f32_16x16x32_bf16 v[184:187], a[156:159], a[180:183], v[184:187]
ds_read_b64_tr_b16 a[236:237], v41 offset:8192
v_mfma_f32_16x16x32_bf16 v[188:191], a[152:155], a[184:187], v[188:191]
v_mfma_f32_16x16x32_bf16 v[188:191], a[156:159], a[188:191], v[188:191]
s_waitcnt lgkmcnt(1)
ds_read_b64_tr_b16 a[238:239], v41 offset:9216
v_mfma_f32_16x16x32_bf16 v[192:195], a[192:195], a[160:163], v[192:195]
v_mfma_f32_16x16x32_bf16 v[192:195], a[196:199], a[164:167], v[192:195]
ds_read_b64_tr_b16 a[240:241], v42 offset:0
v_mfma_f32_16x16x32_bf16 v[196:199], a[192:195], a[168:171], v[196:199]
v_mfma_f32_16x16x32_bf16 v[196:199], a[196:199], a[172:175], v[196:199]
ds_read_b64_tr_b16 a[242:243], v42 offset:1024
v_mfma_f32_16x16x32_bf16 v[200:203], a[192:195], a[176:179], v[200:203]
v_mfma_f32_16x16x32_bf16 v[200:203], a[196:199], a[180:183], v[200:203]
ds_read_b64_tr_b16 a[244:245], v42 offset:8192
v_mfma_f32_16x16x32_bf16 v[204:207], a[192:195], a[184:187], v[204:207]
v_mfma_f32_16x16x32_bf16 v[204:207], a[196:199], a[188:191], v[204:207]
ds_read_b64_tr_b16 a[246:247], v42 offset:9216
v_mfma_f32_16x16x32_bf16 v[208:211], a[200:203], a[160:163], v[208:211]
v_mfma_f32_16x16x32_bf16 v[208:211], a[204:207], a[164:167], v[208:211]
ds_read_b64_tr_b16 a[248:249], v43 offset:0
v_mfma_f32_16x16x32_bf16 v[212:215], a[200:203], a[168:171], v[212:215]
v_mfma_f32_16x16x32_bf16 v[212:215], a[204:207], a[172:175], v[212:215]
ds_read_b64_tr_b16 a[250:251], v43 offset:1024
v_mfma_f32_16x16x32_bf16 v[216:219], a[200:203], a[176:179], v[216:219]
v_mfma_f32_16x16x32_bf16 v[216:219], a[204:207], a[180:183], v[216:219]
ds_read_b64_tr_b16 a[252:253], v43 offset:8192
v_mfma_f32_16x16x32_bf16 v[220:223], a[200:203], a[184:187], v[220:223]
v_mfma_f32_16x16x32_bf16 v[220:223], a[204:207], a[188:191], v[220:223]
ds_read_b64_tr_b16 a[254:255], v43 offset:9216
v_mfma_f32_16x16x32_bf16 v[224:227], a[208:211], a[160:163], v[224:227]
v_mfma_f32_16x16x32_bf16 v[224:227], a[212:215], a[164:167], v[224:227]
v_mfma_f32_16x16x32_bf16 v[228:231], a[208:211], a[168:171], v[228:231]
v_mfma_f32_16x16x32_bf16 v[228:231], a[212:215], a[172:175], v[228:231]
v_mfma_f32_16x16x32_bf16 v[232:235], a[208:211], a[176:179], v[232:235]
v_xor_b32 v38, 0x10000, v38
v_mfma_f32_16x16x32_bf16 v[232:235], a[212:215], a[180:183], v[232:235]
v_xor_b32 v39, 0x10000, v39
v_mfma_f32_16x16x32_bf16 v[236:239], a[208:211], a[184:187], v[236:239]
v_xor_b32 v40, 0x10000, v40
v_mfma_f32_16x16x32_bf16 v[236:239], a[212:215], a[188:191], v[236:239]
v_xor_b32 v41, 0x10000, v41
v_mfma_f32_16x16x32_bf16 v[240:243], a[216:219], a[160:163], v[240:243]
v_xor_b32 v42, 0x10000, v42
v_mfma_f32_16x16x32_bf16 v[240:243], a[220:223], a[164:167], v[240:243]
v_xor_b32 v43, 0x10000, v43
v_mfma_f32_16x16x32_bf16 v[244:247], a[216:219], a[168:171], v[244:247]
v_mfma_f32_16x16x32_bf16 v[244:247], a[220:223], a[172:175], v[244:247]
v_mfma_f32_16x16x32_bf16 v[248:251], a[216:219], a[176:179], v[248:251]
v_mfma_f32_16x16x32_bf16 v[248:251], a[220:223], a[180:183], v[248:251]
v_mfma_f32_16x16x32_bf16 v[252:255], a[216:219], a[184:187], v[252:255]
s_waitcnt vmcnt(2) lgkmcnt(0)
v_mfma_f32_16x16x32_bf16 v[252:255], a[220:223], a[188:191], v[252:255]
s_barrier
v_mfma_f32_16x16x32_bf16 a[0:3], a[224:227], a[128:131], a[0:3]
s_waitcnt vmcnt(5)
v_cmp_gt_u32 vcc, 256, v13
v_mfma_f32_16x16x32_bf16 a[0:3], a[228:231], a[132:135], a[0:3]
s_add_u32 m0, s86, 0
ds_read_b64_tr_b16 a[160:161], v40 offset:16384
v_mfma_f32_16x16x32_bf16 a[4:7], a[232:235], a[128:131], a[4:7]
buffer_load_dwordx4 v26, s[48:51], s84 offen offset:0 lds
v_mfma_f32_16x16x32_bf16 a[4:7], a[236:239], a[132:135], a[4:7]
ds_read_b64_tr_b16 a[162:163], v40 offset:17408
v_mfma_f32_16x16x32_bf16 a[8:11], a[240:243], a[128:131], a[8:11]
s_cbranch_vccnz Lspin2
Lgo3:
v_mfma_f32_16x16x32_bf16 a[8:11], a[244:247], a[132:135], a[8:11]
ds_read_b64_tr_b16 a[164:165], v40 offset:24576
v_mfma_f32_16x16x32_bf16 a[12:15], a[248:251], a[128:131], a[12:15]
buffer_load_dwordx4 v27, s[48:51], s84 offen offset:1024 lds
v_mfma_f32_16x16x32_bf16 a[12:15], a[252:255], a[132:135], a[12:15]
ds_read_b64_tr_b16 a[166:167], v40 offset:25600
v_mfma_f32_16x16x32_bf16 a[16:19], a[224:227], a[136:139], a[16:19]
buffer_load_dwordx2 v[108:109], v16, s[44:47], 0 offen sc1
v_mfma_f32_16x16x32_bf16 a[16:19], a[228:231], a[140:143], a[16:19]
ds_read_b64_tr_b16 a[168:169], v41 offset:16384
v_mfma_f32_16x16x32_bf16 a[20:23], a[232:235], a[136:139], a[20:23]
buffer_load_dwordx4 v28, s[48:51], s84 offen offset:2048 lds
v_mfma_f32_16x16x32_bf16 a[20:23], a[236:239], a[140:143], a[20:23]
ds_read_b64_tr_b16 a[170:171], v41 offset:17408
v_mfma_f32_16x16x32_bf16 a[24:27], a[240:243], a[136:139], a[24:27]
buffer_load_dwordx2 v[110:111], v17, s[44:47], 0 offen sc1
v_mfma_f32_16x16x32_bf16 a[24:27], a[244:247], a[140:143], a[24:27]
ds_read_b64_tr_b16 a[172:173], v41 offset:24576
v_mfma_f32_16x16x32_bf16 a[28:31], a[248:251], a[136:139], a[28:31]
buffer_load_dwordx4 v29, s[48:51], s84 offen offset:3072 lds
v_mfma_f32_16x16x32_bf16 a[28:31], a[252:255], a[140:143], a[28:31]
ds_read_b64_tr_b16 a[174:175], v41 offset:25600
v_mfma_f32_16x16x32_bf16 a[32:35], a[224:227], a[144:147], a[32:35]
buffer_load_dwordx2 v[120:121], v18, s[44:47], 0 offen sc1
v_mfma_f32_16x16x32_bf16 a[32:35], a[228:231], a[148:151], a[32:35]
s_add_u32 m0, s86, 4096
ds_read_b64_tr_b16 a[176:177], v42 offset:16384
v_mfma_f32_16x16x32_bf16 a[36:39], a[232:235], a[144:147], a[36:39]
buffer_load_dwordx4 v30, s[48:51], s84 offen offset:0 lds
v_mfma_f32_16x16x32_bf16 a[36:39], a[236:239], a[148:151], a[36:39]
ds_read_b64_tr_b16 a[178:179], v42 offset:17408
v_mfma_f32_16x16x32_bf16 a[40:43], a[240:243], a[144:147], a[40:43]
buffer_load_dwordx2 v[122:123], v19, s[44:47], 0 offen sc1
v_mfma_f32_16x16x32_bf16 a[40:43], a[244:247], a[148:151], a[40:43]
ds_read_b64_tr_b16 a[180:181], v42 offset:24576
v_mfma_f32_16x16x32_bf16 a[44:47], a[248:251], a[144:147], a[44:47]
buffer_load_dwordx4 v31, s[48:51], s84 offen offset:1024 lds
v_mfma_f32_16x16x32_bf16 a[44:47], a[252:255], a[148:151], a[44:47]
ds_read_b64_tr_b16 a[182:183], v42 offset:25600
v_mfma_f32_16x16x32_bf16 a[48:51], a[224:227], a[152:155], a[48:51]
buffer_load_dword v13, v14, s[60:63], s19 offen sc1
v_mfma_f32_16x16x32_bf16 a[48:51], a[228:231], a[156:159], a[48:51]
ds_read_b64_tr_b16 a[184:185], v43 offset:16384
v_mfma_f32_16x16x32_bf16 a[52:55], a[232:235], a[152:155], a[52:55]
buffer_load_dwordx4 v32, s[48:51], s84 offen offset:2048 lds
v_mfma_f32_16x16x32_bf16 a[52:55], a[236:239], a[156:159], a[52:55]
ds_read_b64_tr_b16 a[186:187], v43 offset:17408
v_mfma_f32_16x16x32_bf16 a[56:59], a[240:243], a[152:155], a[56:59]
v_mfma_f32_16x16x32_bf16 a[56:59], a[244:247], a[156:159], a[56:59]
ds_read_b64_tr_b16 a[188:189], v43 offset:24576
v_mfma_f32_16x16x32_bf16 a[60:63], a[248:251], a[152:155], a[60:63]
buffer_load_dwordx4 v33, s[48:51], s84 offen offset:3072 lds
v_mfma_f32_16x16x32_bf16 a[60:63], a[252:255], a[156:159], a[60:63]
ds_read_b64_tr_b16 a[190:191], v43 offset:25600
v_mfma_f32_16x16x32_bf16 a[64:67], a[224:227], a[192:195], a[64:67]
v_mfma_f32_16x16x32_bf16 a[64:67], a[228:231], a[196:199], a[64:67]
s_add_u32 m0, s87, 32768
ds_read_b128 a[128:131], v38 offset:0
v_mfma_f32_16x16x32_bf16 a[68:71], a[232:235], a[192:195], a[68:71]
buffer_load_dwordx4 v34, s[52:55], s85 offen offset:0 lds
v_mfma_f32_16x16x32_bf16 a[68:71], a[236:239], a[196:199], a[68:71]
ds_read_b128 a[132:135], v39 offset:0
v_mfma_f32_16x16x32_bf16 a[72:75], a[240:243], a[192:195], a[72:75]
v_mfma_f32_16x16x32_bf16 a[72:75], a[244:247], a[196:199], a[72:75]
ds_read_b128 a[136:139], v38 offset:2048
v_mfma_f32_16x16x32_bf16 a[76:79], a[248:251], a[192:195], a[76:79]
buffer_load_dwordx4 v35, s[52:55], s85 offen offset:1024 lds
v_mfma_f32_16x16x32_bf16 a[76:79], a[252:255], a[196:199], a[76:79]
ds_read_b128 a[140:143], v39 offset:2048
v_mfma_f32_16x16x32_bf16 a[80:83], a[224:227], a[200:203], a[80:83]
v_mfma_f32_16x16x32_bf16 a[80:83], a[228:231], a[204:207], a[80:83]
ds_read_b128 a[144:147], v38 offset:4096
v_mfma_f32_16x16x32_bf16 a[84:87], a[232:235], a[200:203], a[84:87]
buffer_load_dwordx4 v36, s[52:55], s85 offen offset:2048 lds
v_mfma_f32_16x16x32_bf16 a[84:87], a[236:239], a[204:207], a[84:87]
ds_read_b128 a[148:151], v39 offset:4096
v_mfma_f32_16x16x32_bf16 a[88:91], a[240:243], a[200:203], a[88:91]
v_mfma_f32_16x16x32_bf16 a[88:91], a[244:247], a[204:207], a[88:91]
ds_read_b128 a[152:155], v38 offset:6144
v_mfma_f32_16x16x32_bf16 a[92:95], a[248:251], a[200:203], a[92:95]
buffer_load_dwordx4 v37, s[52:55], s85 offen offset:3072 lds
v_mfma_f32_16x16x32_bf16 a[92:95], a[252:255], a[204:207], a[92:95]
ds_read_b128 a[156:159], v39 offset:6144
v_mfma_f32_16x16x32_bf16 a[96:99], a[224:227], a[208:211], a[96:99]
v_mfma_f32_16x16x32_bf16 a[96:99], a[228:231], a[212:215], a[96:99]
s_add_u32 m0, s87, 49152
v_mfma_f32_16x16x32_bf16 a[100:103], a[232:235], a[208:211], a[100:103]
buffer_load_dwordx4 v34, s[56:59], s85 offen offset:0 lds
v_mfma_f32_16x16x32_bf16 a[100:103], a[236:239], a[212:215], a[100:103]
v_mfma_f32_16x16x32_bf16 a[104:107], a[240:243], a[208:211], a[104:107]
v_mfma_f32_16x16x32_bf16 a[104:107], a[244:247], a[212:215], a[104:107]
v_mfma_f32_16x16x32_bf16 a[108:111], a[248:251], a[208:211], a[108:111]
buffer_load_dwordx4 v35, s[56:59], s85 offen offset:1024 lds
v_mfma_f32_16x16x32_bf16 a[108:111], a[252:255], a[212:215], a[108:111]
v_mfma_f32_16x16x32_bf16 a[112:115], a[224:227], a[216:219], a[112:115]
v_mfma_f32_16x16x32_bf16 a[112:115], a[228:231], a[220:223], a[112:115]
v_mfma_f32_16x16x32_bf16 a[116:119], a[232:235], a[216:219], a[116:119]
buffer_load_dwordx4 v36, s[56:59], s85 offen offset:2048 lds
v_mfma_f32_16x16x32_bf16 a[116:119], a[236:239], a[220:223], a[116:119]
v_mfma_f32_16x16x32_bf16 a[120:123], a[240:243], a[216:219], a[120:123]
v_mfma_f32_16x16x32_bf16 a[120:123], a[244:247], a[220:223], a[120:123]
s_waitcnt lgkmcnt(0)
v_mfma_f32_16x16x32_bf16 a[124:127], a[248:251], a[216:219], a[124:127]
buffer_load_dwordx4 v37, s[56:59], s85 offen offset:3072 lds
v_mfma_f32_16x16x32_bf16 a[124:127], a[252:255], a[220:223], a[124:127]
s_add_u32 s84, s84, 128
v_mfma_f32_16x16x32_bf16 v[128:131], a[128:131], a[160:163], v[128:131]
s_add_u32 s85, s85, 524288
v_mfma_f32_16x16x32_bf16 v[128:131], a[132:135], a[164:167], v[128:131]
ds_read_b128 a[192:195], v38 offset:8192
v_mfma_f32_16x16x32_bf16 v[132:135], a[128:131], a[168:171], v[132:135]
buffer_load_dword v127, v4, s[72:75], s88 offen
v_mfma_f32_16x16x32_bf16 v[132:135], a[132:135], a[172:175], v[132:135]
s_add_u32 s88, s88, 1048576
ds_read_b128 a[196:199], v39 offset:8192
v_mfma_f32_16x16x32_bf16 v[136:139], a[128:131], a[176:179], v[136:139]
buffer_load_dword v127, v4, s[72:75], s88 offen
v_mfma_f32_16x16x32_bf16 v[136:139], a[132:135], a[180:183], v[136:139]
s_add_u32 s88, s88, 1048576
ds_read_b128 a[200:203], v38 offset:10240
s_mov_b32 s4, s32
v_mfma_f32_16x16x32_bf16 v[140:143], a[128:131], a[184:187], v[140:143]
s_and_b32 s5, s33, 0xffff
s_mov_b32 s6, 0x400000
s_mov_b32 s7, 0x20000
v_mfma_f32_16x16x32_bf16 v[140:143], a[132:135], a[188:191], v[140:143]
s_and_b32 s81, s2, 31
ds_read_b128 a[204:207], v39 offset:10240
s_lshl_b32 s81, s81, 2
v_mfma_f32_16x16x32_bf16 v[144:147], a[136:139], a[160:163], v[144:147]
s_add_u32 s81, s81, s3
s_lshl_b32 s81, s81, 10
s_lshr_b32 s88, s2, 5
v_mfma_f32_16x16x32_bf16 v[144:147], a[140:143], a[164:167], v[144:147]
s_lshl_b32 s88, s88, 20
ds_read_b128 a[208:211], v38 offset:12288
s_add_u32 s81, s81, s88
v_mfma_f32_16x16x32_bf16 v[148:151], a[136:139], a[168:171], v[148:151]
buffer_load_dword v127, v2, s[4:7], s81 offen
v_mfma_f32_16x16x32_bf16 v[148:151], a[140:143], a[172:175], v[148:151]
s_waitcnt vmcnt(13)
ds_read_b128 a[212:215], v39 offset:12288
v_and_b32 v13, 0xff, v13
v_mfma_f32_16x16x32_bf16 v[152:155], a[136:139], a[176:179], v[152:155]
s_and_b32 s18, s16, 0xff
v_cmp_ne_u32 vcc, s18, v13
v_fma_f32 v110, v100, v108, v110
v_mfma_f32_16x16x32_bf16 v[152:155], a[140:143], a[180:183], v[152:155]
ds_read_b128 a[216:219], v38 offset:14336
v_fma_f32 v111, v100, v109, v111
v_mfma_f32_16x16x32_bf16 v[156:159], a[136:139], a[184:187], v[156:159]
v_fma_f32 v110, -v101, v109, v110
v_fma_f32 v111, v101, v108, v111
v_mfma_f32_16x16x32_bf16 v[156:159], a[140:143], a[188:191], v[156:159]
ds_read_b128 a[220:223], v39 offset:14336
v_fma_f32 v120, v100, v110, v120
v_mfma_f32_16x16x32_bf16 v[160:163], a[144:147], a[160:163], v[160:163]
v_fma_f32 v121, v100, v111, v121
v_fma_f32 v120, -v101, v111, v120
v_mfma_f32_16x16x32_bf16 v[160:163], a[148:151], a[164:167], v[160:163]
ds_read_b64_tr_b16 a[224:225], v40 offset:0
v_fma_f32 v121, v101, v110, v121
v_mfma_f32_16x16x32_bf16 v[164:167], a[144:147], a[168:171], v[164:167]
v_fma_f32 v122, v100, v120, v122
v_fma_f32 v123, v100, v121, v123
v_mfma_f32_16x16x32_bf16 v[164:167], a[148:151], a[172:175], v[164:167]
ds_read_b64_tr_b16 a[226:227], v40 offset:1024
v_fma_f32 v122, -v101, v121, v122
v_mfma_f32_16x16x32_bf16 v[168:171], a[144:147], a[176:179], v[168:171]
v_fma_f32 v123, v101, v120, v123
s_or_b32 s17, vcc_lo, vcc_hi
v_mfma_f32_16x16x32_bf16 v[168:171], a[148:151], a[180:183], v[168:171]
ds_read_b64_tr_b16 a[228:229], v40 offset:8192
v_mov_b32 v112, v122
v_mfma_f32_16x16x32_bf16 v[172:175], a[144:147], a[184:187], v[172:175]
v_mov_b32 v113, v123
v_mfma_f32_16x16x32_bf16 v[172:175], a[148:151], a[188:191], v[172:175]
ds_read_b64_tr_b16 a[230:231], v40 offset:9216
v_mfma_f32_16x16x32_bf16 v[176:179], a[152:155], a[160:163], v[176:179]
v_permlane16_swap_b32 v122, v112
v_permlane16_swap_b32 v123, v113
v_mfma_f32_16x16x32_bf16 v[176:179], a[156:159], a[164:167], v[176:179]
ds_read_b64_tr_b16 a[232:233], v41 offset:0
v_fma_f32 v122, v116, v112, v122
v_mfma_f32_16x16x32_bf16 v[180:183], a[152:155], a[168:171], v[180:183]
v_fma_f32 v123, v116, v113, v123
v_fma_f32 v122, -v117, v113, v122
v_mfma_f32_16x16x32_bf16 v[180:183], a[156:159], a[172:175], v[180:183]
ds_read_b64_tr_b16 a[234:235], v41 offset:1024
v_fma_f32 v123, v117, v112, v123
v_mfma_f32_16x16x32_bf16 v[184:187], a[152:155], a[176:179], v[184:187]
v_mov_b32 v112, v122
v_mov_b32 v113, v123
v_mfma_f32_16x16x32_bf16 v[184:187], a[156:159], a[180:183], v[184:187]
ds_read_b64_tr_b16 a[236:237], v41 offset:8192
v_mfma_f32_16x16x32_bf16 v[188:191], a[152:155], a[184:187], v[188:191]
v_permlane32_swap_b32 v122, v112
v_permlane32_swap_b32 v123, v113
v_mfma_f32_16x16x32_bf16 v[188:191], a[156:159], a[188:191], v[188:191]
s_waitcnt lgkmcnt(1)
ds_read_b64_tr_b16 a[238:239], v41 offset:9216
v_fma_f32 v122, v118, v112, v122
v_mfma_f32_16x16x32_bf16 v[192:195], a[192:195], a[160:163], v[192:195]
v_fma_f32 v123, v118, v113, v123
v_fma_f32 v122, -v119, v113, v122
v_mfma_f32_16x16x32_bf16 v[192:195], a[196:199], a[164:167], v[192:195]
ds_read_b64_tr_b16 a[240:241], v42 offset:0
v_fma_f32 v123, v119, v112, v123
v_mfma_f32_16x16x32_bf16 v[196:199], a[192:195], a[168:171], v[196:199]
v_fma_f32 v104, v106, v122, v104
v_fma_f32 v105, v106, v123, v105
v_mfma_f32_16x16x32_bf16 v[196:199], a[196:199], a[172:175], v[196:199]
ds_read_b64_tr_b16 a[242:243], v42 offset:1024
v_fma_f32 v104, -v107, v123, v104
v_mfma_f32_16x16x32_bf16 v[200:203], a[192:195], a[176:179], v[200:203]
v_fma_f32 v105, v107, v122, v105
v_mul_f32 v106, v102, v104
v_mfma_f32_16x16x32_bf16 v[200:203], a[196:199], a[180:183], v[200:203]
ds_read_b64_tr_b16 a[244:245], v42 offset:8192
v_mul_f32 v107, v102, v105
v_mfma_f32_16x16x32_bf16 v[204:207], a[192:195], a[184:187], v[204:207]
v_fma_f32 v106, -v103, v105, v106
v_fma_f32 v107, v103, v104, v107
v_mfma_f32_16x16x32_bf16 v[204:207], a[196:199], a[188:191], v[204:207]
Lcp12:
s_add_u32 s9, s95, Lcp12-L_pc+3072
ds_read_b64_tr_b16 a[246:247], v42 offset:9216
v_fma_f32 v64, v96, v106, v64
v_mfma_f32_16x16x32_bf16 v[208:211], a[200:203], a[160:163], v[208:211]
buffer_load_dword v126, off, s[64:67], s9
v_fma_f32 v68, v96, v107, v68
v_fma_f32 v64, -v97, v107, v64
v_mfma_f32_16x16x32_bf16 v[208:211], a[204:207], a[164:167], v[208:211]
ds_read_b64_tr_b16 a[248:249], v43 offset:0
v_fma_f32 v68, v97, v106, v68
v_mfma_f32_16x16x32_bf16 v[212:215], a[200:203], a[168:171], v[212:215]
v_fma_f32 v65, v96, v64, v65
v_fma_f32 v69, v96, v68, v69
v_mfma_f32_16x16x32_bf16 v[212:215], a[204:207], a[172:175], v[212:215]
ds_read_b64_tr_b16 a[250:251], v43 offset:1024
v_fma_f32 v65, -v97, v68, v65
v_mfma_f32_16x16x32_bf16 v[216:219], a[200:203], a[176:179], v[216:219]
v_fma_f32 v69, v97, v64, v69
v_fma_f32 v66, v96, v65, v66
v_mfma_f32_16x16x32_bf16 v[216:219], a[204:207], a[180:183], v[216:219]
ds_read_b64_tr_b16 a[252:253], v43 offset:8192
v_fma_f32 v70, v96, v69, v70
v_mfma_f32_16x16x32_bf16 v[220:223], a[200:203], a[184:187], v[220:223]
v_fma_f32 v66, -v97, v69, v66
v_fma_f32 v70, v97, v65, v70
v_mfma_f32_16x16x32_bf16 v[220:223], a[204:207], a[188:191], v[220:223]
ds_read_b64_tr_b16 a[254:255], v43 offset:9216
v_fma_f32 v67, v96, v66, v67
v_mfma_f32_16x16x32_bf16 v[224:227], a[208:211], a[160:163], v[224:227]
v_fma_f32 v71, v96, v70, v71
v_fma_f32 v67, -v97, v70, v67
v_mfma_f32_16x16x32_bf16 v[224:227], a[212:215], a[164:167], v[224:227]
v_fma_f32 v71, v97, v66, v71
v_fma_f32 v72, v96, v67, v72
v_mfma_f32_16x16x32_bf16 v[228:231], a[208:211], a[168:171], v[228:231]
v_fma_f32 v76, v96, v71, v76
v_fma_f32 v72, -v97, v71, v72
v_mfma_f32_16x16x32_bf16 v[228:231], a[212:215], a[172:175], v[228:231]
v_fma_f32 v76, v97, v67, v76
v_fma_f32 v73, v96, v72, v73
v_mfma_f32_16x16x32_bf16 v[232:235], a[208:211], a[176:179], v[232:235]
v_xor_b32 v38, 0x10000, v38
v_fma_f32 v77, v96, v76, v77
v_mfma_f32_16x16x32_bf16 v[232:235], a[212:215], a[180:183], v[232:235]
v_xor_b32 v39, 0x10000, v39
v_fma_f32 v73, -v97, v76, v73
v_mfma_f32_16x16x32_bf16 v[236:239], a[208:211], a[184:187], v[236:239]
v_xor_b32 v40, 0x10000, v40
v_fma_f32 v77, v97, v72, v77
v_mfma_f32_16x16x32_bf16 v[236:239], a[212:215], a[188:191], v[236:239]
v_xor_b32 v41, 0x10000, v41
v_fma_f32 v74, v96, v73, v74
v_mfma_f32_16x16x32_bf16 v[240:243], a[216:219], a[160:163], v[240:243]
v_xor_b32 v42, 0x10000, v42
v_fma_f32 v78, v96, v77, v78
v_mfma_f32_16x16x32_bf16 v[240:243], a[220:223], a[164:167], v[240:243]
v_xor_b32 v43, 0x10000, v43
v_fma_f32 v74, -v97, v77, v74
v_mfma_f32_16x16x32_bf16 v[244:247], a[216:219], a[168:171], v[244:247]
v_fma_f32 v78, v97, v73, v78
v_fma_f32 v75, v96, v74, v75
v_mfma_f32_16x16x32_bf16 v[244:247], a[220:223], a[172:175], v[244:247]
v_fma_f32 v79, v96, v78, v79
v_fma_f32 v75, -v97, v78, v75
v_mfma_f32_16x16x32_bf16 v[248:251], a[216:219], a[176:179], v[248:251]
v_fma_f32 v79, v97, v74, v79
v_fma_f32 v80, v96, v75, v80
v_mfma_f32_16x16x32_bf16 v[248:251], a[220:223], a[180:183], v[248:251]
v_fma_f32 v84, v96, v79, v84
v_fma_f32 v80, -v97, v79, v80
v_mfma_f32_16x16x32_bf16 v[252:255], a[216:219], a[184:187], v[252:255]
s_waitcnt vmcnt(4) lgkmcnt(0)
v_fma_f32 v84, v97, v75, v84
v_fma_f32 v81, v96, v80, v81
v_mfma_f32_16x16x32_bf16 v[252:255], a[220:223], a[188:191], v[252:255]
s_barrier
v_mfma_f32_16x16x32_bf16 a[0:3], a[224:227], a[128:131], a[0:3]
s_lshl_b32 s81, s76, 20
v_fma_f32 v85, v96, v84, v85
v_fma_f32 v81, -v97, v84, v81
v_mfma_f32_16x16x32_bf16 a[0:3], a[228:231], a[132:135], a[0:3]
s_add_u32 m0, s86, 98304
ds_read_b64_tr_b16 a[160:161], v40 offset:16384
v_fma_f32 v85, v97, v80, v85
v_mfma_f32_16x16x32_bf16 a[4:7], a[232:235], a[128:131], a[4:7]
buffer_load_dwordx4 v44, s[68:71], s89 offen offset:0 lds
v_mfma_f32_16x16x32_bf16 a[4:7], a[236:239], a[132:135], a[4:7]
s_and_b32 s82, s3, 1
ds_read_b64_tr_b16 a[162:163], v40 offset:17408
v_fma_f32 v82, v96, v81, v82
v_mfma_f32_16x16x32_bf16 a[8:11], a[240:243], a[128:131], a[8:11]
s_lshl_b32 s82, s82, 13
v_fma_f32 v86, v96, v85, v86
v_fma_f32 v82, -v97, v85, v82
v_mfma_f32_16x16x32_bf16 a[8:11], a[244:247], a[132:135], a[8:11]
s_add_u32 s6, s81, s82
ds_read_b64_tr_b16 a[164:165], v40 offset:24576
v_fma_f32 v86, v97, v81, v86
v_mfma_f32_16x16x32_bf16 a[12:15], a[248:251], a[128:131], a[12:15]
buffer_load_dwordx4 v45, s[68:71], s89 offen offset:1024 lds
v_mfma_f32_16x16x32_bf16 a[12:15], a[252:255], a[132:135], a[12:15]
s_lshr_b32 s83, s3, 1
ds_read_b64_tr_b16 a[166:167], v40 offset:25600
v_fma_f32 v83, v96, v82, v83
v_mfma_f32_16x16x32_bf16 a[16:19], a[224:227], a[136:139], a[16:19]
s_xor_b32 s82, s83, 1
v_fma_f32 v87, v96, v86, v87
v_fma_f32 v83, -v97, v86, v83
v_mfma_f32_16x16x32_bf16 a[16:19], a[228:231], a[140:143], a[16:19]
s_lshl_b32 s82, s82, 14
ds_read_b64_tr_b16 a[168:169], v41 offset:16384
v_fma_f32 v87, v97, v82, v87
v_mfma_f32_16x16x32_bf16 a[20:23], a[232:235], a[136:139], a[20:23]
buffer_load_dwordx4 v46, s[68:71], s89 offen offset:2048 lds
v_mfma_f32_16x16x32_bf16 a[20:23], a[236:239], a[140:143], a[20:23]
s_lshl_b32 s83, s83, 15
ds_read_b64_tr_b16 a[170:171], v41 offset:17408
v_fma_f32 v88, v96, v83, v88
v_mfma_f32_16x16x32_bf16 a[24:27], a[240:243], a[136:139], a[24:27]
s_add_u32 s6, s6, s82
v_fma_f32 v92, v96, v87, v92
v_fma_f32 v88, -v97, v87, v88
v_mfma_f32_16x16x32_bf16 a[24:27], a[244:247], a[140:143], a[24:27]
s_add_u32 s4, s6, s83
ds_read_b64_tr_b16 a[172:173], v41 offset:24576
v_fma_f32 v92, v97, v83, v92
v_mfma_f32_16x16x32_bf16 a[28:31], a[248:251], a[136:139], a[28:31]
buffer_load_dwordx4 v47, s[68:71], s89 offen offset:3072 lds
v_mfma_f32_16x16x32_bf16 a[28:31], a[252:255], a[140:143], a[28:31]
s_add_u32 s82, s8, 1
ds_read_b64_tr_b16 a[174:175], v41 offset:25600
v_fma_f32 v89, v96, v88, v89
v_mfma_f32_16x16x32_bf16 a[32:35], a[224:227], a[144:147], a[32:35]
s_lshl_b32 s82, s82, 16
v_fma_f32 v93, v96, v92, v93
v_fma_f32 v89, -v97, v92, v89
v_mfma_f32_16x16x32_bf16 a[32:35], a[228:231], a[148:151], a[32:35]
s_add_u32 m0, s86, 102400
ds_read_b64_tr_b16 a[176:177], v42 offset:16384
v_fma_f32 v93, v97, v88, v93
v_mfma_f32_16x16x32_bf16 a[36:39], a[232:235], a[144:147], a[36:39]
buffer_load_dwordx4 v48, s[68:71], s89 offen offset:0 lds
v_mfma_f32_16x16x32_bf16 a[36:39], a[236:239], a[148:151], a[36:39]
s_add_u32 s5, s6, s82
ds_read_b64_tr_b16 a[178:179], v42 offset:17408
v_fma_f32 v90, v96, v89, v90
v_mfma_f32_16x16x32_bf16 a[40:43], a[240:243], a[144:147], a[40:43]
s_mov_b32 s7, s86
v_fma_f32 v94, v96, v93, v94
v_fma_f32 v90, -v97, v93, v90
v_mfma_f32_16x16x32_bf16 a[40:43], a[244:247], a[148:151], a[40:43]
s_add_u32 s80, s81, s87
ds_read_b64_tr_b16 a[180:181], v42 offset:24576
v_fma_f32 v94, v97, v89, v94
v_mfma_f32_16x16x32_bf16 a[44:47], a[248:251], a[144:147], a[44:47]
buffer_load_dwordx4 v49, s[68:71], s89 offen offset:1024 lds
v_mfma_f32_16x16x32_bf16 a[44:47], a[252:255], a[148:151], a[44:47]
s_mov_b32 s10, 0x47800000
ds_read_b64_tr_b16 a[182:183], v42 offset:25600
v_fma_f32 v91, v96, v90, v91
v_mfma_f32_16x16x32_bf16 a[48:51], a[224:227], a[152:155], a[48:51]
s_sub_u32 s88, s8, 4
v_fma_f32 v95, v96, v94, v95
v_fma_f32 v91, -v97, v94, v91
v_mfma_f32_16x16x32_bf16 a[48:51], a[228:231], a[156:159], a[48:51]
s_lshl_b32 s19, s76, 7
ds_read_b64_tr_b16 a[184:185], v43 offset:16384
v_fma_f32 v95, v97, v90, v95
v_mfma_f32_16x16x32_bf16 a[52:55], a[232:235], a[152:155], a[52:55]
buffer_load_dwordx4 v50, s[68:71], s89 offen offset:2048 lds
v_mfma_f32_16x16x32_bf16 a[52:55], a[236:239], a[156:159], a[52:55]
s_add_u32 s19, s19, 59838464
ds_read_b64_tr_b16 a[186:187], v43 offset:17408
v_cvt_pk_bf16_f32 v8, v64, v65
v_mfma_f32_16x16x32_bf16 a[56:59], a[240:243], a[152:155], a[56:59]
v_cvt_pk_bf16_f32 v16, -v68, -v69
v_cvt_pk_bf16_f32 v9, v66, v67
v_mfma_f32_16x16x32_bf16 a[56:59], a[244:247], a[156:159], a[56:59]
ds_read_b64_tr_b16 a[188:189], v43 offset:24576
v_cvt_pk_bf16_f32 v17, -v70, -v71
v_mfma_f32_16x16x32_bf16 a[60:63], a[248:251], a[152:155], a[60:63]
buffer_load_dwordx4 v51, s[68:71], s89 offen offset:3072 lds
v_mfma_f32_16x16x32_bf16 a[60:63], a[252:255], a[156:159], a[60:63]
ds_read_b64_tr_b16 a[190:191], v43 offset:25600
v_cvt_pk_bf16_f32 v10, v72, v73
v_mfma_f32_16x16x32_bf16 a[64:67], a[224:227], a[192:195], a[64:67]
v_cvt_pk_bf16_f32 v18, -v76, -v77
v_cvt_pk_bf16_f32 v11, v74, v75
v_mfma_f32_16x16x32_bf16 a[64:67], a[228:231], a[196:199], a[64:67]
s_add_u32 m0, s87, 65536
ds_read_b128 a[128:131], v38 offset:0
v_cvt_pk_bf16_f32 v19, -v78, -v79
v_mfma_f32_16x16x32_bf16 a[68:71], a[232:235], a[192:195], a[68:71]
buffer_load_dwordx4 v34, s[72:75], s92 offen offset:0 lds
v_mfma_f32_16x16x32_bf16 a[68:71], a[236:239], a[196:199], a[68:71]
ds_read_b128 a[132:135], v39 offset:0
v_cvt_pk_bf16_f32 v12, v80, v81
v_mfma_f32_16x16x32_bf16 a[72:75], a[240:243], a[192:195], a[72:75]
v_cvt_pk_bf16_f32 v20, -v84, -v85
v_cvt_pk_bf16_f32 v13, v82, v83
v_mfma_f32_16x16x32_bf16 a[72:75], a[244:247], a[196:199], a[72:75]
ds_read_b128 a[136:139], v38 offset:2048
v_cvt_pk_bf16_f32 v21, -v86, -v87
v_mfma_f32_16x16x32_bf16 a[76:79], a[248:251], a[192:195], a[76:79]
buffer_load_dwordx4 v35, s[72:75], s92 offen offset:1024 lds
v_mfma_f32_16x16x32_bf16 a[76:79], a[252:255], a[196:199], a[76:79]
ds_read_b128 a[140:143], v39 offset:2048
v_cvt_pk_bf16_f32 v14, v88, v89
v_mfma_f32_16x16x32_bf16 a[80:83], a[224:227], a[200:203], a[80:83]
v_cvt_pk_bf16_f32 v22, -v92, -v93
v_cvt_pk_bf16_f32 v15, v90, v91
v_mfma_f32_16x16x32_bf16 a[80:83], a[228:231], a[204:207], a[80:83]
ds_read_b128 a[144:147], v38 offset:4096
v_cvt_pk_bf16_f32 v23, -v94, -v95
v_mfma_f32_16x16x32_bf16 a[84:87], a[232:235], a[200:203], a[84:87]
buffer_load_dwordx4 v36, s[72:75], s92 offen offset:2048 lds
v_mfma_f32_16x16x32_bf16 a[84:87], a[236:239], a[204:207], a[84:87]
ds_read_b128 a[148:151], v39 offset:4096
v_and_b32 v7, 7, v1
v_mfma_f32_16x16x32_bf16 a[88:91], a[240:243], a[200:203], a[88:91]
v_lshlrev_b32 v7, 2, v7
v_add_u32 v5, 4096, v2
v_mfma_f32_16x16x32_bf16 a[88:91], a[244:247], a[204:207], a[88:91]
ds_read_b128 a[152:155], v38 offset:6144
v_add_u32 v4, 0x10000, v2
v_mfma_f32_16x16x32_bf16 a[92:95], a[248:251], a[200:203], a[92:95]
buffer_load_dwordx4 v37, s[72:75], s92 offen offset:3072 lds
v_mfma_f32_16x16x32_bf16 a[92:95], a[252:255], a[204:207], a[92:95]
s_add_u32 s89, s89, 128
ds_read_b128 a[156:159], v39 offset:6144
v_mfma_f32_16x16x32_bf16 a[96:99], a[224:227], a[208:211], a[96:99]
s_add_u32 s92, s92, 524288
v_mfma_f32_16x16x32_bf16 a[96:99], a[228:231], a[212:215], a[96:99]
s_add_u32 m0, s86, 131072
v_mfma_f32_16x16x32_bf16 a[100:103], a[232:235], a[208:211], a[100:103]
buffer_load_dwordx4 v44, s[68:71], s89 offen offset:0 lds
v_mfma_f32_16x16x32_bf16 a[100:103], a[236:239], a[212:215], a[100:103]
s_mov_b32 s14, 0xff61b1e6
v_mfma_f32_16x16x32_bf16 a[104:107], a[240:243], a[208:211], a[104:107]
s_mov_b32 s15, 0xff61b1e6
v_mfma_f32_16x16x32_bf16 a[104:107], a[244:247], a[212:215], a[104:107]
s_lshl_b32 s11, s8, 20
v_mfma_f32_16x16x32_bf16 a[108:111], a[248:251], a[208:211], a[108:111]
buffer_load_dwordx4 v45, s[68:71], s89 offen offset:1024 lds
v_mfma_f32_16x16x32_bf16 a[108:111], a[252:255], a[212:215], a[108:111]
s_lshl_b32 s82, s76, 14
v_mfma_f32_16x16x32_bf16 a[112:115], a[224:227], a[216:219], a[112:115]
s_add_u32 s11, s11, s82
v_mfma_f32_16x16x32_bf16 a[112:115], a[228:231], a[220:223], a[112:115]
s_lshl_b32 s82, s3, 10
v_mfma_f32_16x16x32_bf16 a[116:119], a[232:235], a[216:219], a[116:119]
buffer_load_dwordx4 v46, s[68:71], s89 offen offset:2048 lds
v_mfma_f32_16x16x32_bf16 a[116:119], a[236:239], a[220:223], a[116:119]
s_add_u32 s11, s11, s82
v_mfma_f32_16x16x32_bf16 a[120:123], a[240:243], a[216:219], a[120:123]
s_add_u32 s11, s11, 33554432
v_mfma_f32_16x16x32_bf16 a[120:123], a[244:247], a[220:223], a[120:123]
s_mov_b32 s52, s32
v_mfma_f32_16x16x32_bf16 a[124:127], a[248:251], a[216:219], a[124:127]
buffer_load_dwordx4 v47, s[68:71], s89 offen offset:3072 lds
v_mfma_f32_16x16x32_bf16 a[124:127], a[252:255], a[220:223], a[124:127]
s_and_b32 s53, s33, 0xffff
s_waitcnt lgkmcnt(0)
v_mfma_f32_16x16x32_bf16 v[128:131], a[128:131], a[160:163], v[128:131]
s_mov_b32 s54, 0x400000
v_mfma_f32_16x16x32_bf16 v[128:131], a[132:135], a[164:167], v[128:131]
s_add_u32 m0, s86, 135168
ds_read_b128 a[192:195], v38 offset:8192
v_mfma_f32_16x16x32_bf16 v[132:135], a[128:131], a[168:171], v[132:135]
buffer_load_dwordx4 v48, s[68:71], s89 offen offset:0 lds
v_mfma_f32_16x16x32_bf16 v[132:135], a[132:135], a[172:175], v[132:135]
s_mov_b32 s55, 0x20000
ds_read_b128 a[196:199], v39 offset:8192
v_mfma_f32_16x16x32_bf16 v[136:139], a[128:131], a[176:179], v[136:139]
s_lshl_b32 s79, s2, 2
v_mfma_f32_16x16x32_bf16 v[136:139], a[132:135], a[180:183], v[136:139]
s_add_u32 s79, s79, s3
ds_read_b128 a[200:203], v38 offset:10240
v_mfma_f32_16x16x32_bf16 v[140:143], a[128:131], a[184:187], v[140:143]
buffer_load_dwordx4 v49, s[68:71], s89 offen offset:1024 lds
v_mfma_f32_16x16x32_bf16 v[140:143], a[132:135], a[188:191], v[140:143]
s_lshl_b32 s79, s79, 12
ds_read_b128 a[204:207], v39 offset:10240
v_mfma_f32_16x16x32_bf16 v[144:147], a[136:139], a[160:163], v[144:147]
s_sub_u32 s79, s79, 4194304
v_mfma_f32_16x16x32_bf16 v[144:147], a[140:143], a[164:167], v[144:147]
s_sub_u32 s82, s8, 6
ds_read_b128 a[208:211], v38 offset:12288
v_mfma_f32_16x16x32_bf16 v[148:151], a[136:139], a[168:171], v[148:151]
buffer_load_dwordx4 v50, s[68:71], s89 offen offset:2048 lds
v_mfma_f32_16x16x32_bf16 v[148:151], a[140:143], a[172:175], v[148:151]
s_lshl_b32 s82, s82, 22
ds_read_b128 a[212:215], v39 offset:12288
v_mfma_f32_16x16x32_bf16 v[152:155], a[136:139], a[176:179], v[152:155]
s_sub_u32 s79, s79, s82
v_mfma_f32_16x16x32_bf16 v[152:155], a[140:143], a[180:183], v[152:155]
ds_read_b128 a[216:219], v38 offset:14336
v_mfma_f32_16x16x32_bf16 v[156:159], a[136:139], a[184:187], v[156:159]
buffer_load_dwordx4 v51, s[68:71], s89 offen offset:3072 lds
v_mfma_f32_16x16x32_bf16 v[156:159], a[140:143], a[188:191], v[156:159]
ds_read_b128 a[220:223], v39 offset:14336
v_mfma_f32_16x16x32_bf16 v[160:163], a[144:147], a[160:163], v[160:163]
v_mfma_f32_16x16x32_bf16 v[160:163], a[148:151], a[164:167], v[160:163]
s_add_u32 m0, s87, 81920
ds_read_b64_tr_b16 a[224:225], v40 offset:0
v_mfma_f32_16x16x32_bf16 v[164:167], a[144:147], a[168:171], v[164:167]
buffer_load_dwordx4 v34, s[72:75], s92 offen offset:0 lds
v_mfma_f32_16x16x32_bf16 v[164:167], a[148:151], a[172:175], v[164:167]
ds_read_b64_tr_b16 a[226:227], v40 offset:1024
v_mfma_f32_16x16x32_bf16 v[168:171], a[144:147], a[176:179], v[168:171]
v_mfma_f32_16x16x32_bf16 v[168:171], a[148:151], a[180:183], v[168:171]
ds_read_b64_tr_b16 a[228:229], v40 offset:8192
v_cvt_pk_bf16_f32 v128, v128, v129
v_mfma_f32_16x16x32_bf16 v[172:175], a[144:147], a[184:187], v[172:175]
buffer_load_dwordx4 v35, s[72:75], s92 offen offset:1024 lds
v_mfma_f32_16x16x32_bf16 v[172:175], a[148:151], a[188:191], v[172:175]
ds_read_b64_tr_b16 a[230:231], v40 offset:9216
v_cvt_pk_bf16_f32 v129, v130, v131
v_mfma_f32_16x16x32_bf16 v[176:179], a[152:155], a[160:163], v[176:179]
v_cvt_pk_bf16_f32 v130, v144, v145
v_cvt_pk_bf16_f32 v131, v146, v147
v_mfma_f32_16x16x32_bf16 v[176:179], a[156:159], a[164:167], v[176:179]
ds_read_b64_tr_b16 a[232:233], v41 offset:0
v_cvt_pk_bf16_f32 v132, v132, v133
v_mfma_f32_16x16x32_bf16 v[180:183], a[152:155], a[168:171], v[180:183]
buffer_load_dwordx4 v36, s[72:75], s92 offen offset:2048 lds
v_mfma_f32_16x16x32_bf16 v[180:183], a[156:159], a[172:175], v[180:183]
ds_read_b64_tr_b16 a[234:235], v41 offset:1024
v_cvt_pk_bf16_f32 v133, v134, v135
v_mfma_f32_16x16x32_bf16 v[184:187], a[152:155], a[176:179], v[184:187]
v_cvt_pk_bf16_f32 v134, v148, v149
v_cvt_pk_bf16_f32 v135, v150, v151
v_mfma_f32_16x16x32_bf16 v[184:187], a[156:159], a[180:183], v[184:187]
s_waitcnt lgkmcnt(1)
ds_read_b64_tr_b16 a[236:237], v41 offset:8192
v_cvt_pk_bf16_f32 v136, v136, v137
v_mfma_f32_16x16x32_bf16 v[188:191], a[152:155], a[184:187], v[188:191]
buffer_load_dwordx4 v37, s[72:75], s92 offen offset:3072 lds
v_mfma_f32_16x16x32_bf16 v[188:191], a[156:159], a[188:191], v[188:191]
s_add_u32 s89, s89, 128
ds_read_b64_tr_b16 a[238:239], v41 offset:9216
v_cvt_pk_bf16_f32 v137, v138, v139
v_mfma_f32_16x16x32_bf16 v[192:195], a[192:195], a[160:163], v[192:195]
s_add_u32 s92, s92, 524288
v_cvt_pk_bf16_f32 v138, v152, v153
v_cvt_pk_bf16_f32 v139, v154, v155
v_mfma_f32_16x16x32_bf16 v[192:195], a[196:199], a[164:167], v[192:195]
ds_read_b64_tr_b16 a[240:241], v42 offset:0
v_cvt_pk_bf16_f32 v140, v140, v141
v_mfma_f32_16x16x32_bf16 v[196:199], a[192:195], a[168:171], v[196:199]
v_cvt_pk_bf16_f32 v141, v142, v143
v_cvt_pk_bf16_f32 v142, v156, v157
v_mfma_f32_16x16x32_bf16 v[196:199], a[196:199], a[172:175], v[196:199]
ds_read_b64_tr_b16 a[242:243], v42 offset:1024
v_cvt_pk_bf16_f32 v143, v158, v159
v_mfma_f32_16x16x32_bf16 v[200:203], a[192:195], a[176:179], v[200:203]
v_add_u32 v128, 0x1a001a00, v128
v_add_u32 v129, 0x1a001a00, v129
v_mfma_f32_16x16x32_bf16 v[200:203], a[196:199], a[180:183], v[200:203]
ds_read_b64_tr_b16 a[244:245], v42 offset:8192
v_cvt_pk_bf16_f32 v160, v160, v161
v_mfma_f32_16x16x32_bf16 v[204:207], a[192:195], a[184:187], v[204:207]
v_cvt_pk_bf16_f32 v161, v162, v163
v_cvt_pk_bf16_f32 v162, v176, v177
v_mfma_f32_16x16x32_bf16 v[204:207], a[196:199], a[188:191], v[204:207]
ds_read_b64_tr_b16 a[246:247], v42 offset:9216
v_cvt_pk_bf16_f32 v163, v178, v179
v_mfma_f32_16x16x32_bf16 v[208:211], a[200:203], a[160:163], v[208:211]
v_cvt_pk_bf16_f32 v164, v164, v165
v_cvt_pk_bf16_f32 v165, v166, v167
v_mfma_f32_16x16x32_bf16 v[208:211], a[204:207], a[164:167], v[208:211]
ds_read_b64_tr_b16 a[248:249], v43 offset:0
v_cvt_pk_bf16_f32 v166, v180, v181
v_mfma_f32_16x16x32_bf16 v[212:215], a[200:203], a[168:171], v[212:215]
v_cvt_pk_bf16_f32 v167, v182, v183
v_cvt_pk_bf16_f32 v168, v168, v169
v_mfma_f32_16x16x32_bf16 v[212:215], a[204:207], a[172:175], v[212:215]
ds_read_b64_tr_b16 a[250:251], v43 offset:1024
v_cvt_pk_bf16_f32 v169, v170, v171
v_mfma_f32_16x16x32_bf16 v[216:219], a[200:203], a[176:179], v[216:219]
v_cvt_pk_bf16_f32 v170, v184, v185
v_cvt_pk_bf16_f32 v171, v186, v187
v_mfma_f32_16x16x32_bf16 v[216:219], a[204:207], a[180:183], v[216:219]
ds_read_b64_tr_b16 a[252:253], v43 offset:8192
v_cvt_pk_bf16_f32 v172, v172, v173
v_mfma_f32_16x16x32_bf16 v[220:223], a[200:203], a[184:187], v[220:223]
v_cvt_pk_bf16_f32 v173, v174, v175
v_cvt_pk_bf16_f32 v174, v188, v189
v_mfma_f32_16x16x32_bf16 v[220:223], a[204:207], a[188:191], v[220:223]
ds_read_b64_tr_b16 a[254:255], v43 offset:9216
v_cvt_pk_bf16_f32 v175, v190, v191
v_mfma_f32_16x16x32_bf16 v[224:227], a[208:211], a[160:163], v[224:227]
v_add_u32 v130, 0x1a001a00, v130
v_add_u32 v131, 0x1a001a00, v131
v_mfma_f32_16x16x32_bf16 v[224:227], a[212:215], a[164:167], v[224:227]
s_add_u32 s18, s94, 0
v_mfma_f32_16x16x32_bf16 v[228:231], a[208:211], a[168:171], v[228:231]
s_lshl_b32 s82, s3, 4
v_and_b32 v40, 15, v1
v_lshlrev_b32 v41, 2, v3
v_mfma_f32_16x16x32_bf16 v[228:231], a[212:215], a[172:175], v[228:231]
v_sub_u32 v40, v40, v41
v_add_u32 v40, s82, v40
v_mfma_f32_16x16x32_bf16 v[232:235], a[208:211], a[176:179], v[232:235]
buffer_store_dwordx4 v[128:131], v2, s[60:63], s18 offen offset:0
v_mfma_f32_16x16x32_bf16 v[232:235], a[212:215], a[180:183], v[232:235]
v_cvt_pk_bf16_f32 v192, v192, v193
v_cvt_pk_bf16_f32 v193, v194, v195
v_mfma_f32_16x16x32_bf16 v[236:239], a[208:211], a[184:187], v[236:239]
v_cvt_pk_bf16_f32 v194, v208, v209
v_cvt_pk_bf16_f32 v195, v210, v211
v_mfma_f32_16x16x32_bf16 v[236:239], a[212:215], a[188:191], v[236:239]
v_cvt_pk_bf16_f32 v196, v196, v197
v_cvt_pk_bf16_f32 v197, v198, v199
v_mfma_f32_16x16x32_bf16 v[240:243], a[216:219], a[160:163], v[240:243]
v_cvt_pk_bf16_f32 v198, v212, v213
v_cvt_pk_bf16_f32 v199, v214, v215
v_mfma_f32_16x16x32_bf16 v[240:243], a[220:223], a[164:167], v[240:243]
v_cvt_pk_bf16_f32 v200, v200, v201
v_cvt_pk_bf16_f32 v201, v202, v203
v_mfma_f32_16x16x32_bf16 v[244:247], a[216:219], a[168:171], v[244:247]
v_cvt_pk_bf16_f32 v202, v216, v217
v_cvt_pk_bf16_f32 v203, v218, v219
v_mfma_f32_16x16x32_bf16 v[244:247], a[220:223], a[172:175], v[244:247]
v_cvt_pk_bf16_f32 v204, v204, v205
v_cvt_pk_bf16_f32 v205, v206, v207
v_mfma_f32_16x16x32_bf16 v[248:251], a[216:219], a[176:179], v[248:251]
v_cvt_pk_bf16_f32 v206, v220, v221
v_cvt_pk_bf16_f32 v207, v222, v223
v_mfma_f32_16x16x32_bf16 v[248:251], a[220:223], a[180:183], v[248:251]
v_add_u32 v132, 0x1a001a00, v132
v_add_u32 v133, 0x1a001a00, v133
v_mfma_f32_16x16x32_bf16 v[252:255], a[216:219], a[184:187], v[252:255]
v_add_u32 v134, 0x1a001a00, v134
v_add_u32 v135, 0x1a001a00, v135
v_mfma_f32_16x16x32_bf16 v[252:255], a[220:223], a[188:191], v[252:255]
s_add_u32 s18, s94, 0
v_mfma_f32_16x16x32_bf16 a[0:3], a[224:227], a[128:131], a[0:3]
buffer_store_dwordx4 v[132:135], v2, s[60:63], s18 offen offset:2048
v_mfma_f32_16x16x32_bf16 a[0:3], a[228:231], a[132:135], a[0:3]
s_waitcnt lgkmcnt(0)
v_add_u32 v136, 0x1a001a00, v136
v_add_u32 v137, 0x1a001a00, v137
v_mfma_f32_16x16x32_bf16 a[4:7], a[232:235], a[128:131], a[4:7]
v_add_u32 v138, 0x1a001a00, v138
v_add_u32 v139, 0x1a001a00, v139
v_mfma_f32_16x16x32_bf16 a[4:7], a[236:239], a[132:135], a[4:7]
s_add_u32 s18, s94, 4096
v_mfma_f32_16x16x32_bf16 a[8:11], a[240:243], a[128:131], a[8:11]
v_mfma_f32_16x16x32_bf16 a[8:11], a[244:247], a[132:135], a[8:11]
v_cvt_pk_bf16_f32 v224, v224, v225
v_cvt_pk_bf16_f32 v225, v226, v227
v_mfma_f32_16x16x32_bf16 a[12:15], a[248:251], a[128:131], a[12:15]
v_cvt_pk_bf16_f32 v226, v240, v241
v_cvt_pk_bf16_f32 v227, v242, v243
v_mfma_f32_16x16x32_bf16 a[12:15], a[252:255], a[132:135], a[12:15]
v_cvt_pk_bf16_f32 v228, v228, v229
v_cvt_pk_bf16_f32 v229, v230, v231
v_mfma_f32_16x16x32_bf16 a[16:19], a[224:227], a[136:139], a[16:19]
v_cvt_pk_bf16_f32 v230, v244, v245
v_cvt_pk_bf16_f32 v231, v246, v247
v_mfma_f32_16x16x32_bf16 a[16:19], a[228:231], a[140:143], a[16:19]
v_cvt_pk_bf16_f32 v232, v232, v233
v_cvt_pk_bf16_f32 v233, v234, v235
v_mfma_f32_16x16x32_bf16 a[20:23], a[232:235], a[136:139], a[20:23]
v_cvt_pk_bf16_f32 v234, v248, v249
v_cvt_pk_bf16_f32 v235, v250, v251
v_mfma_f32_16x16x32_bf16 a[20:23], a[236:239], a[140:143], a[20:23]
v_cvt_pk_bf16_f32 v236, v236, v237
v_cvt_pk_bf16_f32 v237, v238, v239
v_mfma_f32_16x16x32_bf16 a[24:27], a[240:243], a[136:139], a[24:27]
v_cvt_pk_bf16_f32 v238, v252, v253
v_cvt_pk_bf16_f32 v239, v254, v255
v_mfma_f32_16x16x32_bf16 a[24:27], a[244:247], a[140:143], a[24:27]
buffer_store_dwordx4 v[136:139], v2, s[60:63], s18 offen offset:0
v_mfma_f32_16x16x32_bf16 a[28:31], a[248:251], a[136:139], a[28:31]
v_add_u32 v140, 0x1a001a00, v140
v_add_u32 v141, 0x1a001a00, v141
v_mfma_f32_16x16x32_bf16 a[28:31], a[252:255], a[140:143], a[28:31]
v_add_u32 v142, 0x1a001a00, v142
v_add_u32 v143, 0x1a001a00, v143
v_mfma_f32_16x16x32_bf16 a[32:35], a[224:227], a[144:147], a[32:35]
s_add_u32 s18, s94, 4096
v_mfma_f32_16x16x32_bf16 a[32:35], a[228:231], a[148:151], a[32:35]
v_mfma_f32_16x16x32_bf16 a[36:39], a[232:235], a[144:147], a[36:39]
v_mfma_f32_16x16x32_bf16 a[36:39], a[236:239], a[148:151], a[36:39]
v_mfma_f32_16x16x32_bf16 a[40:43], a[240:243], a[144:147], a[40:43]
v_mfma_f32_16x16x32_bf16 a[40:43], a[244:247], a[148:151], a[40:43]
v_mfma_f32_16x16x32_bf16 a[44:47], a[248:251], a[144:147], a[44:47]
buffer_store_dwordx4 v[140:143], v2, s[60:63], s18 offen offset:2048
v_mfma_f32_16x16x32_bf16 a[44:47], a[252:255], a[148:151], a[44:47]
v_accvgpr_read_b32 v26, a0
v_accvgpr_read_b32 v27, a1
v_mfma_f32_16x16x32_bf16 a[48:51], a[224:227], a[152:155], a[48:51]
v_accvgpr_read_b32 v28, a2
v_accvgpr_read_b32 v29, a3
v_mfma_f32_16x16x32_bf16 a[48:51], a[228:231], a[156:159], a[48:51]
v_accvgpr_read_b32 v30, a4
v_accvgpr_read_b32 v31, a5
v_mfma_f32_16x16x32_bf16 a[52:55], a[232:235], a[152:155], a[52:55]
v_accvgpr_read_b32 v32, a6
v_accvgpr_read_b32 v33, a7
v_mfma_f32_16x16x32_bf16 a[52:55], a[236:239], a[156:159], a[52:55]
v_mul_f32 v26, 0x3e0293ee, v26
v_mul_f32 v27, 0x3e0293ee, v27
v_mfma_f32_16x16x32_bf16 a[56:59], a[240:243], a[152:155], a[56:59]
v_mul_f32 v28, 0x3e0293ee, v28
v_mul_f32 v29, 0x3e0293ee, v29
v_mfma_f32_16x16x32_bf16 a[56:59], a[244:247], a[156:159], a[56:59]
v_mul_f32 v30, 0x3e0293ee, v30
v_mul_f32 v31, 0x3e0293ee, v31
v_mfma_f32_16x16x32_bf16 a[60:63], a[248:251], a[152:155], a[60:63]
s_waitcnt vmcnt(16) lgkmcnt(0)
v_mul_f32 v32, 0x3e0293ee, v32
v_mul_f32 v33, 0x3e0293ee, v33
v_mfma_f32_16x16x32_bf16 a[60:63], a[252:255], a[156:159], a[60:63]
s_barrier
v_mfma_f32_16x16x32_bf16 a[64:67], a[224:227], a[192:195], a[64:67]
ds_read_b64_tr_b16 a[144:145], v54 offset:16384
v_cvt_pk_bf16_f32 v26, v26, v27
v_mfma_f32_16x16x32_bf16 a[64:67], a[228:231], a[196:199], a[64:67]
ds_read_b64_tr_b16 a[146:147], v54 offset:17408
v_cvt_pk_bf16_f32 v27, v28, v29
v_mfma_f32_16x16x32_bf16 a[68:71], a[232:235], a[192:195], a[68:71]
s_add_u32 m0, s86, 0
ds_read_b64_tr_b16 a[148:149], v54 offset:24576
v_cvt_pk_bf16_f32 v28, v30, v31
v_mfma_f32_16x16x32_bf16 a[68:71], a[236:239], a[196:199], a[68:71]
buffer_load_dwordx4 v44, s[68:71], s89 offen offset:0 lds
v_mfma_f32_16x16x32_bf16 a[72:75], a[240:243], a[192:195], a[72:75]
ds_read_b64_tr_b16 a[150:151], v54 offset:25600
v_cvt_pk_bf16_f32 v29, v32, v33
v_mfma_f32_16x16x32_bf16 a[72:75], a[244:247], a[196:199], a[72:75]
s_add_u32 s18, s93, 0
ds_read_b64_tr_b16 a[152:153], v55 offset:16384
v_mfma_f32_16x16x32_bf16 a[76:79], a[248:251], a[192:195], a[76:79]
buffer_store_dwordx4 v[26:29], v2, s[60:63], s18 offen offset:0
ds_read_b64_tr_b16 a[154:155], v55 offset:17408
v_mfma_f32_16x16x32_bf16 a[76:79], a[252:255], a[196:199], a[76:79]
buffer_load_dwordx4 v45, s[68:71], s89 offen offset:1024 lds
v_mfma_f32_16x16x32_bf16 a[80:83], a[224:227], a[200:203], a[80:83]
ds_read_b64_tr_b16 a[156:157], v55 offset:24576
v_accvgpr_read_b32 v26, a8
v_mfma_f32_16x16x32_bf16 a[80:83], a[228:231], a[204:207], a[80:83]
ds_read_b64_tr_b16 a[158:159], v55 offset:25600
v_accvgpr_read_b32 v27, a9
v_mfma_f32_16x16x32_bf16 a[84:87], a[232:235], a[200:203], a[84:87]
ds_read_b64_tr_b16 a[160:161], v56 offset:16384
v_accvgpr_read_b32 v28, a10
v_mfma_f32_16x16x32_bf16 a[84:87], a[236:239], a[204:207], a[84:87]
buffer_load_dwordx4 v46, s[68:71], s89 offen offset:2048 lds
v_mfma_f32_16x16x32_bf16 a[88:91], a[240:243], a[200:203], a[88:91]
ds_read_b64_tr_b16 a[162:163], v56 offset:17408
v_accvgpr_read_b32 v29, a11
v_mfma_f32_16x16x32_bf16 a[88:91], a[244:247], a[204:207], a[88:91]
ds_read_b64_tr_b16 a[164:165], v56 offset:24576
v_accvgpr_read_b32 v30, a12
v_mfma_f32_16x16x32_bf16 a[92:95], a[248:251], a[200:203], a[92:95]
ds_read_b64_tr_b16 a[166:167], v56 offset:25600
v_accvgpr_read_b32 v31, a13
v_mfma_f32_16x16x32_bf16 a[92:95], a[252:255], a[204:207], a[92:95]
buffer_load_dwordx4 v47, s[68:71], s89 offen offset:3072 lds
v_mfma_f32_16x16x32_bf16 a[96:99], a[224:227], a[208:211], a[96:99]
ds_read_b64_tr_b16 a[168:169], v57 offset:16384
v_accvgpr_read_b32 v32, a14
v_mfma_f32_16x16x32_bf16 a[96:99], a[228:231], a[212:215], a[96:99]
ds_read_b64_tr_b16 a[170:171], v57 offset:17408
v_accvgpr_read_b32 v33, a15
v_mfma_f32_16x16x32_bf16 a[100:103], a[232:235], a[208:211], a[100:103]
ds_read_b64_tr_b16 a[172:173], v57 offset:24576
v_mul_f32 v26, 0x3e0293ee, v26
v_mfma_f32_16x16x32_bf16 a[100:103], a[236:239], a[212:215], a[100:103]
v_mul_f32 v27, 0x3e0293ee, v27
v_mul_f32 v28, 0x3e0293ee, v28
v_mfma_f32_16x16x32_bf16 a[104:107], a[240:243], a[208:211], a[104:107]
ds_read_b64_tr_b16 a[174:175], v57 offset:25600
v_mul_f32 v29, 0x3e0293ee, v29
v_mfma_f32_16x16x32_bf16 a[104:107], a[244:247], a[212:215], a[104:107]
ds_read_b128 a[128:131], v52 offset:0
v_mul_f32 v30, 0x3e0293ee, v30
v_mfma_f32_16x16x32_bf16 a[108:111], a[248:251], a[208:211], a[108:111]
s_add_u32 m0, s86, 4096
ds_read_b128 a[132:135], v53 offset:0
v_mul_f32 v31, 0x3e0293ee, v31
v_mfma_f32_16x16x32_bf16 a[108:111], a[252:255], a[212:215], a[108:111]
buffer_load_dwordx4 v48, s[68:71], s89 offen offset:0 lds
v_mfma_f32_16x16x32_bf16 a[112:115], a[224:227], a[216:219], a[112:115]
ds_read_b128 a[136:139], v52 offset:2048
v_mul_f32 v32, 0x3e0293ee, v32
v_mfma_f32_16x16x32_bf16 a[112:115], a[228:231], a[220:223], a[112:115]
ds_read_b128 a[140:143], v53 offset:2048
v_mul_f32 v33, 0x3e0293ee, v33
v_mfma_f32_16x16x32_bf16 a[116:119], a[232:235], a[216:219], a[116:119]
v_cvt_pk_bf16_f32 v26, v26, v27
v_cvt_pk_bf16_f32 v27, v28, v29
v_mfma_f32_16x16x32_bf16 a[116:119], a[236:239], a[220:223], a[116:119]
buffer_load_dwordx4 v49, s[68:71], s89 offen offset:1024 lds
v_mfma_f32_16x16x32_bf16 a[120:123], a[240:243], a[216:219], a[120:123]
v_cvt_pk_bf16_f32 v28, v30, v31
v_cvt_pk_bf16_f32 v29, v32, v33
v_mfma_f32_16x16x32_bf16 a[120:123], a[244:247], a[220:223], a[120:123]
s_add_u32 s18, s93, 0
v_mfma_f32_16x16x32_bf16 a[124:127], a[248:251], a[216:219], a[124:127]
buffer_store_dwordx4 v[26:29], v2, s[60:63], s18 offen offset:1024
v_mfma_f32_16x16x32_bf16 a[124:127], a[252:255], a[220:223], a[124:127]
buffer_load_dwordx4 v50, s[68:71], s89 offen offset:2048 lds
s_waitcnt lgkmcnt(0)
L_q:
v_mfma_f32_16x16x32_bf16 v[64:67], a[144:147], a[128:131], 0
ds_read_b128 a[192:195], v52 offset:4096
v_accvgpr_read_b32 v26, a16
v_mfma_f32_16x16x32_bf16 v[64:67], a[148:151], a[132:135], v[64:67]
ds_read_b128 a[196:199], v53 offset:4096
v_accvgpr_read_b32 v27, a17
v_mfma_f32_16x16x32_bf16 v[68:71], a[152:155], a[128:131], 0
ds_read_b128 a[200:203], v52 offset:6144
v_accvgpr_read_b32 v28, a18
v_mfma_f32_16x16x32_bf16 v[68:71], a[156:159], a[132:135], v[68:71]
buffer_load_dwordx4 v51, s[68:71], s89 offen offset:3072 lds
v_mfma_f32_16x16x32_bf16 v[72:75], a[160:163], a[128:131], 0
ds_read_b128 a[204:207], v53 offset:6144
v_accvgpr_read_b32 v29, a19
v_mfma_f32_16x16x32_bf16 v[72:75], a[164:167], a[132:135], v[72:75]
ds_read_b64_tr_b16 a[208:209], v58 offset:16384
v_accvgpr_read_b32 v30, a20
v_mfma_f32_16x16x32_bf16 v[76:79], a[168:171], a[128:131], 0
ds_read_b64_tr_b16 a[210:211], v58 offset:17408
v_accvgpr_read_b32 v31, a21
v_mfma_f32_16x16x32_bf16 v[76:79], a[172:175], a[132:135], v[76:79]
v_accvgpr_read_b32 v32, a22
v_accvgpr_read_b32 v33, a23
v_mfma_f32_16x16x32_bf16 v[96:99], a[144:147], a[136:139], 0
ds_read_b64_tr_b16 a[212:213], v58 offset:24576
v_mul_f32 v26, 0x3e0293ee, v26
v_mfma_f32_16x16x32_bf16 v[96:99], a[148:151], a[140:143], v[96:99]
ds_read_b64_tr_b16 a[214:215], v58 offset:25600
v_mul_f32 v27, 0x3e0293ee, v27
v_mfma_f32_16x16x32_bf16 v[100:103], a[152:155], a[136:139], 0
s_add_u32 m0, s87, 49152
ds_read_b64_tr_b16 a[216:217], v59 offset:16384
v_mul_f32 v28, 0x3e0293ee, v28
v_mfma_f32_16x16x32_bf16 v[100:103], a[156:159], a[140:143], v[100:103]
buffer_load_dwordx4 v34, s[72:75], s92 offen offset:0 lds
v_mfma_f32_16x16x32_bf16 v[104:107], a[160:163], a[136:139], 0
ds_read_b64_tr_b16 a[218:219], v59 offset:17408
v_mul_f32 v29, 0x3e0293ee, v29
v_mfma_f32_16x16x32_bf16 v[104:107], a[164:167], a[140:143], v[104:107]
ds_read_b64_tr_b16 a[220:221], v59 offset:24576
v_mul_f32 v30, 0x3e0293ee, v30
v_mfma_f32_16x16x32_bf16 v[108:111], a[168:171], a[136:139], 0
s_waitcnt lgkmcnt(2)
ds_read_b64_tr_b16 a[222:223], v59 offset:25600
v_mul_f32 v31, 0x3e0293ee, v31
v_mfma_f32_16x16x32_bf16 v[108:111], a[172:175], a[140:143], v[108:111]
buffer_load_dwordx4 v35, s[72:75], s92 offen offset:1024 lds
v_mfma_f32_16x16x32_bf16 v[144:147], a[144:147], a[192:195], 0
ds_read_b64_tr_b16 a[224:225], v60 offset:16384
v_mul_f32 v32, 0x3e0293ee, v32
v_mfma_f32_16x16x32_bf16 v[144:147], a[148:151], a[196:199], v[144:147]
ds_read_b64_tr_b16 a[226:227], v60 offset:17408
v_mul_f32 v33, 0x3e0293ee, v33
v_mfma_f32_16x16x32_bf16 v[148:151], a[152:155], a[192:195], 0
ds_read_b64_tr_b16 a[228:229], v60 offset:24576
v_cvt_pk_bf16_f32 v26, v26, v27
v_mfma_f32_16x16x32_bf16 v[148:151], a[156:159], a[196:199], v[148:151]
buffer_load_dwordx4 v36, s[72:75], s92 offen offset:2048 lds
v_mfma_f32_16x16x32_bf16 v[152:155], a[160:163], a[192:195], 0
ds_read_b64_tr_b16 a[230:231], v60 offset:25600
v_cvt_pk_bf16_f32 v27, v28, v29
v_mfma_f32_16x16x32_bf16 v[152:155], a[164:167], a[196:199], v[152:155]
ds_read_b64_tr_b16 a[232:233], v61 offset:16384
v_cvt_pk_bf16_f32 v28, v30, v31
v_mfma_f32_16x16x32_bf16 v[156:159], a[168:171], a[192:195], 0
ds_read_b64_tr_b16 a[234:235], v61 offset:17408
v_cvt_pk_bf16_f32 v29, v32, v33
v_mfma_f32_16x16x32_bf16 v[156:159], a[172:175], a[196:199], v[156:159]
buffer_load_dwordx4 v37, s[72:75], s92 offen offset:3072 lds
v_mfma_f32_16x16x32_bf16 v[208:211], a[144:147], a[200:203], 0
s_add_u32 s89, s89, 128
ds_read_b64_tr_b16 a[236:237], v61 offset:24576
s_add_u32 s18, s93, 4096
v_mfma_f32_16x16x32_bf16 v[208:211], a[148:151], a[204:207], v[208:211]
s_add_u32 s92, s92, 524288
ds_read_b64_tr_b16 a[238:239], v61 offset:25600
v_mfma_f32_16x16x32_bf16 v[212:215], a[152:155], a[200:203], 0
buffer_store_dwordx4 v[26:29], v2, s[60:63], s18 offen offset:0
v_mfma_f32_16x16x32_bf16 v[212:215], a[156:159], a[204:207], v[212:215]
s_nop 0
v_accvgpr_read_b32 v26, a24
v_accvgpr_read_b32 v27, a25
v_mfma_f32_16x16x32_bf16 v[216:219], a[160:163], a[200:203], 0
v_add_u32 v52, 0x8000, v52
v_accvgpr_read_b32 v28, a26
v_mfma_f32_16x16x32_bf16 v[216:219], a[164:167], a[204:207], v[216:219]
v_add_u32 v53, 0x8000, v53
v_accvgpr_read_b32 v29, a27
v_mfma_f32_16x16x32_bf16 v[220:223], a[168:171], a[200:203], 0
s_waitcnt vmcnt(19) lgkmcnt(0)
v_accvgpr_read_b32 v30, a28
v_accvgpr_read_b32 v31, a29
v_mfma_f32_16x16x32_bf16 v[220:223], a[172:175], a[204:207], v[220:223]
s_barrier
v_mfma_f32_16x16x32_bf16 v[80:83], a[208:211], a[128:131], 0
ds_read_b64_tr_b16 a[144:145], v54 offset:32768
v_accvgpr_read_b32 v32, a30
v_mfma_f32_16x16x32_bf16 v[80:83], a[212:215], a[132:135], v[80:83]
ds_read_b64_tr_b16 a[146:147], v54 offset:33792
v_accvgpr_read_b32 v33, a31
v_mfma_f32_16x16x32_bf16 v[84:87], a[216:219], a[128:131], 0
s_add_u32 m0, s86, 98304
ds_read_b64_tr_b16 a[148:149], v54 offset:40960
v_mul_f32 v26, 0x3e0293ee, v26
v_mfma_f32_16x16x32_bf16 v[84:87], a[220:223], a[132:135], v[84:87]
buffer_load_dwordx4 v44, s[68:71], s89 offen offset:0 lds
v_mfma_f32_16x16x32_bf16 v[88:91], a[224:227], a[128:131], 0
ds_read_b64_tr_b16 a[150:151], v54 offset:41984
v_mul_f32 v27, 0x3e0293ee, v27
v_mfma_f32_16x16x32_bf16 v[88:91], a[228:231], a[132:135], v[88:91]
ds_read_b64_tr_b16 a[152:153], v55 offset:32768
v_mul_f32 v28, 0x3e0293ee, v28
v_mfma_f32_16x16x32_bf16 v[92:95], a[232:235], a[128:131], 0
ds_read_b64_tr_b16 a[154:155], v55 offset:33792
v_mul_f32 v29, 0x3e0293ee, v29
v_mfma_f32_16x16x32_bf16 v[92:95], a[236:239], a[132:135], v[92:95]
buffer_load_dwordx4 v45, s[68:71], s89 offen offset:1024 lds
v_mfma_f32_16x16x32_bf16 v[112:115], a[208:211], a[136:139], 0
ds_read_b64_tr_b16 a[156:157], v55 offset:40960
v_mul_f32 v30, 0x3e0293ee, v30
v_mfma_f32_16x16x32_bf16 v[112:115], a[212:215], a[140:143], v[112:115]
ds_read_b64_tr_b16 a[158:159], v55 offset:41984
v_mul_f32 v31, 0x3e0293ee, v31
v_mfma_f32_16x16x32_bf16 v[116:119], a[216:219], a[136:139], 0
ds_read_b64_tr_b16 a[160:161], v56 offset:32768
v_mul_f32 v32, 0x3e0293ee, v32
v_mfma_f32_16x16x32_bf16 v[116:119], a[220:223], a[140:143], v[116:119]
buffer_load_dwordx4 v46, s[68:71], s89 offen offset:2048 lds
v_mfma_f32_16x16x32_bf16 v[120:123], a[224:227], a[136:139], 0
ds_read_b64_tr_b16 a[162:163], v56 offset:33792
v_mul_f32 v33, 0x3e0293ee, v33
v_mfma_f32_16x16x32_bf16 v[120:123], a[228:231], a[140:143], v[120:123]
ds_read_b64_tr_b16 a[164:165], v56 offset:40960
v_cvt_pk_bf16_f32 v26, v26, v27
v_mfma_f32_16x16x32_bf16 v[124:127], a[232:235], a[136:139], 0
ds_read_b64_tr_b16 a[166:167], v56 offset:41984
v_cvt_pk_bf16_f32 v27, v28, v29
v_mfma_f32_16x16x32_bf16 v[124:127], a[236:239], a[140:143], v[124:127]
buffer_load_dwordx4 v47, s[68:71], s89 offen offset:3072 lds
v_mfma_f32_16x16x32_bf16 v[176:179], a[208:211], a[192:195], 0
ds_read_b64_tr_b16 a[168:169], v57 offset:32768
v_cvt_pk_bf16_f32 v28, v30, v31
v_mfma_f32_16x16x32_bf16 v[176:179], a[212:215], a[196:199], v[176:179]
ds_read_b64_tr_b16 a[170:171], v57 offset:33792
v_cvt_pk_bf16_f32 v29, v32, v33
v_mfma_f32_16x16x32_bf16 v[180:183], a[216:219], a[192:195], 0
s_add_u32 s18, s93, 4096
ds_read_b64_tr_b16 a[172:173], v57 offset:40960
v_mfma_f32_16x16x32_bf16 v[180:183], a[220:223], a[196:199], v[180:183]
ds_write_b128 v62, v[8:11] offset:0
v_mfma_f32_16x16x32_bf16 v[184:187], a[224:227], a[192:195], 0
buffer_store_dwordx4 v[26:29], v2, s[60:63], s18 offen offset:1024
ds_read_b64_tr_b16 a[174:175], v57 offset:41984
v_mfma_f32_16x16x32_bf16 v[184:187], a[228:231], a[196:199], v[184:187]
ds_read_b128 a[128:131], v52 offset:0
v_accvgpr_read_b32 v26, a32
v_mfma_f32_16x16x32_bf16 v[188:191], a[232:235], a[192:195], 0
s_add_u32 m0, s86, 102400
ds_read_b128 a[132:135], v53 offset:0
v_accvgpr_read_b32 v27, a33
v_mfma_f32_16x16x32_bf16 v[188:191], a[236:239], a[196:199], v[188:191]
buffer_load_dwordx4 v48, s[68:71], s89 offen offset:0 lds
v_mfma_f32_16x16x32_bf16 v[240:243], a[208:211], a[200:203], 0
ds_read_b128 a[136:139], v52 offset:2048
v_accvgpr_read_b32 v28, a34
v_mfma_f32_16x16x32_bf16 v[240:243], a[212:215], a[204:207], v[240:243]
ds_read_b128 a[140:143], v53 offset:2048
v_accvgpr_read_b32 v29, a35
v_mfma_f32_16x16x32_bf16 v[244:247], a[216:219], a[200:203], 0
ds_write_b128 v62, v[12:15] offset:16
v_mfma_f32_16x16x32_bf16 v[244:247], a[220:223], a[204:207], v[244:247]
buffer_load_dwordx4 v49, s[68:71], s89 offen offset:1024 lds
v_mfma_f32_16x16x32_bf16 v[248:251], a[224:227], a[200:203], 0
ds_write_b128 v62, v[16:19] offset:8192
v_mfma_f32_16x16x32_bf16 v[248:251], a[228:231], a[204:207], v[248:251]
ds_write_b128 v62, v[20:23] offset:8208
v_mfma_f32_16x16x32_bf16 v[252:255], a[232:235], a[200:203], 0
s_waitcnt lgkmcnt(2)
v_accvgpr_read_b32 v30, a36
v_accvgpr_read_b32 v31, a37
v_mfma_f32_16x16x32_bf16 v[252:255], a[236:239], a[204:207], v[252:255]
buffer_load_dwordx4 v50, s[68:71], s89 offen offset:2048 lds
v_mfma_f32_16x16x32_bf16 v[64:67], a[144:147], a[128:131], v[64:67]
ds_read_b128 a[192:195], v52 offset:4096
v_accvgpr_read_b32 v32, a38
v_mfma_f32_16x16x32_bf16 v[64:67], a[148:151], a[132:135], v[64:67]
ds_read_b128 a[196:199], v53 offset:4096
v_accvgpr_read_b32 v33, a39
v_mfma_f32_16x16x32_bf16 v[68:71], a[152:155], a[128:131], v[68:71]
ds_read_b128 a[200:203], v52 offset:6144
v_mul_f32 v26, 0x3e0293ee, v26
v_mfma_f32_16x16x32_bf16 v[68:71], a[156:159], a[132:135], v[68:71]
buffer_load_dwordx4 v51, s[68:71], s89 offen offset:3072 lds
v_mfma_f32_16x16x32_bf16 v[72:75], a[160:163], a[128:131], v[72:75]
ds_read_b128 a[204:207], v53 offset:6144
v_mul_f32 v27, 0x3e0293ee, v27
v_mfma_f32_16x16x32_bf16 v[72:75], a[164:167], a[132:135], v[72:75]
ds_read_b64_tr_b16 a[208:209], v58 offset:32768
v_mul_f32 v28, 0x3e0293ee, v28
v_mfma_f32_16x16x32_bf16 v[76:79], a[168:171], a[128:131], v[76:79]
ds_read_b64_tr_b16 a[210:211], v58 offset:33792
v_mul_f32 v29, 0x3e0293ee, v29
v_mfma_f32_16x16x32_bf16 v[76:79], a[172:175], a[132:135], v[76:79]
v_mul_f32 v30, 0x3e0293ee, v30
v_mul_f32 v31, 0x3e0293ee, v31
v_mfma_f32_16x16x32_bf16 v[96:99], a[144:147], a[136:139], v[96:99]
ds_read_b64_tr_b16 a[212:213], v58 offset:40960
v_mul_f32 v32, 0x3e0293ee, v32
v_mfma_f32_16x16x32_bf16 v[96:99], a[148:151], a[140:143], v[96:99]
ds_read_b64_tr_b16 a[214:215], v58 offset:41984
v_mul_f32 v33, 0x3e0293ee, v33
v_mfma_f32_16x16x32_bf16 v[100:103], a[152:155], a[136:139], v[100:103]
s_add_u32 m0, s87, 65536
ds_read_b64_tr_b16 a[216:217], v59 offset:32768
v_cvt_pk_bf16_f32 v26, v26, v27
v_mfma_f32_16x16x32_bf16 v[100:103], a[156:159], a[140:143], v[100:103]
buffer_load_dwordx4 v34, s[72:75], s92 offen offset:0 lds
v_mfma_f32_16x16x32_bf16 v[104:107], a[160:163], a[136:139], v[104:107]
ds_read_b64_tr_b16 a[218:219], v59 offset:33792
v_cvt_pk_bf16_f32 v27, v28, v29
v_mfma_f32_16x16x32_bf16 v[104:107], a[164:167], a[140:143], v[104:107]
ds_read_b64_tr_b16 a[220:221], v59 offset:40960
v_cvt_pk_bf16_f32 v28, v30, v31
v_mfma_f32_16x16x32_bf16 v[108:111], a[168:171], a[136:139], v[108:111]
s_waitcnt lgkmcnt(2)
ds_read_b64_tr_b16 a[222:223], v59 offset:41984
v_cvt_pk_bf16_f32 v29, v32, v33
v_mfma_f32_16x16x32_bf16 v[108:111], a[172:175], a[140:143], v[108:111]
buffer_load_dwordx4 v35, s[72:75], s92 offen offset:1024 lds
v_mfma_f32_16x16x32_bf16 v[144:147], a[144:147], a[192:195], v[144:147]
s_add_u32 s18, s93, 262144
ds_read_b64_tr_b16 a[224:225], v60 offset:32768
v_mfma_f32_16x16x32_bf16 v[144:147], a[148:151], a[196:199], v[144:147]
buffer_store_dwordx4 v[26:29], v2, s[60:63], s18 offen offset:0
ds_read_b64_tr_b16 a[226:227], v60 offset:33792
v_mfma_f32_16x16x32_bf16 v[148:151], a[152:155], a[192:195], v[148:151]
ds_read_b64_tr_b16 a[228:229], v60 offset:40960
v_add_u32 v160, 0x1a001a00, v160
v_mfma_f32_16x16x32_bf16 v[148:151], a[156:159], a[196:199], v[148:151]
buffer_load_dwordx4 v36, s[72:75], s92 offen offset:2048 lds
v_mfma_f32_16x16x32_bf16 v[152:155], a[160:163], a[192:195], v[152:155]
ds_read_b64_tr_b16 a[230:231], v60 offset:41984
v_add_u32 v161, 0x1a001a00, v161
v_mfma_f32_16x16x32_bf16 v[152:155], a[164:167], a[196:199], v[152:155]
ds_read_b64_tr_b16 a[232:233], v61 offset:32768
v_add_u32 v162, 0x1a001a00, v162
v_mfma_f32_16x16x32_bf16 v[156:159], a[168:171], a[192:195], v[156:159]
ds_read_b64_tr_b16 a[234:235], v61 offset:33792
v_add_u32 v163, 0x1a001a00, v163
v_mfma_f32_16x16x32_bf16 v[156:159], a[172:175], a[196:199], v[156:159]
buffer_load_dwordx4 v37, s[72:75], s92 offen offset:3072 lds
v_mfma_f32_16x16x32_bf16 v[208:211], a[144:147], a[200:203], v[208:211]
s_add_u32 s89, s89, 128
ds_read_b64_tr_b16 a[236:237], v61 offset:40960
s_add_u32 s18, s94, 262144
v_mfma_f32_16x16x32_bf16 v[208:211], a[148:151], a[204:207], v[208:211]
s_add_u32 s92, s92, 524288
ds_read_b64_tr_b16 a[238:239], v61 offset:41984
v_mfma_f32_16x16x32_bf16 v[212:215], a[152:155], a[200:203], v[212:215]
buffer_store_dwordx4 v[160:163], v2, s[60:63], s18 offen offset:0
v_mfma_f32_16x16x32_bf16 v[212:215], a[156:159], a[204:207], v[212:215]
v_accvgpr_read_b32 v26, a40
v_accvgpr_read_b32 v27, a41
v_mfma_f32_16x16x32_bf16 v[216:219], a[160:163], a[200:203], v[216:219]
v_add_u32 v52, 0xfffe0000, v52
v_accvgpr_read_b32 v28, a42
v_mfma_f32_16x16x32_bf16 v[216:219], a[164:167], a[204:207], v[216:219]
v_add_u32 v53, 0xfffe0000, v53
v_accvgpr_read_b32 v29, a43
v_mfma_f32_16x16x32_bf16 v[220:223], a[168:171], a[200:203], v[220:223]
s_waitcnt vmcnt(10) lgkmcnt(0)
v_accvgpr_read_b32 v30, a44
v_accvgpr_read_b32 v31, a45
v_mfma_f32_16x16x32_bf16 v[220:223], a[172:175], a[204:207], v[220:223]
s_barrier
v_mfma_f32_16x16x32_bf16 v[80:83], a[208:211], a[128:131], v[80:83]
ds_read_b64_tr_b16 a[144:145], v54 offset:0
ds_read_b64_tr_b16 a[176:177], v63 offset:0
v_mfma_f32_16x16x32_bf16 v[80:83], a[212:215], a[132:135], v[80:83]
ds_read_b64_tr_b16 a[146:147], v54 offset:1024
ds_read_b64_tr_b16 a[178:179], v63 offset:1024
v_mfma_f32_16x16x32_bf16 v[84:87], a[216:219], a[128:131], v[84:87]
s_add_u32 m0, s86, 131072
ds_read_b64_tr_b16 a[148:149], v54 offset:8192
ds_read_b64_tr_b16 a[180:181], v24 offset:0
v_mfma_f32_16x16x32_bf16 v[84:87], a[220:223], a[132:135], v[84:87]
buffer_load_dwordx4 v44, s[68:71], s89 offen offset:0 lds
v_mfma_f32_16x16x32_bf16 v[88:91], a[224:227], a[128:131], v[88:91]
ds_read_b64_tr_b16 a[150:151], v54 offset:9216
ds_read_b64_tr_b16 a[182:183], v24 offset:1024
v_mfma_f32_16x16x32_bf16 v[88:91], a[228:231], a[132:135], v[88:91]
ds_read_b64_tr_b16 a[152:153], v55 offset:0
ds_read_b64_tr_b16 a[184:185], v63 offset:8192
v_mfma_f32_16x16x32_bf16 v[92:95], a[232:235], a[128:131], v[92:95]
ds_read_b64_tr_b16 a[154:155], v55 offset:1024
ds_read_b64_tr_b16 a[186:187], v63 offset:9216
v_mfma_f32_16x16x32_bf16 v[92:95], a[236:239], a[132:135], v[92:95]
buffer_load_dwordx4 v45, s[68:71], s89 offen offset:1024 lds
v_mfma_f32_16x16x32_bf16 v[112:115], a[208:211], a[136:139], v[112:115]
Lcp13:
s_add_u32 s9, s95, Lcp13-L_pc+3072
ds_read_b64_tr_b16 a[156:157], v55 offset:8192
ds_read_b64_tr_b16 a[188:189], v24 offset:8192
v_mfma_f32_16x16x32_bf16 v[112:115], a[212:215], a[140:143], v[112:115]
buffer_load_dword v39, off, s[64:67], s9
ds_read_b64_tr_b16 a[158:159], v55 offset:9216
ds_read_b64_tr_b16 a[190:191], v24 offset:9216
v_mfma_f32_16x16x32_bf16 v[116:119], a[216:219], a[136:139], v[116:119]
ds_read_b64_tr_b16 a[160:161], v56 offset:0
v_accvgpr_read_b32 v32, a46
v_mfma_f32_16x16x32_bf16 v[116:119], a[220:223], a[140:143], v[116:119]
buffer_load_dwordx4 v46, s[68:71], s89 offen offset:2048 lds
v_mfma_f32_16x16x32_bf16 v[120:123], a[224:227], a[136:139], v[120:123]
ds_read_b64_tr_b16 a[162:163], v56 offset:1024
v_accvgpr_read_b32 v33, a47
v_mfma_f32_16x16x32_bf16 v[120:123], a[228:231], a[140:143], v[120:123]
ds_read_b64_tr_b16 a[164:165], v56 offset:8192
v_mul_f32 v26, 0x3e0293ee, v26
v_mfma_f32_16x16x32_bf16 v[124:127], a[232:235], a[136:139], v[124:127]
ds_read_b64_tr_b16 a[166:167], v56 offset:9216
v_mul_f32 v27, 0x3e0293ee, v27
v_mfma_f32_16x16x32_bf16 v[124:127], a[236:239], a[140:143], v[124:127]
buffer_load_dwordx4 v47, s[68:71], s89 offen offset:3072 lds
v_mfma_f32_16x16x32_bf16 v[176:179], a[208:211], a[192:195], v[176:179]
ds_read_b64_tr_b16 a[168:169], v57 offset:0
v_mul_f32 v28, 0x3e0293ee, v28
v_mfma_f32_16x16x32_bf16 v[176:179], a[212:215], a[196:199], v[176:179]
ds_read_b64_tr_b16 a[170:171], v57 offset:1024
v_mul_f32 v29, 0x3e0293ee, v29
v_mfma_f32_16x16x32_bf16 v[180:183], a[216:219], a[192:195], v[180:183]
ds_read_b64_tr_b16 a[172:173], v57 offset:8192
v_mul_f32 v30, 0x3e0293ee, v30
v_mfma_f32_16x16x32_bf16 v[180:183], a[220:223], a[196:199], v[180:183]
s_cmp_lg_u32 s3, 0
s_cbranch_scc1 Lpub5
s_cmp_lg_u32 s17, 0
s_cbranch_scc1 Lwb6
Lwbd7:
s_add_u32 s16, s16, 256
s_mov_b64 exec, 1
v_mov_b32 v38, s16
buffer_store_dword v38, off, s[60:63], s0 sc1
s_mov_b64 exec, -1
s_add_u32 s0, s0, 4096
Lpub5:
v_mfma_f32_16x16x32_bf16 v[184:187], a[224:227], a[192:195], v[184:187]
ds_read_b64_tr_b16 a[174:175], v57 offset:9216
v_mul_f32 v31, 0x3e0293ee, v31
v_mfma_f32_16x16x32_bf16 v[184:187], a[228:231], a[196:199], v[184:187]
ds_read_b128 a[128:131], v52 offset:0
v_mul_f32 v32, 0x3e0293ee, v32
v_mfma_f32_16x16x32_bf16 v[188:191], a[232:235], a[192:195], v[188:191]
s_add_u32 m0, s86, 135168
ds_read_b128 a[132:135], v53 offset:0
v_mul_f32 v33, 0x3e0293ee, v33
v_mfma_f32_16x16x32_bf16 v[188:191], a[236:239], a[196:199], v[188:191]
buffer_load_dwordx4 v48, s[68:71], s89 offen offset:0 lds
v_mfma_f32_16x16x32_bf16 v[240:243], a[208:211], a[200:203], v[240:243]
ds_read_b128 a[136:139], v52 offset:2048
v_cvt_pk_bf16_f32 v26, v26, v27
v_mfma_f32_16x16x32_bf16 v[240:243], a[212:215], a[204:207], v[240:243]
ds_read_b128 a[140:143], v53 offset:2048
v_cvt_pk_bf16_f32 v27, v28, v29
v_mfma_f32_16x16x32_bf16 v[244:247], a[216:219], a[200:203], v[244:247]
v_cvt_pk_bf16_f32 v28, v30, v31
v_cvt_pk_bf16_f32 v29, v32, v33
v_mfma_f32_16x16x32_bf16 v[244:247], a[220:223], a[204:207], v[244:247]
buffer_load_dwordx4 v49, s[68:71], s89 offen offset:1024 lds
v_mfma_f32_16x16x32_bf16 v[248:251], a[224:227], a[200:203], v[248:251]
s_add_u32 s18, s93, 262144
v_mfma_f32_16x16x32_bf16 v[248:251], a[228:231], a[204:207], v[248:251]
buffer_store_dwordx4 v[26:29], v2, s[60:63], s18 offen offset:1024
v_mfma_f32_16x16x32_bf16 v[252:255], a[232:235], a[200:203], v[252:255]
s_waitcnt lgkmcnt(0)
v_add_u32 v164, 0x1a001a00, v164
v_add_u32 v165, 0x1a001a00, v165
v_mfma_f32_16x16x32_bf16 v[252:255], a[236:239], a[204:207], v[252:255]
buffer_load_dwordx4 v50, s[68:71], s89 offen offset:2048 lds
v_mfma_f32_16x16x32_bf16 v[64:67], a[144:147], a[128:131], v[64:67]
ds_read_b128 a[192:195], v52 offset:4096
v_add_u32 v166, 0x1a001a00, v166
v_mfma_f32_16x16x32_bf16 v[64:67], a[148:151], a[132:135], v[64:67]
ds_read_b128 a[196:199], v53 offset:4096
v_add_u32 v167, 0x1a001a00, v167
v_mfma_f32_16x16x32_bf16 v[68:71], a[152:155], a[128:131], v[68:71]
s_add_u32 s18, s94, 262144
ds_read_b128 a[200:203], v52 offset:6144
v_mfma_f32_16x16x32_bf16 v[68:71], a[156:159], a[132:135], v[68:71]
buffer_load_dwordx4 v51, s[68:71], s89 offen offset:3072 lds
v_mfma_f32_16x16x32_bf16 v[72:75], a[160:163], a[128:131], v[72:75]
buffer_store_dwordx4 v[164:167], v2, s[60:63], s18 offen offset:2048
ds_read_b128 a[204:207], v53 offset:6144
v_mfma_f32_16x16x32_bf16 v[72:75], a[164:167], a[132:135], v[72:75]
ds_read_b64_tr_b16 a[208:209], v58 offset:0
v_accvgpr_read_b32 v26, a48
v_mfma_f32_16x16x32_bf16 v[76:79], a[168:171], a[128:131], v[76:79]
ds_read_b64_tr_b16 a[210:211], v58 offset:1024
v_accvgpr_read_b32 v27, a49
v_mfma_f32_16x16x32_bf16 v[76:79], a[172:175], a[132:135], v[76:79]
v_accvgpr_read_b32 v28, a50
v_accvgpr_read_b32 v29, a51
v_mfma_f32_16x16x32_bf16 v[96:99], a[144:147], a[136:139], v[96:99]
ds_read_b64_tr_b16 a[212:213], v58 offset:8192
v_accvgpr_read_b32 v30, a52
v_mfma_f32_16x16x32_bf16 v[96:99], a[148:151], a[140:143], v[96:99]
ds_read_b64_tr_b16 a[214:215], v58 offset:9216
v_accvgpr_read_b32 v31, a53
v_mfma_f32_16x16x32_bf16 v[100:103], a[152:155], a[136:139], v[100:103]
s_add_u32 m0, s87, 81920
ds_read_b64_tr_b16 a[216:217], v59 offset:0
v_accvgpr_read_b32 v32, a54
v_mfma_f32_16x16x32_bf16 v[100:103], a[156:159], a[140:143], v[100:103]
buffer_load_dwordx4 v34, s[72:75], s92 offen offset:0 lds
v_mfma_f32_16x16x32_bf16 v[104:107], a[160:163], a[136:139], v[104:107]
ds_read_b64_tr_b16 a[218:219], v59 offset:1024
v_accvgpr_read_b32 v33, a55
v_mfma_f32_16x16x32_bf16 v[104:107], a[164:167], a[140:143], v[104:107]
ds_read_b64_tr_b16 a[220:221], v59 offset:8192
v_mul_f32 v26, 0x3e0293ee, v26
v_mfma_f32_16x16x32_bf16 v[108:111], a[168:171], a[136:139], v[108:111]
s_waitcnt lgkmcnt(2)
ds_read_b64_tr_b16 a[222:223], v59 offset:9216
v_mul_f32 v27, 0x3e0293ee, v27
v_mfma_f32_16x16x32_bf16 v[108:111], a[172:175], a[140:143], v[108:111]
buffer_load_dwordx4 v35, s[72:75], s92 offen offset:1024 lds
v_mfma_f32_16x16x32_bf16 v[144:147], a[144:147], a[192:195], v[144:147]
ds_read_b64_tr_b16 a[224:225], v60 offset:0
v_mul_f32 v28, 0x3e0293ee, v28
v_mfma_f32_16x16x32_bf16 v[144:147], a[148:151], a[196:199], v[144:147]
ds_read_b64_tr_b16 a[226:227], v60 offset:1024
v_mul_f32 v29, 0x3e0293ee, v29
v_mfma_f32_16x16x32_bf16 v[148:151], a[152:155], a[192:195], v[148:151]
ds_read_b64_tr_b16 a[228:229], v60 offset:8192
v_mul_f32 v30, 0x3e0293ee, v30
v_mfma_f32_16x16x32_bf16 v[148:151], a[156:159], a[196:199], v[148:151]
buffer_load_dwordx4 v36, s[72:75], s92 offen offset:2048 lds
v_mfma_f32_16x16x32_bf16 v[152:155], a[160:163], a[192:195], v[152:155]
ds_read_b64_tr_b16 a[230:231], v60 offset:9216
v_mul_f32 v31, 0x3e0293ee, v31
v_mfma_f32_16x16x32_bf16 v[152:155], a[164:167], a[196:199], v[152:155]
ds_read_b64_tr_b16 a[232:233], v61 offset:0
v_mul_f32 v32, 0x3e0293ee, v32
v_mfma_f32_16x16x32_bf16 v[156:159], a[168:171], a[192:195], v[156:159]
ds_read_b64_tr_b16 a[234:235], v61 offset:1024
v_mul_f32 v33, 0x3e0293ee, v33
v_mfma_f32_16x16x32_bf16 v[156:159], a[172:175], a[196:199], v[156:159]
buffer_load_dwordx4 v37, s[72:75], s92 offen offset:3072 lds
v_mfma_f32_16x16x32_bf16 v[208:211], a[144:147], a[200:203], v[208:211]
s_add_u32 s89, s89, 128
ds_read_b64_tr_b16 a[236:237], v61 offset:8192
v_cvt_pk_bf16_f32 v26, v26, v27
v_mfma_f32_16x16x32_bf16 v[208:211], a[148:151], a[204:207], v[208:211]
s_add_u32 s92, s92, 524288
ds_read_b64_tr_b16 a[238:239], v61 offset:9216
v_cvt_pk_bf16_f32 v27, v28, v29
v_mfma_f32_16x16x32_bf16 v[212:215], a[152:155], a[200:203], v[212:215]
v_cvt_pk_bf16_f32 v28, v30, v31
v_cvt_pk_bf16_f32 v29, v32, v33
v_mfma_f32_16x16x32_bf16 v[212:215], a[156:159], a[204:207], v[212:215]
s_add_u32 s18, s93, 266240
v_mfma_f32_16x16x32_bf16 v[216:219], a[160:163], a[200:203], v[216:219]
v_add_u32 v52, 0x18000, v52
v_mfma_f32_16x16x32_bf16 v[216:219], a[164:167], a[204:207], v[216:219]
v_add_u32 v53, 0x18000, v53
v_mfma_f32_16x16x32_bf16 v[220:223], a[168:171], a[200:203], v[220:223]
s_waitcnt vmcnt(16) lgkmcnt(0)
v_mfma_f32_16x16x32_bf16 v[220:223], a[172:175], a[204:207], v[220:223]
s_barrier
v_mfma_f32_16x16x32_bf16 v[80:83], a[208:211], a[128:131], v[80:83]
buffer_store_dwordx4 v[26:29], v2, s[60:63], s18 offen offset:0
ds_read_b64_tr_b16 a[144:145], v54 offset:16384
v_mfma_f32_16x16x32_bf16 v[80:83], a[212:215], a[132:135], v[80:83]
ds_read_b64_tr_b16 a[146:147], v54 offset:17408
v_add_u32 v168, 0x1a001a00, v168
v_mfma_f32_16x16x32_bf16 v[84:87], a[216:219], a[128:131], v[84:87]
s_add_u32 m0, s86, 0
ds_read_b64_tr_b16 a[148:149], v54 offset:24576
v_add_u32 v169, 0x1a001a00, v169
v_mfma_f32_16x16x32_bf16 v[84:87], a[220:223], a[132:135], v[84:87]
buffer_load_dwordx4 v44, s[68:71], s89 offen offset:0 lds
v_mfma_f32_16x16x32_bf16 v[88:91], a[224:227], a[128:131], v[88:91]
ds_read_b64_tr_b16 a[150:151], v54 offset:25600
v_add_u32 v170, 0x1a001a00, v170
v_mfma_f32_16x16x32_bf16 v[88:91], a[228:231], a[132:135], v[88:91]
ds_read_b64_tr_b16 a[152:153], v55 offset:16384
v_add_u32 v171, 0x1a001a00, v171
v_mfma_f32_16x16x32_bf16 v[92:95], a[232:235], a[128:131], v[92:95]
s_add_u32 s18, s94, 266240
ds_read_b64_tr_b16 a[154:155], v55 offset:17408
v_mfma_f32_16x16x32_bf16 v[92:95], a[236:239], a[132:135], v[92:95]
buffer_load_dwordx4 v45, s[68:71], s89 offen offset:1024 lds
v_mfma_f32_16x16x32_bf16 v[112:115], a[208:211], a[136:139], v[112:115]
buffer_store_dwordx4 v[168:171], v2, s[60:63], s18 offen offset:0
ds_read_b64_tr_b16 a[156:157], v55 offset:24576
v_mfma_f32_16x16x32_bf16 v[112:115], a[212:215], a[140:143], v[112:115]
ds_read_b64_tr_b16 a[158:159], v55 offset:25600
v_accvgpr_read_b32 v26, a56
v_mfma_f32_16x16x32_bf16 v[116:119], a[216:219], a[136:139], v[116:119]
ds_read_b64_tr_b16 a[160:161], v56 offset:16384
v_accvgpr_read_b32 v27, a57
v_mfma_f32_16x16x32_bf16 v[116:119], a[220:223], a[140:143], v[116:119]
buffer_load_dwordx4 v46, s[68:71], s89 offen offset:2048 lds
v_mfma_f32_16x16x32_bf16 v[120:123], a[224:227], a[136:139], v[120:123]
ds_read_b64_tr_b16 a[162:163], v56 offset:17408
v_accvgpr_read_b32 v28, a58
v_mfma_f32_16x16x32_bf16 v[120:123], a[228:231], a[140:143], v[120:123]
ds_read_b64_tr_b16 a[164:165], v56 offset:24576
v_accvgpr_read_b32 v29, a59
v_mfma_f32_16x16x32_bf16 v[124:127], a[232:235], a[136:139], v[124:127]
ds_read_b64_tr_b16 a[166:167], v56 offset:25600
v_accvgpr_read_b32 v30, a60
v_mfma_f32_16x16x32_bf16 v[124:127], a[236:239], a[140:143], v[124:127]
buffer_load_dwordx4 v47, s[68:71], s89 offen offset:3072 lds
v_mfma_f32_16x16x32_bf16 v[176:179], a[208:211], a[192:195], v[176:179]
ds_read_b64_tr_b16 a[168:169], v57 offset:16384
v_accvgpr_read_b32 v31, a61
v_mfma_f32_16x16x32_bf16 v[176:179], a[212:215], a[196:199], v[176:179]
ds_read_b64_tr_b16 a[170:171], v57 offset:17408
v_accvgpr_read_b32 v32, a62
v_mfma_f32_16x16x32_bf16 v[180:183], a[216:219], a[192:195], v[180:183]
ds_read_b64_tr_b16 a[172:173], v57 offset:24576
v_accvgpr_read_b32 v33, a63
v_mfma_f32_16x16x32_bf16 v[180:183], a[220:223], a[196:199], v[180:183]
v_mul_f32 v26, 0x3e0293ee, v26
v_mul_f32 v27, 0x3e0293ee, v27
v_mfma_f32_16x16x32_bf16 v[184:187], a[224:227], a[192:195], v[184:187]
ds_read_b64_tr_b16 a[174:175], v57 offset:25600
v_mul_f32 v28, 0x3e0293ee, v28
v_mfma_f32_16x16x32_bf16 v[184:187], a[228:231], a[196:199], v[184:187]
ds_read_b128 a[128:131], v52 offset:0
v_mul_f32 v29, 0x3e0293ee, v29
v_mfma_f32_16x16x32_bf16 v[188:191], a[232:235], a[192:195], v[188:191]
s_add_u32 m0, s86, 4096
ds_read_b128 a[132:135], v53 offset:0
v_mul_f32 v30, 0x3e0293ee, v30
v_mfma_f32_16x16x32_bf16 v[188:191], a[236:239], a[196:199], v[188:191]
buffer_load_dwordx4 v48, s[68:71], s89 offen offset:0 lds
v_mfma_f32_16x16x32_bf16 v[240:243], a[208:211], a[200:203], v[240:243]
ds_read_b128 a[136:139], v52 offset:2048
v_mul_f32 v31, 0x3e0293ee, v31
v_mfma_f32_16x16x32_bf16 v[240:243], a[212:215], a[204:207], v[240:243]
ds_read_b128 a[140:143], v53 offset:2048
v_mul_f32 v32, 0x3e0293ee, v32
v_mfma_f32_16x16x32_bf16 v[244:247], a[216:219], a[200:203], v[244:247]
v_mul_f32 v33, 0x3e0293ee, v33
v_cvt_pk_bf16_f32 v26, v26, v27
v_mfma_f32_16x16x32_bf16 v[244:247], a[220:223], a[204:207], v[244:247]
buffer_load_dwordx4 v49, s[68:71], s89 offen offset:1024 lds
v_mfma_f32_16x16x32_bf16 v[248:251], a[224:227], a[200:203], v[248:251]
v_cvt_pk_bf16_f32 v27, v28, v29
v_cvt_pk_bf16_f32 v28, v30, v31
v_mfma_f32_16x16x32_bf16 v[248:251], a[228:231], a[204:207], v[248:251]
s_waitcnt lgkmcnt(0)
v_cvt_pk_bf16_f32 v29, v32, v33
s_add_u32 s18, s93, 266240
v_mfma_f32_16x16x32_bf16 v[252:255], a[232:235], a[200:203], v[252:255]
buffer_store_dwordx4 v[26:29], v2, s[60:63], s18 offen offset:1024
v_mfma_f32_16x16x32_bf16 v[252:255], a[236:239], a[204:207], v[252:255]
buffer_load_dwordx4 v50, s[68:71], s89 offen offset:2048 lds
v_mfma_f32_16x16x32_bf16 v[64:67], a[144:147], a[128:131], v[64:67]
ds_read_b128 a[192:195], v52 offset:4096
v_add_u32 v172, 0x1a001a00, v172
v_mfma_f32_16x16x32_bf16 v[64:67], a[148:151], a[132:135], v[64:67]
ds_read_b128 a[196:199], v53 offset:4096
v_add_u32 v173, 0x1a001a00, v173
v_mfma_f32_16x16x32_bf16 v[68:71], a[152:155], a[128:131], v[68:71]
ds_read_b128 a[200:203], v52 offset:6144
v_add_u32 v174, 0x1a001a00, v174
v_mfma_f32_16x16x32_bf16 v[68:71], a[156:159], a[132:135], v[68:71]
buffer_load_dwordx4 v51, s[68:71], s89 offen offset:3072 lds
v_mfma_f32_16x16x32_bf16 v[72:75], a[160:163], a[128:131], v[72:75]
ds_read_b128 a[204:207], v53 offset:6144
v_add_u32 v175, 0x1a001a00, v175
v_mfma_f32_16x16x32_bf16 v[72:75], a[164:167], a[132:135], v[72:75]
s_add_u32 s18, s94, 266240
ds_read_b64_tr_b16 a[208:209], v58 offset:16384
v_mfma_f32_16x16x32_bf16 v[76:79], a[168:171], a[128:131], v[76:79]
buffer_store_dwordx4 v[172:175], v2, s[60:63], s18 offen offset:2048
ds_read_b64_tr_b16 a[210:211], v58 offset:17408
v_mfma_f32_16x16x32_bf16 v[76:79], a[172:175], a[132:135], v[76:79]
v_accvgpr_read_b32 v26, a64
v_accvgpr_read_b32 v27, a65
v_mfma_f32_16x16x32_bf16 v[96:99], a[144:147], a[136:139], v[96:99]
ds_read_b64_tr_b16 a[212:213], v58 offset:24576
v_accvgpr_read_b32 v28, a66
v_mfma_f32_16x16x32_bf16 v[96:99], a[148:151], a[140:143], v[96:99]
ds_read_b64_tr_b16 a[214:215], v58 offset:25600
v_accvgpr_read_b32 v29, a67
v_mfma_f32_16x16x32_bf16 v[100:103], a[152:155], a[136:139], v[100:103]
s_add_u32 m0, s87, 49152
ds_read_b64_tr_b16 a[216:217], v59 offset:16384
v_accvgpr_read_b32 v30, a68
v_mfma_f32_16x16x32_bf16 v[100:103], a[156:159], a[140:143], v[100:103]
buffer_load_dwordx4 v34, s[72:75], s92 offen offset:0 lds
v_mfma_f32_16x16x32_bf16 v[104:107], a[160:163], a[136:139], v[104:107]
ds_read_b64_tr_b16 a[218:219], v59 offset:17408
v_accvgpr_read_b32 v31, a69
v_mfma_f32_16x16x32_bf16 v[104:107], a[164:167], a[140:143], v[104:107]
ds_read_b64_tr_b16 a[220:221], v59 offset:24576
v_accvgpr_read_b32 v32, a70
v_mfma_f32_16x16x32_bf16 v[108:111], a[168:171], a[136:139], v[108:111]
s_waitcnt lgkmcnt(2)
ds_read_b64_tr_b16 a[222:223], v59 offset:25600
v_accvgpr_read_b32 v33, a71
v_mfma_f32_16x16x32_bf16 v[108:111], a[172:175], a[140:143], v[108:111]
buffer_load_dwordx4 v35, s[72:75], s92 offen offset:1024 lds
v_mfma_f32_16x16x32_bf16 v[144:147], a[144:147], a[192:195], v[144:147]
ds_read_b64_tr_b16 a[224:225], v60 offset:16384
v_mul_f32 v26, 0x3e0293ee, v26
v_mfma_f32_16x16x32_bf16 v[144:147], a[148:151], a[196:199], v[144:147]
ds_read_b64_tr_b16 a[226:227], v60 offset:17408
v_mul_f32 v27, 0x3e0293ee, v27
v_mfma_f32_16x16x32_bf16 v[148:151], a[152:155], a[192:195], v[148:151]
ds_read_b64_tr_b16 a[228:229], v60 offset:24576
v_mul_f32 v28, 0x3e0293ee, v28
v_mfma_f32_16x16x32_bf16 v[148:151], a[156:159], a[196:199], v[148:151]
buffer_load_dwordx4 v36, s[72:75], s92 offen offset:2048 lds
v_mfma_f32_16x16x32_bf16 v[152:155], a[160:163], a[192:195], v[152:155]
ds_read_b64_tr_b16 a[230:231], v60 offset:25600
v_mul_f32 v29, 0x3e0293ee, v29
v_mfma_f32_16x16x32_bf16 v[152:155], a[164:167], a[196:199], v[152:155]
ds_read_b64_tr_b16 a[232:233], v61 offset:16384
v_mul_f32 v30, 0x3e0293ee, v30
v_mfma_f32_16x16x32_bf16 v[156:159], a[168:171], a[192:195], v[156:159]
ds_read_b64_tr_b16 a[234:235], v61 offset:17408
v_mul_f32 v31, 0x3e0293ee, v31
v_mfma_f32_16x16x32_bf16 v[156:159], a[172:175], a[196:199], v[156:159]
buffer_load_dwordx4 v37, s[72:75], s92 offen offset:3072 lds
v_mfma_f32_16x16x32_bf16 v[208:211], a[144:147], a[200:203], v[208:211]
s_add_u32 s89, s89, 128
ds_read_b64_tr_b16 a[236:237], v61 offset:24576
v_mul_f32 v32, 0x3e0293ee, v32
v_mfma_f32_16x16x32_bf16 v[208:211], a[148:151], a[204:207], v[208:211]
s_add_u32 s92, s92, 524288
ds_read_b64_tr_b16 a[238:239], v61 offset:25600
v_mul_f32 v33, 0x3e0293ee, v33
v_mfma_f32_16x16x32_bf16 v[212:215], a[152:155], a[200:203], v[212:215]
v_cvt_pk_bf16_f32 v26, v26, v27
v_cvt_pk_bf16_f32 v27, v28, v29
v_mfma_f32_16x16x32_bf16 v[212:215], a[156:159], a[204:207], v[212:215]
v_cvt_pk_bf16_f32 v28, v30, v31
v_cvt_pk_bf16_f32 v29, v32, v33
v_mfma_f32_16x16x32_bf16 v[216:219], a[160:163], a[200:203], v[216:219]
s_add_u32 s18, s93, 524288
v_add_u32 v52, 0x8000, v52
v_mfma_f32_16x16x32_bf16 v[216:219], a[164:167], a[204:207], v[216:219]
v_add_u32 v53, 0x8000, v53
v_mfma_f32_16x16x32_bf16 v[220:223], a[168:171], a[200:203], v[220:223]
s_waitcnt vmcnt(16) lgkmcnt(0)
v_mfma_f32_16x16x32_bf16 v[220:223], a[172:175], a[204:207], v[220:223]
s_barrier
v_mfma_f32_16x16x32_bf16 v[80:83], a[208:211], a[128:131], v[80:83]
buffer_store_dwordx4 v[26:29], v2, s[60:63], s18 offen offset:0
ds_read_b64_tr_b16 a[144:145], v54 offset:32768
v_mfma_f32_16x16x32_bf16 v[80:83], a[212:215], a[132:135], v[80:83]
ds_read_b64_tr_b16 a[146:147], v54 offset:33792
v_add_u32 v192, 0x1a001a00, v192
v_mfma_f32_16x16x32_bf16 v[84:87], a[216:219], a[128:131], v[84:87]
s_add_u32 m0, s86, 98304
ds_read_b64_tr_b16 a[148:149], v54 offset:40960
v_add_u32 v193, 0x1a001a00, v193
v_mfma_f32_16x16x32_bf16 v[84:87], a[220:223], a[132:135], v[84:87]
buffer_load_dwordx4 v44, s[68:71], s89 offen offset:0 lds
v_mfma_f32_16x16x32_bf16 v[88:91], a[224:227], a[128:131], v[88:91]
ds_read_b64_tr_b16 a[150:151], v54 offset:41984
v_add_u32 v194, 0x1a001a00, v194
v_mfma_f32_16x16x32_bf16 v[88:91], a[228:231], a[132:135], v[88:91]
ds_read_b64_tr_b16 a[152:153], v55 offset:32768
v_add_u32 v195, 0x1a001a00, v195
v_mfma_f32_16x16x32_bf16 v[92:95], a[232:235], a[128:131], v[92:95]
s_add_u32 s18, s94, 524288
ds_read_b64_tr_b16 a[154:155], v55 offset:33792
v_mfma_f32_16x16x32_bf16 v[92:95], a[236:239], a[132:135], v[92:95]
buffer_load_dwordx4 v45, s[68:71], s89 offen offset:1024 lds
v_mfma_f32_16x16x32_bf16 v[112:115], a[208:211], a[136:139], v[112:115]
buffer_store_dwordx4 v[192:195], v2, s[60:63], s18 offen offset:0
ds_read_b64_tr_b16 a[156:157], v55 offset:40960
v_mfma_f32_16x16x32_bf16 v[112:115], a[212:215], a[140:143], v[112:115]
ds_read_b64_tr_b16 a[158:159], v55 offset:41984
v_accvgpr_read_b32 v26, a72
v_mfma_f32_16x16x32_bf16 v[116:119], a[216:219], a[136:139], v[116:119]
ds_read_b64_tr_b16 a[160:161], v56 offset:32768
v_accvgpr_read_b32 v27, a73
v_mfma_f32_16x16x32_bf16 v[116:119], a[220:223], a[140:143], v[116:119]
buffer_load_dwordx4 v46, s[68:71], s89 offen offset:2048 lds
v_mfma_f32_16x16x32_bf16 v[120:123], a[224:227], a[136:139], v[120:123]
ds_read_b64_tr_b16 a[162:163], v56 offset:33792
v_accvgpr_read_b32 v28, a74
v_mfma_f32_16x16x32_bf16 v[120:123], a[228:231], a[140:143], v[120:123]
ds_read_b64_tr_b16 a[164:165], v56 offset:40960
v_accvgpr_read_b32 v29, a75
v_mfma_f32_16x16x32_bf16 v[124:127], a[232:235], a[136:139], v[124:127]
ds_read_b64_tr_b16 a[166:167], v56 offset:41984
v_accvgpr_read_b32 v30, a76
v_mfma_f32_16x16x32_bf16 v[124:127], a[236:239], a[140:143], v[124:127]
buffer_load_dwordx4 v47, s[68:71], s89 offen offset:3072 lds
v_mfma_f32_16x16x32_bf16 v[176:179], a[208:211], a[192:195], v[176:179]
ds_read_b64_tr_b16 a[168:169], v57 offset:32768
v_accvgpr_read_b32 v31, a77
v_mfma_f32_16x16x32_bf16 v[176:179], a[212:215], a[196:199], v[176:179]
ds_read_b64_tr_b16 a[170:171], v57 offset:33792
v_accvgpr_read_b32 v32, a78
v_mfma_f32_16x16x32_bf16 v[180:183], a[216:219], a[192:195], v[180:183]
ds_read_b64_tr_b16 a[172:173], v57 offset:40960
v_accvgpr_read_b32 v33, a79
v_mfma_f32_16x16x32_bf16 v[180:183], a[220:223], a[196:199], v[180:183]
v_mul_f32 v26, 0x3e0293ee, v26
v_mul_f32 v27, 0x3e0293ee, v27
v_mfma_f32_16x16x32_bf16 v[184:187], a[224:227], a[192:195], v[184:187]
ds_read_b64_tr_b16 a[174:175], v57 offset:41984
v_mul_f32 v28, 0x3e0293ee, v28
v_mfma_f32_16x16x32_bf16 v[184:187], a[228:231], a[196:199], v[184:187]
ds_read_b128 a[128:131], v52 offset:0
v_mul_f32 v29, 0x3e0293ee, v29
v_mfma_f32_16x16x32_bf16 v[188:191], a[232:235], a[192:195], v[188:191]
s_add_u32 m0, s86, 102400
ds_read_b128 a[132:135], v53 offset:0
v_mul_f32 v30, 0x3e0293ee, v30
v_mfma_f32_16x16x32_bf16 v[188:191], a[236:239], a[196:199], v[188:191]
buffer_load_dwordx4 v48, s[68:71], s89 offen offset:0 lds
v_mfma_f32_16x16x32_bf16 v[240:243], a[208:211], a[200:203], v[240:243]
ds_read_b128 a[136:139], v52 offset:2048
v_mul_f32 v31, 0x3e0293ee, v31
v_mfma_f32_16x16x32_bf16 v[240:243], a[212:215], a[204:207], v[240:243]
ds_read_b128 a[140:143], v53 offset:2048
v_mul_f32 v32, 0x3e0293ee, v32
v_mfma_f32_16x16x32_bf16 v[244:247], a[216:219], a[200:203], v[244:247]
v_mul_f32 v33, 0x3e0293ee, v33
v_cvt_pk_bf16_f32 v26, v26, v27
v_mfma_f32_16x16x32_bf16 v[244:247], a[220:223], a[204:207], v[244:247]
buffer_load_dwordx4 v49, s[68:71], s89 offen offset:1024 lds
v_mfma_f32_16x16x32_bf16 v[248:251], a[224:227], a[200:203], v[248:251]
v_cvt_pk_bf16_f32 v27, v28, v29
v_cvt_pk_bf16_f32 v28, v30, v31
v_mfma_f32_16x16x32_bf16 v[248:251], a[228:231], a[204:207], v[248:251]
s_waitcnt lgkmcnt(0)
v_cvt_pk_bf16_f32 v29, v32, v33
s_add_u32 s18, s93, 524288
v_mfma_f32_16x16x32_bf16 v[252:255], a[232:235], a[200:203], v[252:255]
buffer_store_dwordx4 v[26:29], v2, s[60:63], s18 offen offset:1024
v_mfma_f32_16x16x32_bf16 v[252:255], a[236:239], a[204:207], v[252:255]
buffer_load_dwordx4 v50, s[68:71], s89 offen offset:2048 lds
v_mfma_f32_16x16x32_bf16 v[64:67], a[144:147], a[128:131], v[64:67]
ds_read_b128 a[192:195], v52 offset:4096
v_add_u32 v196, 0x1a001a00, v196
v_mfma_f32_16x16x32_bf16 v[64:67], a[148:151], a[132:135], v[64:67]
ds_read_b128 a[196:199], v53 offset:4096
v_add_u32 v197, 0x1a001a00, v197
v_mfma_f32_16x16x32_bf16 v[68:71], a[152:155], a[128:131], v[68:71]
ds_read_b128 a[200:203], v52 offset:6144
v_add_u32 v198, 0x1a001a00, v198
v_mfma_f32_16x16x32_bf16 v[68:71], a[156:159], a[132:135], v[68:71]
buffer_load_dwordx4 v51, s[68:71], s89 offen offset:3072 lds
v_mfma_f32_16x16x32_bf16 v[72:75], a[160:163], a[128:131], v[72:75]
ds_read_b128 a[204:207], v53 offset:6144
v_add_u32 v199, 0x1a001a00, v199
v_mfma_f32_16x16x32_bf16 v[72:75], a[164:167], a[132:135], v[72:75]
s_add_u32 s18, s94, 524288
ds_read_b64_tr_b16 a[208:209], v58 offset:32768
v_mfma_f32_16x16x32_bf16 v[76:79], a[168:171], a[128:131], v[76:79]
buffer_store_dwordx4 v[196:199], v2, s[60:63], s18 offen offset:2048
ds_read_b64_tr_b16 a[210:211], v58 offset:33792
v_mfma_f32_16x16x32_bf16 v[76:79], a[172:175], a[132:135], v[76:79]
v_accvgpr_read_b32 v26, a80
v_accvgpr_read_b32 v27, a81
v_mfma_f32_16x16x32_bf16 v[96:99], a[144:147], a[136:139], v[96:99]
ds_read_b64_tr_b16 a[212:213], v58 offset:40960
v_accvgpr_read_b32 v28, a82
v_mfma_f32_16x16x32_bf16 v[96:99], a[148:151], a[140:143], v[96:99]
ds_read_b64_tr_b16 a[214:215], v58 offset:41984
v_accvgpr_read_b32 v29, a83
v_mfma_f32_16x16x32_bf16 v[100:103], a[152:155], a[136:139], v[100:103]
s_add_u32 m0, s87, 65536
ds_read_b64_tr_b16 a[216:217], v59 offset:32768
v_accvgpr_read_b32 v30, a84
v_mfma_f32_16x16x32_bf16 v[100:103], a[156:159], a[140:143], v[100:103]
buffer_load_dwordx4 v34, s[72:75], s92 offen offset:0 lds
v_mfma_f32_16x16x32_bf16 v[104:107], a[160:163], a[136:139], v[104:107]
ds_read_b64_tr_b16 a[218:219], v59 offset:33792
v_accvgpr_read_b32 v31, a85
v_mfma_f32_16x16x32_bf16 v[104:107], a[164:167], a[140:143], v[104:107]
ds_read_b64_tr_b16 a[220:221], v59 offset:40960
v_accvgpr_read_b32 v32, a86
v_mfma_f32_16x16x32_bf16 v[108:111], a[168:171], a[136:139], v[108:111]
s_waitcnt lgkmcnt(2)
ds_read_b64_tr_b16 a[222:223], v59 offset:41984
v_accvgpr_read_b32 v33, a87
v_mfma_f32_16x16x32_bf16 v[108:111], a[172:175], a[140:143], v[108:111]
buffer_load_dwordx4 v35, s[72:75], s92 offen offset:1024 lds
v_mfma_f32_16x16x32_bf16 v[144:147], a[144:147], a[192:195], v[144:147]
ds_read_b64_tr_b16 a[224:225], v60 offset:32768
v_mul_f32 v26, 0x3e0293ee, v26
v_mfma_f32_16x16x32_bf16 v[144:147], a[148:151], a[196:199], v[144:147]
ds_read_b64_tr_b16 a[226:227], v60 offset:33792
v_mul_f32 v27, 0x3e0293ee, v27
v_mfma_f32_16x16x32_bf16 v[148:151], a[152:155], a[192:195], v[148:151]
ds_read_b64_tr_b16 a[228:229], v60 offset:40960
v_mul_f32 v28, 0x3e0293ee, v28
v_mfma_f32_16x16x32_bf16 v[148:151], a[156:159], a[196:199], v[148:151]
buffer_load_dwordx4 v36, s[72:75], s92 offen offset:2048 lds
v_mfma_f32_16x16x32_bf16 v[152:155], a[160:163], a[192:195], v[152:155]
ds_read_b64_tr_b16 a[230:231], v60 offset:41984
v_mul_f32 v29, 0x3e0293ee, v29
v_mfma_f32_16x16x32_bf16 v[152:155], a[164:167], a[196:199], v[152:155]
ds_read_b64_tr_b16 a[232:233], v61 offset:32768
v_mul_f32 v30, 0x3e0293ee, v30
v_mfma_f32_16x16x32_bf16 v[156:159], a[168:171], a[192:195], v[156:159]
ds_read_b64_tr_b16 a[234:235], v61 offset:33792
v_mul_f32 v31, 0x3e0293ee, v31
v_mfma_f32_16x16x32_bf16 v[156:159], a[172:175], a[196:199], v[156:159]
buffer_load_dwordx4 v37, s[72:75], s92 offen offset:3072 lds
v_mfma_f32_16x16x32_bf16 v[208:211], a[144:147], a[200:203], v[208:211]
s_add_u32 s89, s89, 128
ds_read_b64_tr_b16 a[236:237], v61 offset:40960
v_mul_f32 v32, 0x3e0293ee, v32
v_mfma_f32_16x16x32_bf16 v[208:211], a[148:151], a[204:207], v[208:211]
s_add_u32 s92, s92, 524288
ds_read_b64_tr_b16 a[238:239], v61 offset:41984
v_mul_f32 v33, 0x3e0293ee, v33
v_mfma_f32_16x16x32_bf16 v[212:215], a[152:155], a[200:203], v[212:215]
buffer_load_dword v42, v7, s[60:63], s19 offen sc1
v_mfma_f32_16x16x32_bf16 v[212:215], a[156:159], a[204:207], v[212:215]
v_cvt_pk_bf16_f32 v26, v26, v27
v_cvt_pk_bf16_f32 v27, v28, v29
v_mfma_f32_16x16x32_bf16 v[216:219], a[160:163], a[200:203], v[216:219]
v_add_u32 v52, 0xfffe0000, v52
v_cvt_pk_bf16_f32 v28, v30, v31
v_mfma_f32_16x16x32_bf16 v[216:219], a[164:167], a[204:207], v[216:219]
v_add_u32 v53, 0xfffe0000, v53
v_cvt_pk_bf16_f32 v29, v32, v33
v_mfma_f32_16x16x32_bf16 v[220:223], a[168:171], a[200:203], v[220:223]
s_waitcnt vmcnt(17) lgkmcnt(0)
s_add_u32 s18, s93, 528384
v_mfma_f32_16x16x32_bf16 v[220:223], a[172:175], a[204:207], v[220:223]
s_barrier
v_mfma_f32_16x16x32_bf16 v[80:83], a[208:211], a[128:131], v[80:83]
buffer_store_dwordx4 v[26:29], v2, s[60:63], s18 offen offset:0
ds_read_b64_tr_b16 a[144:145], v54 offset:0
v_mfma_f32_16x16x32_bf16 v[80:83], a[212:215], a[132:135], v[80:83]
ds_read_b64_tr_b16 a[146:147], v54 offset:1024
v_add_u32 v200, 0x1a001a00, v200
v_mfma_f32_16x16x32_bf16 v[84:87], a[216:219], a[128:131], v[84:87]
s_add_u32 m0, s86, 131072
ds_read_b64_tr_b16 a[148:149], v54 offset:8192
v_add_u32 v201, 0x1a001a00, v201
v_mfma_f32_16x16x32_bf16 v[84:87], a[220:223], a[132:135], v[84:87]
buffer_load_dwordx4 v44, s[68:71], s89 offen offset:0 lds
v_mfma_f32_16x16x32_bf16 v[88:91], a[224:227], a[128:131], v[88:91]
ds_read_b64_tr_b16 a[150:151], v54 offset:9216
v_add_u32 v202, 0x1a001a00, v202
v_mfma_f32_16x16x32_bf16 v[88:91], a[228:231], a[132:135], v[88:91]
ds_read_b64_tr_b16 a[152:153], v55 offset:0
v_add_u32 v203, 0x1a001a00, v203
v_mfma_f32_16x16x32_bf16 v[92:95], a[232:235], a[128:131], v[92:95]
s_add_u32 s18, s94, 528384
ds_read_b64_tr_b16 a[154:155], v55 offset:1024
v_mfma_f32_16x16x32_bf16 v[92:95], a[236:239], a[132:135], v[92:95]
buffer_load_dwordx4 v45, s[68:71], s89 offen offset:1024 lds
v_mfma_f32_16x16x32_bf16 v[112:115], a[208:211], a[136:139], v[112:115]
buffer_store_dwordx4 v[200:203], v2, s[60:63], s18 offen offset:0
ds_read_b64_tr_b16 a[156:157], v55 offset:8192
v_mfma_f32_16x16x32_bf16 v[112:115], a[212:215], a[140:143], v[112:115]
ds_read_b64_tr_b16 a[158:159], v55 offset:9216
v_accvgpr_read_b32 v26, a88
v_mfma_f32_16x16x32_bf16 v[116:119], a[216:219], a[136:139], v[116:119]
ds_read_b64_tr_b16 a[160:161], v56 offset:0
v_accvgpr_read_b32 v27, a89
v_mfma_f32_16x16x32_bf16 v[116:119], a[220:223], a[140:143], v[116:119]
buffer_load_dwordx4 v46, s[68:71], s89 offen offset:2048 lds
v_mfma_f32_16x16x32_bf16 v[120:123], a[224:227], a[136:139], v[120:123]
ds_read_b64_tr_b16 a[162:163], v56 offset:1024
v_accvgpr_read_b32 v28, a90
v_mfma_f32_16x16x32_bf16 v[120:123], a[228:231], a[140:143], v[120:123]
ds_read_b64_tr_b16 a[164:165], v56 offset:8192
v_accvgpr_read_b32 v29, a91
v_mfma_f32_16x16x32_bf16 v[124:127], a[232:235], a[136:139], v[124:127]
ds_read_b64_tr_b16 a[166:167], v56 offset:9216
v_accvgpr_read_b32 v30, a92
v_mfma_f32_16x16x32_bf16 v[124:127], a[236:239], a[140:143], v[124:127]
buffer_load_dwordx4 v47, s[68:71], s89 offen offset:3072 lds
v_mfma_f32_16x16x32_bf16 v[176:179], a[208:211], a[192:195], v[176:179]
ds_read_b64_tr_b16 a[168:169], v57 offset:0
v_accvgpr_read_b32 v31, a93
v_mfma_f32_16x16x32_bf16 v[176:179], a[212:215], a[196:199], v[176:179]
ds_read_b64_tr_b16 a[170:171], v57 offset:1024
v_accvgpr_read_b32 v32, a94
v_mfma_f32_16x16x32_bf16 v[180:183], a[216:219], a[192:195], v[180:183]
ds_read_b64_tr_b16 a[172:173], v57 offset:8192
v_accvgpr_read_b32 v33, a95
v_mfma_f32_16x16x32_bf16 v[180:183], a[220:223], a[196:199], v[180:183]
v_mul_f32 v26, 0x3e0293ee, v26
v_mul_f32 v27, 0x3e0293ee, v27
v_mfma_f32_16x16x32_bf16 v[184:187], a[224:227], a[192:195], v[184:187]
ds_read_b64_tr_b16 a[174:175], v57 offset:9216
v_mul_f32 v28, 0x3e0293ee, v28
v_mfma_f32_16x16x32_bf16 v[184:187], a[228:231], a[196:199], v[184:187]
ds_read_b128 a[128:131], v52 offset:0
v_mul_f32 v29, 0x3e0293ee, v29
v_mfma_f32_16x16x32_bf16 v[188:191], a[232:235], a[192:195], v[188:191]
s_add_u32 m0, s86, 135168
ds_read_b128 a[132:135], v53 offset:0
v_mul_f32 v30, 0x3e0293ee, v30
v_mfma_f32_16x16x32_bf16 v[188:191], a[236:239], a[196:199], v[188:191]
buffer_load_dwordx4 v48, s[68:71], s89 offen offset:0 lds
v_mfma_f32_16x16x32_bf16 v[240:243], a[208:211], a[200:203], v[240:243]
ds_read_b128 a[136:139], v52 offset:2048
v_mul_f32 v31, 0x3e0293ee, v31
v_mfma_f32_16x16x32_bf16 v[240:243], a[212:215], a[204:207], v[240:243]
ds_read_b128 a[140:143], v53 offset:2048
v_mul_f32 v32, 0x3e0293ee, v32
v_mfma_f32_16x16x32_bf16 v[244:247], a[216:219], a[200:203], v[244:247]
v_mul_f32 v33, 0x3e0293ee, v33
v_cvt_pk_bf16_f32 v26, v26, v27
v_mfma_f32_16x16x32_bf16 v[244:247], a[220:223], a[204:207], v[244:247]
buffer_load_dwordx4 v49, s[68:71], s89 offen offset:1024 lds
v_mfma_f32_16x16x32_bf16 v[248:251], a[224:227], a[200:203], v[248:251]
v_cvt_pk_bf16_f32 v27, v28, v29
v_cvt_pk_bf16_f32 v28, v30, v31
v_mfma_f32_16x16x32_bf16 v[248:251], a[228:231], a[204:207], v[248:251]
s_waitcnt lgkmcnt(0)
v_cvt_pk_bf16_f32 v29, v32, v33
s_add_u32 s18, s93, 528384
v_mfma_f32_16x16x32_bf16 v[252:255], a[232:235], a[200:203], v[252:255]
buffer_store_dwordx4 v[26:29], v2, s[60:63], s18 offen offset:1024
v_mfma_f32_16x16x32_bf16 v[252:255], a[236:239], a[204:207], v[252:255]
buffer_load_dwordx4 v50, s[68:71], s89 offen offset:2048 lds
v_mfma_f32_16x16x32_bf16 v[64:67], a[144:147], a[128:131], v[64:67]
ds_read_b128 a[192:195], v52 offset:4096
v_add_u32 v204, 0x1a001a00, v204
v_mfma_f32_16x16x32_bf16 v[64:67], a[148:151], a[132:135], v[64:67]
ds_read_b128 a[196:199], v53 offset:4096
v_add_u32 v205, 0x1a001a00, v205
v_mfma_f32_16x16x32_bf16 v[68:71], a[152:155], a[128:131], v[68:71]
ds_read_b128 a[200:203], v52 offset:6144
v_add_u32 v206, 0x1a001a00, v206
v_mfma_f32_16x16x32_bf16 v[68:71], a[156:159], a[132:135], v[68:71]
buffer_load_dwordx4 v51, s[68:71], s89 offen offset:3072 lds
v_mfma_f32_16x16x32_bf16 v[72:75], a[160:163], a[128:131], v[72:75]
ds_read_b128 a[204:207], v53 offset:6144
v_add_u32 v207, 0x1a001a00, v207
v_mfma_f32_16x16x32_bf16 v[72:75], a[164:167], a[132:135], v[72:75]
s_add_u32 s18, s94, 528384
ds_read_b64_tr_b16 a[208:209], v58 offset:0
v_mfma_f32_16x16x32_bf16 v[76:79], a[168:171], a[128:131], v[76:79]
buffer_store_dwordx4 v[204:207], v2, s[60:63], s18 offen offset:2048
ds_read_b64_tr_b16 a[210:211], v58 offset:1024
v_mfma_f32_16x16x32_bf16 v[76:79], a[172:175], a[132:135], v[76:79]
v_accvgpr_read_b32 v26, a96
v_accvgpr_read_b32 v27, a97
v_mfma_f32_16x16x32_bf16 v[96:99], a[144:147], a[136:139], v[96:99]
ds_read_b64_tr_b16 a[212:213], v58 offset:8192
v_accvgpr_read_b32 v28, a98
v_mfma_f32_16x16x32_bf16 v[96:99], a[148:151], a[140:143], v[96:99]
ds_read_b64_tr_b16 a[214:215], v58 offset:9216
v_accvgpr_read_b32 v29, a99
v_mfma_f32_16x16x32_bf16 v[100:103], a[152:155], a[136:139], v[100:103]
s_add_u32 m0, s87, 81920
ds_read_b64_tr_b16 a[216:217], v59 offset:0
v_accvgpr_read_b32 v30, a100
v_mfma_f32_16x16x32_bf16 v[100:103], a[156:159], a[140:143], v[100:103]
buffer_load_dwordx4 v34, s[72:75], s92 offen offset:0 lds
v_mfma_f32_16x16x32_bf16 v[104:107], a[160:163], a[136:139], v[104:107]
ds_read_b64_tr_b16 a[218:219], v59 offset:1024
v_accvgpr_read_b32 v31, a101
v_mfma_f32_16x16x32_bf16 v[104:107], a[164:167], a[140:143], v[104:107]
ds_read_b64_tr_b16 a[220:221], v59 offset:8192
v_accvgpr_read_b32 v32, a102
v_mfma_f32_16x16x32_bf16 v[108:111], a[168:171], a[136:139], v[108:111]
s_waitcnt lgkmcnt(2)
ds_read_b64_tr_b16 a[222:223], v59 offset:9216
v_accvgpr_read_b32 v33, a103
v_mfma_f32_16x16x32_bf16 v[108:111], a[172:175], a[140:143], v[108:111]
buffer_load_dwordx4 v35, s[72:75], s92 offen offset:1024 lds
v_mfma_f32_16x16x32_bf16 v[144:147], a[144:147], a[192:195], v[144:147]
ds_read_b64_tr_b16 a[224:225], v60 offset:0
v_mul_f32 v26, 0x3e0293ee, v26
v_mfma_f32_16x16x32_bf16 v[144:147], a[148:151], a[196:199], v[144:147]
ds_read_b64_tr_b16 a[226:227], v60 offset:1024
v_mul_f32 v27, 0x3e0293ee, v27
v_mfma_f32_16x16x32_bf16 v[148:151], a[152:155], a[192:195], v[148:151]
ds_read_b64_tr_b16 a[228:229], v60 offset:8192
v_mul_f32 v28, 0x3e0293ee, v28
v_mfma_f32_16x16x32_bf16 v[148:151], a[156:159], a[196:199], v[148:151]
buffer_load_dwordx4 v36, s[72:75], s92 offen offset:2048 lds
v_mfma_f32_16x16x32_bf16 v[152:155], a[160:163], a[192:195], v[152:155]
ds_read_b64_tr_b16 a[230:231], v60 offset:9216
v_mul_f32 v29, 0x3e0293ee, v29
v_mfma_f32_16x16x32_bf16 v[152:155], a[164:167], a[196:199], v[152:155]
ds_read_b64_tr_b16 a[232:233], v61 offset:0
v_mul_f32 v30, 0x3e0293ee, v30
v_mfma_f32_16x16x32_bf16 v[156:159], a[168:171], a[192:195], v[156:159]
ds_read_b64_tr_b16 a[234:235], v61 offset:1024
v_mul_f32 v31, 0x3e0293ee, v31
v_mfma_f32_16x16x32_bf16 v[156:159], a[172:175], a[196:199], v[156:159]
buffer_load_dwordx4 v37, s[72:75], s92 offen offset:3072 lds
v_mfma_f32_16x16x32_bf16 v[208:211], a[144:147], a[200:203], v[208:211]
s_add_u32 s89, s89, 128
ds_read_b64_tr_b16 a[236:237], v61 offset:8192
v_mul_f32 v32, 0x3e0293ee, v32
v_mfma_f32_16x16x32_bf16 v[208:211], a[148:151], a[204:207], v[208:211]
s_add_u32 s92, s92, 524288
ds_read_b64_tr_b16 a[238:239], v61 offset:9216
v_mul_f32 v33, 0x3e0293ee, v33
v_mfma_f32_16x16x32_bf16 v[212:215], a[152:155], a[200:203], v[212:215]
v_cvt_pk_bf16_f32 v26, v26, v27
v_cvt_pk_bf16_f32 v27, v28, v29
v_mfma_f32_16x16x32_bf16 v[212:215], a[156:159], a[204:207], v[212:215]
v_cvt_pk_bf16_f32 v28, v30, v31
v_cvt_pk_bf16_f32 v29, v32, v33
v_mfma_f32_16x16x32_bf16 v[216:219], a[160:163], a[200:203], v[216:219]
s_add_u32 s18, s93, 786432
v_add_u32 v52, 0x18000, v52
v_mfma_f32_16x16x32_bf16 v[216:219], a[164:167], a[204:207], v[216:219]
v_add_u32 v53, 0x18000, v53
v_mfma_f32_16x16x32_bf16 v[220:223], a[168:171], a[200:203], v[220:223]
s_waitcnt vmcnt(16) lgkmcnt(0)
v_mfma_f32_16x16x32_bf16 v[220:223], a[172:175], a[204:207], v[220:223]
s_barrier
v_mfma_f32_16x16x32_bf16 v[80:83], a[208:211], a[128:131], v[80:83]
ds_read_b64_tr_b16 a[144:145], v54 offset:16384
v_cmp_gt_u32 vcc, 512, v42
v_mfma_f32_16x16x32_bf16 v[80:83], a[212:215], a[132:135], v[80:83]
buffer_store_dwordx4 v[26:29], v2, s[60:63], s18 offen offset:0
ds_read_b64_tr_b16 a[146:147], v54 offset:17408
v_mfma_f32_16x16x32_bf16 v[84:87], a[216:219], a[128:131], v[84:87]
ds_read_b64_tr_b16 a[148:149], v54 offset:24576
v_add_u32 v224, 0x1a001a00, v224
v_mfma_f32_16x16x32_bf16 v[84:87], a[220:223], a[132:135], v[84:87]
v_add_u32 v225, 0x1a001a00, v225
v_add_u32 v226, 0x1a001a00, v226
v_mfma_f32_16x16x32_bf16 v[88:91], a[224:227], a[128:131], v[88:91]
ds_read_b64_tr_b16 a[150:151], v54 offset:25600
v_add_u32 v227, 0x1a001a00, v227
v_mfma_f32_16x16x32_bf16 v[88:91], a[228:231], a[132:135], v[88:91]
s_add_u32 s18, s94, 786432
ds_read_b64_tr_b16 a[152:153], v55 offset:16384
v_mfma_f32_16x16x32_bf16 v[92:95], a[232:235], a[128:131], v[92:95]
buffer_store_dwordx4 v[224:227], v2, s[60:63], s18 offen offset:0
ds_read_b64_tr_b16 a[154:155], v55 offset:17408
v_mfma_f32_16x16x32_bf16 v[92:95], a[236:239], a[132:135], v[92:95]
s_cbranch_vccnz Lspin8
Lgo9:
v_mfma_f32_16x16x32_bf16 v[112:115], a[208:211], a[136:139], v[112:115]
ds_read_b64_tr_b16 a[156:157], v55 offset:24576
v_accvgpr_read_b32 v26, a104
v_mfma_f32_16x16x32_bf16 v[112:115], a[212:215], a[140:143], v[112:115]
ds_read_b64_tr_b16 a[158:159], v55 offset:25600
v_accvgpr_read_b32 v27, a105
v_mfma_f32_16x16x32_bf16 v[116:119], a[216:219], a[136:139], v[116:119]
ds_read_b64_tr_b16 a[160:161], v56 offset:16384
v_accvgpr_read_b32 v28, a106
v_mfma_f32_16x16x32_bf16 v[116:119], a[220:223], a[140:143], v[116:119]
v_accvgpr_read_b32 v29, a107
v_accvgpr_read_b32 v30, a108
v_mfma_f32_16x16x32_bf16 v[120:123], a[224:227], a[136:139], v[120:123]
ds_read_b64_tr_b16 a[162:163], v56 offset:17408
v_accvgpr_read_b32 v31, a109
v_mfma_f32_16x16x32_bf16 v[120:123], a[228:231], a[140:143], v[120:123]
ds_read_b64_tr_b16 a[164:165], v56 offset:24576
v_accvgpr_read_b32 v32, a110
v_mfma_f32_16x16x32_bf16 v[124:127], a[232:235], a[136:139], v[124:127]
ds_read_b64_tr_b16 a[166:167], v56 offset:25600
v_accvgpr_read_b32 v33, a111
v_mfma_f32_16x16x32_bf16 v[124:127], a[236:239], a[140:143], v[124:127]
v_mul_f32 v26, 0x3e0293ee, v26
v_mul_f32 v27, 0x3e0293ee, v27
v_mfma_f32_16x16x32_bf16 v[176:179], a[208:211], a[192:195], v[176:179]
ds_read_b64_tr_b16 a[168:169], v57 offset:16384
v_mul_f32 v28, 0x3e0293ee, v28
v_mfma_f32_16x16x32_bf16 v[176:179], a[212:215], a[196:199], v[176:179]
ds_read_b64_tr_b16 a[170:171], v57 offset:17408
v_mul_f32 v29, 0x3e0293ee, v29
v_mfma_f32_16x16x32_bf16 v[180:183], a[216:219], a[192:195], v[180:183]
ds_read_b64_tr_b16 a[172:173], v57 offset:24576
v_mul_f32 v30, 0x3e0293ee, v30
v_mfma_f32_16x16x32_bf16 v[180:183], a[220:223], a[196:199], v[180:183]
v_mul_f32 v31, 0x3e0293ee, v31
v_mul_f32 v32, 0x3e0293ee, v32
v_mfma_f32_16x16x32_bf16 v[184:187], a[224:227], a[192:195], v[184:187]
ds_read_b64_tr_b16 a[174:175], v57 offset:25600
v_mul_f32 v33, 0x3e0293ee, v33
v_mfma_f32_16x16x32_bf16 v[184:187], a[228:231], a[196:199], v[184:187]
ds_read_b128 a[128:131], v52 offset:0
v_cvt_pk_bf16_f32 v26, v26, v27
v_mfma_f32_16x16x32_bf16 v[188:191], a[232:235], a[192:195], v[188:191]
s_mov_b32 m0, s7
ds_read_b128 a[132:135], v53 offset:0
v_cvt_pk_bf16_f32 v27, v28, v29
v_mfma_f32_16x16x32_bf16 v[188:191], a[236:239], a[196:199], v[188:191]
buffer_load_dwordx4 v2, s[60:63], s4 offen offset:0 sc1 lds
v_mfma_f32_16x16x32_bf16 v[240:243], a[208:211], a[200:203], v[240:243]
ds_read_b128 a[136:139], v52 offset:2048
v_cvt_pk_bf16_f32 v28, v30, v31
v_mfma_f32_16x16x32_bf16 v[240:243], a[212:215], a[204:207], v[240:243]
ds_read_b128 a[140:143], v53 offset:2048
v_cvt_pk_bf16_f32 v29, v32, v33
v_mfma_f32_16x16x32_bf16 v[244:247], a[216:219], a[200:203], v[244:247]
s_add_u32 s18, s93, 786432
v_cvt_f32_i32 v23, v40
v_mfma_f32_16x16x32_bf16 v[244:247], a[220:223], a[204:207], v[244:247]
buffer_load_dwordx4 v2, s[60:63], s4 offen offset:1024 sc1 lds
v_mfma_f32_16x16x32_bf16 v[248:251], a[224:227], a[200:203], v[248:251]
buffer_store_dwordx4 v[26:29], v2, s[60:63], s18 offen offset:1024
v_mfma_f32_16x16x32_bf16 v[248:251], a[228:231], a[204:207], v[248:251]
v_add_u32 v228, 0x1a001a00, v228
v_add_u32 v229, 0x1a001a00, v229
v_mfma_f32_16x16x32_bf16 v[252:255], a[232:235], a[200:203], v[252:255]
s_waitcnt lgkmcnt(0)
v_add_u32 v230, 0x1a001a00, v230
v_add_u32 v231, 0x1a001a00, v231
v_mfma_f32_16x16x32_bf16 v[252:255], a[236:239], a[204:207], v[252:255]
buffer_load_dwordx4 v2, s[60:63], s4 offen offset:2048 sc1 lds
v_mfma_f32_16x16x32_bf16 v[64:67], a[144:147], a[128:131], v[64:67]
s_add_u32 s18, s94, 786432
ds_read_b128 a[192:195], v52 offset:4096
v_mfma_f32_16x16x32_bf16 v[64:67], a[148:151], a[132:135], v[64:67]
buffer_store_dwordx4 v[228:231], v2, s[60:63], s18 offen offset:2048
ds_read_b128 a[196:199], v53 offset:4096
v_mfma_f32_16x16x32_bf16 v[68:71], a[152:155], a[128:131], v[68:71]
ds_read_b128 a[200:203], v52 offset:6144
v_accvgpr_read_b32 v26, a112
v_mfma_f32_16x16x32_bf16 v[68:71], a[156:159], a[132:135], v[68:71]
buffer_load_dwordx4 v2, s[60:63], s4 offen offset:3072 sc1 lds
v_mfma_f32_16x16x32_bf16 v[72:75], a[160:163], a[128:131], v[72:75]
ds_read_b128 a[204:207], v53 offset:6144
v_accvgpr_read_b32 v27, a113
v_mfma_f32_16x16x32_bf16 v[72:75], a[164:167], a[132:135], v[72:75]
ds_read_b64_tr_b16 a[208:209], v58 offset:16384
v_accvgpr_read_b32 v28, a114
v_mfma_f32_16x16x32_bf16 v[76:79], a[168:171], a[128:131], v[76:79]
ds_read_b64_tr_b16 a[210:211], v58 offset:17408
v_accvgpr_read_b32 v29, a115
v_mfma_f32_16x16x32_bf16 v[76:79], a[172:175], a[132:135], v[76:79]
v_accvgpr_read_b32 v30, a116
v_accvgpr_read_b32 v31, a117
v_mfma_f32_16x16x32_bf16 v[96:99], a[144:147], a[136:139], v[96:99]
ds_read_b64_tr_b16 a[212:213], v58 offset:24576
v_accvgpr_read_b32 v32, a118
v_mfma_f32_16x16x32_bf16 v[96:99], a[148:151], a[140:143], v[96:99]
ds_read_b64_tr_b16 a[214:215], v58 offset:25600
v_accvgpr_read_b32 v33, a119
v_mfma_f32_16x16x32_bf16 v[100:103], a[152:155], a[136:139], v[100:103]
s_add_u32 m0, s7, 4096
ds_read_b64_tr_b16 a[216:217], v59 offset:16384
v_mul_f32 v26, 0x3e0293ee, v26
v_mfma_f32_16x16x32_bf16 v[100:103], a[156:159], a[140:143], v[100:103]
buffer_load_dwordx4 v5, s[60:63], s4 offen offset:0 sc1 lds
v_mfma_f32_16x16x32_bf16 v[104:107], a[160:163], a[136:139], v[104:107]
ds_read_b64_tr_b16 a[218:219], v59 offset:17408
v_mul_f32 v27, 0x3e0293ee, v27
v_mfma_f32_16x16x32_bf16 v[104:107], a[164:167], a[140:143], v[104:107]
ds_read_b64_tr_b16 a[220:221], v59 offset:24576
v_mul_f32 v28, 0x3e0293ee, v28
v_mfma_f32_16x16x32_bf16 v[108:111], a[168:171], a[136:139], v[108:111]
s_waitcnt lgkmcnt(2)
ds_read_b64_tr_b16 a[222:223], v59 offset:25600
v_mul_f32 v29, 0x3e0293ee, v29
v_mfma_f32_16x16x32_bf16 v[108:111], a[172:175], a[140:143], v[108:111]
buffer_load_dwordx4 v5, s[60:63], s4 offen offset:1024 sc1 lds
v_mfma_f32_16x16x32_bf16 v[144:147], a[144:147], a[192:195], v[144:147]
ds_read_b64_tr_b16 a[224:225], v60 offset:16384
v_mul_f32 v30, 0x3e0293ee, v30
v_mfma_f32_16x16x32_bf16 v[144:147], a[148:151], a[196:199], v[144:147]
ds_read_b64_tr_b16 a[226:227], v60 offset:17408
v_mul_f32 v31, 0x3e0293ee, v31
v_mfma_f32_16x16x32_bf16 v[148:151], a[152:155], a[192:195], v[148:151]
ds_read_b64_tr_b16 a[228:229], v60 offset:24576
v_mul_f32 v32, 0x3e0293ee, v32
v_mfma_f32_16x16x32_bf16 v[148:151], a[156:159], a[196:199], v[148:151]
buffer_load_dwordx4 v5, s[60:63], s4 offen offset:2048 sc1 lds
v_mfma_f32_16x16x32_bf16 v[152:155], a[160:163], a[192:195], v[152:155]
Lcp14:
s_add_u32 s9, s95, Lcp14-L_pc+3072
ds_read_b64_tr_b16 a[230:231], v60 offset:25600
v_mul_f32 v33, 0x3e0293ee, v33
v_mfma_f32_16x16x32_bf16 v[152:155], a[164:167], a[196:199], v[152:155]
buffer_load_dword v39, off, s[64:67], s9
ds_read_b64_tr_b16 a[232:233], v61 offset:16384
v_cvt_pk_bf16_f32 v26, v26, v27
v_mfma_f32_16x16x32_bf16 v[156:159], a[168:171], a[192:195], v[156:159]
ds_read_b64_tr_b16 a[234:235], v61 offset:17408
v_cvt_pk_bf16_f32 v27, v28, v29
v_mfma_f32_16x16x32_bf16 v[156:159], a[172:175], a[196:199], v[156:159]
buffer_load_dwordx4 v5, s[60:63], s4 offen offset:3072 sc1 lds
v_mfma_f32_16x16x32_bf16 v[208:211], a[144:147], a[200:203], v[208:211]
s_add_u32 s7, s7, 0x8000
ds_read_b64_tr_b16 a[236:237], v61 offset:24576
v_cvt_pk_bf16_f32 v28, v30, v31
v_mfma_f32_16x16x32_bf16 v[208:211], a[148:151], a[204:207], v[208:211]
s_and_b32 s7, s7, 0x1ffff
ds_read_b64_tr_b16 a[238:239], v61 offset:25600
v_cvt_pk_bf16_f32 v29, v32, v33
v_mfma_f32_16x16x32_bf16 v[212:215], a[152:155], a[200:203], v[212:215]
s_add_u32 s4, s4, 0x8000
s_add_u32 s18, s93, 790528
v_mfma_f32_16x16x32_bf16 v[212:215], a[156:159], a[204:207], v[212:215]
buffer_store_dwordx4 v[26:29], v2, s[60:63], s18 offen offset:0
v_mfma_f32_16x16x32_bf16 v[216:219], a[160:163], a[200:203], v[216:219]
s_cmp_eq_u32 s4, s5
s_cselect_b32 s4, s6, s4
v_add_u32 v52, 0x8000, v52
v_add_u32 v232, 0x1a001a00, v232
v_mfma_f32_16x16x32_bf16 v[216:219], a[164:167], a[204:207], v[216:219]
v_add_u32 v53, 0x8000, v53
v_add_u32 v233, 0x1a001a00, v233
v_mfma_f32_16x16x32_bf16 v[220:223], a[168:171], a[200:203], v[220:223]
s_waitcnt vmcnt(14) lgkmcnt(0)
v_add_u32 v234, 0x1a001a00, v234
v_add_u32 v235, 0x1a001a00, v235
v_mfma_f32_16x16x32_bf16 v[220:223], a[172:175], a[204:207], v[220:223]
s_barrier
v_mfma_f32_16x16x32_bf16 v[80:83], a[208:211], a[128:131], v[80:83]
s_add_u32 s18, s94, 790528
ds_read_b64_tr_b16 a[144:145], v54 offset:32768
v_mfma_f32_16x16x32_bf16 v[80:83], a[212:215], a[132:135], v[80:83]
buffer_store_dwordx4 v[232:235], v2, s[60:63], s18 offen offset:0
ds_read_b64_tr_b16 a[146:147], v54 offset:33792
v_mfma_f32_16x16x32_bf16 v[84:87], a[216:219], a[128:131], v[84:87]
s_add_u32 m0, s87, 114688
ds_read_b64_tr_b16 a[148:149], v54 offset:40960
v_accvgpr_read_b32 v26, a120
v_mfma_f32_16x16x32_bf16 v[84:87], a[220:223], a[132:135], v[84:87]
buffer_load_dwordx4 v2, s[60:63], s80 offen offset:0 sc1 lds
v_mfma_f32_16x16x32_bf16 v[88:91], a[224:227], a[128:131], v[88:91]
ds_read_b64_tr_b16 a[150:151], v54 offset:41984
v_accvgpr_read_b32 v27, a121
v_mfma_f32_16x16x32_bf16 v[88:91], a[228:231], a[132:135], v[88:91]
ds_read_b64_tr_b16 a[152:153], v55 offset:32768
v_accvgpr_read_b32 v28, a122
v_mfma_f32_16x16x32_bf16 v[92:95], a[232:235], a[128:131], v[92:95]
ds_read_b64_tr_b16 a[154:155], v55 offset:33792
v_accvgpr_read_b32 v29, a123
v_mfma_f32_16x16x32_bf16 v[92:95], a[236:239], a[132:135], v[92:95]
buffer_load_dwordx4 v2, s[60:63], s80 offen offset:1024 sc1 lds
v_mfma_f32_16x16x32_bf16 v[112:115], a[208:211], a[136:139], v[112:115]
ds_read_b64_tr_b16 a[156:157], v55 offset:40960
v_accvgpr_read_b32 v30, a124
v_mfma_f32_16x16x32_bf16 v[112:115], a[212:215], a[140:143], v[112:115]
ds_read_b64_tr_b16 a[158:159], v55 offset:41984
v_accvgpr_read_b32 v31, a125
v_mfma_f32_16x16x32_bf16 v[116:119], a[216:219], a[136:139], v[116:119]
ds_read_b64_tr_b16 a[160:161], v56 offset:32768
v_accvgpr_read_b32 v32, a126
v_mfma_f32_16x16x32_bf16 v[116:119], a[220:223], a[140:143], v[116:119]
buffer_load_dwordx4 v2, s[60:63], s80 offen offset:2048 sc1 lds
v_mfma_f32_16x16x32_bf16 v[120:123], a[224:227], a[136:139], v[120:123]
ds_read_b64_tr_b16 a[162:163], v56 offset:33792
v_accvgpr_read_b32 v33, a127
v_mfma_f32_16x16x32_bf16 v[120:123], a[228:231], a[140:143], v[120:123]
ds_read_b64_tr_b16 a[164:165], v56 offset:40960
v_mul_f32 v26, 0x3e0293ee, v26
v_mfma_f32_16x16x32_bf16 v[124:127], a[232:235], a[136:139], v[124:127]
ds_read_b64_tr_b16 a[166:167], v56 offset:41984
v_mul_f32 v27, 0x3e0293ee, v27
v_mfma_f32_16x16x32_bf16 v[124:127], a[236:239], a[140:143], v[124:127]
buffer_load_dwordx4 v2, s[60:63], s80 offen offset:3072 sc1 lds
v_mfma_f32_16x16x32_bf16 v[176:179], a[208:211], a[192:195], v[176:179]
ds_read_b64_tr_b16 a[168:169], v57 offset:32768
v_mul_f32 v28, 0x3e0293ee, v28
v_mfma_f32_16x16x32_bf16 v[176:179], a[212:215], a[196:199], v[176:179]
ds_read_b64_tr_b16 a[170:171], v57 offset:33792
v_mul_f32 v29, 0x3e0293ee, v29
v_mfma_f32_16x16x32_bf16 v[180:183], a[216:219], a[192:195], v[180:183]
ds_read_b64_tr_b16 a[172:173], v57 offset:40960
v_mul_f32 v30, 0x3e0293ee, v30
v_mfma_f32_16x16x32_bf16 v[180:183], a[220:223], a[196:199], v[180:183]
v_mul_f32 v31, 0x3e0293ee, v31
v_mul_f32 v32, 0x3e0293ee, v32
v_mfma_f32_16x16x32_bf16 v[184:187], a[224:227], a[192:195], v[184:187]
ds_read_b64_tr_b16 a[174:175], v57 offset:41984
v_mul_f32 v33, 0x3e0293ee, v33
v_mfma_f32_16x16x32_bf16 v[184:187], a[228:231], a[196:199], v[184:187]
ds_read_b128 a[128:131], v52 offset:0
v_cvt_pk_bf16_f32 v26, v26, v27
v_mfma_f32_16x16x32_bf16 v[188:191], a[232:235], a[192:195], v[188:191]
s_mov_b32 m0, s7
ds_read_b128 a[132:135], v53 offset:0
v_cvt_pk_bf16_f32 v27, v28, v29
v_mfma_f32_16x16x32_bf16 v[188:191], a[236:239], a[196:199], v[188:191]
buffer_load_dwordx4 v2, s[60:63], s4 offen offset:0 sc1 lds
v_mfma_f32_16x16x32_bf16 v[240:243], a[208:211], a[200:203], v[240:243]
ds_read_b128 a[136:139], v52 offset:2048
v_cvt_pk_bf16_f32 v28, v30, v31
v_mfma_f32_16x16x32_bf16 v[240:243], a[212:215], a[204:207], v[240:243]
ds_read_b128 a[140:143], v53 offset:2048
v_cvt_pk_bf16_f32 v29, v32, v33
v_mfma_f32_16x16x32_bf16 v[244:247], a[216:219], a[200:203], v[244:247]
s_add_u32 s18, s93, 790528
v_mfma_f32_16x16x32_bf16 v[244:247], a[220:223], a[204:207], v[244:247]
buffer_load_dwordx4 v2, s[60:63], s4 offen offset:1024 sc1 lds
v_mfma_f32_16x16x32_bf16 v[248:251], a[224:227], a[200:203], v[248:251]
buffer_store_dwordx4 v[26:29], v2, s[60:63], s18 offen offset:1024
v_mfma_f32_16x16x32_bf16 v[248:251], a[228:231], a[204:207], v[248:251]
v_add_u32 v236, 0x1a001a00, v236
v_add_u32 v237, 0x1a001a00, v237
v_mfma_f32_16x16x32_bf16 v[252:255], a[232:235], a[200:203], v[252:255]
s_waitcnt lgkmcnt(0)
v_add_u32 v238, 0x1a001a00, v238
v_add_u32 v239, 0x1a001a00, v239
v_mfma_f32_16x16x32_bf16 v[252:255], a[236:239], a[204:207], v[252:255]
buffer_load_dwordx4 v2, s[60:63], s4 offen offset:2048 sc1 lds
v_mfma_f32_16x16x32_bf16 v[64:67], a[144:147], a[128:131], v[64:67]
s_add_u32 s18, s94, 790528
ds_read_b128 a[192:195], v52 offset:4096
v_mfma_f32_16x16x32_bf16 v[64:67], a[148:151], a[132:135], v[64:67]
buffer_store_dwordx4 v[236:239], v2, s[60:63], s18 offen offset:2048
ds_read_b128 a[196:199], v53 offset:4096
v_mfma_f32_16x16x32_bf16 v[68:71], a[152:155], a[128:131], v[68:71]
buffer_store_dwordx4 a[176:179], v2, s[60:63], s91 offen offset:0
ds_read_b128 a[200:203], v52 offset:6144
v_mfma_f32_16x16x32_bf16 v[68:71], a[156:159], a[132:135], v[68:71]
buffer_load_dwordx4 v2, s[60:63], s4 offen offset:3072 sc1 lds
v_mfma_f32_16x16x32_bf16 v[72:75], a[160:163], a[128:131], v[72:75]
ds_read_b128 a[204:207], v53 offset:6144
v_mfma_f32_16x16x32_bf16 v[72:75], a[164:167], a[132:135], v[72:75]
ds_read_b64_tr_b16 a[208:209], v58 offset:32768
v_mfma_f32_16x16x32_bf16 v[76:79], a[168:171], a[128:131], v[76:79]
ds_read_b64_tr_b16 a[210:211], v58 offset:33792
v_mfma_f32_16x16x32_bf16 v[76:79], a[172:175], a[132:135], v[76:79]
v_mfma_f32_16x16x32_bf16 v[96:99], a[144:147], a[136:139], v[96:99]
ds_read_b64_tr_b16 a[212:213], v58 offset:40960
v_mfma_f32_16x16x32_bf16 v[96:99], a[148:151], a[140:143], v[96:99]
ds_read_b64_tr_b16 a[214:215], v58 offset:41984
v_mfma_f32_16x16x32_bf16 v[100:103], a[152:155], a[136:139], v[100:103]
s_add_u32 m0, s7, 4096
ds_read_b64_tr_b16 a[216:217], v59 offset:32768
v_mfma_f32_16x16x32_bf16 v[100:103], a[156:159], a[140:143], v[100:103]
buffer_load_dwordx4 v5, s[60:63], s4 offen offset:0 sc1 lds
v_mfma_f32_16x16x32_bf16 v[104:107], a[160:163], a[136:139], v[104:107]
buffer_store_dwordx4 a[180:183], v2, s[60:63], s91 offen offset:1024
ds_read_b64_tr_b16 a[218:219], v59 offset:33792
v_mfma_f32_16x16x32_bf16 v[104:107], a[164:167], a[140:143], v[104:107]
s_add_u32 s91, s91, 65536
ds_read_b64_tr_b16 a[220:221], v59 offset:40960
v_cvt_pk_bf16_f32 v64, v64, v65
v_mfma_f32_16x16x32_bf16 v[108:111], a[168:171], a[136:139], v[108:111]
s_waitcnt lgkmcnt(2)
ds_read_b64_tr_b16 a[222:223], v59 offset:41984
v_cvt_pk_bf16_f32 v65, v66, v67
v_mfma_f32_16x16x32_bf16 v[108:111], a[172:175], a[140:143], v[108:111]
buffer_load_dwordx4 v5, s[60:63], s4 offen offset:1024 sc1 lds
v_mfma_f32_16x16x32_bf16 v[144:147], a[144:147], a[192:195], v[144:147]
ds_read_b64_tr_b16 a[224:225], v60 offset:32768
v_cvt_pk_bf16_f32 v66, v68, v69
v_mfma_f32_16x16x32_bf16 v[144:147], a[148:151], a[196:199], v[144:147]
ds_read_b64_tr_b16 a[226:227], v60 offset:33792
v_cvt_pk_bf16_f32 v67, v70, v71
v_mfma_f32_16x16x32_bf16 v[148:151], a[152:155], a[192:195], v[148:151]
ds_read_b64_tr_b16 a[228:229], v60 offset:40960
v_accvgpr_write_b32 a0, v64
v_mfma_f32_16x16x32_bf16 v[148:151], a[156:159], a[196:199], v[148:151]
buffer_load_dwordx4 v5, s[60:63], s4 offen offset:2048 sc1 lds
v_mfma_f32_16x16x32_bf16 v[152:155], a[160:163], a[192:195], v[152:155]
ds_read_b64_tr_b16 a[230:231], v60 offset:41984
v_accvgpr_write_b32 a1, v65
v_mfma_f32_16x16x32_bf16 v[152:155], a[164:167], a[196:199], v[152:155]
ds_read_b64_tr_b16 a[232:233], v61 offset:32768
v_accvgpr_write_b32 a2, v66
v_mfma_f32_16x16x32_bf16 v[156:159], a[168:171], a[192:195], v[156:159]
ds_read_b64_tr_b16 a[234:235], v61 offset:33792
v_accvgpr_write_b32 a3, v67
v_mfma_f32_16x16x32_bf16 v[156:159], a[172:175], a[196:199], v[156:159]
buffer_load_dwordx4 v5, s[60:63], s4 offen offset:3072 sc1 lds
v_mfma_f32_16x16x32_bf16 v[208:211], a[144:147], a[200:203], v[208:211]
s_add_u32 s7, s7, 0x8000
ds_read_b64_tr_b16 a[236:237], v61 offset:40960
v_cvt_pk_bf16_f32 v72, v72, v73
v_mfma_f32_16x16x32_bf16 v[208:211], a[148:151], a[204:207], v[208:211]
s_and_b32 s7, s7, 0x1ffff
ds_read_b64_tr_b16 a[238:239], v61 offset:41984
v_cvt_pk_bf16_f32 v73, v74, v75
v_mfma_f32_16x16x32_bf16 v[212:215], a[152:155], a[200:203], v[212:215]
s_add_u32 s4, s4, 0x8000
v_cvt_pk_bf16_f32 v74, v76, v77
v_cvt_pk_bf16_f32 v75, v78, v79
v_mfma_f32_16x16x32_bf16 v[212:215], a[156:159], a[204:207], v[212:215]
buffer_store_dwordx4 a[184:187], v2, s[60:63], s91 offen offset:0
v_mfma_f32_16x16x32_bf16 v[216:219], a[160:163], a[200:203], v[216:219]
s_cmp_eq_u32 s4, s5
s_cselect_b32 s4, s6, s4
v_accvgpr_write_b32 a4, v72
v_accvgpr_write_b32 a5, v73
v_mfma_f32_16x16x32_bf16 v[216:219], a[164:167], a[204:207], v[216:219]
v_accvgpr_write_b32 a6, v74
v_accvgpr_write_b32 a7, v75
v_mfma_f32_16x16x32_bf16 v[220:223], a[168:171], a[200:203], v[220:223]
s_waitcnt vmcnt(13) lgkmcnt(0)
v_cvt_pk_bf16_f32 v96, v96, v97
v_cvt_pk_bf16_f32 v97, v98, v99
v_mfma_f32_16x16x32_bf16 v[220:223], a[172:175], a[204:207], v[220:223]
s_barrier
v_mfma_f32_16x16x32_bf16 v[80:83], a[208:211], a[128:131], v[80:83]
v_cvt_pk_bf16_f32 v98, v100, v101
v_cvt_pk_bf16_f32 v99, v102, v103
v_mfma_f32_16x16x32_bf16 v[80:83], a[212:215], a[132:135], v[80:83]
v_accvgpr_write_b32 a16, v96
v_accvgpr_write_b32 a17, v97
v_mfma_f32_16x16x32_bf16 v[84:87], a[216:219], a[128:131], v[84:87]
v_accvgpr_write_b32 a18, v98
v_accvgpr_write_b32 a19, v99
v_mfma_f32_16x16x32_bf16 v[84:87], a[220:223], a[132:135], v[84:87]
v_cvt_pk_bf16_f32 v104, v104, v105
v_cvt_pk_bf16_f32 v105, v106, v107
v_mfma_f32_16x16x32_bf16 v[88:91], a[224:227], a[128:131], v[88:91]
v_cvt_pk_bf16_f32 v106, v108, v109
v_cvt_pk_bf16_f32 v107, v110, v111
v_mfma_f32_16x16x32_bf16 v[88:91], a[228:231], a[132:135], v[88:91]
v_accvgpr_write_b32 a20, v104
v_accvgpr_write_b32 a21, v105
v_mfma_f32_16x16x32_bf16 v[92:95], a[232:235], a[128:131], v[92:95]
v_accvgpr_write_b32 a22, v106
v_accvgpr_write_b32 a23, v107
v_mfma_f32_16x16x32_bf16 v[92:95], a[236:239], a[132:135], v[92:95]
v_cvt_pk_bf16_f32 v144, v144, v145
v_cvt_pk_bf16_f32 v145, v146, v147
v_mfma_f32_16x16x32_bf16 v[112:115], a[208:211], a[136:139], v[112:115]
v_cvt_pk_bf16_f32 v146, v148, v149
v_cvt_pk_bf16_f32 v147, v150, v151
v_mfma_f32_16x16x32_bf16 v[112:115], a[212:215], a[140:143], v[112:115]
v_accvgpr_write_b32 a32, v144
v_accvgpr_write_b32 a33, v145
v_mfma_f32_16x16x32_bf16 v[116:119], a[216:219], a[136:139], v[116:119]
v_accvgpr_write_b32 a34, v146
v_accvgpr_write_b32 a35, v147
v_mfma_f32_16x16x32_bf16 v[116:119], a[220:223], a[140:143], v[116:119]
buffer_store_dwordx4 a[188:191], v2, s[60:63], s91 offen offset:1024
v_mfma_f32_16x16x32_bf16 v[120:123], a[224:227], a[136:139], v[120:123]
v_cvt_pk_bf16_f32 v152, v152, v153
v_cvt_pk_bf16_f32 v153, v154, v155
v_mfma_f32_16x16x32_bf16 v[120:123], a[228:231], a[140:143], v[120:123]
v_cvt_pk_bf16_f32 v154, v156, v157
v_cvt_pk_bf16_f32 v155, v158, v159
v_mfma_f32_16x16x32_bf16 v[124:127], a[232:235], a[136:139], v[124:127]
v_accvgpr_write_b32 a36, v152
v_accvgpr_write_b32 a37, v153
v_mfma_f32_16x16x32_bf16 v[124:127], a[236:239], a[140:143], v[124:127]
v_accvgpr_write_b32 a38, v154
v_accvgpr_write_b32 a39, v155
v_mfma_f32_16x16x32_bf16 v[176:179], a[208:211], a[192:195], v[176:179]
v_cvt_pk_bf16_f32 v208, v208, v209
v_cvt_pk_bf16_f32 v209, v210, v211
v_mfma_f32_16x16x32_bf16 v[176:179], a[212:215], a[196:199], v[176:179]
v_cvt_pk_bf16_f32 v210, v212, v213
v_cvt_pk_bf16_f32 v211, v214, v215
v_mfma_f32_16x16x32_bf16 v[180:183], a[216:219], a[192:195], v[180:183]
v_accvgpr_write_b32 a48, v208
v_accvgpr_write_b32 a49, v209
v_mfma_f32_16x16x32_bf16 v[180:183], a[220:223], a[196:199], v[180:183]
v_accvgpr_write_b32 a50, v210
v_accvgpr_write_b32 a51, v211
v_mfma_f32_16x16x32_bf16 v[184:187], a[224:227], a[192:195], v[184:187]
v_cvt_pk_bf16_f32 v216, v216, v217
v_cvt_pk_bf16_f32 v217, v218, v219
v_mfma_f32_16x16x32_bf16 v[184:187], a[228:231], a[196:199], v[184:187]
v_cvt_pk_bf16_f32 v218, v220, v221
v_cvt_pk_bf16_f32 v219, v222, v223
v_mfma_f32_16x16x32_bf16 v[188:191], a[232:235], a[192:195], v[188:191]
v_accvgpr_write_b32 a52, v216
v_accvgpr_write_b32 a53, v217
v_mfma_f32_16x16x32_bf16 v[188:191], a[236:239], a[196:199], v[188:191]
v_accvgpr_write_b32 a54, v218
v_accvgpr_write_b32 a55, v219
v_mfma_f32_16x16x32_bf16 v[240:243], a[208:211], a[200:203], v[240:243]
v_cvt_pk_bf16_f32 v80, v80, v81
v_cvt_pk_bf16_f32 v81, v82, v83
v_mfma_f32_16x16x32_bf16 v[240:243], a[212:215], a[204:207], v[240:243]
v_cvt_pk_bf16_f32 v82, v84, v85
v_cvt_pk_bf16_f32 v83, v86, v87
v_mfma_f32_16x16x32_bf16 v[244:247], a[216:219], a[200:203], v[244:247]
v_accvgpr_write_b32 a8, v80
v_accvgpr_write_b32 a9, v81
v_mfma_f32_16x16x32_bf16 v[244:247], a[220:223], a[204:207], v[244:247]
v_accvgpr_write_b32 a10, v82
v_accvgpr_write_b32 a11, v83
v_mfma_f32_16x16x32_bf16 v[248:251], a[224:227], a[200:203], v[248:251]
v_cvt_pk_bf16_f32 v88, v88, v89
v_cvt_pk_bf16_f32 v89, v90, v91
v_mfma_f32_16x16x32_bf16 v[248:251], a[228:231], a[204:207], v[248:251]
v_cvt_pk_bf16_f32 v90, v92, v93
v_cvt_pk_bf16_f32 v91, v94, v95
v_mfma_f32_16x16x32_bf16 v[252:255], a[232:235], a[200:203], v[252:255]
v_accvgpr_write_b32 a12, v88
v_accvgpr_write_b32 a13, v89
v_mfma_f32_16x16x32_bf16 v[252:255], a[236:239], a[204:207], v[252:255]
v_accvgpr_write_b32 a14, v90
v_accvgpr_write_b32 a15, v91
ds_read_b128 a[192:195], v4 offset:49152
ds_read_b128 a[196:199], v4 offset:50176
ds_read_b128 a[200:203], v4 offset:51200
ds_read_b128 a[204:207], v4 offset:52224
v_cvt_pk_bf16_f32 v112, v112, v113
v_cvt_pk_bf16_f32 v113, v114, v115
v_cvt_pk_bf16_f32 v114, v116, v117
ds_read_b128 a[208:211], v4 offset:53248
ds_read_b128 a[212:215], v4 offset:54272
v_cvt_pk_bf16_f32 v115, v118, v119
v_accvgpr_write_b32 a24, v112
v_accvgpr_write_b32 a25, v113
v_accvgpr_write_b32 a26, v114
ds_read_b128 a[216:219], v4 offset:55296
ds_read_b128 a[220:223], v4 offset:56320
v_accvgpr_write_b32 a27, v115
v_cvt_pk_bf16_f32 v120, v120, v121
v_cvt_pk_bf16_f32 v121, v122, v123
v_cvt_pk_bf16_f32 v122, v124, v125
ds_read_b128 a[224:227], v4 offset:57344
ds_read_b128 a[228:231], v4 offset:58368
v_cvt_pk_bf16_f32 v123, v126, v127
v_accvgpr_write_b32 a28, v120
v_accvgpr_write_b32 a29, v121
v_accvgpr_write_b32 a30, v122
ds_read_b128 a[232:235], v4 offset:59392
ds_read_b128 a[236:239], v4 offset:60416
v_accvgpr_write_b32 a31, v123
ds_read_b128 a[240:243], v4 offset:61440
ds_read_b128 a[244:247], v4 offset:62464
ds_read_b128 a[248:251], v4 offset:63488
ds_read_b128 a[252:255], v4 offset:64512
v_mov_b32 v28, 0x3f803f80
v_mov_b32 v29, 0x3f803f80
v_mov_b32 v30, 0x3f803f80
v_mov_b32 v31, 0x3f803f80
v_mov_b64 v[24:25], 0
v_mov_b64 v[26:27], 0
v_mov_b64 v[60:61], 0
v_mov_b64 v[62:63], 0
s_waitcnt lgkmcnt(0)
v_mfma_f32_16x16x32_bf16 v[192:195], a[192:195], a[0:3], 0
s_waitcnt vmcnt(20) lgkmcnt(0)
v_xor_b32 v4, 0x10000, v4
v_cvt_pk_bf16_f32 v176, v176, v177
v_mfma_f32_16x16x32_bf16 v[192:195], a[196:199], a[4:7], v[192:195]
s_barrier
v_mfma_f32_16x16x32_bf16 v[192:195], a[200:203], a[8:11], v[192:195]
s_mov_b32 m0, s7
ds_read_b128 a[128:131], v4 offset:0
v_cvt_pk_bf16_f32 v177, v178, v179
v_mfma_f32_16x16x32_bf16 v[192:195], a[204:207], a[12:15], v[192:195]
buffer_load_dwordx4 v2, s[60:63], s4 offen offset:0 sc1 lds
ds_read_b128 a[132:135], v4 offset:1024
v_mfma_f32_16x16x32_bf16 v[196:199], a[208:211], a[0:3], 0
ds_read_b128 a[136:139], v4 offset:2048
v_cvt_pk_bf16_f32 v178, v180, v181
v_mfma_f32_16x16x32_bf16 v[196:199], a[212:215], a[4:7], v[196:199]
ds_read_b128 a[140:143], v4 offset:3072
v_cvt_pk_bf16_f32 v179, v182, v183
v_mfma_f32_16x16x32_bf16 v[196:199], a[216:219], a[8:11], v[196:199]
buffer_load_dwordx4 v2, s[60:63], s4 offen offset:1024 sc1 lds
ds_read_b128 a[144:147], v4 offset:4096
v_mfma_f32_16x16x32_bf16 v[196:199], a[220:223], a[12:15], v[196:199]
ds_read_b128 a[148:151], v4 offset:5120
v_accvgpr_write_b32 a40, v176
v_mfma_f32_16x16x32_bf16 v[200:203], a[224:227], a[0:3], 0
v_accvgpr_write_b32 a41, v177
v_accvgpr_write_b32 a42, v178
v_mfma_f32_16x16x32_bf16 v[200:203], a[228:231], a[4:7], v[200:203]
buffer_load_dwordx4 v2, s[60:63], s4 offen offset:2048 sc1 lds
v_mfma_f32_16x16x32_bf16 v[200:203], a[232:235], a[8:11], v[200:203]
v_accvgpr_write_b32 a43, v179
v_cvt_pk_bf16_f32 v184, v184, v185
v_mfma_f32_16x16x32_bf16 v[200:203], a[236:239], a[12:15], v[200:203]
v_cvt_pk_bf16_f32 v185, v186, v187
v_cvt_pk_bf16_f32 v186, v188, v189
v_mfma_f32_16x16x32_bf16 v[204:207], a[240:243], a[0:3], 0
buffer_load_dwordx4 v2, s[60:63], s4 offen offset:3072 sc1 lds
v_mfma_f32_16x16x32_bf16 v[204:207], a[244:247], a[4:7], v[204:207]
v_cvt_pk_bf16_f32 v187, v190, v191
v_accvgpr_write_b32 a44, v184
v_mfma_f32_16x16x32_bf16 v[204:207], a[248:251], a[8:11], v[204:207]
s_add_u32 m0, s7, 4096
v_accvgpr_write_b32 a45, v185
v_accvgpr_write_b32 a46, v186
v_mfma_f32_16x16x32_bf16 v[204:207], a[252:255], a[12:15], v[204:207]
buffer_load_dwordx4 v5, s[60:63], s4 offen offset:0 sc1 lds
v_mfma_f32_16x16x32_bf16 v[208:211], a[192:195], a[16:19], 0
ds_read_b128 a[192:195], v4 offset:16384
v_accvgpr_write_b32 a47, v187
v_mfma_f32_16x16x32_bf16 v[208:211], a[196:199], a[20:23], v[208:211]
ds_read_b128 a[196:199], v4 offset:17408
v_cvt_pk_bf16_f32 v240, v240, v241
v_mfma_f32_16x16x32_bf16 v[208:211], a[200:203], a[24:27], v[208:211]
buffer_load_dwordx4 v5, s[60:63], s4 offen offset:1024 sc1 lds
ds_read_b128 a[200:203], v4 offset:18432
v_mfma_f32_16x16x32_bf16 v[208:211], a[204:207], a[28:31], v[208:211]
ds_read_b128 a[204:207], v4 offset:19456
v_cvt_pk_bf16_f32 v241, v242, v243
v_mfma_f32_16x16x32_bf16 v[212:215], a[208:211], a[16:19], 0
ds_read_b128 a[208:211], v4 offset:20480
v_max3_f32 v48, v192, v193, v194
v_mfma_f32_16x16x32_bf16 v[212:215], a[212:215], a[20:23], v[212:215]
buffer_load_dwordx4 v5, s[60:63], s4 offen offset:2048 sc1 lds
ds_read_b128 a[212:215], v4 offset:21504
v_mfma_f32_16x16x32_bf16 v[212:215], a[216:219], a[24:27], v[212:215]
ds_read_b128 a[216:219], v4 offset:22528
v_max3_f32 v48, v48, v195, v196
v_mfma_f32_16x16x32_bf16 v[212:215], a[220:223], a[28:31], v[212:215]
ds_read_b128 a[220:223], v4 offset:23552
v_max3_f32 v48, v48, v197, v198
v_mfma_f32_16x16x32_bf16 v[216:219], a[224:227], a[16:19], 0
buffer_load_dwordx4 v5, s[60:63], s4 offen offset:3072 sc1 lds
ds_read_b128 a[224:227], v4 offset:24576
v_mfma_f32_16x16x32_bf16 v[216:219], a[228:231], a[20:23], v[216:219]
ds_read_b128 a[228:231], v4 offset:25600
v_max3_f32 v48, v48, v199, v200
v_mfma_f32_16x16x32_bf16 v[216:219], a[232:235], a[24:27], v[216:219]
ds_read_b128 a[232:235], v4 offset:26624
v_max3_f32 v48, v48, v201, v202
v_mfma_f32_16x16x32_bf16 v[216:219], a[236:239], a[28:31], v[216:219]
ds_read_b128 a[236:239], v4 offset:27648
v_max3_f32 v48, v48, v203, v204
v_mfma_f32_16x16x32_bf16 v[220:223], a[240:243], a[16:19], 0
ds_read_b128 a[240:243], v4 offset:28672
v_max3_f32 v48, v48, v205, v206
v_mfma_f32_16x16x32_bf16 v[220:223], a[244:247], a[20:23], v[220:223]
ds_read_b128 a[244:247], v4 offset:29696
v_max_f32 v48, v48, v207
v_mfma_f32_16x16x32_bf16 v[220:223], a[248:251], a[24:27], v[220:223]
ds_read_b128 a[248:251], v4 offset:30720
v_mov_b32 v49, v48
v_mfma_f32_16x16x32_bf16 v[220:223], a[252:255], a[28:31], v[220:223]
ds_read_b128 a[252:255], v4 offset:31744
v_permlane32_swap_b32 v48, v49
v_max_f32 v48, v48, v49
v_mov_b32 v49, v48
s_nop 1
v_permlane16_swap_b32 v48, v49
v_max_f32 v48, v48, v49
v_sub_f32 v40, 0xc2ca0000, v48
v_sub_f32 v41, 0xc2ca0000, v48
v_cvt_pk_bf16_f32 v242, v244, v245
v_cvt_pk_bf16_f32 v243, v246, v247
v_accvgpr_write_b32 a56, v240
v_accvgpr_write_b32 a57, v241
v_accvgpr_write_b32 a58, v242
v_accvgpr_write_b32 a59, v243
v_cvt_pk_bf16_f32 v248, v248, v249
v_cvt_pk_bf16_f32 v249, v250, v251
v_cvt_pk_bf16_f32 v250, v252, v253
v_cvt_pk_bf16_f32 v251, v254, v255
v_accvgpr_write_b32 a60, v248
v_accvgpr_write_b32 a61, v249
v_accvgpr_write_b32 a62, v250
v_accvgpr_write_b32 a63, v251
v_pk_add_f32 v[192:193], v[192:193], v[40:41]
v_pk_add_f32 v[194:195], v[194:195], v[40:41]
v_pk_add_f32 v[196:197], v[196:197], v[40:41]
v_pk_add_f32 v[198:199], v[198:199], v[40:41]
v_pk_add_f32 v[200:201], v[200:201], v[40:41]
v_pk_add_f32 v[202:203], v[202:203], v[40:41]
v_pk_add_f32 v[204:205], v[204:205], v[40:41]
v_pk_add_f32 v[206:207], v[206:207], v[40:41]
v_mov_b64 v[42:43], v[40:41]
v_exp_f32 v96, v192
v_exp_f32 v97, v193
v_exp_f32 v98, v194
v_exp_f32 v99, v195
v_exp_f32 v100, v196
v_exp_f32 v101, v197
v_exp_f32 v102, v198
v_exp_f32 v103, v199
v_exp_f32 v104, v200
v_exp_f32 v105, v201
v_exp_f32 v106, v202
v_exp_f32 v107, v203
v_exp_f32 v108, v204
v_exp_f32 v109, v205
v_exp_f32 v110, v206
v_exp_f32 v111, v207
v_max3_f32 v50, v208, v209, v210
v_max3_f32 v50, v50, v211, v212
v_max3_f32 v50, v50, v213, v214
v_max3_f32 v50, v50, v215, v216
v_max3_f32 v50, v50, v217, v218
v_max3_f32 v50, v50, v219, v220
v_max3_f32 v50, v50, v221, v222
v_max_f32 v50, v50, v223
v_mov_b32 v49, v50
s_nop 1
v_permlane32_swap_b32 v50, v49
v_max_f32 v50, v50, v49
v_mov_b32 v49, v50
s_nop 1
v_permlane16_swap_b32 v50, v49
v_max_f32 v50, v50, v49
v_sub_f32 v44, 0xc2ca0000, v50
v_sub_f32 v45, 0xc2ca0000, v50
v_cvt_pk_bf16_f32 v80, v96, v97
v_cvt_pk_bf16_f32 v81, v98, v99
v_cvt_pk_bf16_f32 v82, v100, v101
v_cvt_pk_bf16_f32 v83, v102, v103
v_cvt_pk_bf16_f32 v84, v104, v105
v_cvt_pk_bf16_f32 v85, v106, v107
v_cvt_pk_bf16_f32 v86, v108, v109
v_cvt_pk_bf16_f32 v87, v110, v111
v_pk_add_f32 v[208:209], v[208:209], v[44:45]
v_pk_add_f32 v[210:211], v[210:211], v[44:45]
v_pk_add_f32 v[212:213], v[212:213], v[44:45]
v_pk_add_f32 v[214:215], v[214:215], v[44:45]
v_pk_add_f32 v[216:217], v[216:217], v[44:45]
v_pk_add_f32 v[218:219], v[218:219], v[44:45]
v_pk_add_f32 v[220:221], v[220:221], v[44:45]
v_pk_add_f32 v[222:223], v[222:223], v[44:45]
v_mov_b64 v[46:47], v[44:45]
s_add_u32 s7, s7, 0x8000
s_and_b32 s7, s7, 0x1ffff
s_add_u32 s4, s4, 0x8000
s_cmp_eq_u32 s4, s5
s_cselect_b32 s4, s6, s4
s_waitcnt lgkmcnt(0)
v_mfma_f32_16x16x32_bf16 v[32:35], v[28:31], v[80:83], v[24:27]
s_mov_b32 s81, 0x0
ds_read_b128 a[152:155], v4 offset:6144
ds_read_b128 a[156:159], v4 offset:7168
v_mfma_f32_16x16x32_bf16 v[32:35], v[28:31], v[84:87], v[32:35]
s_waitcnt lgkmcnt(5)
v_exp_f32 v112, v208
v_mfma_f32_16x16x32_bf16 v[224:227], a[192:195], a[0:3], v[40:43]
ds_read_b128 a[160:163], v4 offset:8192
ds_read_b128 a[164:167], v4 offset:9216
v_mfma_f32_16x16x32_bf16 v[224:227], a[196:199], a[4:7], v[224:227]
s_mov_b32 m0, s7
v_exp_f32 v113, v209
v_mfma_f32_16x16x32_bf16 v[224:227], a[200:203], a[8:11], v[224:227]
buffer_load_dwordx4 v2, s[60:63], s4 offen offset:0 sc1 lds
v_mfma_f32_16x16x32_bf16 v[224:227], a[204:207], a[12:15], v[224:227]
v_exp_f32 v114, v210
v_mfma_f32_16x16x32_bf16 v[228:231], a[208:211], a[0:3], v[40:43]
ds_read_b128 a[168:171], v4 offset:10240
ds_read_b128 a[172:175], v4 offset:11264
v_mfma_f32_16x16x32_bf16 v[228:231], a[212:215], a[4:7], v[228:231]
v_exp_f32 v115, v211
v_mfma_f32_16x16x32_bf16 v[228:231], a[216:219], a[8:11], v[228:231]
buffer_load_dwordx4 v2, s[60:63], s4 offen offset:1024 sc1 lds
v_mfma_f32_16x16x32_bf16 v[228:231], a[220:223], a[12:15], v[228:231]
v_exp_f32 v116, v212
v_mfma_f32_16x16x32_bf16 v[232:235], a[224:227], a[0:3], v[40:43]
ds_read_b128 a[176:179], v4 offset:12288
v_cmp_lt_f32 vcc, s10, v32
v_mfma_f32_16x16x32_bf16 v[232:235], a[228:231], a[4:7], v[232:235]
v_exp_f32 v117, v213
v_mfma_f32_16x16x32_bf16 v[232:235], a[232:235], a[8:11], v[232:235]
buffer_load_dwordx4 v2, s[60:63], s4 offen offset:2048 sc1 lds
v_mfma_f32_16x16x32_bf16 v[232:235], a[236:239], a[12:15], v[232:235]
v_exp_f32 v118, v214
v_mfma_f32_16x16x32_bf16 v[236:239], a[240:243], a[0:3], v[40:43]
ds_read_b128 a[180:183], v4 offset:13312
ds_read_b128 a[184:187], v4 offset:14336
v_mfma_f32_16x16x32_bf16 v[236:239], a[244:247], a[4:7], v[236:239]
v_exp_f32 v119, v215
v_mfma_f32_16x16x32_bf16 v[236:239], a[248:251], a[8:11], v[236:239]
buffer_load_dwordx4 v2, s[60:63], s4 offen offset:3072 sc1 lds
v_mfma_f32_16x16x32_bf16 v[236:239], a[252:255], a[12:15], v[236:239]
s_cbranch_vccnz Lstub33
Lret34:
v_exp_f32 v120, v216
v_mfma_f32_16x16x32_bf16 v[128:131], a[128:131], v[80:83], 0
s_waitcnt lgkmcnt(2)
ds_read_b128 a[188:191], v4 offset:15360
v_cvt_pk_bf16_f32 v88, v112, v113
v_mfma_f32_16x16x32_bf16 v[128:131], a[132:135], v[84:87], v[128:131]
s_add_u32 m0, s7, 4096
v_exp_f32 v121, v217
v_mfma_f32_16x16x32_bf16 v[132:135], a[136:139], v[80:83], 0
buffer_load_dwordx4 v5, s[60:63], s4 offen offset:0 sc1 lds
v_mfma_f32_16x16x32_bf16 v[132:135], a[140:143], v[84:87], v[132:135]
v_exp_f32 v122, v218
v_mfma_f32_16x16x32_bf16 v[136:139], a[144:147], v[80:83], 0
v_cvt_pk_bf16_f32 v89, v114, v115
v_sub_f32 v8, s81, v23 clamp
v_mfma_f32_16x16x32_bf16 v[136:139], a[148:151], v[84:87], v[136:139]
s_mov_b32 s81, 0x3f800000
v_exp_f32 v123, v219
v_mfma_f32_16x16x32_bf16 v[140:143], a[152:155], v[80:83], 0
buffer_load_dwordx4 v5, s[60:63], s4 offen offset:1024 sc1 lds
v_mfma_f32_16x16x32_bf16 v[140:143], a[156:159], v[84:87], v[140:143]
v_exp_f32 v124, v220
v_mfma_f32_16x16x32_bf16 v[144:147], a[160:163], v[80:83], 0
v_cvt_pk_bf16_f32 v90, v116, v117
v_cvt_pk_bf16_f32 v91, v118, v119
v_mfma_f32_16x16x32_bf16 v[144:147], a[164:167], v[84:87], v[144:147]
v_exp_f32 v125, v221
v_mfma_f32_16x16x32_bf16 v[148:151], a[168:171], v[80:83], 0
buffer_load_dwordx4 v5, s[60:63], s4 offen offset:2048 sc1 lds
v_mfma_f32_16x16x32_bf16 v[148:151], a[172:175], v[84:87], v[148:151]
v_exp_f32 v126, v222
v_mfma_f32_16x16x32_bf16 v[152:155], a[176:179], v[80:83], 0
s_waitcnt lgkmcnt(0)
v_cvt_pk_bf16_f32 v92, v120, v121
v_cvt_pk_bf16_f32 v93, v122, v123
v_mfma_f32_16x16x32_bf16 v[152:155], a[180:183], v[84:87], v[152:155]
v_exp_f32 v127, v223
v_mfma_f32_16x16x32_bf16 v[156:159], a[184:187], v[80:83], 0
buffer_load_dwordx4 v5, s[60:63], s4 offen offset:3072 sc1 lds
v_mfma_f32_16x16x32_bf16 v[156:159], a[188:191], v[84:87], v[156:159]
s_waitcnt vmcnt(16) lgkmcnt(0)
v_cvt_pk_bf16_f32 v94, v124, v125
v_cvt_pk_bf16_f32 v95, v126, v127
v_mfma_f32_16x16x32_bf16 v[36:39], v[28:31], v[88:91], v[60:63]
s_barrier
v_mfma_f32_16x16x32_bf16 v[36:39], v[28:31], v[92:95], v[36:39]
v_exp_f32 v96, v224
v_mfma_f32_16x16x32_bf16 v[240:243], a[192:195], a[16:19], v[44:47]
ds_read_b128 a[192:195], v4 offset:49152
s_cmp_lg_u32 s3, 0
s_cbranch_scc1 Lpub41
s_cmp_lg_u32 s17, 0
s_cbranch_scc1 Lwb42
Lwbd43:
s_add_u32 s16, s16, 256
s_mov_b64 exec, 1
v_mov_b32 v56, s16
buffer_store_dword v56, off, s[60:63], s0 sc1
s_mov_b64 exec, -1
s_add_u32 s0, s0, 4096
Lpub41:
v_mfma_f32_16x16x32_bf16 v[240:243], a[196:199], a[20:23], v[240:243]
v_exp_f32 v97, v225
v_mfma_f32_16x16x32_bf16 v[240:243], a[200:203], a[24:27], v[240:243]
s_add_u32 s7, s7, 0x8000
ds_read_b128 a[196:199], v4 offset:50176
v_cvt_pk_bf16_f32 v80, v96, v97
v_mfma_f32_16x16x32_bf16 v[240:243], a[204:207], a[28:31], v[240:243]
v_exp_f32 v98, v226
v_mfma_f32_16x16x32_bf16 v[244:247], a[208:211], a[16:19], v[44:47]
s_and_b32 s7, s7, 0x1ffff
ds_read_b128 a[200:203], v4 offset:51200
ds_read_b128 a[204:207], v4 offset:52224
v_mfma_f32_16x16x32_bf16 v[244:247], a[212:215], a[20:23], v[244:247]
v_exp_f32 v99, v227
v_mfma_f32_16x16x32_bf16 v[244:247], a[216:219], a[24:27], v[244:247]
s_add_u32 s4, s4, 0x8000
ds_read_b128 a[208:211], v4 offset:53248
v_cmp_lt_f32 vcc, s10, v36
v_mfma_f32_16x16x32_bf16 v[244:247], a[220:223], a[28:31], v[244:247]
v_exp_f32 v100, v228
v_mfma_f32_16x16x32_bf16 v[248:251], a[224:227], a[16:19], v[44:47]
s_cmp_eq_u32 s4, s5
ds_read_b128 a[212:215], v4 offset:54272
ds_read_b128 a[216:219], v4 offset:55296
v_mfma_f32_16x16x32_bf16 v[248:251], a[228:231], a[20:23], v[248:251]
v_exp_f32 v101, v229
v_mfma_f32_16x16x32_bf16 v[248:251], a[232:235], a[24:27], v[248:251]
s_cselect_b32 s4, s6, s4
ds_read_b128 a[220:223], v4 offset:56320
v_cvt_pk_bf16_f32 v81, v98, v99
v_mfma_f32_16x16x32_bf16 v[248:251], a[236:239], a[28:31], v[248:251]
v_exp_f32 v102, v230
v_mfma_f32_16x16x32_bf16 v[252:255], a[240:243], a[16:19], v[44:47]
ds_read_b128 a[224:227], v4 offset:57344
v_cvt_pk_bf16_f32 v82, v100, v101
v_mfma_f32_16x16x32_bf16 v[252:255], a[244:247], a[20:23], v[252:255]
v_exp_f32 v103, v231
v_mfma_f32_16x16x32_bf16 v[252:255], a[248:251], a[24:27], v[252:255]
ds_read_b128 a[228:231], v4 offset:58368
v_cvt_pk_bf16_f32 v83, v102, v103
v_mfma_f32_16x16x32_bf16 v[252:255], a[252:255], a[28:31], v[252:255]
s_cbranch_vccnz Lstub35
Lret36:
v_exp_f32 v104, v232
v_mfma_f32_16x16x32_bf16 v[160:163], a[128:131], v[88:91], 0
ds_read_b128 a[232:235], v4 offset:59392
ds_read_b128 a[236:239], v4 offset:60416
v_mfma_f32_16x16x32_bf16 v[160:163], a[132:135], v[92:95], v[160:163]
v_exp_f32 v105, v233
v_mfma_f32_16x16x32_bf16 v[164:167], a[136:139], v[88:91], 0
ds_read_b128 a[240:243], v4 offset:61440
ds_read_b128 a[244:247], v4 offset:62464
v_mfma_f32_16x16x32_bf16 v[164:167], a[140:143], v[92:95], v[164:167]
v_exp_f32 v106, v234
v_mfma_f32_16x16x32_bf16 v[168:171], a[144:147], v[88:91], 0
ds_read_b128 a[248:251], v4 offset:63488
ds_read_b128 a[252:255], v4 offset:64512
v_mfma_f32_16x16x32_bf16 v[168:171], a[148:151], v[92:95], v[168:171]
v_exp_f32 v107, v235
v_mfma_f32_16x16x32_bf16 v[172:175], a[152:155], v[88:91], 0
ds_read_b128 a[128:131], v4 offset:32768
ds_read_b128 a[132:135], v4 offset:33792
v_mfma_f32_16x16x32_bf16 v[172:175], a[156:159], v[92:95], v[172:175]
v_exp_f32 v108, v236
v_mfma_f32_16x16x32_bf16 v[176:179], a[160:163], v[88:91], 0
ds_read_b128 a[136:139], v4 offset:34816
ds_read_b128 a[140:143], v4 offset:35840
v_mfma_f32_16x16x32_bf16 v[176:179], a[164:167], v[92:95], v[176:179]
v_exp_f32 v109, v237
v_mfma_f32_16x16x32_bf16 v[180:183], a[168:171], v[88:91], 0
ds_read_b128 a[144:147], v4 offset:36864
v_cvt_pk_bf16_f32 v84, v104, v105
v_mfma_f32_16x16x32_bf16 v[180:183], a[172:175], v[92:95], v[180:183]
v_exp_f32 v110, v238
v_mfma_f32_16x16x32_bf16 v[184:187], a[176:179], v[88:91], 0
ds_read_b128 a[148:151], v4 offset:37888
v_cvt_pk_bf16_f32 v85, v106, v107
v_mfma_f32_16x16x32_bf16 v[184:187], a[180:183], v[92:95], v[184:187]
v_exp_f32 v111, v239
v_mfma_f32_16x16x32_bf16 v[188:191], a[184:187], v[88:91], 0
ds_read_b128 a[152:155], v4 offset:38912
v_cvt_pk_bf16_f32 v86, v108, v109
v_mfma_f32_16x16x32_bf16 v[188:191], a[188:191], v[92:95], v[188:191]
ds_read_b128 a[156:159], v4 offset:39936
v_cvt_pk_bf16_f32 v87, v110, v111
v_mfma_f32_16x16x32_bf16 v[24:27], v[28:31], v[80:83], v[32:35]
ds_read_b128 a[160:163], v4 offset:40960
ds_read_b128 a[164:167], v4 offset:41984
v_mfma_f32_16x16x32_bf16 v[24:27], v[28:31], v[84:87], v[24:27]
s_waitcnt lgkmcnt(6)
v_exp_f32 v112, v240
v_mfma_f32_16x16x32_bf16 v[192:195], a[192:195], a[0:3], v[40:43]
ds_read_b128 a[168:171], v4 offset:43008
ds_read_b128 a[172:175], v4 offset:44032
v_mfma_f32_16x16x32_bf16 v[192:195], a[196:199], a[4:7], v[192:195]
s_mov_b32 m0, s7
v_exp_f32 v113, v241
v_mfma_f32_16x16x32_bf16 v[192:195], a[200:203], a[8:11], v[192:195]
buffer_load_dwordx4 v2, s[60:63], s4 offen offset:0 sc1 lds
v_mfma_f32_16x16x32_bf16 v[192:195], a[204:207], a[12:15], v[192:195]
v_exp_f32 v114, v242
v_mfma_f32_16x16x32_bf16 v[196:199], a[208:211], a[0:3], v[40:43]
ds_read_b128 a[176:179], v4 offset:45056
ds_read_b128 a[180:183], v4 offset:46080
v_mfma_f32_16x16x32_bf16 v[196:199], a[212:215], a[4:7], v[196:199]
v_exp_f32 v115, v243
v_mfma_f32_16x16x32_bf16 v[196:199], a[216:219], a[8:11], v[196:199]
buffer_load_dwordx4 v2, s[60:63], s4 offen offset:1024 sc1 lds
v_mfma_f32_16x16x32_bf16 v[196:199], a[220:223], a[12:15], v[196:199]
v_exp_f32 v116, v244
v_mfma_f32_16x16x32_bf16 v[200:203], a[224:227], a[0:3], v[40:43]
v_cvt_pk_bf16_f32 v88, v112, v113
v_cmp_lt_f32 vcc, s10, v24
v_mfma_f32_16x16x32_bf16 v[200:203], a[228:231], a[4:7], v[200:203]
v_exp_f32 v117, v245
v_mfma_f32_16x16x32_bf16 v[200:203], a[232:235], a[8:11], v[200:203]
buffer_load_dwordx4 v2, s[60:63], s4 offen offset:2048 sc1 lds
v_mfma_f32_16x16x32_bf16 v[200:203], a[236:239], a[12:15], v[200:203]
v_exp_f32 v118, v246
v_mfma_f32_16x16x32_bf16 v[204:207], a[240:243], a[0:3], v[40:43]
ds_read_b128 a[184:187], v4 offset:47104
v_cvt_pk_bf16_f32 v89, v114, v115
v_mfma_f32_16x16x32_bf16 v[204:207], a[244:247], a[4:7], v[204:207]
v_exp_f32 v119, v247
v_mfma_f32_16x16x32_bf16 v[204:207], a[248:251], a[8:11], v[204:207]
buffer_load_dwordx4 v2, s[60:63], s4 offen offset:3072 sc1 lds
v_mfma_f32_16x16x32_bf16 v[204:207], a[252:255], a[12:15], v[204:207]
s_cbranch_vccnz Lstub37
Lret38:
v_exp_f32 v120, v248
v_mfma_f32_16x16x32_bf16 v[128:131], a[128:131], v[80:83], v[128:131]
ds_read_b128 a[188:191], v4 offset:48128
v_cvt_pk_bf16_f32 v90, v116, v117
v_mfma_f32_16x16x32_bf16 v[128:131], a[132:135], v[84:87], v[128:131]
s_add_u32 m0, s7, 4096
v_exp_f32 v121, v249
v_mfma_f32_16x16x32_bf16 v[132:135], a[136:139], v[80:83], v[132:135]
buffer_load_dwordx4 v5, s[60:63], s4 offen offset:0 sc1 lds
v_mfma_f32_16x16x32_bf16 v[132:135], a[140:143], v[84:87], v[132:135]
s_waitcnt lgkmcnt(2)
v_exp_f32 v122, v250
v_mfma_f32_16x16x32_bf16 v[136:139], a[144:147], v[80:83], v[136:139]
v_cvt_pk_bf16_f32 v91, v118, v119
v_cvt_pk_bf16_f32 v92, v120, v121
v_mfma_f32_16x16x32_bf16 v[136:139], a[148:151], v[84:87], v[136:139]
v_exp_f32 v123, v251
v_mfma_f32_16x16x32_bf16 v[140:143], a[152:155], v[80:83], v[140:143]
buffer_load_dwordx4 v5, s[60:63], s4 offen offset:1024 sc1 lds
v_mfma_f32_16x16x32_bf16 v[140:143], a[156:159], v[84:87], v[140:143]
v_exp_f32 v124, v252
v_mfma_f32_16x16x32_bf16 v[144:147], a[160:163], v[80:83], v[144:147]
v_cvt_pk_bf16_f32 v93, v122, v123
v_sub_f32 v9, s81, v23 clamp
v_mfma_f32_16x16x32_bf16 v[144:147], a[164:167], v[84:87], v[144:147]
s_mov_b32 s81, 0x40000000
v_exp_f32 v125, v253
v_mfma_f32_16x16x32_bf16 v[148:151], a[168:171], v[80:83], v[148:151]
buffer_load_dwordx4 v5, s[60:63], s4 offen offset:2048 sc1 lds
v_mfma_f32_16x16x32_bf16 v[148:151], a[172:175], v[84:87], v[148:151]
v_exp_f32 v126, v254
v_mfma_f32_16x16x32_bf16 v[152:155], a[176:179], v[80:83], v[152:155]
s_waitcnt lgkmcnt(0)
v_xor_b32 v4, 0x10000, v4
v_sub_f32 v10, s81, v23 clamp
v_mfma_f32_16x16x32_bf16 v[152:155], a[180:183], v[84:87], v[152:155]
s_mov_b32 s81, 0x40400000
v_exp_f32 v127, v255
v_mfma_f32_16x16x32_bf16 v[156:159], a[184:187], v[80:83], v[156:159]
buffer_load_dwordx4 v5, s[60:63], s4 offen offset:3072 sc1 lds
v_mfma_f32_16x16x32_bf16 v[156:159], a[188:191], v[84:87], v[156:159]
s_waitcnt vmcnt(16) lgkmcnt(0)
v_cvt_pk_bf16_f32 v94, v124, v125
v_cvt_pk_bf16_f32 v95, v126, v127
v_mfma_f32_16x16x32_bf16 v[60:63], v[28:31], v[88:91], v[36:39]
s_barrier
v_mfma_f32_16x16x32_bf16 v[60:63], v[28:31], v[92:95], v[60:63]
v_exp_f32 v96, v192
v_mfma_f32_16x16x32_bf16 v[208:211], a[192:195], a[16:19], v[44:47]
ds_read_b128 a[192:195], v4 offset:16384
v_sub_f32 v11, s81, v23 clamp
v_mfma_f32_16x16x32_bf16 v[208:211], a[196:199], a[20:23], v[208:211]
s_mov_b32 s81, 0x41800000
v_exp_f32 v97, v193
v_mfma_f32_16x16x32_bf16 v[208:211], a[200:203], a[24:27], v[208:211]
s_add_u32 s7, s7, 0x8000
ds_read_b128 a[196:199], v4 offset:17408
v_cvt_pk_bf16_f32 v80, v96, v97
v_mfma_f32_16x16x32_bf16 v[208:211], a[204:207], a[28:31], v[208:211]
v_exp_f32 v98, v194
v_mfma_f32_16x16x32_bf16 v[212:215], a[208:211], a[16:19], v[44:47]
s_and_b32 s7, s7, 0x1ffff
ds_read_b128 a[200:203], v4 offset:18432
ds_read_b128 a[204:207], v4 offset:19456
v_mfma_f32_16x16x32_bf16 v[212:215], a[212:215], a[20:23], v[212:215]
v_exp_f32 v99, v195
v_mfma_f32_16x16x32_bf16 v[212:215], a[216:219], a[24:27], v[212:215]
s_add_u32 s4, s4, 0x8000
ds_read_b128 a[208:211], v4 offset:20480
v_cmp_lt_f32 vcc, s10, v60
v_mfma_f32_16x16x32_bf16 v[212:215], a[220:223], a[28:31], v[212:215]
v_exp_f32 v100, v196
v_mfma_f32_16x16x32_bf16 v[216:219], a[224:227], a[16:19], v[44:47]
s_cmp_eq_u32 s4, s5
ds_read_b128 a[212:215], v4 offset:21504
ds_read_b128 a[216:219], v4 offset:22528
v_mfma_f32_16x16x32_bf16 v[216:219], a[228:231], a[20:23], v[216:219]
v_exp_f32 v101, v197
v_mfma_f32_16x16x32_bf16 v[216:219], a[232:235], a[24:27], v[216:219]
s_cselect_b32 s4, s6, s4
ds_read_b128 a[220:223], v4 offset:23552
v_cvt_pk_bf16_f32 v81, v98, v99
v_mfma_f32_16x16x32_bf16 v[216:219], a[236:239], a[28:31], v[216:219]
v_exp_f32 v102, v198
v_mfma_f32_16x16x32_bf16 v[220:223], a[240:243], a[16:19], v[44:47]
ds_read_b128 a[224:227], v4 offset:24576
v_cvt_pk_bf16_f32 v82, v100, v101
v_mfma_f32_16x16x32_bf16 v[220:223], a[244:247], a[20:23], v[220:223]
v_exp_f32 v103, v199
v_mfma_f32_16x16x32_bf16 v[220:223], a[248:251], a[24:27], v[220:223]
ds_read_b128 a[228:231], v4 offset:25600
ds_read_b128 a[232:235], v4 offset:26624
v_mfma_f32_16x16x32_bf16 v[220:223], a[252:255], a[28:31], v[220:223]
s_cbranch_vccnz Lstub39
Lret40:
v_exp_f32 v104, v200
v_mfma_f32_16x16x32_bf16 v[160:163], a[128:131], v[88:91], v[160:163]
ds_read_b128 a[236:239], v4 offset:27648
ds_read_b128 a[240:243], v4 offset:28672
v_mfma_f32_16x16x32_bf16 v[160:163], a[132:135], v[92:95], v[160:163]
v_exp_f32 v105, v201
v_mfma_f32_16x16x32_bf16 v[164:167], a[136:139], v[88:91], v[164:167]
ds_read_b128 a[244:247], v4 offset:29696
ds_read_b128 a[248:251], v4 offset:30720
v_mfma_f32_16x16x32_bf16 v[164:167], a[140:143], v[92:95], v[164:167]
v_exp_f32 v106, v202
v_mfma_f32_16x16x32_bf16 v[168:171], a[144:147], v[88:91], v[168:171]
ds_read_b128 a[252:255], v4 offset:31744
ds_read_b128 a[128:131], v4 offset:0
v_mfma_f32_16x16x32_bf16 v[168:171], a[148:151], v[92:95], v[168:171]
v_exp_f32 v107, v203
v_mfma_f32_16x16x32_bf16 v[172:175], a[152:155], v[88:91], v[172:175]
ds_read_b128 a[132:135], v4 offset:1024
v_cvt_pk_bf16_f32 v83, v102, v103
v_mfma_f32_16x16x32_bf16 v[172:175], a[156:159], v[92:95], v[172:175]
v_exp_f32 v108, v204
v_mfma_f32_16x16x32_bf16 v[176:179], a[160:163], v[88:91], v[176:179]
ds_read_b128 a[136:139], v4 offset:2048
v_cvt_pk_bf16_f32 v84, v104, v105
v_mfma_f32_16x16x32_bf16 v[176:179], a[164:167], v[92:95], v[176:179]
v_exp_f32 v109, v205
v_mfma_f32_16x16x32_bf16 v[180:183], a[168:171], v[88:91], v[180:183]
ds_read_b128 a[140:143], v4 offset:3072
v_cvt_pk_bf16_f32 v85, v106, v107
v_mfma_f32_16x16x32_bf16 v[180:183], a[172:175], v[92:95], v[180:183]
v_exp_f32 v110, v206
v_mfma_f32_16x16x32_bf16 v[184:187], a[176:179], v[88:91], v[184:187]
ds_read_b128 a[144:147], v4 offset:4096
v_cvt_pk_bf16_f32 v86, v108, v109
v_mfma_f32_16x16x32_bf16 v[184:187], a[180:183], v[92:95], v[184:187]
v_exp_f32 v111, v207
v_mfma_f32_16x16x32_bf16 v[188:191], a[184:187], v[88:91], v[188:191]
ds_read_b128 a[148:151], v4 offset:5120
v_cvt_pk_bf16_f32 v87, v110, v111
v_sub_f32 v12, s81, v23 clamp
s_mov_b32 s81, 0x41880000
v_sub_f32 v13, s81, v23 clamp
s_mov_b32 s81, 0x41900000
v_sub_f32 v14, s81, v23 clamp
s_mov_b32 s81, 0x41980000
v_sub_f32 v15, s81, v23 clamp
v_mfma_f32_16x16x32_bf16 v[188:191], a[188:191], v[92:95], v[188:191]
v_mfma_f32_16x16x32_bf16 v[32:35], v[28:31], v[80:83], v[24:27]
s_mov_b32 s81, 0x42000000
ds_read_b128 a[152:155], v4 offset:6144
ds_read_b128 a[156:159], v4 offset:7168
v_mfma_f32_16x16x32_bf16 v[32:35], v[28:31], v[84:87], v[32:35]
s_waitcnt lgkmcnt(5)
v_exp_f32 v112, v208
v_mfma_f32_16x16x32_bf16 v[224:227], a[192:195], a[0:3], v[40:43]
ds_read_b128 a[160:163], v4 offset:8192
ds_read_b128 a[164:167], v4 offset:9216
v_mfma_f32_16x16x32_bf16 v[224:227], a[196:199], a[4:7], v[224:227]
s_mov_b32 m0, s7
v_exp_f32 v113, v209
v_mfma_f32_16x16x32_bf16 v[224:227], a[200:203], a[8:11], v[224:227]
buffer_load_dwordx4 v2, s[60:63], s4 offen offset:0 sc1 lds
v_mfma_f32_16x16x32_bf16 v[224:227], a[204:207], a[12:15], v[224:227]
v_exp_f32 v114, v210
v_mfma_f32_16x16x32_bf16 v[228:231], a[208:211], a[0:3], v[40:43]
ds_read_b128 a[168:171], v4 offset:10240
ds_read_b128 a[172:175], v4 offset:11264
v_mfma_f32_16x16x32_bf16 v[228:231], a[212:215], a[4:7], v[228:231]
v_exp_f32 v115, v211
v_mfma_f32_16x16x32_bf16 v[228:231], a[216:219], a[8:11], v[228:231]
buffer_load_dwordx4 v2, s[60:63], s4 offen offset:1024 sc1 lds
v_mfma_f32_16x16x32_bf16 v[228:231], a[220:223], a[12:15], v[228:231]
v_exp_f32 v116, v212
v_mfma_f32_16x16x32_bf16 v[232:235], a[224:227], a[0:3], v[40:43]
ds_read_b128 a[176:179], v4 offset:12288
v_cmp_lt_f32 vcc, s10, v32
v_mfma_f32_16x16x32_bf16 v[232:235], a[228:231], a[4:7], v[232:235]
v_exp_f32 v117, v213
v_mfma_f32_16x16x32_bf16 v[232:235], a[232:235], a[8:11], v[232:235]
buffer_load_dwordx4 v2, s[60:63], s4 offen offset:2048 sc1 lds
v_mfma_f32_16x16x32_bf16 v[232:235], a[236:239], a[12:15], v[232:235]
v_exp_f32 v118, v214
v_mfma_f32_16x16x32_bf16 v[236:239], a[240:243], a[0:3], v[40:43]
ds_read_b128 a[180:183], v4 offset:13312
ds_read_b128 a[184:187], v4 offset:14336
v_mfma_f32_16x16x32_bf16 v[236:239], a[244:247], a[4:7], v[236:239]
v_exp_f32 v119, v215
v_mfma_f32_16x16x32_bf16 v[236:239], a[248:251], a[8:11], v[236:239]
buffer_load_dwordx4 v2, s[60:63], s4 offen offset:3072 sc1 lds
v_mfma_f32_16x16x32_bf16 v[236:239], a[252:255], a[12:15], v[236:239]
s_cbranch_vccnz Lstub44
Lret45:
v_exp_f32 v120, v216
v_mfma_f32_16x16x32_bf16 v[128:131], a[128:131], v[80:83], v[128:131]
s_waitcnt lgkmcnt(2)
ds_read_b128 a[188:191], v4 offset:15360
v_cvt_pk_bf16_f32 v88, v112, v113
v_mfma_f32_16x16x32_bf16 v[128:131], a[132:135], v[84:87], v[128:131]
s_add_u32 m0, s7, 4096
v_exp_f32 v121, v217
v_mfma_f32_16x16x32_bf16 v[132:135], a[136:139], v[80:83], v[132:135]
buffer_load_dwordx4 v5, s[60:63], s4 offen offset:0 sc1 lds
v_mfma_f32_16x16x32_bf16 v[132:135], a[140:143], v[84:87], v[132:135]
v_exp_f32 v122, v218
v_mfma_f32_16x16x32_bf16 v[136:139], a[144:147], v[80:83], v[136:139]
v_cvt_pk_bf16_f32 v89, v114, v115
v_sub_f32 v16, s81, v23 clamp
v_mfma_f32_16x16x32_bf16 v[136:139], a[148:151], v[84:87], v[136:139]
s_mov_b32 s81, 0x42040000
v_exp_f32 v123, v219
v_mfma_f32_16x16x32_bf16 v[140:143], a[152:155], v[80:83], v[140:143]
buffer_load_dwordx4 v5, s[60:63], s4 offen offset:1024 sc1 lds
v_mfma_f32_16x16x32_bf16 v[140:143], a[156:159], v[84:87], v[140:143]
v_exp_f32 v124, v220
v_mfma_f32_16x16x32_bf16 v[144:147], a[160:163], v[80:83], v[144:147]
v_cvt_pk_bf16_f32 v90, v116, v117
v_cvt_pk_bf16_f32 v91, v118, v119
v_mfma_f32_16x16x32_bf16 v[144:147], a[164:167], v[84:87], v[144:147]
v_exp_f32 v125, v221
v_mfma_f32_16x16x32_bf16 v[148:151], a[168:171], v[80:83], v[148:151]
buffer_load_dwordx4 v5, s[60:63], s4 offen offset:2048 sc1 lds
v_mfma_f32_16x16x32_bf16 v[148:151], a[172:175], v[84:87], v[148:151]
v_exp_f32 v126, v222
v_mfma_f32_16x16x32_bf16 v[152:155], a[176:179], v[80:83], v[152:155]
s_waitcnt lgkmcnt(0)
v_cvt_pk_bf16_f32 v92, v120, v121
v_cvt_pk_bf16_f32 v93, v122, v123
v_mfma_f32_16x16x32_bf16 v[152:155], a[180:183], v[84:87], v[152:155]
v_exp_f32 v127, v223
v_mfma_f32_16x16x32_bf16 v[156:159], a[184:187], v[80:83], v[156:159]
buffer_load_dwordx4 v5, s[60:63], s4 offen offset:3072 sc1 lds
v_mfma_f32_16x16x32_bf16 v[156:159], a[188:191], v[84:87], v[156:159]
s_waitcnt vmcnt(16) lgkmcnt(0)
v_cvt_pk_bf16_f32 v94, v124, v125
v_cvt_pk_bf16_f32 v95, v126, v127
v_mfma_f32_16x16x32_bf16 v[36:39], v[28:31], v[88:91], v[60:63]
s_barrier
v_mfma_f32_16x16x32_bf16 v[36:39], v[28:31], v[92:95], v[36:39]
v_exp_f32 v96, v224
v_mfma_f32_16x16x32_bf16 v[240:243], a[192:195], a[16:19], v[44:47]
ds_read_b128 a[192:195], v4 offset:49152
v_sub_f32 v17, s81, v23 clamp
v_mfma_f32_16x16x32_bf16 v[240:243], a[196:199], a[20:23], v[240:243]
s_mov_b32 s81, 0x42080000
v_exp_f32 v97, v225
v_mfma_f32_16x16x32_bf16 v[240:243], a[200:203], a[24:27], v[240:243]
s_add_u32 s7, s7, 0x8000
ds_read_b128 a[196:199], v4 offset:50176
v_cvt_pk_bf16_f32 v80, v96, v97
v_mfma_f32_16x16x32_bf16 v[240:243], a[204:207], a[28:31], v[240:243]
v_exp_f32 v98, v226
v_mfma_f32_16x16x32_bf16 v[244:247], a[208:211], a[16:19], v[44:47]
s_and_b32 s7, s7, 0x1ffff
ds_read_b128 a[200:203], v4 offset:51200
ds_read_b128 a[204:207], v4 offset:52224
v_mfma_f32_16x16x32_bf16 v[244:247], a[212:215], a[20:23], v[244:247]
v_exp_f32 v99, v227
v_mfma_f32_16x16x32_bf16 v[244:247], a[216:219], a[24:27], v[244:247]
s_add_u32 s4, s4, 0x8000
ds_read_b128 a[208:211], v4 offset:53248
v_cmp_lt_f32 vcc, s10, v36
v_mfma_f32_16x16x32_bf16 v[244:247], a[220:223], a[28:31], v[244:247]
v_exp_f32 v100, v228
v_mfma_f32_16x16x32_bf16 v[248:251], a[224:227], a[16:19], v[44:47]
s_cmp_eq_u32 s4, s5
ds_read_b128 a[212:215], v4 offset:54272
ds_read_b128 a[216:219], v4 offset:55296
v_mfma_f32_16x16x32_bf16 v[248:251], a[228:231], a[20:23], v[248:251]
v_exp_f32 v101, v229
v_mfma_f32_16x16x32_bf16 v[248:251], a[232:235], a[24:27], v[248:251]
s_cselect_b32 s4, s6, s4
ds_read_b128 a[220:223], v4 offset:56320
v_cvt_pk_bf16_f32 v81, v98, v99
v_mfma_f32_16x16x32_bf16 v[248:251], a[236:239], a[28:31], v[248:251]
s_add_u32 s19, s19, 4096
v_exp_f32 v102, v230
v_mfma_f32_16x16x32_bf16 v[252:255], a[240:243], a[16:19], v[44:47]
buffer_load_dword v59, v7, s[60:63], s19 offen sc1
ds_read_b128 a[224:227], v4 offset:57344
v_cvt_pk_bf16_f32 v82, v100, v101
v_mfma_f32_16x16x32_bf16 v[252:255], a[244:247], a[20:23], v[252:255]
v_exp_f32 v103, v231
v_mfma_f32_16x16x32_bf16 v[252:255], a[248:251], a[24:27], v[252:255]
ds_read_b128 a[228:231], v4 offset:58368
v_cvt_pk_bf16_f32 v83, v102, v103
v_mfma_f32_16x16x32_bf16 v[252:255], a[252:255], a[28:31], v[252:255]
s_cbranch_vccnz Lstub46
Lret47:
v_exp_f32 v104, v232
v_mfma_f32_16x16x32_bf16 v[160:163], a[128:131], v[88:91], v[160:163]
ds_read_b128 a[232:235], v4 offset:59392
ds_read_b128 a[236:239], v4 offset:60416
v_mfma_f32_16x16x32_bf16 v[160:163], a[132:135], v[92:95], v[160:163]
v_exp_f32 v105, v233
v_mfma_f32_16x16x32_bf16 v[164:167], a[136:139], v[88:91], v[164:167]
ds_read_b128 a[240:243], v4 offset:61440
ds_read_b128 a[244:247], v4 offset:62464
v_mfma_f32_16x16x32_bf16 v[164:167], a[140:143], v[92:95], v[164:167]
Lcp55:
s_add_u32 s9, s95, Lcp55-L_pc+3072
v_exp_f32 v106, v234
v_mfma_f32_16x16x32_bf16 v[168:171], a[144:147], v[88:91], v[168:171]
buffer_load_dword v51, off, s[64:67], s9
ds_read_b128 a[248:251], v4 offset:63488
ds_read_b128 a[252:255], v4 offset:64512
v_mfma_f32_16x16x32_bf16 v[168:171], a[148:151], v[92:95], v[168:171]
v_exp_f32 v107, v235
v_mfma_f32_16x16x32_bf16 v[172:175], a[152:155], v[88:91], v[172:175]
ds_read_b128 a[128:131], v4 offset:32768
ds_read_b128 a[132:135], v4 offset:33792
v_mfma_f32_16x16x32_bf16 v[172:175], a[156:159], v[92:95], v[172:175]
v_exp_f32 v108, v236
v_mfma_f32_16x16x32_bf16 v[176:179], a[160:163], v[88:91], v[176:179]
ds_read_b128 a[136:139], v4 offset:34816
ds_read_b128 a[140:143], v4 offset:35840
v_mfma_f32_16x16x32_bf16 v[176:179], a[164:167], v[92:95], v[176:179]
v_exp_f32 v109, v237
v_mfma_f32_16x16x32_bf16 v[180:183], a[168:171], v[88:91], v[180:183]
ds_read_b128 a[144:147], v4 offset:36864
v_cvt_pk_bf16_f32 v84, v104, v105
v_mfma_f32_16x16x32_bf16 v[180:183], a[172:175], v[92:95], v[180:183]
v_exp_f32 v110, v238
v_mfma_f32_16x16x32_bf16 v[184:187], a[176:179], v[88:91], v[184:187]
ds_read_b128 a[148:151], v4 offset:37888
v_cvt_pk_bf16_f32 v85, v106, v107
v_mfma_f32_16x16x32_bf16 v[184:187], a[180:183], v[92:95], v[184:187]
v_exp_f32 v111, v239
v_mfma_f32_16x16x32_bf16 v[188:191], a[184:187], v[88:91], v[188:191]
ds_read_b128 a[152:155], v4 offset:38912
v_cvt_pk_bf16_f32 v86, v108, v109
v_mfma_f32_16x16x32_bf16 v[188:191], a[188:191], v[92:95], v[188:191]
ds_read_b128 a[156:159], v4 offset:39936
v_cvt_pk_bf16_f32 v87, v110, v111
v_mfma_f32_16x16x32_bf16 v[24:27], v[28:31], v[80:83], v[32:35]
ds_read_b128 a[160:163], v4 offset:40960
ds_read_b128 a[164:167], v4 offset:41984
v_mfma_f32_16x16x32_bf16 v[24:27], v[28:31], v[84:87], v[24:27]
s_waitcnt lgkmcnt(6)
v_exp_f32 v112, v240
v_mfma_f32_16x16x32_bf16 v[192:195], a[192:195], a[0:3], v[40:43]
ds_read_b128 a[168:171], v4 offset:43008
ds_read_b128 a[172:175], v4 offset:44032
v_mfma_f32_16x16x32_bf16 v[192:195], a[196:199], a[4:7], v[192:195]
s_mov_b32 m0, s7
v_exp_f32 v113, v241
v_mfma_f32_16x16x32_bf16 v[192:195], a[200:203], a[8:11], v[192:195]
buffer_load_dwordx4 v2, s[60:63], s4 offen offset:0 sc1 lds
v_mfma_f32_16x16x32_bf16 v[192:195], a[204:207], a[12:15], v[192:195]
v_exp_f32 v114, v242
v_mfma_f32_16x16x32_bf16 v[196:199], a[208:211], a[0:3], v[40:43]
ds_read_b128 a[176:179], v4 offset:45056
ds_read_b128 a[180:183], v4 offset:46080
v_mfma_f32_16x16x32_bf16 v[196:199], a[212:215], a[4:7], v[196:199]
v_exp_f32 v115, v243
v_mfma_f32_16x16x32_bf16 v[196:199], a[216:219], a[8:11], v[196:199]
buffer_load_dwordx4 v2, s[60:63], s4 offen offset:1024 sc1 lds
v_mfma_f32_16x16x32_bf16 v[196:199], a[220:223], a[12:15], v[196:199]
v_exp_f32 v116, v244
v_mfma_f32_16x16x32_bf16 v[200:203], a[224:227], a[0:3], v[40:43]
v_cvt_pk_bf16_f32 v88, v112, v113
v_cmp_lt_f32 vcc, s10, v24
v_mfma_f32_16x16x32_bf16 v[200:203], a[228:231], a[4:7], v[200:203]
v_exp_f32 v117, v245
v_mfma_f32_16x16x32_bf16 v[200:203], a[232:235], a[8:11], v[200:203]
buffer_load_dwordx4 v2, s[60:63], s4 offen offset:2048 sc1 lds
v_mfma_f32_16x16x32_bf16 v[200:203], a[236:239], a[12:15], v[200:203]
v_exp_f32 v118, v246
v_mfma_f32_16x16x32_bf16 v[204:207], a[240:243], a[0:3], v[40:43]
ds_read_b128 a[184:187], v4 offset:47104
v_cvt_pk_bf16_f32 v89, v114, v115
v_mfma_f32_16x16x32_bf16 v[204:207], a[244:247], a[4:7], v[204:207]
v_exp_f32 v119, v247
v_mfma_f32_16x16x32_bf16 v[204:207], a[248:251], a[8:11], v[204:207]
buffer_load_dwordx4 v2, s[60:63], s4 offen offset:3072 sc1 lds
v_mfma_f32_16x16x32_bf16 v[204:207], a[252:255], a[12:15], v[204:207]
s_cbranch_vccnz Lstub48
Lret49:
v_exp_f32 v120, v248
v_mfma_f32_16x16x32_bf16 v[128:131], a[128:131], v[80:83], v[128:131]
ds_read_b128 a[188:191], v4 offset:48128
v_cvt_pk_bf16_f32 v90, v116, v117
v_mfma_f32_16x16x32_bf16 v[128:131], a[132:135], v[84:87], v[128:131]
s_add_u32 m0, s7, 4096
v_exp_f32 v121, v249
v_mfma_f32_16x16x32_bf16 v[132:135], a[136:139], v[80:83], v[132:135]
buffer_load_dwordx4 v5, s[60:63], s4 offen offset:0 sc1 lds
v_mfma_f32_16x16x32_bf16 v[132:135], a[140:143], v[84:87], v[132:135]
s_waitcnt lgkmcnt(2)
v_exp_f32 v122, v250
v_mfma_f32_16x16x32_bf16 v[136:139], a[144:147], v[80:83], v[136:139]
v_cvt_pk_bf16_f32 v91, v118, v119
v_cvt_pk_bf16_f32 v92, v120, v121
v_mfma_f32_16x16x32_bf16 v[136:139], a[148:151], v[84:87], v[136:139]
v_exp_f32 v123, v251
v_mfma_f32_16x16x32_bf16 v[140:143], a[152:155], v[80:83], v[140:143]
buffer_load_dwordx4 v5, s[60:63], s4 offen offset:1024 sc1 lds
v_mfma_f32_16x16x32_bf16 v[140:143], a[156:159], v[84:87], v[140:143]
v_exp_f32 v124, v252
v_mfma_f32_16x16x32_bf16 v[144:147], a[160:163], v[80:83], v[144:147]
v_cvt_pk_bf16_f32 v93, v122, v123
v_sub_f32 v18, s81, v23 clamp
v_mfma_f32_16x16x32_bf16 v[144:147], a[164:167], v[84:87], v[144:147]
s_mov_b32 s81, 0x420c0000
v_exp_f32 v125, v253
v_mfma_f32_16x16x32_bf16 v[148:151], a[168:171], v[80:83], v[148:151]
buffer_load_dwordx4 v5, s[60:63], s4 offen offset:2048 sc1 lds
v_mfma_f32_16x16x32_bf16 v[148:151], a[172:175], v[84:87], v[148:151]
v_exp_f32 v126, v254
v_mfma_f32_16x16x32_bf16 v[152:155], a[176:179], v[80:83], v[152:155]
s_waitcnt lgkmcnt(0)
v_xor_b32 v4, 0x10000, v4
v_sub_f32 v19, s81, v23 clamp
v_mfma_f32_16x16x32_bf16 v[152:155], a[180:183], v[84:87], v[152:155]
s_mov_b32 s81, 0x42400000
v_exp_f32 v127, v255
v_mfma_f32_16x16x32_bf16 v[156:159], a[184:187], v[80:83], v[156:159]
buffer_load_dwordx4 v5, s[60:63], s4 offen offset:3072 sc1 lds
v_mfma_f32_16x16x32_bf16 v[156:159], a[188:191], v[84:87], v[156:159]
s_waitcnt vmcnt(9) lgkmcnt(0)
v_cvt_pk_bf16_f32 v94, v124, v125
v_cvt_pk_bf16_f32 v95, v126, v127
v_mfma_f32_16x16x32_bf16 v[60:63], v[28:31], v[88:91], v[36:39]
s_barrier
v_mfma_f32_16x16x32_bf16 v[60:63], v[28:31], v[92:95], v[60:63]
v_exp_f32 v96, v192
v_mfma_f32_16x16x32_bf16 v[208:211], a[192:195], a[16:19], v[44:47]
ds_read_b128 a[192:195], v4 offset:16384
v_sub_f32 v20, s81, v23 clamp
v_mfma_f32_16x16x32_bf16 v[208:211], a[196:199], a[20:23], v[208:211]
s_mov_b32 s81, 0x42440000
v_exp_f32 v97, v193
v_mfma_f32_16x16x32_bf16 v[208:211], a[200:203], a[24:27], v[208:211]
s_add_u32 s7, s7, 0x8000
ds_read_b128 a[196:199], v4 offset:17408
v_cvt_pk_bf16_f32 v80, v96, v97
v_mfma_f32_16x16x32_bf16 v[208:211], a[204:207], a[28:31], v[208:211]
v_exp_f32 v98, v194
v_mfma_f32_16x16x32_bf16 v[212:215], a[208:211], a[16:19], v[44:47]
s_and_b32 s7, s7, 0x1ffff
ds_read_b128 a[200:203], v4 offset:18432
ds_read_b128 a[204:207], v4 offset:19456
v_mfma_f32_16x16x32_bf16 v[212:215], a[212:215], a[20:23], v[212:215]
v_exp_f32 v99, v195
v_mfma_f32_16x16x32_bf16 v[212:215], a[216:219], a[24:27], v[212:215]
s_add_u32 s4, s4, 0x8000
ds_read_b128 a[208:211], v4 offset:20480
v_cmp_lt_f32 vcc, s10, v60
v_mfma_f32_16x16x32_bf16 v[212:215], a[220:223], a[28:31], v[212:215]
v_exp_f32 v100, v196
v_mfma_f32_16x16x32_bf16 v[216:219], a[224:227], a[16:19], v[44:47]
s_cmp_eq_u32 s4, s5
ds_read_b128 a[212:215], v4 offset:21504
ds_read_b128 a[216:219], v4 offset:22528
v_mfma_f32_16x16x32_bf16 v[216:219], a[228:231], a[20:23], v[216:219]
v_exp_f32 v101, v197
v_mfma_f32_16x16x32_bf16 v[216:219], a[232:235], a[24:27], v[216:219]
s_cselect_b32 s4, s6, s4
ds_read_b128 a[220:223], v4 offset:23552
v_cvt_pk_bf16_f32 v81, v98, v99
v_mfma_f32_16x16x32_bf16 v[216:219], a[236:239], a[28:31], v[216:219]
v_exp_f32 v102, v198
v_mfma_f32_16x16x32_bf16 v[220:223], a[240:243], a[16:19], v[44:47]
ds_read_b128 a[224:227], v4 offset:24576
v_cvt_pk_bf16_f32 v82, v100, v101
v_mfma_f32_16x16x32_bf16 v[220:223], a[244:247], a[20:23], v[220:223]
v_exp_f32 v103, v199
v_mfma_f32_16x16x32_bf16 v[220:223], a[248:251], a[24:27], v[220:223]
ds_read_b128 a[228:231], v4 offset:25600
ds_read_b128 a[232:235], v4 offset:26624
v_mfma_f32_16x16x32_bf16 v[220:223], a[252:255], a[28:31], v[220:223]
s_cbranch_vccnz Lstub50
Lret51:
v_exp_f32 v104, v200
v_mfma_f32_16x16x32_bf16 v[160:163], a[128:131], v[88:91], v[160:163]
ds_read_b128 a[236:239], v4 offset:27648
ds_read_b128 a[240:243], v4 offset:28672
v_cmp_gt_u32 vcc, 768, v59
v_mfma_f32_16x16x32_bf16 v[160:163], a[132:135], v[92:95], v[160:163]
v_exp_f32 v105, v201
v_mfma_f32_16x16x32_bf16 v[164:167], a[136:139], v[88:91], v[164:167]
ds_read_b128 a[244:247], v4 offset:29696
ds_read_b128 a[248:251], v4 offset:30720
v_mfma_f32_16x16x32_bf16 v[164:167], a[140:143], v[92:95], v[164:167]
v_exp_f32 v106, v202
v_mfma_f32_16x16x32_bf16 v[168:171], a[144:147], v[88:91], v[168:171]
ds_read_b128 a[252:255], v4 offset:31744
ds_read_b128 a[128:131], v4 offset:0
v_mfma_f32_16x16x32_bf16 v[168:171], a[148:151], v[92:95], v[168:171]
v_exp_f32 v107, v203
v_mfma_f32_16x16x32_bf16 v[172:175], a[152:155], v[88:91], v[172:175]
ds_read_b128 a[132:135], v4 offset:1024
v_cvt_pk_bf16_f32 v83, v102, v103
v_mfma_f32_16x16x32_bf16 v[172:175], a[156:159], v[92:95], v[172:175]
v_exp_f32 v108, v204
v_mfma_f32_16x16x32_bf16 v[176:179], a[160:163], v[88:91], v[176:179]
ds_read_b128 a[136:139], v4 offset:2048
v_cvt_pk_bf16_f32 v84, v104, v105
v_mfma_f32_16x16x32_bf16 v[176:179], a[164:167], v[92:95], v[176:179]
v_exp_f32 v109, v205
v_mfma_f32_16x16x32_bf16 v[180:183], a[168:171], v[88:91], v[180:183]
ds_read_b128 a[140:143], v4 offset:3072
v_cvt_pk_bf16_f32 v85, v106, v107
v_mfma_f32_16x16x32_bf16 v[180:183], a[172:175], v[92:95], v[180:183]
v_exp_f32 v110, v206
v_mfma_f32_16x16x32_bf16 v[184:187], a[176:179], v[88:91], v[184:187]
ds_read_b128 a[144:147], v4 offset:4096
v_cvt_pk_bf16_f32 v86, v108, v109
s_cbranch_vccnz Lspin52
Lgo53:
v_mfma_f32_16x16x32_bf16 v[184:187], a[180:183], v[92:95], v[184:187]
v_exp_f32 v111, v207
v_mfma_f32_16x16x32_bf16 v[188:191], a[184:187], v[88:91], v[188:191]
ds_read_b128 a[148:151], v4 offset:5120
v_cvt_pk_bf16_f32 v87, v110, v111
v_sub_f32 v21, s81, v23 clamp
s_mov_b32 s81, 0x42480000
v_sub_f32 v22, s81, v23 clamp
s_mov_b32 s81, 0x424c0000
v_sub_f32 v23, s81, v23 clamp
v_mfma_f32_16x16x32_bf16 v[188:191], a[188:191], v[92:95], v[188:191]
.p2align 4
L_loop1:
v_mfma_f32_16x16x32_bf16 v[32:35], v[28:31], v[80:83], v[24:27]
ds_read_b128 a[152:155], v4 offset:6144
ds_read_b128 a[156:159], v4 offset:7168
v_mfma_f32_16x16x32_bf16 v[32:35], v[28:31], v[84:87], v[32:35]
s_waitcnt lgkmcnt(5)
v_exp_f32 v112, v208
v_mfma_f32_16x16x32_bf16 v[224:227], a[192:195], a[0:3], v[40:43]
ds_read_b128 a[160:163], v4 offset:8192
ds_read_b128 a[164:167], v4 offset:9216
v_mfma_f32_16x16x32_bf16 v[224:227], a[196:199], a[4:7], v[224:227]
s_mov_b32 m0, s7
v_exp_f32 v113, v209
v_mfma_f32_16x16x32_bf16 v[224:227], a[200:203], a[8:11], v[224:227]
buffer_load_dwordx4 v2, s[60:63], s4 offen offset:0 sc1 lds
v_mfma_f32_16x16x32_bf16 v[224:227], a[204:207], a[12:15], v[224:227]
v_exp_f32 v114, v210
v_mfma_f32_16x16x32_bf16 v[228:231], a[208:211], a[0:3], v[40:43]
ds_read_b128 a[168:171], v4 offset:10240
ds_read_b128 a[172:175], v4 offset:11264
v_mfma_f32_16x16x32_bf16 v[228:231], a[212:215], a[4:7], v[228:231]
v_exp_f32 v115, v211
v_mfma_f32_16x16x32_bf16 v[228:231], a[216:219], a[8:11], v[228:231]
buffer_load_dwordx4 v2, s[60:63], s4 offen offset:1024 sc1 lds
v_mfma_f32_16x16x32_bf16 v[228:231], a[220:223], a[12:15], v[228:231]
v_exp_f32 v116, v212
v_mfma_f32_16x16x32_bf16 v[232:235], a[224:227], a[0:3], v[40:43]
ds_read_b128 a[176:179], v4 offset:12288
v_cmp_lt_f32 vcc, s10, v32
v_mfma_f32_16x16x32_bf16 v[232:235], a[228:231], a[4:7], v[232:235]
v_exp_f32 v117, v213
v_mfma_f32_16x16x32_bf16 v[232:235], a[232:235], a[8:11], v[232:235]
buffer_load_dwordx4 v2, s[60:63], s4 offen offset:2048 sc1 lds
v_mfma_f32_16x16x32_bf16 v[232:235], a[236:239], a[12:15], v[232:235]
v_exp_f32 v118, v214
v_mfma_f32_16x16x32_bf16 v[236:239], a[240:243], a[0:3], v[40:43]
ds_read_b128 a[180:183], v4 offset:13312
ds_read_b128 a[184:187], v4 offset:14336
v_mfma_f32_16x16x32_bf16 v[236:239], a[244:247], a[4:7], v[236:239]
v_exp_f32 v119, v215
v_mfma_f32_16x16x32_bf16 v[236:239], a[248:251], a[8:11], v[236:239]
buffer_load_dwordx4 v2, s[60:63], s4 offen offset:3072 sc1 lds
v_mfma_f32_16x16x32_bf16 v[236:239], a[252:255], a[12:15], v[236:239]
s_cbranch_vccnz Lstub15
Lret16:
v_exp_f32 v120, v216
v_mfma_f32_16x16x32_bf16 v[128:131], a[128:131], v[80:83], v[128:131]
s_waitcnt lgkmcnt(2)
ds_read_b128 a[188:191], v4 offset:15360
v_cvt_pk_bf16_f32 v88, v112, v113
v_mfma_f32_16x16x32_bf16 v[128:131], a[132:135], v[84:87], v[128:131]
s_add_u32 m0, s7, 4096
v_exp_f32 v121, v217
v_mfma_f32_16x16x32_bf16 v[132:135], a[136:139], v[80:83], v[132:135]
buffer_load_dwordx4 v5, s[60:63], s4 offen offset:0 sc1 lds
v_mfma_f32_16x16x32_bf16 v[132:135], a[140:143], v[84:87], v[132:135]
v_exp_f32 v122, v218
v_mfma_f32_16x16x32_bf16 v[136:139], a[144:147], v[80:83], v[136:139]
v_cvt_pk_bf16_f32 v89, v114, v115
v_mfma_f32_16x16x32_bf16 v[136:139], a[148:151], v[84:87], v[136:139]
v_exp_f32 v123, v219
v_mfma_f32_16x16x32_bf16 v[140:143], a[152:155], v[80:83], v[140:143]
buffer_load_dwordx4 v5, s[60:63], s4 offen offset:1024 sc1 lds
v_mfma_f32_16x16x32_bf16 v[140:143], a[156:159], v[84:87], v[140:143]
v_exp_f32 v124, v220
v_mfma_f32_16x16x32_bf16 v[144:147], a[160:163], v[80:83], v[144:147]
v_cvt_pk_bf16_f32 v90, v116, v117
v_cvt_pk_bf16_f32 v91, v118, v119
v_mfma_f32_16x16x32_bf16 v[144:147], a[164:167], v[84:87], v[144:147]
v_exp_f32 v125, v221
v_mfma_f32_16x16x32_bf16 v[148:151], a[168:171], v[80:83], v[148:151]
buffer_load_dwordx4 v5, s[60:63], s4 offen offset:2048 sc1 lds
v_mfma_f32_16x16x32_bf16 v[148:151], a[172:175], v[84:87], v[148:151]
v_exp_f32 v126, v222
v_mfma_f32_16x16x32_bf16 v[152:155], a[176:179], v[80:83], v[152:155]
s_waitcnt lgkmcnt(0)
v_cvt_pk_bf16_f32 v92, v120, v121
v_cvt_pk_bf16_f32 v93, v122, v123
v_mfma_f32_16x16x32_bf16 v[152:155], a[180:183], v[84:87], v[152:155]
v_exp_f32 v127, v223
v_mfma_f32_16x16x32_bf16 v[156:159], a[184:187], v[80:83], v[156:159]
buffer_load_dwordx4 v5, s[60:63], s4 offen offset:3072 sc1 lds
v_mfma_f32_16x16x32_bf16 v[156:159], a[188:191], v[84:87], v[156:159]
s_waitcnt vmcnt(16) lgkmcnt(0)
v_cvt_pk_bf16_f32 v94, v124, v125
v_cvt_pk_bf16_f32 v95, v126, v127
v_mfma_f32_16x16x32_bf16 v[36:39], v[28:31], v[88:91], v[60:63]
s_barrier
v_mfma_f32_16x16x32_bf16 v[36:39], v[28:31], v[92:95], v[36:39]
s_add_u32 s79, s79, 4194304
v_exp_f32 v96, v224
v_mfma_f32_16x16x32_bf16 v[240:243], a[192:195], a[16:19], v[44:47]
buffer_load_dword v51, v0, s[52:55], s79 offen
ds_read_b128 a[192:195], v4 offset:49152
v_mfma_f32_16x16x32_bf16 v[240:243], a[196:199], a[20:23], v[240:243]
v_exp_f32 v97, v225
v_mfma_f32_16x16x32_bf16 v[240:243], a[200:203], a[24:27], v[240:243]
s_add_u32 s7, s7, 0x8000
ds_read_b128 a[196:199], v4 offset:50176
v_cvt_pk_bf16_f32 v80, v96, v97
v_mfma_f32_16x16x32_bf16 v[240:243], a[204:207], a[28:31], v[240:243]
v_exp_f32 v98, v226
v_mfma_f32_16x16x32_bf16 v[244:247], a[208:211], a[16:19], v[44:47]
s_and_b32 s7, s7, 0x1ffff
ds_read_b128 a[200:203], v4 offset:51200
ds_read_b128 a[204:207], v4 offset:52224
v_mfma_f32_16x16x32_bf16 v[244:247], a[212:215], a[20:23], v[244:247]
v_exp_f32 v99, v227
v_mfma_f32_16x16x32_bf16 v[244:247], a[216:219], a[24:27], v[244:247]
s_add_u32 s4, s4, 0x8000
ds_read_b128 a[208:211], v4 offset:53248
v_cmp_lt_f32 vcc, s10, v36
v_mfma_f32_16x16x32_bf16 v[244:247], a[220:223], a[28:31], v[244:247]
v_exp_f32 v100, v228
v_mfma_f32_16x16x32_bf16 v[248:251], a[224:227], a[16:19], v[44:47]
s_cmp_eq_u32 s4, s5
ds_read_b128 a[212:215], v4 offset:54272
ds_read_b128 a[216:219], v4 offset:55296
v_mfma_f32_16x16x32_bf16 v[248:251], a[228:231], a[20:23], v[248:251]
v_exp_f32 v101, v229
v_mfma_f32_16x16x32_bf16 v[248:251], a[232:235], a[24:27], v[248:251]
s_cselect_b32 s4, s6, s4
ds_read_b128 a[220:223], v4 offset:56320
v_cvt_pk_bf16_f32 v81, v98, v99
v_mfma_f32_16x16x32_bf16 v[248:251], a[236:239], a[28:31], v[248:251]
v_exp_f32 v102, v230
v_mfma_f32_16x16x32_bf16 v[252:255], a[240:243], a[16:19], v[44:47]
ds_read_b128 a[224:227], v4 offset:57344
v_cvt_pk_bf16_f32 v82, v100, v101
v_mfma_f32_16x16x32_bf16 v[252:255], a[244:247], a[20:23], v[252:255]
v_exp_f32 v103, v231
v_mfma_f32_16x16x32_bf16 v[252:255], a[248:251], a[24:27], v[252:255]
ds_read_b128 a[228:231], v4 offset:58368
v_cvt_pk_bf16_f32 v83, v102, v103
v_mfma_f32_16x16x32_bf16 v[252:255], a[252:255], a[28:31], v[252:255]
s_cbranch_vccnz Lstub17
Lret18:
v_exp_f32 v104, v232
v_mfma_f32_16x16x32_bf16 v[160:163], a[128:131], v[88:91], v[160:163]
ds_read_b128 a[232:235], v4 offset:59392
ds_read_b128 a[236:239], v4 offset:60416
v_mfma_f32_16x16x32_bf16 v[160:163], a[132:135], v[92:95], v[160:163]
v_exp_f32 v105, v233
v_mfma_f32_16x16x32_bf16 v[164:167], a[136:139], v[88:91], v[164:167]
ds_read_b128 a[240:243], v4 offset:61440
ds_read_b128 a[244:247], v4 offset:62464
v_mfma_f32_16x16x32_bf16 v[164:167], a[140:143], v[92:95], v[164:167]
Lcp23:
s_add_u32 s9, s95, Lcp23-L_pc+1536
v_exp_f32 v106, v234
v_mfma_f32_16x16x32_bf16 v[168:171], a[144:147], v[88:91], v[168:171]
buffer_load_dword v51, off, s[64:67], s9
ds_read_b128 a[248:251], v4 offset:63488
ds_read_b128 a[252:255], v4 offset:64512
v_mfma_f32_16x16x32_bf16 v[168:171], a[148:151], v[92:95], v[168:171]
v_exp_f32 v107, v235
v_mfma_f32_16x16x32_bf16 v[172:175], a[152:155], v[88:91], v[172:175]
ds_read_b128 a[128:131], v4 offset:32768
ds_read_b128 a[132:135], v4 offset:33792
v_mfma_f32_16x16x32_bf16 v[172:175], a[156:159], v[92:95], v[172:175]
v_exp_f32 v108, v236
v_mfma_f32_16x16x32_bf16 v[176:179], a[160:163], v[88:91], v[176:179]
ds_read_b128 a[136:139], v4 offset:34816
ds_read_b128 a[140:143], v4 offset:35840
v_mfma_f32_16x16x32_bf16 v[176:179], a[164:167], v[92:95], v[176:179]
v_exp_f32 v109, v237
v_mfma_f32_16x16x32_bf16 v[180:183], a[168:171], v[88:91], v[180:183]
ds_read_b128 a[144:147], v4 offset:36864
v_cvt_pk_bf16_f32 v84, v104, v105
v_mfma_f32_16x16x32_bf16 v[180:183], a[172:175], v[92:95], v[180:183]
v_exp_f32 v110, v238
v_mfma_f32_16x16x32_bf16 v[184:187], a[176:179], v[88:91], v[184:187]
ds_read_b128 a[148:151], v4 offset:37888
v_cvt_pk_bf16_f32 v85, v106, v107
v_mfma_f32_16x16x32_bf16 v[184:187], a[180:183], v[92:95], v[184:187]
v_exp_f32 v111, v239
v_mfma_f32_16x16x32_bf16 v[188:191], a[184:187], v[88:91], v[188:191]
ds_read_b128 a[152:155], v4 offset:38912
v_cvt_pk_bf16_f32 v86, v108, v109
v_mfma_f32_16x16x32_bf16 v[188:191], a[188:191], v[92:95], v[188:191]
ds_read_b128 a[156:159], v4 offset:39936
v_cvt_pk_bf16_f32 v87, v110, v111
v_mfma_f32_16x16x32_bf16 v[24:27], v[28:31], v[80:83], v[32:35]
ds_read_b128 a[160:163], v4 offset:40960
ds_read_b128 a[164:167], v4 offset:41984
v_mfma_f32_16x16x32_bf16 v[24:27], v[28:31], v[84:87], v[24:27]
s_waitcnt lgkmcnt(6)
v_exp_f32 v112, v240
v_mfma_f32_16x16x32_bf16 v[192:195], a[192:195], a[0:3], v[40:43]
ds_read_b128 a[168:171], v4 offset:43008
ds_read_b128 a[172:175], v4 offset:44032
v_mfma_f32_16x16x32_bf16 v[192:195], a[196:199], a[4:7], v[192:195]
s_mov_b32 m0, s7
v_exp_f32 v113, v241
v_mfma_f32_16x16x32_bf16 v[192:195], a[200:203], a[8:11], v[192:195]
buffer_load_dwordx4 v2, s[60:63], s4 offen offset:0 sc1 lds
v_mfma_f32_16x16x32_bf16 v[192:195], a[204:207], a[12:15], v[192:195]
v_exp_f32 v114, v242
v_mfma_f32_16x16x32_bf16 v[196:199], a[208:211], a[0:3], v[40:43]
ds_read_b128 a[176:179], v4 offset:45056
ds_read_b128 a[180:183], v4 offset:46080
v_mfma_f32_16x16x32_bf16 v[196:199], a[212:215], a[4:7], v[196:199]
v_exp_f32 v115, v243
v_mfma_f32_16x16x32_bf16 v[196:199], a[216:219], a[8:11], v[196:199]
buffer_load_dwordx4 v2, s[60:63], s4 offen offset:1024 sc1 lds
v_mfma_f32_16x16x32_bf16 v[196:199], a[220:223], a[12:15], v[196:199]
v_exp_f32 v116, v244
v_mfma_f32_16x16x32_bf16 v[200:203], a[224:227], a[0:3], v[40:43]
v_cvt_pk_bf16_f32 v88, v112, v113
v_cmp_lt_f32 vcc, s10, v24
v_mfma_f32_16x16x32_bf16 v[200:203], a[228:231], a[4:7], v[200:203]
v_exp_f32 v117, v245
v_mfma_f32_16x16x32_bf16 v[200:203], a[232:235], a[8:11], v[200:203]
buffer_load_dwordx4 v2, s[60:63], s4 offen offset:2048 sc1 lds
v_mfma_f32_16x16x32_bf16 v[200:203], a[236:239], a[12:15], v[200:203]
v_exp_f32 v118, v246
v_mfma_f32_16x16x32_bf16 v[204:207], a[240:243], a[0:3], v[40:43]
ds_read_b128 a[184:187], v4 offset:47104
v_cvt_pk_bf16_f32 v89, v114, v115
v_mfma_f32_16x16x32_bf16 v[204:207], a[244:247], a[4:7], v[204:207]
v_exp_f32 v119, v247
v_mfma_f32_16x16x32_bf16 v[204:207], a[248:251], a[8:11], v[204:207]
buffer_load_dwordx4 v2, s[60:63], s4 offen offset:3072 sc1 lds
v_mfma_f32_16x16x32_bf16 v[204:207], a[252:255], a[12:15], v[204:207]
s_cbranch_vccnz Lstub19
Lret20:
v_exp_f32 v120, v248
v_mfma_f32_16x16x32_bf16 v[128:131], a[128:131], v[80:83], v[128:131]
ds_read_b128 a[188:191], v4 offset:48128
v_cvt_pk_bf16_f32 v90, v116, v117
v_mfma_f32_16x16x32_bf16 v[128:131], a[132:135], v[84:87], v[128:131]
s_add_u32 m0, s7, 4096
v_exp_f32 v121, v249
v_mfma_f32_16x16x32_bf16 v[132:135], a[136:139], v[80:83], v[132:135]
buffer_load_dwordx4 v5, s[60:63], s4 offen offset:0 sc1 lds
v_mfma_f32_16x16x32_bf16 v[132:135], a[140:143], v[84:87], v[132:135]
s_waitcnt lgkmcnt(2)
v_exp_f32 v122, v250
v_mfma_f32_16x16x32_bf16 v[136:139], a[144:147], v[80:83], v[136:139]
v_cvt_pk_bf16_f32 v91, v118, v119
v_cvt_pk_bf16_f32 v92, v120, v121
v_mfma_f32_16x16x32_bf16 v[136:139], a[148:151], v[84:87], v[136:139]
v_exp_f32 v123, v251
v_mfma_f32_16x16x32_bf16 v[140:143], a[152:155], v[80:83], v[140:143]
buffer_load_dwordx4 v5, s[60:63], s4 offen offset:1024 sc1 lds
v_mfma_f32_16x16x32_bf16 v[140:143], a[156:159], v[84:87], v[140:143]
v_exp_f32 v124, v252
v_mfma_f32_16x16x32_bf16 v[144:147], a[160:163], v[80:83], v[144:147]
v_cvt_pk_bf16_f32 v93, v122, v123
v_mfma_f32_16x16x32_bf16 v[144:147], a[164:167], v[84:87], v[144:147]
v_exp_f32 v125, v253
v_mfma_f32_16x16x32_bf16 v[148:151], a[168:171], v[80:83], v[148:151]
buffer_load_dwordx4 v5, s[60:63], s4 offen offset:2048 sc1 lds
v_mfma_f32_16x16x32_bf16 v[148:151], a[172:175], v[84:87], v[148:151]
v_exp_f32 v126, v254
v_mfma_f32_16x16x32_bf16 v[152:155], a[176:179], v[80:83], v[152:155]
v_xor_b32 v4, 0x10000, v4
v_mfma_f32_16x16x32_bf16 v[152:155], a[180:183], v[84:87], v[152:155]
s_waitcnt lgkmcnt(0)
v_exp_f32 v127, v255
v_mfma_f32_16x16x32_bf16 v[156:159], a[184:187], v[80:83], v[156:159]
buffer_load_dwordx4 v5, s[60:63], s4 offen offset:3072 sc1 lds
v_mfma_f32_16x16x32_bf16 v[156:159], a[188:191], v[84:87], v[156:159]
s_waitcnt vmcnt(16) lgkmcnt(0)
v_cvt_pk_bf16_f32 v94, v124, v125
v_cvt_pk_bf16_f32 v95, v126, v127
v_mfma_f32_16x16x32_bf16 v[60:63], v[28:31], v[88:91], v[36:39]
s_barrier
v_mfma_f32_16x16x32_bf16 v[60:63], v[28:31], v[92:95], v[60:63]
v_exp_f32 v96, v192
v_mfma_f32_16x16x32_bf16 v[208:211], a[192:195], a[16:19], v[44:47]
ds_read_b128 a[192:195], v4 offset:16384
v_mfma_f32_16x16x32_bf16 v[208:211], a[196:199], a[20:23], v[208:211]
v_exp_f32 v97, v193
v_mfma_f32_16x16x32_bf16 v[208:211], a[200:203], a[24:27], v[208:211]
s_add_u32 s7, s7, 0x8000
ds_read_b128 a[196:199], v4 offset:17408
v_cvt_pk_bf16_f32 v80, v96, v97
v_mfma_f32_16x16x32_bf16 v[208:211], a[204:207], a[28:31], v[208:211]
v_exp_f32 v98, v194
v_mfma_f32_16x16x32_bf16 v[212:215], a[208:211], a[16:19], v[44:47]
s_and_b32 s7, s7, 0x1ffff
ds_read_b128 a[200:203], v4 offset:18432
ds_read_b128 a[204:207], v4 offset:19456
v_mfma_f32_16x16x32_bf16 v[212:215], a[212:215], a[20:23], v[212:215]
v_exp_f32 v99, v195
v_mfma_f32_16x16x32_bf16 v[212:215], a[216:219], a[24:27], v[212:215]
s_add_u32 s4, s4, 0x8000
ds_read_b128 a[208:211], v4 offset:20480
v_cmp_lt_f32 vcc, s10, v60
v_mfma_f32_16x16x32_bf16 v[212:215], a[220:223], a[28:31], v[212:215]
v_exp_f32 v100, v196
v_mfma_f32_16x16x32_bf16 v[216:219], a[224:227], a[16:19], v[44:47]
s_cmp_eq_u32 s4, s5
ds_read_b128 a[212:215], v4 offset:21504
ds_read_b128 a[216:219], v4 offset:22528
v_mfma_f32_16x16x32_bf16 v[216:219], a[228:231], a[20:23], v[216:219]
v_exp_f32 v101, v197
v_mfma_f32_16x16x32_bf16 v[216:219], a[232:235], a[24:27], v[216:219]
s_cselect_b32 s4, s6, s4
ds_read_b128 a[220:223], v4 offset:23552
v_cvt_pk_bf16_f32 v81, v98, v99
v_mfma_f32_16x16x32_bf16 v[216:219], a[236:239], a[28:31], v[216:219]
v_exp_f32 v102, v198
v_mfma_f32_16x16x32_bf16 v[220:223], a[240:243], a[16:19], v[44:47]
ds_read_b128 a[224:227], v4 offset:24576
v_cvt_pk_bf16_f32 v82, v100, v101
v_mfma_f32_16x16x32_bf16 v[220:223], a[244:247], a[20:23], v[220:223]
v_exp_f32 v103, v199
v_mfma_f32_16x16x32_bf16 v[220:223], a[248:251], a[24:27], v[220:223]
ds_read_b128 a[228:231], v4 offset:25600
ds_read_b128 a[232:235], v4 offset:26624
v_mfma_f32_16x16x32_bf16 v[220:223], a[252:255], a[28:31], v[220:223]
s_cbranch_vccnz Lstub21
Lret22:
v_exp_f32 v104, v200
v_mfma_f32_16x16x32_bf16 v[160:163], a[128:131], v[88:91], v[160:163]
ds_read_b128 a[236:239], v4 offset:27648
ds_read_b128 a[240:243], v4 offset:28672
v_mfma_f32_16x16x32_bf16 v[160:163], a[132:135], v[92:95], v[160:163]
v_exp_f32 v105, v201
v_mfma_f32_16x16x32_bf16 v[164:167], a[136:139], v[88:91], v[164:167]
ds_read_b128 a[244:247], v4 offset:29696
ds_read_b128 a[248:251], v4 offset:30720
v_mfma_f32_16x16x32_bf16 v[164:167], a[140:143], v[92:95], v[164:167]
v_exp_f32 v106, v202
v_mfma_f32_16x16x32_bf16 v[168:171], a[144:147], v[88:91], v[168:171]
ds_read_b128 a[252:255], v4 offset:31744
ds_read_b128 a[128:131], v4 offset:0
v_mfma_f32_16x16x32_bf16 v[168:171], a[148:151], v[92:95], v[168:171]
v_exp_f32 v107, v203
v_mfma_f32_16x16x32_bf16 v[172:175], a[152:155], v[88:91], v[172:175]
ds_read_b128 a[132:135], v4 offset:1024
v_cvt_pk_bf16_f32 v83, v102, v103
v_mfma_f32_16x16x32_bf16 v[172:175], a[156:159], v[92:95], v[172:175]
v_exp_f32 v108, v204
v_mfma_f32_16x16x32_bf16 v[176:179], a[160:163], v[88:91], v[176:179]
ds_read_b128 a[136:139], v4 offset:2048
v_cvt_pk_bf16_f32 v84, v104, v105
v_mfma_f32_16x16x32_bf16 v[176:179], a[164:167], v[92:95], v[176:179]
v_exp_f32 v109, v205
v_mfma_f32_16x16x32_bf16 v[180:183], a[168:171], v[88:91], v[180:183]
s_sub_u32 s88, s88, 1
ds_read_b128 a[140:143], v4 offset:3072
v_cvt_pk_bf16_f32 v85, v106, v107
v_mfma_f32_16x16x32_bf16 v[180:183], a[172:175], v[92:95], v[180:183]
v_exp_f32 v110, v206
v_mfma_f32_16x16x32_bf16 v[184:187], a[176:179], v[88:91], v[184:187]
s_cmp_lg_u32 s88, 0
ds_read_b128 a[144:147], v4 offset:4096
v_cvt_pk_bf16_f32 v86, v108, v109
v_mfma_f32_16x16x32_bf16 v[184:187], a[180:183], v[92:95], v[184:187]
v_exp_f32 v111, v207
v_mfma_f32_16x16x32_bf16 v[188:191], a[184:187], v[88:91], v[188:191]
ds_read_b128 a[148:151], v4 offset:5120
v_cvt_pk_bf16_f32 v87, v110, v111
v_mfma_f32_16x16x32_bf16 v[188:191], a[188:191], v[92:95], v[188:191]
s_cbranch_scc1 L_loop1
v_mfma_f32_16x16x32_bf16 v[32:35], v[28:31], v[80:83], v[24:27]
s_mov_b32 s19, 59842560
ds_read_b128 a[152:155], v4 offset:6144
ds_read_b128 a[156:159], v4 offset:7168
v_mfma_f32_16x16x32_bf16 v[32:35], v[28:31], v[84:87], v[32:35]
buffer_load_dwordx4 v[56:59], v0, s[60:63], s19 offen sc1
v_exp_f32 v112, v208
s_waitcnt lgkmcnt(5)
v_mfma_f32_16x16x32_bf16 v[224:227], a[192:195], a[0:3], v[40:43]
ds_read_b128 a[160:163], v4 offset:8192
ds_read_b128 a[164:167], v4 offset:9216
v_mfma_f32_16x16x32_bf16 v[224:227], a[196:199], a[4:7], v[224:227]
s_mov_b32 m0, s7
v_exp_f32 v113, v209
v_mfma_f32_16x16x32_bf16 v[224:227], a[200:203], a[8:11], v[224:227]
buffer_load_dwordx4 v2, s[60:63], s4 offen offset:0 sc1 lds
v_mfma_f32_16x16x32_bf16 v[224:227], a[204:207], a[12:15], v[224:227]
v_exp_f32 v114, v210
v_mfma_f32_16x16x32_bf16 v[228:231], a[208:211], a[0:3], v[40:43]
s_mov_b32 s78, s76
ds_read_b128 a[168:171], v4 offset:10240
ds_read_b128 a[172:175], v4 offset:11264
v_mfma_f32_16x16x32_bf16 v[228:231], a[212:215], a[4:7], v[228:231]
s_lshl_b32 s82, s3, 15
v_exp_f32 v115, v211
v_mfma_f32_16x16x32_bf16 v[228:231], a[216:219], a[8:11], v[228:231]
buffer_load_dwordx4 v2, s[60:63], s4 offen offset:1024 sc1 lds
v_mfma_f32_16x16x32_bf16 v[228:231], a[220:223], a[12:15], v[228:231]
s_lshl_b32 s84, s77, 17
v_exp_f32 v116, v212
v_mfma_f32_16x16x32_bf16 v[232:235], a[224:227], a[0:3], v[40:43]
s_add_u32 s84, s84, s82
ds_read_b128 a[176:179], v4 offset:12288
v_cmp_lt_f32 vcc, s10, v32
v_mfma_f32_16x16x32_bf16 v[232:235], a[228:231], a[4:7], v[232:235]
s_add_u32 s84, s84, 58720256
v_exp_f32 v117, v213
v_mfma_f32_16x16x32_bf16 v[232:235], a[232:235], a[8:11], v[232:235]
buffer_load_dwordx4 v2, s[60:63], s4 offen offset:2048 sc1 lds
v_mfma_f32_16x16x32_bf16 v[232:235], a[236:239], a[12:15], v[232:235]
s_lshl_b32 s85, s78, 17
v_exp_f32 v118, v214
v_mfma_f32_16x16x32_bf16 v[236:239], a[240:243], a[0:3], v[40:43]
s_add_u32 s85, s85, s82
ds_read_b128 a[180:183], v4 offset:13312
ds_read_b128 a[184:187], v4 offset:14336
v_mfma_f32_16x16x32_bf16 v[236:239], a[244:247], a[4:7], v[236:239]
s_add_u32 s85, s85, 50331648
v_exp_f32 v119, v215
v_mfma_f32_16x16x32_bf16 v[236:239], a[248:251], a[8:11], v[236:239]
buffer_load_dwordx4 v2, s[60:63], s4 offen offset:3072 sc1 lds
v_mfma_f32_16x16x32_bf16 v[236:239], a[252:255], a[12:15], v[236:239]
s_cbranch_vccnz Lstub56
Lret57:
v_exp_f32 v120, v216
v_mfma_f32_16x16x32_bf16 v[128:131], a[128:131], v[80:83], v[128:131]
s_add_u32 s94, s84, 24576
ds_read_b128 a[188:191], v4 offset:15360
v_cvt_pk_bf16_f32 v88, v112, v113
v_mfma_f32_16x16x32_bf16 v[128:131], a[132:135], v[84:87], v[128:131]
s_add_u32 m0, s7, 4096
v_exp_f32 v121, v217
v_mfma_f32_16x16x32_bf16 v[132:135], a[136:139], v[80:83], v[132:135]
buffer_load_dwordx4 v5, s[60:63], s4 offen offset:0 sc1 lds
s_waitcnt lgkmcnt(3)
v_mfma_f32_16x16x32_bf16 v[132:135], a[140:143], v[84:87], v[132:135]
s_add_u32 s1, s85, 24576
v_exp_f32 v122, v218
v_mfma_f32_16x16x32_bf16 v[136:139], a[144:147], v[80:83], v[136:139]
s_and_b32 s82, s3, 1
v_cvt_pk_bf16_f32 v89, v114, v115
s_lshl_b32 s82, s82, 2
v_mfma_f32_16x16x32_bf16 v[136:139], a[148:151], v[84:87], v[136:139]
s_lshr_b32 s81, s76, 3
v_exp_f32 v123, v219
v_mfma_f32_16x16x32_bf16 v[140:143], a[152:155], v[80:83], v[140:143]
buffer_load_dwordx4 v5, s[60:63], s4 offen offset:1024 sc1 lds
v_mfma_f32_16x16x32_bf16 v[140:143], a[156:159], v[84:87], v[140:143]
s_add_u32 s82, s82, s81
v_exp_f32 v124, v220
v_mfma_f32_16x16x32_bf16 v[144:147], a[160:163], v[80:83], v[144:147]
s_lshl_b32 s82, s82, 5
v_cvt_pk_bf16_f32 v90, v116, v117
v_cvt_pk_bf16_f32 v91, v118, v119
v_mfma_f32_16x16x32_bf16 v[144:147], a[164:167], v[84:87], v[144:147]
s_lshr_b32 s81, s3, 1
v_exp_f32 v125, v221
v_mfma_f32_16x16x32_bf16 v[148:151], a[168:171], v[80:83], v[148:151]
buffer_load_dwordx4 v5, s[60:63], s4 offen offset:2048 sc1 lds
v_mfma_f32_16x16x32_bf16 v[148:151], a[172:175], v[84:87], v[148:151]
s_add_u32 s82, s82, s81
v_exp_f32 v126, v222
v_mfma_f32_16x16x32_bf16 v[152:155], a[176:179], v[80:83], v[152:155]
s_lshl_b32 s82, s82, 12
v_cvt_pk_bf16_f32 v92, v120, v121
v_cvt_pk_bf16_f32 v93, v122, v123
s_waitcnt lgkmcnt(0)
v_mfma_f32_16x16x32_bf16 v[152:155], a[180:183], v[84:87], v[152:155]
s_lshr_b32 s89, s76, 3
v_exp_f32 v127, v223
v_mfma_f32_16x16x32_bf16 v[156:159], a[184:187], v[80:83], v[156:159]
buffer_load_dwordx4 v5, s[60:63], s4 offen offset:3072 sc1 lds
v_mfma_f32_16x16x32_bf16 v[156:159], a[188:191], v[84:87], v[156:159]
s_waitcnt vmcnt(16) lgkmcnt(0)
v_cvt_pk_bf16_f32 v94, v124, v125
v_cvt_pk_bf16_f32 v95, v126, v127
v_mfma_f32_16x16x32_bf16 v[36:39], v[28:31], v[88:91], v[60:63]
s_barrier
v_mfma_f32_16x16x32_bf16 v[36:39], v[28:31], v[92:95], v[36:39]
s_lshl_b32 s89, s89, 5
v_exp_f32 v96, v224
v_mfma_f32_16x16x32_bf16 v[240:243], a[192:195], a[16:19], v[44:47]
s_add_u32 s89, s89, s3
ds_read_b128 a[192:195], v4 offset:49152
s_lshl_b32 s89, s89, 7
v_mfma_f32_16x16x32_bf16 v[240:243], a[196:199], a[20:23], v[240:243]
v_exp_f32 v97, v225
v_mfma_f32_16x16x32_bf16 v[240:243], a[200:203], a[24:27], v[240:243]
s_add_u32 s7, s7, 0x8000
ds_read_b128 a[196:199], v4 offset:50176
v_cvt_pk_bf16_f32 v80, v96, v97
v_mfma_f32_16x16x32_bf16 v[240:243], a[204:207], a[28:31], v[240:243]
v_exp_f32 v98, v226
v_mfma_f32_16x16x32_bf16 v[244:247], a[208:211], a[16:19], v[44:47]
s_and_b32 s7, s7, 0x1ffff
ds_read_b128 a[200:203], v4 offset:51200
ds_read_b128 a[204:207], v4 offset:52224
v_mfma_f32_16x16x32_bf16 v[244:247], a[212:215], a[20:23], v[244:247]
v_exp_f32 v99, v227
v_mfma_f32_16x16x32_bf16 v[244:247], a[216:219], a[24:27], v[244:247]
s_add_u32 s4, s4, 0x8000
ds_read_b128 a[208:211], v4 offset:53248
v_cmp_lt_f32 vcc, s10, v36
v_mfma_f32_16x16x32_bf16 v[244:247], a[220:223], a[28:31], v[244:247]
v_exp_f32 v100, v228
v_mfma_f32_16x16x32_bf16 v[248:251], a[224:227], a[16:19], v[44:47]
s_cmp_eq_u32 s4, s5
ds_read_b128 a[212:215], v4 offset:54272
ds_read_b128 a[216:219], v4 offset:55296
v_mfma_f32_16x16x32_bf16 v[248:251], a[228:231], a[20:23], v[248:251]
v_exp_f32 v101, v229
v_mfma_f32_16x16x32_bf16 v[248:251], a[232:235], a[24:27], v[248:251]
s_cselect_b32 s4, s6, s4
ds_read_b128 a[220:223], v4 offset:56320
v_cvt_pk_bf16_f32 v81, v98, v99
v_mfma_f32_16x16x32_bf16 v[248:251], a[236:239], a[28:31], v[248:251]
s_and_b32 s81, s77, 3
v_exp_f32 v102, v230
v_mfma_f32_16x16x32_bf16 v[252:255], a[240:243], a[16:19], v[44:47]
s_add_u32 s89, s89, s81
ds_read_b128 a[224:227], v4 offset:57344
v_cvt_pk_bf16_f32 v82, v100, v101
v_mfma_f32_16x16x32_bf16 v[252:255], a[244:247], a[20:23], v[252:255]
s_lshl_b32 s89, s89, 8
v_exp_f32 v103, v231
v_mfma_f32_16x16x32_bf16 v[252:255], a[248:251], a[24:27], v[252:255]
s_and_b32 s93, s76, 3
ds_read_b128 a[228:231], v4 offset:58368
v_cvt_pk_bf16_f32 v83, v102, v103
v_mfma_f32_16x16x32_bf16 v[252:255], a[252:255], a[28:31], v[252:255]
s_cbranch_vccnz Lstub58
Lret59:
v_exp_f32 v104, v232
v_mfma_f32_16x16x32_bf16 v[160:163], a[128:131], v[88:91], v[160:163]
s_lshl_b32 s93, s93, 1
ds_read_b128 a[232:235], v4 offset:59392
ds_read_b128 a[236:239], v4 offset:60416
v_mfma_f32_16x16x32_bf16 v[160:163], a[132:135], v[92:95], v[160:163]
s_lshr_b32 s81, s77, 2
v_exp_f32 v105, v233
v_mfma_f32_16x16x32_bf16 v[164:167], a[136:139], v[88:91], v[164:167]
s_add_u32 s93, s93, s81
ds_read_b128 a[240:243], v4 offset:61440
ds_read_b128 a[244:247], v4 offset:62464
v_mfma_f32_16x16x32_bf16 v[164:167], a[140:143], v[92:95], v[164:167]
s_bfe_u32 s81, s76, 0x10002
v_exp_f32 v106, v234
v_mfma_f32_16x16x32_bf16 v[168:171], a[144:147], v[88:91], v[168:171]
s_xor_b32 s81, s81, 0
ds_read_b128 a[248:251], v4 offset:63488
ds_read_b128 a[252:255], v4 offset:64512
v_mfma_f32_16x16x32_bf16 v[168:171], a[148:151], v[92:95], v[168:171]
s_lshl_b32 s81, s81, 3
v_exp_f32 v107, v235
v_mfma_f32_16x16x32_bf16 v[172:175], a[152:155], v[88:91], v[172:175]
s_add_u32 s93, s93, s81
ds_read_b128 a[128:131], v4 offset:32768
ds_read_b128 a[132:135], v4 offset:33792
v_mfma_f32_16x16x32_bf16 v[172:175], a[156:159], v[92:95], v[172:175]
s_lshr_b32 s0, s76, 3
v_exp_f32 v108, v236
v_mfma_f32_16x16x32_bf16 v[176:179], a[160:163], v[88:91], v[176:179]
s_lshl_b32 s0, s0, 3
ds_read_b128 a[136:139], v4 offset:34816
ds_read_b128 a[140:143], v4 offset:35840
v_mfma_f32_16x16x32_bf16 v[176:179], a[164:167], v[92:95], v[176:179]
s_add_u32 s0, s0, s77
v_exp_f32 v109, v237
v_mfma_f32_16x16x32_bf16 v[180:183], a[168:171], v[88:91], v[180:183]
s_lshl_b32 s0, s0, 7
ds_read_b128 a[144:147], v4 offset:36864
v_cvt_pk_bf16_f32 v84, v104, v105
v_mfma_f32_16x16x32_bf16 v[180:183], a[172:175], v[92:95], v[180:183]
s_and_b32 s81, s76, 4
v_exp_f32 v110, v238
v_mfma_f32_16x16x32_bf16 v[184:187], a[176:179], v[88:91], v[184:187]
s_add_u32 s0, s0, s81
ds_read_b128 a[148:151], v4 offset:37888
v_cvt_pk_bf16_f32 v85, v106, v107
v_mfma_f32_16x16x32_bf16 v[184:187], a[180:183], v[92:95], v[184:187]
s_add_u32 s0, s0, 59846656
v_exp_f32 v111, v239
v_mfma_f32_16x16x32_bf16 v[188:191], a[184:187], v[88:91], v[188:191]
s_lshl_b32 s90, s93, 20
ds_read_b128 a[152:155], v4 offset:38912
v_cvt_pk_bf16_f32 v86, v108, v109
v_mfma_f32_16x16x32_bf16 v[188:191], a[188:191], v[92:95], v[188:191]
s_add_u32 s90, s90, s82
ds_read_b128 a[156:159], v4 offset:39936
v_cvt_pk_bf16_f32 v87, v110, v111
v_mfma_f32_16x16x32_bf16 v[24:27], v[28:31], v[80:83], v[32:35]
s_add_u32 s90, s90, 33550336
ds_read_b128 a[160:163], v4 offset:40960
ds_read_b128 a[164:167], v4 offset:41984
v_mfma_f32_16x16x32_bf16 v[24:27], v[28:31], v[84:87], v[24:27]
s_waitcnt lgkmcnt(6)
v_exp_f32 v112, v240
v_mfma_f32_16x16x32_bf16 v[192:195], a[192:195], a[0:3], v[40:43]
ds_read_b128 a[168:171], v4 offset:43008
ds_read_b128 a[172:175], v4 offset:44032
v_mfma_f32_16x16x32_bf16 v[192:195], a[196:199], a[4:7], v[192:195]
s_mov_b32 m0, s7
v_exp_f32 v113, v241
v_mfma_f32_16x16x32_bf16 v[192:195], a[200:203], a[8:11], v[192:195]
buffer_load_dwordx4 v2, s[60:63], s4 offen offset:0 sc1 lds
v_mfma_f32_16x16x32_bf16 v[192:195], a[204:207], a[12:15], v[192:195]
v_exp_f32 v114, v242
v_mfma_f32_16x16x32_bf16 v[196:199], a[208:211], a[0:3], v[40:43]
ds_read_b128 a[176:179], v4 offset:45056
ds_read_b128 a[180:183], v4 offset:46080
v_mfma_f32_16x16x32_bf16 v[196:199], a[212:215], a[4:7], v[196:199]
v_exp_f32 v115, v243
v_mfma_f32_16x16x32_bf16 v[196:199], a[216:219], a[8:11], v[196:199]
buffer_load_dwordx4 v2, s[60:63], s4 offen offset:1024 sc1 lds
v_mfma_f32_16x16x32_bf16 v[196:199], a[220:223], a[12:15], v[196:199]
v_exp_f32 v116, v244
v_mfma_f32_16x16x32_bf16 v[200:203], a[224:227], a[0:3], v[40:43]
v_cvt_pk_bf16_f32 v88, v112, v113
v_cmp_lt_f32 vcc, s10, v24
v_mfma_f32_16x16x32_bf16 v[200:203], a[228:231], a[4:7], v[200:203]
v_exp_f32 v117, v245
v_mfma_f32_16x16x32_bf16 v[200:203], a[232:235], a[8:11], v[200:203]
buffer_load_dwordx4 v2, s[60:63], s4 offen offset:2048 sc1 lds
v_mfma_f32_16x16x32_bf16 v[200:203], a[236:239], a[12:15], v[200:203]
v_exp_f32 v118, v246
v_mfma_f32_16x16x32_bf16 v[204:207], a[240:243], a[0:3], v[40:43]
ds_read_b128 a[184:187], v4 offset:47104
v_cvt_pk_bf16_f32 v89, v114, v115
v_mfma_f32_16x16x32_bf16 v[204:207], a[244:247], a[4:7], v[204:207]
v_exp_f32 v119, v247
v_mfma_f32_16x16x32_bf16 v[204:207], a[248:251], a[8:11], v[204:207]
buffer_load_dwordx4 v2, s[60:63], s4 offen offset:3072 sc1 lds
v_mfma_f32_16x16x32_bf16 v[204:207], a[252:255], a[12:15], v[204:207]
s_cbranch_vccnz Lstub60
Lret61:
v_exp_f32 v120, v248
v_mfma_f32_16x16x32_bf16 v[128:131], a[128:131], v[80:83], v[128:131]
ds_read_b128 a[188:191], v4 offset:48128
v_cvt_pk_bf16_f32 v90, v116, v117
v_mfma_f32_16x16x32_bf16 v[128:131], a[132:135], v[84:87], v[128:131]
s_add_u32 m0, s7, 4096
v_exp_f32 v121, v249
v_mfma_f32_16x16x32_bf16 v[132:135], a[136:139], v[80:83], v[132:135]
buffer_load_dwordx4 v5, s[60:63], s4 offen offset:0 sc1 lds
s_waitcnt vmcnt(8)
v_min3_u32 v56, v56, v57, v58
v_min_u32 v56, v56, v59
v_cmp_gt_u32 vcc, 768, v56
v_mfma_f32_16x16x32_bf16 v[132:135], a[140:143], v[84:87], v[132:135]
s_waitcnt lgkmcnt(2)
v_exp_f32 v122, v250
v_mfma_f32_16x16x32_bf16 v[136:139], a[144:147], v[80:83], v[136:139]
v_cvt_pk_bf16_f32 v91, v118, v119
v_cvt_pk_bf16_f32 v92, v120, v121
v_mfma_f32_16x16x32_bf16 v[136:139], a[148:151], v[84:87], v[136:139]
v_exp_f32 v123, v251
v_mfma_f32_16x16x32_bf16 v[140:143], a[152:155], v[80:83], v[140:143]
buffer_load_dwordx4 v5, s[60:63], s4 offen offset:1024 sc1 lds
v_mfma_f32_16x16x32_bf16 v[140:143], a[156:159], v[84:87], v[140:143]
v_exp_f32 v124, v252
v_mfma_f32_16x16x32_bf16 v[144:147], a[160:163], v[80:83], v[144:147]
v_cvt_pk_bf16_f32 v93, v122, v123
v_and_b32 v65, 15, v1
v_mfma_f32_16x16x32_bf16 v[144:147], a[164:167], v[84:87], v[144:147]
v_exp_f32 v125, v253
v_mfma_f32_16x16x32_bf16 v[148:151], a[168:171], v[80:83], v[148:151]
buffer_load_dwordx4 v5, s[60:63], s4 offen offset:2048 sc1 lds
s_cbranch_vccnz Lspin64
Lgo65:
v_mfma_f32_16x16x32_bf16 v[148:151], a[172:175], v[84:87], v[148:151]
v_exp_f32 v126, v254
v_mfma_f32_16x16x32_bf16 v[152:155], a[176:179], v[80:83], v[152:155]
v_xor_b32 v4, 0x10000, v4
v_lshlrev_b32 v64, 1, v3
v_mfma_f32_16x16x32_bf16 v[152:155], a[180:183], v[84:87], v[152:155]
s_waitcnt lgkmcnt(0)
v_exp_f32 v127, v255
v_mfma_f32_16x16x32_bf16 v[156:159], a[184:187], v[80:83], v[156:159]
buffer_load_dwordx4 v5, s[60:63], s4 offen offset:3072 sc1 lds
v_xor_b32 v64, v64, v65
v_lshlrev_b32 v64, 4, v64
v_lshl_add_u32 v64, v3, 10, v64
v_xor_b32 v65, 128, v64
v_add_u32 v66, 6144, v64
v_add_u32 v67, 9216, v65
v_add_u32 v65, 3072, v65
v_mfma_f32_16x16x32_bf16 v[156:159], a[188:191], v[84:87], v[156:159]
s_waitcnt vmcnt(16) lgkmcnt(0)
v_cvt_pk_bf16_f32 v94, v124, v125
v_cvt_pk_bf16_f32 v95, v126, v127
v_mfma_f32_16x16x32_bf16 v[60:63], v[28:31], v[88:91], v[36:39]
s_barrier
v_mfma_f32_16x16x32_bf16 v[60:63], v[28:31], v[92:95], v[60:63]
v_exp_f32 v96, v192
v_mfma_f32_16x16x32_bf16 v[208:211], a[192:195], a[16:19], v[44:47]
s_add_u32 m0, s86, 131072
ds_read_b128 a[192:195], v4 offset:16384
v_mfma_f32_16x16x32_bf16 v[208:211], a[196:199], a[20:23], v[208:211]
buffer_load_dwordx4 v64, s[52:55], s89 offen offset:0 lds
v_exp_f32 v97, v193
v_mfma_f32_16x16x32_bf16 v[208:211], a[200:203], a[24:27], v[208:211]
s_add_u32 s7, s7, 0x8000
ds_read_b128 a[196:199], v4 offset:17408
v_cvt_pk_bf16_f32 v80, v96, v97
v_mfma_f32_16x16x32_bf16 v[208:211], a[204:207], a[28:31], v[208:211]
buffer_load_dwordx4 v65, s[52:55], s89 offen offset:1024 lds
v_exp_f32 v98, v194
v_mfma_f32_16x16x32_bf16 v[212:215], a[208:211], a[16:19], v[44:47]
s_and_b32 s7, s7, 0x1ffff
ds_read_b128 a[200:203], v4 offset:18432
ds_read_b128 a[204:207], v4 offset:19456
v_mfma_f32_16x16x32_bf16 v[212:215], a[212:215], a[20:23], v[212:215]
buffer_load_dwordx4 v66, s[52:55], s89 offen offset:2048 lds
v_exp_f32 v99, v195
v_mfma_f32_16x16x32_bf16 v[212:215], a[216:219], a[24:27], v[212:215]
s_add_u32 s4, s4, 0x8000
ds_read_b128 a[208:211], v4 offset:20480
v_cmp_lt_f32 vcc, s10, v60
v_mfma_f32_16x16x32_bf16 v[212:215], a[220:223], a[28:31], v[212:215]
buffer_load_dwordx4 v67, s[52:55], s89 offen offset:3072 lds
v_exp_f32 v100, v196
v_mfma_f32_16x16x32_bf16 v[216:219], a[224:227], a[16:19], v[44:47]
s_cmp_eq_u32 s4, s5
ds_read_b128 a[212:215], v4 offset:21504
ds_read_b128 a[216:219], v4 offset:22528
v_mfma_f32_16x16x32_bf16 v[216:219], a[228:231], a[20:23], v[216:219]
v_exp_f32 v101, v197
v_mfma_f32_16x16x32_bf16 v[216:219], a[232:235], a[24:27], v[216:219]
s_cselect_b32 s4, s6, s4
ds_read_b128 a[220:223], v4 offset:23552
v_cvt_pk_bf16_f32 v81, v98, v99
v_mfma_f32_16x16x32_bf16 v[216:219], a[236:239], a[28:31], v[216:219]
s_add_u32 m0, s86, 135168
s_add_u32 s89, s89, 16384
v_exp_f32 v102, v198
v_mfma_f32_16x16x32_bf16 v[220:223], a[240:243], a[16:19], v[44:47]
buffer_load_dwordx4 v64, s[52:55], s89 offen offset:0 lds
ds_read_b128 a[224:227], v4 offset:24576
v_cvt_pk_bf16_f32 v82, v100, v101
v_mfma_f32_16x16x32_bf16 v[220:223], a[244:247], a[20:23], v[220:223]
v_exp_f32 v103, v199
v_mfma_f32_16x16x32_bf16 v[220:223], a[248:251], a[24:27], v[220:223]
buffer_load_dwordx4 v65, s[52:55], s89 offen offset:1024 lds
ds_read_b128 a[228:231], v4 offset:25600
ds_read_b128 a[232:235], v4 offset:26624
v_mfma_f32_16x16x32_bf16 v[220:223], a[252:255], a[28:31], v[220:223]
s_cbranch_vccnz Lstub62
Lret63:
v_exp_f32 v104, v200
v_mfma_f32_16x16x32_bf16 v[160:163], a[128:131], v[88:91], v[160:163]
buffer_load_dwordx4 v66, s[52:55], s89 offen offset:2048 lds
ds_read_b128 a[236:239], v4 offset:27648
ds_read_b128 a[240:243], v4 offset:28672
v_mfma_f32_16x16x32_bf16 v[160:163], a[132:135], v[92:95], v[160:163]
v_exp_f32 v105, v201
v_mfma_f32_16x16x32_bf16 v[164:167], a[136:139], v[88:91], v[164:167]
buffer_load_dwordx4 v67, s[52:55], s89 offen offset:3072 lds
ds_read_b128 a[244:247], v4 offset:29696
ds_read_b128 a[248:251], v4 offset:30720
v_mfma_f32_16x16x32_bf16 v[164:167], a[140:143], v[92:95], v[164:167]
v_exp_f32 v106, v202
v_mfma_f32_16x16x32_bf16 v[168:171], a[144:147], v[88:91], v[168:171]
ds_read_b128 a[252:255], v4 offset:31744
ds_read_b128 a[128:131], v4 offset:0
v_mfma_f32_16x16x32_bf16 v[168:171], a[148:151], v[92:95], v[168:171]
v_exp_f32 v107, v203
v_mfma_f32_16x16x32_bf16 v[172:175], a[152:155], v[88:91], v[172:175]
ds_read_b128 a[132:135], v4 offset:1024
v_cvt_pk_bf16_f32 v83, v102, v103
v_mfma_f32_16x16x32_bf16 v[172:175], a[156:159], v[92:95], v[172:175]
v_exp_f32 v108, v204
v_mfma_f32_16x16x32_bf16 v[176:179], a[160:163], v[88:91], v[176:179]
ds_read_b128 a[136:139], v4 offset:2048
v_cvt_pk_bf16_f32 v84, v104, v105
v_mfma_f32_16x16x32_bf16 v[176:179], a[164:167], v[92:95], v[176:179]
v_exp_f32 v109, v205
v_mfma_f32_16x16x32_bf16 v[180:183], a[168:171], v[88:91], v[180:183]
ds_read_b128 a[140:143], v4 offset:3072
v_cvt_pk_bf16_f32 v85, v106, v107
v_mfma_f32_16x16x32_bf16 v[180:183], a[172:175], v[92:95], v[180:183]
v_exp_f32 v110, v206
v_mfma_f32_16x16x32_bf16 v[184:187], a[176:179], v[88:91], v[184:187]
ds_read_b128 a[144:147], v4 offset:4096
v_cvt_pk_bf16_f32 v86, v108, v109
v_mfma_f32_16x16x32_bf16 v[184:187], a[180:183], v[92:95], v[184:187]
v_exp_f32 v111, v207
v_mfma_f32_16x16x32_bf16 v[188:191], a[184:187], v[88:91], v[188:191]
ds_read_b128 a[148:151], v4 offset:5120
v_cvt_pk_bf16_f32 v87, v110, v111
v_mfma_f32_16x16x32_bf16 v[188:191], a[188:191], v[92:95], v[188:191]
s_add_u32 s89, s89, 114688
v_mfma_f32_16x16x32_bf16 v[32:35], v[28:31], v[80:83], v[24:27]
ds_read_b128 a[152:155], v4 offset:6144
ds_read_b128 a[156:159], v4 offset:7168
v_mfma_f32_16x16x32_bf16 v[32:35], v[28:31], v[84:87], v[32:35]
s_waitcnt lgkmcnt(5)
v_exp_f32 v112, v208
v_mfma_f32_16x16x32_bf16 v[224:227], a[192:195], a[0:3], v[40:43]
ds_read_b128 a[160:163], v4 offset:8192
ds_read_b128 a[164:167], v4 offset:9216
v_mfma_f32_16x16x32_bf16 v[224:227], a[196:199], a[4:7], v[224:227]
s_mov_b32 m0, s7
v_exp_f32 v113, v209
v_mfma_f32_16x16x32_bf16 v[224:227], a[200:203], a[8:11], v[224:227]
buffer_load_dwordx4 v2, s[60:63], s4 offen offset:0 sc1 lds
v_mfma_f32_16x16x32_bf16 v[224:227], a[204:207], a[12:15], v[224:227]
v_exp_f32 v114, v210
v_mfma_f32_16x16x32_bf16 v[228:231], a[208:211], a[0:3], v[40:43]
ds_read_b128 a[168:171], v4 offset:10240
ds_read_b128 a[172:175], v4 offset:11264
v_mfma_f32_16x16x32_bf16 v[228:231], a[212:215], a[4:7], v[228:231]
v_exp_f32 v115, v211
v_mfma_f32_16x16x32_bf16 v[228:231], a[216:219], a[8:11], v[228:231]
buffer_load_dwordx4 v2, s[60:63], s4 offen offset:1024 sc1 lds
v_mfma_f32_16x16x32_bf16 v[228:231], a[220:223], a[12:15], v[228:231]
v_exp_f32 v116, v212
v_mfma_f32_16x16x32_bf16 v[232:235], a[224:227], a[0:3], v[40:43]
ds_read_b128 a[176:179], v4 offset:12288
v_cmp_lt_f32 vcc, s10, v32
v_mfma_f32_16x16x32_bf16 v[232:235], a[228:231], a[4:7], v[232:235]
v_exp_f32 v117, v213
v_mfma_f32_16x16x32_bf16 v[232:235], a[232:235], a[8:11], v[232:235]
buffer_load_dwordx4 v2, s[60:63], s4 offen offset:2048 sc1 lds
v_mfma_f32_16x16x32_bf16 v[232:235], a[236:239], a[12:15], v[232:235]
v_exp_f32 v118, v214
v_mfma_f32_16x16x32_bf16 v[236:239], a[240:243], a[0:3], v[40:43]
ds_read_b128 a[180:183], v4 offset:13312
ds_read_b128 a[184:187], v4 offset:14336
v_mfma_f32_16x16x32_bf16 v[236:239], a[244:247], a[4:7], v[236:239]
v_exp_f32 v119, v215
v_mfma_f32_16x16x32_bf16 v[236:239], a[248:251], a[8:11], v[236:239]
buffer_load_dwordx4 v2, s[60:63], s4 offen offset:3072 sc1 lds
v_mfma_f32_16x16x32_bf16 v[236:239], a[252:255], a[12:15], v[236:239]
s_cbranch_vccnz Lstub67
Lret68:
v_exp_f32 v120, v216
v_mfma_f32_16x16x32_bf16 v[128:131], a[128:131], v[80:83], v[128:131]
s_waitcnt lgkmcnt(2)
ds_read_b128 a[188:191], v4 offset:15360
v_cvt_pk_bf16_f32 v88, v112, v113
v_mfma_f32_16x16x32_bf16 v[128:131], a[132:135], v[84:87], v[128:131]
s_add_u32 m0, s7, 4096
v_exp_f32 v121, v217
v_mfma_f32_16x16x32_bf16 v[132:135], a[136:139], v[80:83], v[132:135]
buffer_load_dwordx4 v5, s[60:63], s4 offen offset:0 sc1 lds
v_mfma_f32_16x16x32_bf16 v[132:135], a[140:143], v[84:87], v[132:135]
v_exp_f32 v122, v218
v_mfma_f32_16x16x32_bf16 v[136:139], a[144:147], v[80:83], v[136:139]
v_cvt_pk_bf16_f32 v89, v114, v115
v_fma_f32 v64, v8, s14, v40
v_mfma_f32_16x16x32_bf16 v[136:139], a[148:151], v[84:87], v[136:139]
v_exp_f32 v123, v219
v_mfma_f32_16x16x32_bf16 v[140:143], a[152:155], v[80:83], v[140:143]
buffer_load_dwordx4 v5, s[60:63], s4 offen offset:1024 sc1 lds
v_mfma_f32_16x16x32_bf16 v[140:143], a[156:159], v[84:87], v[140:143]
v_exp_f32 v124, v220
v_mfma_f32_16x16x32_bf16 v[144:147], a[160:163], v[80:83], v[144:147]
v_cvt_pk_bf16_f32 v90, v116, v117
v_cvt_pk_bf16_f32 v91, v118, v119
v_mfma_f32_16x16x32_bf16 v[144:147], a[164:167], v[84:87], v[144:147]
v_exp_f32 v125, v221
v_mfma_f32_16x16x32_bf16 v[148:151], a[168:171], v[80:83], v[148:151]
buffer_load_dwordx4 v5, s[60:63], s4 offen offset:2048 sc1 lds
v_mfma_f32_16x16x32_bf16 v[148:151], a[172:175], v[84:87], v[148:151]
v_exp_f32 v126, v222
v_mfma_f32_16x16x32_bf16 v[152:155], a[176:179], v[80:83], v[152:155]
s_waitcnt lgkmcnt(0)
v_cvt_pk_bf16_f32 v92, v120, v121
v_cvt_pk_bf16_f32 v93, v122, v123
v_mfma_f32_16x16x32_bf16 v[152:155], a[180:183], v[84:87], v[152:155]
v_exp_f32 v127, v223
v_mfma_f32_16x16x32_bf16 v[156:159], a[184:187], v[80:83], v[156:159]
buffer_load_dwordx4 v5, s[60:63], s4 offen offset:3072 sc1 lds
v_mfma_f32_16x16x32_bf16 v[156:159], a[188:191], v[84:87], v[156:159]
s_waitcnt vmcnt(16) lgkmcnt(0)
v_cvt_pk_bf16_f32 v94, v124, v125
v_cvt_pk_bf16_f32 v95, v126, v127
v_mfma_f32_16x16x32_bf16 v[36:39], v[28:31], v[88:91], v[60:63]
s_barrier
v_mfma_f32_16x16x32_bf16 v[36:39], v[28:31], v[92:95], v[36:39]
v_exp_f32 v96, v224
v_mfma_f32_16x16x32_bf16 v[240:243], a[192:195], a[16:19], v[44:47]
ds_read_b128 a[192:195], v4 offset:49152
v_fma_f32 v65, v9, s14, v40
v_fma_f32 v66, v10, s14, v40
v_mfma_f32_16x16x32_bf16 v[240:243], a[196:199], a[20:23], v[240:243]
buffer_load_dwordx4 a[64:67], v2, s[60:63], s84 offen offset:0 sc1
v_exp_f32 v97, v225
v_mfma_f32_16x16x32_bf16 v[240:243], a[200:203], a[24:27], v[240:243]
s_add_u32 s7, s7, 0x8000
ds_read_b128 a[196:199], v4 offset:50176
v_cvt_pk_bf16_f32 v80, v96, v97
v_fma_f32 v67, v11, s14, v40
v_mfma_f32_16x16x32_bf16 v[240:243], a[204:207], a[28:31], v[240:243]
v_exp_f32 v98, v226
v_mfma_f32_16x16x32_bf16 v[244:247], a[208:211], a[16:19], v[44:47]
s_and_b32 s7, s7, 0x1ffff
ds_read_b128 a[200:203], v4 offset:51200
ds_read_b128 a[204:207], v4 offset:52224
v_fma_f32 v68, v12, s14, v40
v_mfma_f32_16x16x32_bf16 v[244:247], a[212:215], a[20:23], v[244:247]
buffer_load_dwordx4 a[68:71], v2, s[60:63], s84 offen offset:1024 sc1
v_exp_f32 v99, v227
v_mfma_f32_16x16x32_bf16 v[244:247], a[216:219], a[24:27], v[244:247]
s_add_u32 s4, s4, 0x8000
ds_read_b128 a[208:211], v4 offset:53248
v_cmp_lt_f32 vcc, s10, v36
v_fma_f32 v69, v13, s14, v40
v_mfma_f32_16x16x32_bf16 v[244:247], a[220:223], a[28:31], v[244:247]
v_exp_f32 v100, v228
v_mfma_f32_16x16x32_bf16 v[248:251], a[224:227], a[16:19], v[44:47]
s_cmp_eq_u32 s4, s5
ds_read_b128 a[212:215], v4 offset:54272
ds_read_b128 a[216:219], v4 offset:55296
v_fma_f32 v70, v14, s14, v40
v_mfma_f32_16x16x32_bf16 v[248:251], a[228:231], a[20:23], v[248:251]
v_exp_f32 v101, v229
v_mfma_f32_16x16x32_bf16 v[248:251], a[232:235], a[24:27], v[248:251]
s_cselect_b32 s4, s6, s4
ds_read_b128 a[220:223], v4 offset:56320
v_cvt_pk_bf16_f32 v81, v98, v99
v_fma_f32 v71, v15, s14, v40
v_mfma_f32_16x16x32_bf16 v[248:251], a[236:239], a[28:31], v[248:251]
buffer_load_dwordx4 a[72:75], v2, s[60:63], s84 offen offset:2048 sc1
v_exp_f32 v102, v230
v_mfma_f32_16x16x32_bf16 v[252:255], a[240:243], a[16:19], v[44:47]
ds_read_b128 a[224:227], v4 offset:57344
v_cvt_pk_bf16_f32 v82, v100, v101
v_fma_f32 v72, v16, s14, v40
v_mfma_f32_16x16x32_bf16 v[252:255], a[244:247], a[20:23], v[252:255]
v_exp_f32 v103, v231
v_mfma_f32_16x16x32_bf16 v[252:255], a[248:251], a[24:27], v[252:255]
ds_read_b128 a[228:231], v4 offset:58368
v_cvt_pk_bf16_f32 v83, v102, v103
v_fma_f32 v73, v17, s14, v40
v_mfma_f32_16x16x32_bf16 v[252:255], a[252:255], a[28:31], v[252:255]
s_cbranch_vccnz Lstub69
Lret70:
v_exp_f32 v104, v232
v_mfma_f32_16x16x32_bf16 v[160:163], a[128:131], v[88:91], v[160:163]
ds_read_b128 a[232:235], v4 offset:59392
ds_read_b128 a[236:239], v4 offset:60416
v_fma_f32 v74, v18, s14, v40
v_mfma_f32_16x16x32_bf16 v[160:163], a[132:135], v[92:95], v[160:163]
buffer_load_dwordx4 a[76:79], v2, s[60:63], s84 offen offset:3072 sc1
v_exp_f32 v105, v233
v_mfma_f32_16x16x32_bf16 v[164:167], a[136:139], v[88:91], v[164:167]
s_add_u32 s84, s84, 4096
ds_read_b128 a[240:243], v4 offset:61440
ds_read_b128 a[244:247], v4 offset:62464
v_fma_f32 v75, v19, s14, v40
v_mfma_f32_16x16x32_bf16 v[164:167], a[140:143], v[92:95], v[164:167]
buffer_load_dwordx4 a[80:83], v2, s[60:63], s85 offen offset:0 sc1
v_exp_f32 v106, v234
v_mfma_f32_16x16x32_bf16 v[168:171], a[144:147], v[88:91], v[168:171]
ds_read_b128 a[248:251], v4 offset:63488
ds_read_b128 a[252:255], v4 offset:64512
v_fma_f32 v76, v20, s14, v40
v_mfma_f32_16x16x32_bf16 v[168:171], a[148:151], v[92:95], v[168:171]
buffer_load_dwordx4 a[84:87], v2, s[60:63], s85 offen offset:1024 sc1
v_exp_f32 v107, v235
v_mfma_f32_16x16x32_bf16 v[172:175], a[152:155], v[88:91], v[172:175]
ds_read_b128 a[128:131], v4 offset:32768
ds_read_b128 a[132:135], v4 offset:33792
v_fma_f32 v77, v21, s14, v40
v_mfma_f32_16x16x32_bf16 v[172:175], a[156:159], v[92:95], v[172:175]
buffer_load_dwordx4 a[88:91], v2, s[60:63], s85 offen offset:2048 sc1
v_exp_f32 v108, v236
v_mfma_f32_16x16x32_bf16 v[176:179], a[160:163], v[88:91], v[176:179]
ds_read_b128 a[136:139], v4 offset:34816
ds_read_b128 a[140:143], v4 offset:35840
v_fma_f32 v78, v22, s14, v40
v_mfma_f32_16x16x32_bf16 v[176:179], a[164:167], v[92:95], v[176:179]
v_exp_f32 v109, v237
v_mfma_f32_16x16x32_bf16 v[180:183], a[168:171], v[88:91], v[180:183]
ds_read_b128 a[144:147], v4 offset:36864
v_cvt_pk_bf16_f32 v84, v104, v105
v_fma_f32 v79, v23, s14, v40
v_mfma_f32_16x16x32_bf16 v[180:183], a[172:175], v[92:95], v[180:183]
buffer_load_dwordx4 a[92:95], v2, s[60:63], s85 offen offset:3072 sc1
v_exp_f32 v110, v238
v_mfma_f32_16x16x32_bf16 v[184:187], a[176:179], v[88:91], v[184:187]
Lcp75:
s_add_u32 s9, s95, L_lastb-L_pc+0
ds_read_b128 a[148:151], v4 offset:37888
v_cvt_pk_bf16_f32 v85, v106, v107
v_mfma_f32_16x16x32_bf16 v[184:187], a[180:183], v[92:95], v[184:187]
buffer_load_dword v51, off, s[64:67], s9
v_exp_f32 v111, v239
v_mfma_f32_16x16x32_bf16 v[188:191], a[184:187], v[88:91], v[188:191]
ds_read_b128 a[152:155], v4 offset:38912
v_cvt_pk_bf16_f32 v86, v108, v109
v_mfma_f32_16x16x32_bf16 v[188:191], a[188:191], v[92:95], v[188:191]
ds_read_b128 a[156:159], v4 offset:39936
v_cvt_pk_bf16_f32 v87, v110, v111
v_mfma_f32_16x16x32_bf16 v[24:27], v[28:31], v[80:83], v[32:35]
ds_read_b128 a[160:163], v4 offset:40960
ds_read_b128 a[164:167], v4 offset:41984
v_mfma_f32_16x16x32_bf16 v[24:27], v[28:31], v[84:87], v[24:27]
s_waitcnt lgkmcnt(6)
v_exp_f32 v112, v240
v_mfma_f32_16x16x32_bf16 v[192:195], a[192:195], a[0:3], v[64:67]
ds_read_b128 a[168:171], v4 offset:43008
ds_read_b128 a[172:175], v4 offset:44032
v_mfma_f32_16x16x32_bf16 v[192:195], a[196:199], a[4:7], v[192:195]
s_mov_b32 m0, s7
v_exp_f32 v113, v241
v_mfma_f32_16x16x32_bf16 v[192:195], a[200:203], a[8:11], v[192:195]
buffer_load_dwordx4 v2, s[60:63], s4 offen offset:0 sc1 lds
v_mfma_f32_16x16x32_bf16 v[192:195], a[204:207], a[12:15], v[192:195]
v_exp_f32 v114, v242
v_mfma_f32_16x16x32_bf16 v[196:199], a[208:211], a[0:3], v[68:71]
ds_read_b128 a[176:179], v4 offset:45056
ds_read_b128 a[180:183], v4 offset:46080
v_mfma_f32_16x16x32_bf16 v[196:199], a[212:215], a[4:7], v[196:199]
v_exp_f32 v115, v243
v_mfma_f32_16x16x32_bf16 v[196:199], a[216:219], a[8:11], v[196:199]
buffer_load_dwordx4 v2, s[60:63], s4 offen offset:1024 sc1 lds
v_mfma_f32_16x16x32_bf16 v[196:199], a[220:223], a[12:15], v[196:199]
v_exp_f32 v116, v244
v_mfma_f32_16x16x32_bf16 v[200:203], a[224:227], a[0:3], v[72:75]
v_cvt_pk_bf16_f32 v88, v112, v113
v_cmp_lt_f32 vcc, s10, v24
v_mfma_f32_16x16x32_bf16 v[200:203], a[228:231], a[4:7], v[200:203]
v_exp_f32 v117, v245
v_mfma_f32_16x16x32_bf16 v[200:203], a[232:235], a[8:11], v[200:203]
buffer_load_dwordx4 v2, s[60:63], s4 offen offset:2048 sc1 lds
v_mfma_f32_16x16x32_bf16 v[200:203], a[236:239], a[12:15], v[200:203]
v_exp_f32 v118, v246
v_mfma_f32_16x16x32_bf16 v[204:207], a[240:243], a[0:3], v[76:79]
ds_read_b128 a[184:187], v4 offset:47104
v_cvt_pk_bf16_f32 v89, v114, v115
v_mfma_f32_16x16x32_bf16 v[204:207], a[244:247], a[4:7], v[204:207]
v_exp_f32 v119, v247
v_mfma_f32_16x16x32_bf16 v[204:207], a[248:251], a[8:11], v[204:207]
buffer_load_dwordx4 v2, s[60:63], s4 offen offset:3072 sc1 lds
v_mfma_f32_16x16x32_bf16 v[204:207], a[252:255], a[12:15], v[204:207]
s_cbranch_vccnz Lstub71
Lret72:
v_exp_f32 v120, v248
v_mfma_f32_16x16x32_bf16 v[128:131], a[128:131], v[80:83], v[128:131]
ds_read_b128 a[188:191], v4 offset:48128
v_cvt_pk_bf16_f32 v90, v116, v117
v_mfma_f32_16x16x32_bf16 v[128:131], a[132:135], v[84:87], v[128:131]
s_add_u32 m0, s7, 4096
v_exp_f32 v121, v249
v_mfma_f32_16x16x32_bf16 v[132:135], a[136:139], v[80:83], v[132:135]
buffer_load_dwordx4 v5, s[60:63], s4 offen offset:0 sc1 lds
v_mfma_f32_16x16x32_bf16 v[132:135], a[140:143], v[84:87], v[132:135]
s_waitcnt lgkmcnt(2)
v_exp_f32 v122, v250
v_mfma_f32_16x16x32_bf16 v[136:139], a[144:147], v[80:83], v[136:139]
v_cvt_pk_bf16_f32 v91, v118, v119
v_cvt_pk_bf16_f32 v92, v120, v121
v_mfma_f32_16x16x32_bf16 v[136:139], a[148:151], v[84:87], v[136:139]
v_exp_f32 v123, v251
v_mfma_f32_16x16x32_bf16 v[140:143], a[152:155], v[80:83], v[140:143]
buffer_load_dwordx4 v5, s[60:63], s4 offen offset:1024 sc1 lds
v_mfma_f32_16x16x32_bf16 v[140:143], a[156:159], v[84:87], v[140:143]
v_exp_f32 v124, v252
v_mfma_f32_16x16x32_bf16 v[144:147], a[160:163], v[80:83], v[144:147]
v_cvt_pk_bf16_f32 v93, v122, v123
v_mfma_f32_16x16x32_bf16 v[144:147], a[164:167], v[84:87], v[144:147]
v_exp_f32 v125, v253
v_mfma_f32_16x16x32_bf16 v[148:151], a[168:171], v[80:83], v[148:151]
buffer_load_dwordx4 v5, s[60:63], s4 offen offset:2048 sc1 lds
v_mfma_f32_16x16x32_bf16 v[148:151], a[172:175], v[84:87], v[148:151]
v_exp_f32 v126, v254
v_mfma_f32_16x16x32_bf16 v[152:155], a[176:179], v[80:83], v[152:155]
v_xor_b32 v4, 0x10000, v4
v_mfma_f32_16x16x32_bf16 v[152:155], a[180:183], v[84:87], v[152:155]
s_waitcnt lgkmcnt(0)
v_exp_f32 v127, v255
v_mfma_f32_16x16x32_bf16 v[156:159], a[184:187], v[80:83], v[156:159]
buffer_load_dwordx4 v5, s[60:63], s4 offen offset:3072 sc1 lds
v_mfma_f32_16x16x32_bf16 v[156:159], a[188:191], v[84:87], v[156:159]
s_waitcnt vmcnt(16) lgkmcnt(0)
v_cvt_pk_bf16_f32 v94, v124, v125
v_cvt_pk_bf16_f32 v95, v126, v127
v_mfma_f32_16x16x32_bf16 v[60:63], v[28:31], v[88:91], v[36:39]
s_barrier
v_mfma_f32_16x16x32_bf16 v[60:63], v[28:31], v[92:95], v[60:63]
v_exp_f32 v96, v192
v_mfma_f32_16x16x32_bf16 v[208:211], a[192:195], a[16:19], v[44:47]
s_add_u32 s85, s85, 4096
ds_read_b128 a[192:195], v4 offset:16384
v_mfma_f32_16x16x32_bf16 v[208:211], a[196:199], a[20:23], v[208:211]
buffer_load_dwordx4 a[96:99], v2, s[60:63], s84 offen offset:0 sc1
v_exp_f32 v97, v193
v_mfma_f32_16x16x32_bf16 v[208:211], a[200:203], a[24:27], v[208:211]
s_add_u32 s7, s7, 0x8000
ds_read_b128 a[196:199], v4 offset:17408
v_cvt_pk_bf16_f32 v80, v96, v97
v_mfma_f32_16x16x32_bf16 v[208:211], a[204:207], a[28:31], v[208:211]
v_exp_f32 v98, v194
v_mfma_f32_16x16x32_bf16 v[212:215], a[208:211], a[16:19], v[44:47]
s_and_b32 s7, s7, 0x1ffff
ds_read_b128 a[200:203], v4 offset:18432
ds_read_b128 a[204:207], v4 offset:19456
v_mfma_f32_16x16x32_bf16 v[212:215], a[212:215], a[20:23], v[212:215]
buffer_load_dwordx4 a[100:103], v2, s[60:63], s84 offen offset:1024 sc1
v_exp_f32 v99, v195
v_mfma_f32_16x16x32_bf16 v[212:215], a[216:219], a[24:27], v[212:215]
s_add_u32 s4, s4, 0x8000
ds_read_b128 a[208:211], v4 offset:20480
v_cmp_lt_f32 vcc, s10, v60
v_mfma_f32_16x16x32_bf16 v[212:215], a[220:223], a[28:31], v[212:215]
v_exp_f32 v100, v196
v_mfma_f32_16x16x32_bf16 v[216:219], a[224:227], a[16:19], v[44:47]
s_cmp_eq_u32 s4, s5
ds_read_b128 a[212:215], v4 offset:21504
ds_read_b128 a[216:219], v4 offset:22528
v_mfma_f32_16x16x32_bf16 v[216:219], a[228:231], a[20:23], v[216:219]
v_exp_f32 v101, v197
v_mfma_f32_16x16x32_bf16 v[216:219], a[232:235], a[24:27], v[216:219]
s_cselect_b32 s4, s6, s4
ds_read_b128 a[220:223], v4 offset:23552
v_cvt_pk_bf16_f32 v81, v98, v99
v_mfma_f32_16x16x32_bf16 v[216:219], a[236:239], a[28:31], v[216:219]
buffer_load_dwordx4 a[104:107], v2, s[60:63], s84 offen offset:2048 sc1
v_exp_f32 v102, v198
v_mfma_f32_16x16x32_bf16 v[220:223], a[240:243], a[16:19], v[44:47]
ds_read_b128 a[224:227], v4 offset:24576
v_cvt_pk_bf16_f32 v82, v100, v101
v_mfma_f32_16x16x32_bf16 v[220:223], a[244:247], a[20:23], v[220:223]
v_exp_f32 v103, v199
v_mfma_f32_16x16x32_bf16 v[220:223], a[248:251], a[24:27], v[220:223]
buffer_load_dwordx4 a[108:111], v2, s[60:63], s84 offen offset:3072 sc1
ds_read_b128 a[228:231], v4 offset:25600
ds_read_b128 a[232:235], v4 offset:26624
v_mfma_f32_16x16x32_bf16 v[220:223], a[252:255], a[28:31], v[220:223]
s_cbranch_vccnz Lstub73
Lret74:
v_exp_f32 v104, v200
v_mfma_f32_16x16x32_bf16 v[160:163], a[128:131], v[88:91], v[160:163]
s_add_u32 s84, s84, 4096
ds_read_b128 a[236:239], v4 offset:27648
ds_read_b128 a[240:243], v4 offset:28672
v_mfma_f32_16x16x32_bf16 v[160:163], a[132:135], v[92:95], v[160:163]
buffer_load_dwordx4 a[112:115], v2, s[60:63], s85 offen offset:0 sc1
v_exp_f32 v105, v201
v_mfma_f32_16x16x32_bf16 v[164:167], a[136:139], v[88:91], v[164:167]
ds_read_b128 a[244:247], v4 offset:29696
ds_read_b128 a[248:251], v4 offset:30720
v_mfma_f32_16x16x32_bf16 v[164:167], a[140:143], v[92:95], v[164:167]
v_exp_f32 v106, v202
v_mfma_f32_16x16x32_bf16 v[168:171], a[144:147], v[88:91], v[168:171]
buffer_load_dwordx4 a[116:119], v2, s[60:63], s85 offen offset:1024 sc1
ds_read_b128 a[252:255], v4 offset:31744
ds_read_b128 a[128:131], v4 offset:0
v_mfma_f32_16x16x32_bf16 v[168:171], a[148:151], v[92:95], v[168:171]
v_exp_f32 v107, v203
v_mfma_f32_16x16x32_bf16 v[172:175], a[152:155], v[88:91], v[172:175]
ds_read_b128 a[132:135], v4 offset:1024
v_cvt_pk_bf16_f32 v83, v102, v103
v_mfma_f32_16x16x32_bf16 v[172:175], a[156:159], v[92:95], v[172:175]
buffer_load_dwordx4 a[120:123], v2, s[60:63], s85 offen offset:2048 sc1
v_exp_f32 v108, v204
v_mfma_f32_16x16x32_bf16 v[176:179], a[160:163], v[88:91], v[176:179]
ds_read_b128 a[136:139], v4 offset:2048
v_cvt_pk_bf16_f32 v84, v104, v105
v_mfma_f32_16x16x32_bf16 v[176:179], a[164:167], v[92:95], v[176:179]
v_exp_f32 v109, v205
v_mfma_f32_16x16x32_bf16 v[180:183], a[168:171], v[88:91], v[180:183]
ds_read_b128 a[140:143], v4 offset:3072
v_cvt_pk_bf16_f32 v85, v106, v107
v_mfma_f32_16x16x32_bf16 v[180:183], a[172:175], v[92:95], v[180:183]
v_exp_f32 v110, v206
v_mfma_f32_16x16x32_bf16 v[184:187], a[176:179], v[88:91], v[184:187]
ds_read_b128 a[144:147], v4 offset:4096
v_cvt_pk_bf16_f32 v86, v108, v109
v_mfma_f32_16x16x32_bf16 v[184:187], a[180:183], v[92:95], v[184:187]
v_exp_f32 v111, v207
v_mfma_f32_16x16x32_bf16 v[188:191], a[184:187], v[88:91], v[188:191]
ds_read_b128 a[148:151], v4 offset:5120
v_cvt_pk_bf16_f32 v87, v110, v111
v_mfma_f32_16x16x32_bf16 v[188:191], a[188:191], v[92:95], v[188:191]
buffer_load_dwordx4 a[124:127], v2, s[60:63], s85 offen offset:3072 sc1
s_add_u32 s85, s85, 4096
L_tr:
v_fma_f32 v64, v8, s14, v44
v_fma_f32 v65, v9, s14, v44
v_fma_f32 v66, v10, s14, v44
v_fma_f32 v67, v11, s14, v44
v_fma_f32 v68, v12, s14, v44
v_fma_f32 v69, v13, s14, v44
v_fma_f32 v70, v14, s14, v44
v_fma_f32 v71, v15, s14, v44
v_fma_f32 v72, v16, s14, v44
v_fma_f32 v73, v17, s14, v44
v_fma_f32 v74, v18, s14, v44
v_fma_f32 v75, v19, s14, v44
v_fma_f32 v76, v20, s14, v44
v_fma_f32 v77, v21, s14, v44
v_fma_f32 v78, v22, s14, v44
v_fma_f32 v79, v23, s14, v44
s_waitcnt lgkmcnt(0)
v_mfma_f32_16x16x32_bf16 v[32:35], v[28:31], v[80:83], v[24:27]
ds_read_b128 a[152:155], v4 offset:6144
ds_read_b128 a[156:159], v4 offset:7168
v_mfma_f32_16x16x32_bf16 v[32:35], v[28:31], v[84:87], v[32:35]
v_exp_f32 v112, v208
v_mfma_f32_16x16x32_bf16 v[240:243], a[192:195], a[16:19], v[64:67]
ds_read_b128 a[160:163], v4 offset:8192
ds_read_b128 a[164:167], v4 offset:9216
v_mfma_f32_16x16x32_bf16 v[240:243], a[196:199], a[20:23], v[240:243]
s_mov_b32 m0, s7
v_exp_f32 v113, v209
v_mfma_f32_16x16x32_bf16 v[240:243], a[200:203], a[24:27], v[240:243]
buffer_load_dwordx4 v2, s[60:63], s4 offen offset:0 sc1 lds
v_mfma_f32_16x16x32_bf16 v[240:243], a[204:207], a[28:31], v[240:243]
v_exp_f32 v114, v210
v_mfma_f32_16x16x32_bf16 v[244:247], a[208:211], a[16:19], v[68:71]
ds_read_b128 a[168:171], v4 offset:10240
ds_read_b128 a[172:175], v4 offset:11264
v_mfma_f32_16x16x32_bf16 v[244:247], a[212:215], a[20:23], v[244:247]
v_exp_f32 v115, v211
v_mfma_f32_16x16x32_bf16 v[244:247], a[216:219], a[24:27], v[244:247]
buffer_load_dwordx4 v2, s[60:63], s4 offen offset:1024 sc1 lds
v_mfma_f32_16x16x32_bf16 v[244:247], a[220:223], a[28:31], v[244:247]
v_exp_f32 v116, v212
v_mfma_f32_16x16x32_bf16 v[248:251], a[224:227], a[16:19], v[72:75]
ds_read_b128 a[176:179], v4 offset:12288
v_cmp_lt_f32 vcc, s10, v32
v_mfma_f32_16x16x32_bf16 v[248:251], a[228:231], a[20:23], v[248:251]
v_exp_f32 v117, v213
v_mfma_f32_16x16x32_bf16 v[248:251], a[232:235], a[24:27], v[248:251]
buffer_load_dwordx4 v2, s[60:63], s4 offen offset:2048 sc1 lds
v_mfma_f32_16x16x32_bf16 v[248:251], a[236:239], a[28:31], v[248:251]
v_exp_f32 v118, v214
v_mfma_f32_16x16x32_bf16 v[252:255], a[240:243], a[16:19], v[76:79]
ds_read_b128 a[180:183], v4 offset:13312
ds_read_b128 a[184:187], v4 offset:14336
v_mfma_f32_16x16x32_bf16 v[252:255], a[244:247], a[20:23], v[252:255]
v_exp_f32 v119, v215
v_mfma_f32_16x16x32_bf16 v[252:255], a[248:251], a[24:27], v[252:255]
buffer_load_dwordx4 v2, s[60:63], s4 offen offset:3072 sc1 lds
v_mfma_f32_16x16x32_bf16 v[252:255], a[252:255], a[28:31], v[252:255]
s_cbranch_vccnz Lstub76
Lret77:
v_exp_f32 v120, v216
v_mfma_f32_16x16x32_bf16 v[128:131], a[128:131], v[80:83], v[128:131]
ds_read_b128 a[188:191], v4 offset:15360
v_cvt_pk_bf16_f32 v88, v112, v113
v_mfma_f32_16x16x32_bf16 v[128:131], a[132:135], v[84:87], v[128:131]
s_add_u32 m0, s7, 4096
v_exp_f32 v121, v217
v_mfma_f32_16x16x32_bf16 v[132:135], a[136:139], v[80:83], v[132:135]
buffer_load_dwordx4 v5, s[60:63], s4 offen offset:0 sc1 lds
v_mfma_f32_16x16x32_bf16 v[132:135], a[140:143], v[84:87], v[132:135]
v_exp_f32 v122, v218
v_mfma_f32_16x16x32_bf16 v[136:139], a[144:147], v[80:83], v[136:139]
v_cvt_pk_bf16_f32 v89, v114, v115
v_mfma_f32_16x16x32_bf16 v[136:139], a[148:151], v[84:87], v[136:139]
s_waitcnt lgkmcnt(0)
v_exp_f32 v123, v219
v_mfma_f32_16x16x32_bf16 v[140:143], a[152:155], v[80:83], v[140:143]
buffer_load_dwordx4 v5, s[60:63], s4 offen offset:1024 sc1 lds
v_mfma_f32_16x16x32_bf16 v[140:143], a[156:159], v[84:87], v[140:143]
v_exp_f32 v124, v220
v_mfma_f32_16x16x32_bf16 v[144:147], a[160:163], v[80:83], v[144:147]
v_cvt_pk_bf16_f32 v90, v116, v117
v_cvt_pk_bf16_f32 v91, v118, v119
v_mfma_f32_16x16x32_bf16 v[144:147], a[164:167], v[84:87], v[144:147]
v_exp_f32 v125, v221
v_mfma_f32_16x16x32_bf16 v[148:151], a[168:171], v[80:83], v[148:151]
buffer_load_dwordx4 v5, s[60:63], s4 offen offset:2048 sc1 lds
v_mfma_f32_16x16x32_bf16 v[148:151], a[172:175], v[84:87], v[148:151]
v_exp_f32 v126, v222
v_mfma_f32_16x16x32_bf16 v[152:155], a[176:179], v[80:83], v[152:155]
v_cvt_pk_bf16_f32 v92, v120, v121
v_cvt_pk_bf16_f32 v93, v122, v123
v_mfma_f32_16x16x32_bf16 v[152:155], a[180:183], v[84:87], v[152:155]
v_exp_f32 v127, v223
v_mfma_f32_16x16x32_bf16 v[156:159], a[184:187], v[80:83], v[156:159]
buffer_load_dwordx4 v5, s[60:63], s4 offen offset:3072 sc1 lds
v_mfma_f32_16x16x32_bf16 v[156:159], a[188:191], v[84:87], v[156:159]
v_cvt_pk_bf16_f32 v94, v124, v125
v_cvt_pk_bf16_f32 v95, v126, v127
v_mfma_f32_16x16x32_bf16 v[36:39], v[28:31], v[88:91], v[60:63]
s_nop 0
v_mfma_f32_16x16x32_bf16 v[36:39], v[28:31], v[92:95], v[36:39]
s_waitcnt vmcnt(16) lgkmcnt(0)
s_barrier
ds_read_b128 a[192:195], v4 offset:49152
ds_read_b128 a[196:199], v4 offset:50176
ds_read_b128 a[200:203], v4 offset:51200
ds_read_b128 a[204:207], v4 offset:52224
v_rcp_f32 v54, v32
s_add_u32 s80, s11, 0
v_mul_f32 v54, 0x25800000, v54
v_mov_b32 v24, 0
v_mov_b32 v25, 0
v_mov_b32 v26, 0
v_mov_b32 v27, 0
v_cmp_lt_f32 vcc, s10, v36
v_mul_f32 v128, v128, v54
v_mul_f32 v129, v129, v54
v_mul_f32 v130, v130, v54
v_mul_f32 v131, v131, v54
v_mul_f32 v132, v132, v54
v_mul_f32 v133, v133, v54
v_mul_f32 v134, v134, v54
v_mul_f32 v135, v135, v54
v_cvt_pk_bf16_f32 v128, v128, v129
v_cvt_pk_bf16_f32 v129, v130, v131
v_cvt_pk_bf16_f32 v130, v132, v133
v_cvt_pk_bf16_f32 v131, v134, v135
v_mfma_f32_16x16x32_bf16 v[132:135], v[28:31], v[24:27], 0
buffer_store_dwordx4 v[128:131], v2, s[60:63], s80 offen sc1
v_mul_f32 v136, v136, v54
v_mul_f32 v137, v137, v54
v_mul_f32 v138, v138, v54
v_mfma_f32_16x16x32_bf16 v[128:131], v[28:31], v[24:27], 0
s_add_u32 s80, s80, 4096
ds_read_b128 a[208:211], v4 offset:53248
ds_read_b128 a[212:215], v4 offset:54272
ds_read_b128 a[216:219], v4 offset:55296
ds_read_b128 a[220:223], v4 offset:56320
v_mul_f32 v139, v139, v54
v_mul_f32 v140, v140, v54
v_mul_f32 v141, v141, v54
v_mul_f32 v142, v142, v54
v_mul_f32 v143, v143, v54
v_cvt_pk_bf16_f32 v136, v136, v137
v_cvt_pk_bf16_f32 v137, v138, v139
v_cvt_pk_bf16_f32 v138, v140, v141
v_cvt_pk_bf16_f32 v139, v142, v143
v_mfma_f32_16x16x32_bf16 v[140:143], v[28:31], v[24:27], 0
buffer_store_dwordx4 v[136:139], v2, s[60:63], s80 offen sc1
v_mul_f32 v144, v144, v54
v_mul_f32 v145, v145, v54
v_mul_f32 v146, v146, v54
v_mfma_f32_16x16x32_bf16 v[136:139], v[28:31], v[24:27], 0
s_add_u32 s80, s80, 4096
ds_read_b128 a[224:227], v4 offset:57344
ds_read_b128 a[228:231], v4 offset:58368
ds_read_b128 a[232:235], v4 offset:59392
ds_read_b128 a[236:239], v4 offset:60416
v_mul_f32 v147, v147, v54
v_mul_f32 v148, v148, v54
v_mul_f32 v149, v149, v54
v_mul_f32 v150, v150, v54
v_mul_f32 v151, v151, v54
v_cvt_pk_bf16_f32 v144, v144, v145
v_cvt_pk_bf16_f32 v145, v146, v147
v_cvt_pk_bf16_f32 v146, v148, v149
v_cvt_pk_bf16_f32 v147, v150, v151
v_mfma_f32_16x16x32_bf16 v[148:151], v[28:31], v[24:27], 0
buffer_store_dwordx4 v[144:147], v2, s[60:63], s80 offen sc1
v_mul_f32 v152, v152, v54
v_mul_f32 v153, v153, v54
v_mul_f32 v154, v154, v54
v_mfma_f32_16x16x32_bf16 v[144:147], v[28:31], v[24:27], 0
s_add_u32 s80, s80, 4096
ds_read_b128 a[240:243], v4 offset:61440
ds_read_b128 a[244:247], v4 offset:62464
ds_read_b128 a[248:251], v4 offset:63488
ds_read_b128 a[252:255], v4 offset:64512
v_mul_f32 v155, v155, v54
v_mul_f32 v156, v156, v54
v_mul_f32 v157, v157, v54
v_mul_f32 v158, v158, v54
v_mul_f32 v159, v159, v54
v_cvt_pk_bf16_f32 v152, v152, v153
v_cvt_pk_bf16_f32 v153, v154, v155
v_cvt_pk_bf16_f32 v154, v156, v157
v_cvt_pk_bf16_f32 v155, v158, v159
v_mfma_f32_16x16x32_bf16 v[156:159], v[28:31], v[24:27], 0
buffer_store_dwordx4 v[152:155], v2, s[60:63], s80 offen sc1
s_add_u32 s7, s7, 0x8000
s_and_b32 s7, s7, 0x1ffff
s_add_u32 s4, s4, 0x8000
s_cmp_eq_u32 s4, s5
s_cselect_b32 s4, s6, s4
s_cmp_eq_u32 s77, 0
s_cselect_b32 s4, s94, s4
v_mfma_f32_16x16x32_bf16 v[152:155], v[28:31], v[24:27], 0
s_cbranch_vccnz Lstub78
Lret79:
v_mfma_f32_16x16x32_bf16 v[160:163], a[128:131], v[88:91], v[160:163]
s_mov_b32 m0, s7
v_exp_f32 v112, v240
v_mfma_f32_16x16x32_bf16 v[160:163], a[132:135], v[92:95], v[160:163]
ds_read_b128 a[128:131], v4 offset:32768
ds_read_b128 a[132:135], v4 offset:33792
v_mfma_f32_16x16x32_bf16 v[164:167], a[136:139], v[88:91], v[164:167]
buffer_load_dwordx4 v2, s[60:63], s4 offen offset:0 sc1 lds
v_exp_f32 v113, v241
v_mfma_f32_16x16x32_bf16 v[164:167], a[140:143], v[92:95], v[164:167]
ds_read_b128 a[136:139], v4 offset:34816
v_cvt_pk_bf16_f32 v224, v112, v113
v_mfma_f32_16x16x32_bf16 v[168:171], a[144:147], v[88:91], v[168:171]
v_exp_f32 v114, v242
v_mfma_f32_16x16x32_bf16 v[168:171], a[148:151], v[92:95], v[168:171]
buffer_load_dwordx4 v2, s[60:63], s4 offen offset:1024 sc1 lds
v_mfma_f32_16x16x32_bf16 v[172:175], a[152:155], v[88:91], v[172:175]
v_exp_f32 v115, v243
v_mfma_f32_16x16x32_bf16 v[172:175], a[156:159], v[92:95], v[172:175]
ds_read_b128 a[140:143], v4 offset:35840
ds_read_b128 a[144:147], v4 offset:36864
v_mfma_f32_16x16x32_bf16 v[176:179], a[160:163], v[88:91], v[176:179]
v_exp_f32 v116, v244
v_mfma_f32_16x16x32_bf16 v[176:179], a[164:167], v[92:95], v[176:179]
ds_read_b128 a[148:151], v4 offset:37888
ds_read_b128 a[152:155], v4 offset:38912
v_mfma_f32_16x16x32_bf16 v[180:183], a[168:171], v[88:91], v[180:183]
buffer_load_dwordx4 v2, s[60:63], s4 offen offset:2048 sc1 lds
v_exp_f32 v117, v245
v_mfma_f32_16x16x32_bf16 v[180:183], a[172:175], v[92:95], v[180:183]
ds_read_b128 a[156:159], v4 offset:39936
ds_read_b128 a[160:163], v4 offset:40960
v_mfma_f32_16x16x32_bf16 v[184:187], a[176:179], v[88:91], v[184:187]
v_exp_f32 v118, v246
v_mfma_f32_16x16x32_bf16 v[184:187], a[180:183], v[92:95], v[184:187]
buffer_load_dwordx4 v2, s[60:63], s4 offen offset:3072 sc1 lds
v_mfma_f32_16x16x32_bf16 v[188:191], a[184:187], v[88:91], v[188:191]
s_waitcnt lgkmcnt(8)
v_exp_f32 v119, v247
v_mfma_f32_16x16x32_bf16 v[188:191], a[188:191], v[92:95], v[188:191]
ds_read_b128 a[164:167], v4 offset:41984
ds_read_b128 a[168:171], v4 offset:43008
v_mfma_f32_16x16x32_bf16 v[192:195], a[192:195], a[32:35], 0
s_add_u32 m0, s7, 4096
v_exp_f32 v120, v248
v_mfma_f32_16x16x32_bf16 v[192:195], a[196:199], a[36:39], v[192:195]
ds_read_b128 a[172:175], v4 offset:44032
v_cvt_pk_bf16_f32 v225, v114, v115
v_mfma_f32_16x16x32_bf16 v[192:195], a[200:203], a[40:43], v[192:195]
buffer_load_dwordx4 v5, s[60:63], s4 offen offset:0 sc1 lds
v_exp_f32 v121, v249
v_mfma_f32_16x16x32_bf16 v[192:195], a[204:207], a[44:47], v[192:195]
ds_read_b128 a[176:179], v4 offset:45056
v_cvt_pk_bf16_f32 v226, v116, v117
v_mfma_f32_16x16x32_bf16 v[196:199], a[208:211], a[32:35], 0
v_exp_f32 v122, v250
v_mfma_f32_16x16x32_bf16 v[196:199], a[212:215], a[36:39], v[196:199]
buffer_load_dwordx4 v5, s[60:63], s4 offen offset:1024 sc1 lds
v_mfma_f32_16x16x32_bf16 v[196:199], a[216:219], a[40:43], v[196:199]
v_exp_f32 v123, v251
v_mfma_f32_16x16x32_bf16 v[196:199], a[220:223], a[44:47], v[196:199]
ds_read_b128 a[180:183], v4 offset:46080
v_cvt_pk_bf16_f32 v227, v118, v119
v_mfma_f32_16x16x32_bf16 v[200:203], a[224:227], a[32:35], 0
v_exp_f32 v124, v252
v_mfma_f32_16x16x32_bf16 v[200:203], a[228:231], a[36:39], v[200:203]
ds_read_b128 a[184:187], v4 offset:47104
v_cvt_pk_bf16_f32 v228, v120, v121
v_mfma_f32_16x16x32_bf16 v[200:203], a[232:235], a[40:43], v[200:203]
buffer_load_dwordx4 v5, s[60:63], s4 offen offset:2048 sc1 lds
v_exp_f32 v125, v253
v_mfma_f32_16x16x32_bf16 v[200:203], a[236:239], a[44:47], v[200:203]
ds_read_b128 a[188:191], v4 offset:48128
v_cvt_pk_bf16_f32 v229, v122, v123
v_mfma_f32_16x16x32_bf16 v[204:207], a[240:243], a[32:35], 0
v_exp_f32 v126, v254
v_mfma_f32_16x16x32_bf16 v[204:207], a[244:247], a[36:39], v[204:207]
buffer_load_dwordx4 v5, s[60:63], s4 offen offset:3072 sc1 lds
v_mfma_f32_16x16x32_bf16 v[204:207], a[248:251], a[40:43], v[204:207]
v_exp_f32 v127, v255
v_mfma_f32_16x16x32_bf16 v[204:207], a[252:255], a[44:47], v[204:207]
v_cvt_pk_bf16_f32 v230, v124, v125
v_cvt_pk_bf16_f32 v231, v126, v127
v_xor_b32 v4, 0x10000, v4
s_cmp_eq_u32 s77, 0
v_mfma_f32_16x16x32_bf16 v[60:63], v[28:31], v[224:227], v[36:39]
v_mfma_f32_16x16x32_bf16 v[60:63], v[28:31], v[228:231], v[60:63]
s_cbranch_scc1 L_cbm
L_cbd:
v_max3_f32 v48, v192, v193, v194
v_max3_f32 v48, v48, v195, v196
v_max3_f32 v48, v48, v197, v198
v_max3_f32 v48, v48, v199, v200
v_max3_f32 v48, v48, v201, v202
v_max3_f32 v48, v48, v203, v204
v_max3_f32 v48, v48, v205, v206
v_max_f32 v48, v48, v207
v_mov_b32 v49, v48
s_add_u32 s7, s7, 0x8000
s_nop 0
v_permlane32_swap_b32 v48, v49
s_and_b32 s7, s7, 0x1ffff
v_max_f32 v48, v48, v49
s_add_u32 s4, s4, 0x8000
v_mov_b32 v49, v48
s_cmp_eq_u32 s4, s5
s_cselect_b32 s4, s6, s4
v_permlane16_swap_b32 v48, v49
v_max_f32 v48, v48, v49
v_sub_f32 v40, 0xc2ca0000, v48
v_sub_f32 v41, 0xc2ca0000, v48
v_cmp_lt_f32 vcc, s10, v60
v_pk_add_f32 v[192:193], v[192:193], v[40:41]
v_pk_add_f32 v[194:195], v[194:195], v[40:41]
v_pk_add_f32 v[196:197], v[196:197], v[40:41]
v_pk_add_f32 v[198:199], v[198:199], v[40:41]
v_pk_add_f32 v[200:201], v[200:201], v[40:41]
v_pk_add_f32 v[202:203], v[202:203], v[40:41]
v_pk_add_f32 v[204:205], v[204:205], v[40:41]
v_pk_add_f32 v[206:207], v[206:207], v[40:41]
v_mov_b64 v[42:43], v[40:41]
s_cbranch_vccnz Lstub80
Lret81:
s_waitcnt vmcnt(16) lgkmcnt(0)
s_barrier
v_mfma_f32_16x16x32_bf16 v[208:211], a[192:195], a[48:51], 0
v_exp_f32 v96, v192
v_mfma_f32_16x16x32_bf16 v[208:211], a[196:199], a[52:55], v[208:211]
ds_read_b128 a[192:195], v4 offset:16384
ds_read_b128 a[196:199], v4 offset:17408
v_mfma_f32_16x16x32_bf16 v[208:211], a[200:203], a[56:59], v[208:211]
v_exp_f32 v97, v193
v_mfma_f32_16x16x32_bf16 v[208:211], a[204:207], a[60:63], v[208:211]
ds_read_b128 a[200:203], v4 offset:18432
v_cvt_pk_bf16_f32 v80, v96, v97
v_mfma_f32_16x16x32_bf16 v[212:215], a[208:211], a[48:51], 0
v_exp_f32 v98, v194
v_mfma_f32_16x16x32_bf16 v[212:215], a[212:215], a[52:55], v[212:215]
ds_read_b128 a[204:207], v4 offset:19456
ds_read_b128 a[208:211], v4 offset:20480
v_mfma_f32_16x16x32_bf16 v[212:215], a[216:219], a[56:59], v[212:215]
v_exp_f32 v99, v195
v_mfma_f32_16x16x32_bf16 v[212:215], a[220:223], a[60:63], v[212:215]
ds_read_b128 a[212:215], v4 offset:21504
v_cvt_pk_bf16_f32 v81, v98, v99
v_mfma_f32_16x16x32_bf16 v[216:219], a[224:227], a[48:51], 0
v_exp_f32 v100, v196
v_mfma_f32_16x16x32_bf16 v[216:219], a[228:231], a[52:55], v[216:219]
ds_read_b128 a[216:219], v4 offset:22528
ds_read_b128 a[220:223], v4 offset:23552
v_mfma_f32_16x16x32_bf16 v[216:219], a[232:235], a[56:59], v[216:219]
v_exp_f32 v101, v197
v_mfma_f32_16x16x32_bf16 v[216:219], a[236:239], a[60:63], v[216:219]
ds_read_b128 a[224:227], v4 offset:24576
ds_read_b128 a[228:231], v4 offset:25600
v_mfma_f32_16x16x32_bf16 v[220:223], a[240:243], a[48:51], 0
v_exp_f32 v102, v198
v_mfma_f32_16x16x32_bf16 v[220:223], a[244:247], a[52:55], v[220:223]
ds_read_b128 a[232:235], v4 offset:26624
ds_read_b128 a[236:239], v4 offset:27648
v_mfma_f32_16x16x32_bf16 v[220:223], a[248:251], a[56:59], v[220:223]
v_exp_f32 v103, v199
v_mfma_f32_16x16x32_bf16 v[220:223], a[252:255], a[60:63], v[220:223]
ds_read_b128 a[240:243], v4 offset:28672
ds_read_b128 a[244:247], v4 offset:29696
v_mfma_f32_16x16x32_bf16 v[160:163], a[128:131], v[224:227], v[160:163]
v_exp_f32 v104, v200
v_mfma_f32_16x16x32_bf16 v[160:163], a[132:135], v[228:231], v[160:163]
ds_read_b128 a[248:251], v4 offset:30720
v_cvt_pk_bf16_f32 v82, v100, v101
v_mfma_f32_16x16x32_bf16 v[164:167], a[136:139], v[224:227], v[164:167]
v_exp_f32 v105, v201
v_mfma_f32_16x16x32_bf16 v[164:167], a[140:143], v[228:231], v[164:167]
ds_read_b128 a[252:255], v4 offset:31744
v_cvt_pk_bf16_f32 v83, v102, v103
v_mfma_f32_16x16x32_bf16 v[168:171], a[144:147], v[224:227], v[168:171]
v_exp_f32 v106, v202
v_mfma_f32_16x16x32_bf16 v[168:171], a[148:151], v[228:231], v[168:171]
ds_read_b128 a[128:131], v4 offset:0
v_cvt_pk_bf16_f32 v84, v104, v105
v_mfma_f32_16x16x32_bf16 v[172:175], a[152:155], v[224:227], v[172:175]
v_exp_f32 v107, v203
v_mfma_f32_16x16x32_bf16 v[172:175], a[156:159], v[228:231], v[172:175]
ds_read_b128 a[132:135], v4 offset:1024
v_cvt_pk_bf16_f32 v85, v106, v107
v_mfma_f32_16x16x32_bf16 v[176:179], a[160:163], v[224:227], v[176:179]
v_exp_f32 v108, v204
v_mfma_f32_16x16x32_bf16 v[176:179], a[164:167], v[228:231], v[176:179]
ds_read_b128 a[136:139], v4 offset:2048
v_mfma_f32_16x16x32_bf16 v[180:183], a[168:171], v[224:227], v[180:183]
v_exp_f32 v109, v205
v_mfma_f32_16x16x32_bf16 v[180:183], a[172:175], v[228:231], v[180:183]
ds_read_b128 a[140:143], v4 offset:3072
v_cvt_pk_bf16_f32 v86, v108, v109
v_mfma_f32_16x16x32_bf16 v[184:187], a[176:179], v[224:227], v[184:187]
v_exp_f32 v110, v206
v_mfma_f32_16x16x32_bf16 v[184:187], a[180:183], v[228:231], v[184:187]
ds_read_b128 a[144:147], v4 offset:4096
v_mfma_f32_16x16x32_bf16 v[188:191], a[184:187], v[224:227], v[188:191]
v_exp_f32 v111, v207
v_mfma_f32_16x16x32_bf16 v[188:191], a[188:191], v[228:231], v[188:191]
ds_read_b128 a[148:151], v4 offset:5120
v_cvt_pk_bf16_f32 v87, v110, v111
v_max3_f32 v50, v208, v209, v210
v_max3_f32 v50, v50, v211, v212
v_max3_f32 v50, v50, v213, v214
v_max3_f32 v50, v50, v215, v216
v_max3_f32 v50, v50, v217, v218
v_max3_f32 v50, v50, v219, v220
v_max3_f32 v50, v50, v221, v222
v_max_f32 v50, v50, v223
v_mov_b32 v49, v50
s_nop 1
v_permlane32_swap_b32 v50, v49
v_max_f32 v50, v50, v49
v_mov_b32 v49, v50
s_nop 1
v_permlane16_swap_b32 v50, v49
v_max_f32 v50, v50, v49
v_sub_f32 v44, 0xc2ca0000, v50
v_sub_f32 v45, 0xc2ca0000, v50
v_rcp_f32 v54, v60
s_add_u32 s80, s11, 524288
v_mul_f32 v54, 0x25800000, v54
v_mov_b32 v60, 0
v_mov_b32 v61, 0
v_mov_b32 v62, 0
v_mov_b32 v63, 0
v_mul_f32 v160, v160, v54
v_mul_f32 v161, v161, v54
v_mul_f32 v162, v162, v54
v_mul_f32 v163, v163, v54
v_mul_f32 v164, v164, v54
v_mul_f32 v165, v165, v54
v_mul_f32 v166, v166, v54
v_mul_f32 v167, v167, v54
v_cvt_pk_bf16_f32 v160, v160, v161
v_cvt_pk_bf16_f32 v161, v162, v163
v_cvt_pk_bf16_f32 v162, v164, v165
v_cvt_pk_bf16_f32 v163, v166, v167
v_mfma_f32_16x16x32_bf16 v[164:167], v[28:31], v[60:63], 0
buffer_store_dwordx4 v[160:163], v2, s[60:63], s80 offen sc1
v_mul_f32 v168, v168, v54
v_mul_f32 v169, v169, v54
v_mul_f32 v170, v170, v54
v_mfma_f32_16x16x32_bf16 v[160:163], v[28:31], v[60:63], 0
s_add_u32 s80, s80, 4096
buffer_load_dwordx4 a[0:3], v2, s[60:63], s84 offen offset:0 sc1
buffer_load_dwordx4 a[4:7], v2, s[60:63], s84 offen offset:1024 sc1
v_mul_f32 v171, v171, v54
v_mul_f32 v172, v172, v54
v_mul_f32 v173, v173, v54
v_mul_f32 v174, v174, v54
v_mul_f32 v175, v175, v54
v_cvt_pk_bf16_f32 v168, v168, v169
v_cvt_pk_bf16_f32 v169, v170, v171
v_cvt_pk_bf16_f32 v170, v172, v173
v_cvt_pk_bf16_f32 v171, v174, v175
v_mfma_f32_16x16x32_bf16 v[172:175], v[28:31], v[60:63], 0
buffer_store_dwordx4 v[168:171], v2, s[60:63], s80 offen sc1
v_mul_f32 v176, v176, v54
v_mul_f32 v177, v177, v54
v_mul_f32 v178, v178, v54
v_mfma_f32_16x16x32_bf16 v[168:171], v[28:31], v[60:63], 0
s_add_u32 s80, s80, 4096
buffer_load_dwordx4 a[8:11], v2, s[60:63], s84 offen offset:2048 sc1
buffer_load_dwordx4 a[12:15], v2, s[60:63], s84 offen offset:3072 sc1
s_add_u32 s84, s84, 4096
v_mul_f32 v179, v179, v54
v_mul_f32 v180, v180, v54
v_mul_f32 v181, v181, v54
v_mul_f32 v182, v182, v54
v_mul_f32 v183, v183, v54
v_cvt_pk_bf16_f32 v176, v176, v177
v_cvt_pk_bf16_f32 v177, v178, v179
v_cvt_pk_bf16_f32 v178, v180, v181
v_cvt_pk_bf16_f32 v179, v182, v183
v_mfma_f32_16x16x32_bf16 v[180:183], v[28:31], v[60:63], 0
buffer_store_dwordx4 v[176:179], v2, s[60:63], s80 offen sc1
v_mul_f32 v184, v184, v54
v_mul_f32 v185, v185, v54
v_mul_f32 v186, v186, v54
v_mfma_f32_16x16x32_bf16 v[176:179], v[28:31], v[60:63], 0
s_add_u32 s80, s80, 4096
buffer_load_dwordx4 a[16:19], v2, s[60:63], s85 offen offset:0 sc1
buffer_load_dwordx4 a[20:23], v2, s[60:63], s85 offen offset:1024 sc1
v_mul_f32 v187, v187, v54
v_mul_f32 v188, v188, v54
v_mul_f32 v189, v189, v54
v_mul_f32 v190, v190, v54
v_mul_f32 v191, v191, v54
v_cvt_pk_bf16_f32 v184, v184, v185
v_cvt_pk_bf16_f32 v185, v186, v187
v_cvt_pk_bf16_f32 v186, v188, v189
v_cvt_pk_bf16_f32 v187, v190, v191
v_mfma_f32_16x16x32_bf16 v[188:191], v[28:31], v[60:63], 0
buffer_store_dwordx4 v[184:187], v2, s[60:63], s80 offen sc1
v_add_f32 v208, v208, v44
v_add_f32 v209, v209, v45
v_add_f32 v210, v210, v44
v_mfma_f32_16x16x32_bf16 v[184:187], v[28:31], v[60:63], 0
buffer_load_dwordx4 a[24:27], v2, s[60:63], s85 offen offset:2048 sc1
buffer_load_dwordx4 a[28:31], v2, s[60:63], s85 offen offset:3072 sc1
s_add_u32 s85, s85, 4096
v_add_f32 v211, v211, v45
v_add_f32 v212, v212, v44
v_add_f32 v213, v213, v45
v_add_f32 v214, v214, v44
v_add_f32 v215, v215, v45
v_add_f32 v216, v216, v44
v_add_f32 v217, v217, v45
v_add_f32 v218, v218, v44
v_add_f32 v219, v219, v45
v_add_f32 v220, v220, v44
v_add_f32 v221, v221, v45
v_add_f32 v222, v222, v44
v_add_f32 v223, v223, v45
v_mov_b64 v[46:47], v[44:45]
s_lshl_b32 s11, s77, 20
s_lshl_b32 s80, s76, 14
s_add_u32 s11, s11, s80
s_lshl_b32 s80, s3, 10
s_add_u32 s11, s11, s80
s_add_u32 s11, s11, 33554432
s_sub_u32 s88, s77, 1
s_waitcnt lgkmcnt(0)
s_cmp_eq_u32 s77, 0
s_cbranch_scc1 L_last
s_cmp_eq_u32 s77, 1
s_cbranch_scc1 L_lastb
.p2align 4
L_loop2:
v_mfma_f32_16x16x32_bf16 v[32:35], v[28:31], v[80:83], v[24:27]
ds_read_b128 a[152:155], v4 offset:6144
ds_read_b128 a[156:159], v4 offset:7168
v_mfma_f32_16x16x32_bf16 v[32:35], v[28:31], v[84:87], v[32:35]
s_waitcnt lgkmcnt(5)
v_exp_f32 v112, v208
v_mfma_f32_16x16x32_bf16 v[224:227], a[192:195], a[32:35], v[40:43]
ds_read_b128 a[160:163], v4 offset:8192
ds_read_b128 a[164:167], v4 offset:9216
v_mfma_f32_16x16x32_bf16 v[224:227], a[196:199], a[36:39], v[224:227]
s_mov_b32 m0, s7
v_exp_f32 v113, v209
v_mfma_f32_16x16x32_bf16 v[224:227], a[200:203], a[40:43], v[224:227]
buffer_load_dwordx4 v2, s[60:63], s4 offen offset:0 sc1 lds
v_mfma_f32_16x16x32_bf16 v[224:227], a[204:207], a[44:47], v[224:227]
v_exp_f32 v114, v210
v_mfma_f32_16x16x32_bf16 v[228:231], a[208:211], a[32:35], v[40:43]
ds_read_b128 a[168:171], v4 offset:10240
ds_read_b128 a[172:175], v4 offset:11264
v_mfma_f32_16x16x32_bf16 v[228:231], a[212:215], a[36:39], v[228:231]
v_exp_f32 v115, v211
v_mfma_f32_16x16x32_bf16 v[228:231], a[216:219], a[40:43], v[228:231]
buffer_load_dwordx4 v2, s[60:63], s4 offen offset:1024 sc1 lds
v_mfma_f32_16x16x32_bf16 v[228:231], a[220:223], a[44:47], v[228:231]
v_exp_f32 v116, v212
v_mfma_f32_16x16x32_bf16 v[232:235], a[224:227], a[32:35], v[40:43]
ds_read_b128 a[176:179], v4 offset:12288
v_cmp_lt_f32 vcc, s10, v32
v_mfma_f32_16x16x32_bf16 v[232:235], a[228:231], a[36:39], v[232:235]
v_exp_f32 v117, v213
v_mfma_f32_16x16x32_bf16 v[232:235], a[232:235], a[40:43], v[232:235]
buffer_load_dwordx4 v2, s[60:63], s4 offen offset:2048 sc1 lds
v_mfma_f32_16x16x32_bf16 v[232:235], a[236:239], a[44:47], v[232:235]
v_exp_f32 v118, v214
v_mfma_f32_16x16x32_bf16 v[236:239], a[240:243], a[32:35], v[40:43]
ds_read_b128 a[180:183], v4 offset:13312
ds_read_b128 a[184:187], v4 offset:14336
v_mfma_f32_16x16x32_bf16 v[236:239], a[244:247], a[36:39], v[236:239]
v_exp_f32 v119, v215
v_mfma_f32_16x16x32_bf16 v[236:239], a[248:251], a[40:43], v[236:239]
buffer_load_dwordx4 v2, s[60:63], s4 offen offset:3072 sc1 lds
v_mfma_f32_16x16x32_bf16 v[236:239], a[252:255], a[44:47], v[236:239]
s_cbranch_vccnz Lstub24
Lret25:
v_exp_f32 v120, v216
v_mfma_f32_16x16x32_bf16 v[128:131], a[128:131], v[80:83], v[128:131]
s_waitcnt lgkmcnt(2)
ds_read_b128 a[188:191], v4 offset:15360
v_cvt_pk_bf16_f32 v88, v112, v113
v_mfma_f32_16x16x32_bf16 v[128:131], a[132:135], v[84:87], v[128:131]
s_add_u32 m0, s7, 4096
v_exp_f32 v121, v217
v_mfma_f32_16x16x32_bf16 v[132:135], a[136:139], v[80:83], v[132:135]
buffer_load_dwordx4 v5, s[60:63], s4 offen offset:0 sc1 lds
v_mfma_f32_16x16x32_bf16 v[132:135], a[140:143], v[84:87], v[132:135]
v_exp_f32 v122, v218
v_mfma_f32_16x16x32_bf16 v[136:139], a[144:147], v[80:83], v[136:139]
v_cvt_pk_bf16_f32 v89, v114, v115
v_mfma_f32_16x16x32_bf16 v[136:139], a[148:151], v[84:87], v[136:139]
v_exp_f32 v123, v219
v_mfma_f32_16x16x32_bf16 v[140:143], a[152:155], v[80:83], v[140:143]
buffer_load_dwordx4 v5, s[60:63], s4 offen offset:1024 sc1 lds
v_mfma_f32_16x16x32_bf16 v[140:143], a[156:159], v[84:87], v[140:143]
v_exp_f32 v124, v220
v_mfma_f32_16x16x32_bf16 v[144:147], a[160:163], v[80:83], v[144:147]
v_cvt_pk_bf16_f32 v90, v116, v117
v_cvt_pk_bf16_f32 v91, v118, v119
v_mfma_f32_16x16x32_bf16 v[144:147], a[164:167], v[84:87], v[144:147]
v_exp_f32 v125, v221
v_mfma_f32_16x16x32_bf16 v[148:151], a[168:171], v[80:83], v[148:151]
buffer_load_dwordx4 v5, s[60:63], s4 offen offset:2048 sc1 lds
v_mfma_f32_16x16x32_bf16 v[148:151], a[172:175], v[84:87], v[148:151]
v_exp_f32 v126, v222
v_mfma_f32_16x16x32_bf16 v[152:155], a[176:179], v[80:83], v[152:155]
s_waitcnt lgkmcnt(0)
v_cvt_pk_bf16_f32 v92, v120, v121
v_cvt_pk_bf16_f32 v93, v122, v123
v_mfma_f32_16x16x32_bf16 v[152:155], a[180:183], v[84:87], v[152:155]
v_exp_f32 v127, v223
v_mfma_f32_16x16x32_bf16 v[156:159], a[184:187], v[80:83], v[156:159]
buffer_load_dwordx4 v5, s[60:63], s4 offen offset:3072 sc1 lds
v_mfma_f32_16x16x32_bf16 v[156:159], a[188:191], v[84:87], v[156:159]
s_waitcnt vmcnt(16) lgkmcnt(0)
v_cvt_pk_bf16_f32 v94, v124, v125
v_cvt_pk_bf16_f32 v95, v126, v127
v_mfma_f32_16x16x32_bf16 v[36:39], v[28:31], v[88:91], v[60:63]
s_barrier
v_mfma_f32_16x16x32_bf16 v[36:39], v[28:31], v[92:95], v[36:39]
v_exp_f32 v96, v224
v_mfma_f32_16x16x32_bf16 v[240:243], a[192:195], a[48:51], v[44:47]
ds_read_b128 a[192:195], v4 offset:49152
v_mfma_f32_16x16x32_bf16 v[240:243], a[196:199], a[52:55], v[240:243]
v_exp_f32 v97, v225
v_mfma_f32_16x16x32_bf16 v[240:243], a[200:203], a[56:59], v[240:243]
s_add_u32 s7, s7, 0x8000
ds_read_b128 a[196:199], v4 offset:50176
v_cvt_pk_bf16_f32 v80, v96, v97
v_mfma_f32_16x16x32_bf16 v[240:243], a[204:207], a[60:63], v[240:243]
v_exp_f32 v98, v226
v_mfma_f32_16x16x32_bf16 v[244:247], a[208:211], a[48:51], v[44:47]
s_and_b32 s7, s7, 0x1ffff
ds_read_b128 a[200:203], v4 offset:51200
ds_read_b128 a[204:207], v4 offset:52224
v_mfma_f32_16x16x32_bf16 v[244:247], a[212:215], a[52:55], v[244:247]
v_exp_f32 v99, v227
v_mfma_f32_16x16x32_bf16 v[244:247], a[216:219], a[56:59], v[244:247]
s_add_u32 s4, s4, 0x8000
ds_read_b128 a[208:211], v4 offset:53248
v_cmp_lt_f32 vcc, s10, v36
v_mfma_f32_16x16x32_bf16 v[244:247], a[220:223], a[60:63], v[244:247]
v_exp_f32 v100, v228
v_mfma_f32_16x16x32_bf16 v[248:251], a[224:227], a[48:51], v[44:47]
s_cmp_eq_u32 s4, s5
ds_read_b128 a[212:215], v4 offset:54272
ds_read_b128 a[216:219], v4 offset:55296
v_mfma_f32_16x16x32_bf16 v[248:251], a[228:231], a[52:55], v[248:251]
v_exp_f32 v101, v229
v_mfma_f32_16x16x32_bf16 v[248:251], a[232:235], a[56:59], v[248:251]
s_cselect_b32 s4, s6, s4
ds_read_b128 a[220:223], v4 offset:56320
v_cvt_pk_bf16_f32 v81, v98, v99
v_mfma_f32_16x16x32_bf16 v[248:251], a[236:239], a[60:63], v[248:251]
v_exp_f32 v102, v230
v_mfma_f32_16x16x32_bf16 v[252:255], a[240:243], a[48:51], v[44:47]
ds_read_b128 a[224:227], v4 offset:57344
v_cvt_pk_bf16_f32 v82, v100, v101
v_mfma_f32_16x16x32_bf16 v[252:255], a[244:247], a[52:55], v[252:255]
v_exp_f32 v103, v231
v_mfma_f32_16x16x32_bf16 v[252:255], a[248:251], a[56:59], v[252:255]
ds_read_b128 a[228:231], v4 offset:58368
v_cvt_pk_bf16_f32 v83, v102, v103
v_mfma_f32_16x16x32_bf16 v[252:255], a[252:255], a[60:63], v[252:255]
s_cbranch_vccnz Lstub26
Lret27:
v_exp_f32 v104, v232
v_mfma_f32_16x16x32_bf16 v[160:163], a[128:131], v[88:91], v[160:163]
ds_read_b128 a[232:235], v4 offset:59392
ds_read_b128 a[236:239], v4 offset:60416
v_mfma_f32_16x16x32_bf16 v[160:163], a[132:135], v[92:95], v[160:163]
v_exp_f32 v105, v233
v_mfma_f32_16x16x32_bf16 v[164:167], a[136:139], v[88:91], v[164:167]
ds_read_b128 a[240:243], v4 offset:61440
ds_read_b128 a[244:247], v4 offset:62464
v_mfma_f32_16x16x32_bf16 v[164:167], a[140:143], v[92:95], v[164:167]
Lcp32:
s_add_u32 s9, s95, Lcp32-L_pc+1536
v_exp_f32 v106, v234
v_mfma_f32_16x16x32_bf16 v[168:171], a[144:147], v[88:91], v[168:171]
buffer_load_dword v51, off, s[64:67], s9
ds_read_b128 a[248:251], v4 offset:63488
ds_read_b128 a[252:255], v4 offset:64512
v_mfma_f32_16x16x32_bf16 v[168:171], a[148:151], v[92:95], v[168:171]
v_exp_f32 v107, v235
v_mfma_f32_16x16x32_bf16 v[172:175], a[152:155], v[88:91], v[172:175]
ds_read_b128 a[128:131], v4 offset:32768
ds_read_b128 a[132:135], v4 offset:33792
v_mfma_f32_16x16x32_bf16 v[172:175], a[156:159], v[92:95], v[172:175]
v_exp_f32 v108, v236
v_mfma_f32_16x16x32_bf16 v[176:179], a[160:163], v[88:91], v[176:179]
ds_read_b128 a[136:139], v4 offset:34816
ds_read_b128 a[140:143], v4 offset:35840
v_mfma_f32_16x16x32_bf16 v[176:179], a[164:167], v[92:95], v[176:179]
v_exp_f32 v109, v237
v_mfma_f32_16x16x32_bf16 v[180:183], a[168:171], v[88:91], v[180:183]
ds_read_b128 a[144:147], v4 offset:36864
v_cvt_pk_bf16_f32 v84, v104, v105
v_mfma_f32_16x16x32_bf16 v[180:183], a[172:175], v[92:95], v[180:183]
v_exp_f32 v110, v238
v_mfma_f32_16x16x32_bf16 v[184:187], a[176:179], v[88:91], v[184:187]
ds_read_b128 a[148:151], v4 offset:37888
v_cvt_pk_bf16_f32 v85, v106, v107
v_mfma_f32_16x16x32_bf16 v[184:187], a[180:183], v[92:95], v[184:187]
v_exp_f32 v111, v239
v_mfma_f32_16x16x32_bf16 v[188:191], a[184:187], v[88:91], v[188:191]
ds_read_b128 a[152:155], v4 offset:38912
v_cvt_pk_bf16_f32 v86, v108, v109
v_mfma_f32_16x16x32_bf16 v[188:191], a[188:191], v[92:95], v[188:191]
ds_read_b128 a[156:159], v4 offset:39936
v_cvt_pk_bf16_f32 v87, v110, v111
v_mfma_f32_16x16x32_bf16 v[24:27], v[28:31], v[80:83], v[32:35]
ds_read_b128 a[160:163], v4 offset:40960
ds_read_b128 a[164:167], v4 offset:41984
v_mfma_f32_16x16x32_bf16 v[24:27], v[28:31], v[84:87], v[24:27]
s_waitcnt lgkmcnt(6)
v_exp_f32 v112, v240
v_mfma_f32_16x16x32_bf16 v[192:195], a[192:195], a[32:35], v[40:43]
ds_read_b128 a[168:171], v4 offset:43008
ds_read_b128 a[172:175], v4 offset:44032
v_mfma_f32_16x16x32_bf16 v[192:195], a[196:199], a[36:39], v[192:195]
s_mov_b32 m0, s7
v_exp_f32 v113, v241
v_mfma_f32_16x16x32_bf16 v[192:195], a[200:203], a[40:43], v[192:195]
buffer_load_dwordx4 v2, s[60:63], s4 offen offset:0 sc1 lds
v_mfma_f32_16x16x32_bf16 v[192:195], a[204:207], a[44:47], v[192:195]
v_exp_f32 v114, v242
v_mfma_f32_16x16x32_bf16 v[196:199], a[208:211], a[32:35], v[40:43]
ds_read_b128 a[176:179], v4 offset:45056
ds_read_b128 a[180:183], v4 offset:46080
v_mfma_f32_16x16x32_bf16 v[196:199], a[212:215], a[36:39], v[196:199]
v_exp_f32 v115, v243
v_mfma_f32_16x16x32_bf16 v[196:199], a[216:219], a[40:43], v[196:199]
buffer_load_dwordx4 v2, s[60:63], s4 offen offset:1024 sc1 lds
v_mfma_f32_16x16x32_bf16 v[196:199], a[220:223], a[44:47], v[196:199]
v_exp_f32 v116, v244
v_mfma_f32_16x16x32_bf16 v[200:203], a[224:227], a[32:35], v[40:43]
v_cvt_pk_bf16_f32 v88, v112, v113
v_cmp_lt_f32 vcc, s10, v24
v_mfma_f32_16x16x32_bf16 v[200:203], a[228:231], a[36:39], v[200:203]
v_exp_f32 v117, v245
v_mfma_f32_16x16x32_bf16 v[200:203], a[232:235], a[40:43], v[200:203]
buffer_load_dwordx4 v2, s[60:63], s4 offen offset:2048 sc1 lds
v_mfma_f32_16x16x32_bf16 v[200:203], a[236:239], a[44:47], v[200:203]
v_exp_f32 v118, v246
v_mfma_f32_16x16x32_bf16 v[204:207], a[240:243], a[32:35], v[40:43]
ds_read_b128 a[184:187], v4 offset:47104
v_cvt_pk_bf16_f32 v89, v114, v115
v_mfma_f32_16x16x32_bf16 v[204:207], a[244:247], a[36:39], v[204:207]
v_exp_f32 v119, v247
v_mfma_f32_16x16x32_bf16 v[204:207], a[248:251], a[40:43], v[204:207]
buffer_load_dwordx4 v2, s[60:63], s4 offen offset:3072 sc1 lds
v_mfma_f32_16x16x32_bf16 v[204:207], a[252:255], a[44:47], v[204:207]
s_cbranch_vccnz Lstub28
Lret29:
v_exp_f32 v120, v248
v_mfma_f32_16x16x32_bf16 v[128:131], a[128:131], v[80:83], v[128:131]
ds_read_b128 a[188:191], v4 offset:48128
v_cvt_pk_bf16_f32 v90, v116, v117
v_mfma_f32_16x16x32_bf16 v[128:131], a[132:135], v[84:87], v[128:131]
s_add_u32 m0, s7, 4096
v_exp_f32 v121, v249
v_mfma_f32_16x16x32_bf16 v[132:135], a[136:139], v[80:83], v[132:135]
buffer_load_dwordx4 v5, s[60:63], s4 offen offset:0 sc1 lds
v_mfma_f32_16x16x32_bf16 v[132:135], a[140:143], v[84:87], v[132:135]
s_waitcnt lgkmcnt(2)
v_exp_f32 v122, v250
v_mfma_f32_16x16x32_bf16 v[136:139], a[144:147], v[80:83], v[136:139]
v_cvt_pk_bf16_f32 v91, v118, v119
v_cvt_pk_bf16_f32 v92, v120, v121
v_mfma_f32_16x16x32_bf16 v[136:139], a[148:151], v[84:87], v[136:139]
v_exp_f32 v123, v251
v_mfma_f32_16x16x32_bf16 v[140:143], a[152:155], v[80:83], v[140:143]
buffer_load_dwordx4 v5, s[60:63], s4 offen offset:1024 sc1 lds
v_mfma_f32_16x16x32_bf16 v[140:143], a[156:159], v[84:87], v[140:143]
v_exp_f32 v124, v252
v_mfma_f32_16x16x32_bf16 v[144:147], a[160:163], v[80:83], v[144:147]
v_cvt_pk_bf16_f32 v93, v122, v123
v_mfma_f32_16x16x32_bf16 v[144:147], a[164:167], v[84:87], v[144:147]
v_exp_f32 v125, v253
v_mfma_f32_16x16x32_bf16 v[148:151], a[168:171], v[80:83], v[148:151]
buffer_load_dwordx4 v5, s[60:63], s4 offen offset:2048 sc1 lds
v_mfma_f32_16x16x32_bf16 v[148:151], a[172:175], v[84:87], v[148:151]
v_exp_f32 v126, v254
v_mfma_f32_16x16x32_bf16 v[152:155], a[176:179], v[80:83], v[152:155]
v_xor_b32 v4, 0x10000, v4
v_mfma_f32_16x16x32_bf16 v[152:155], a[180:183], v[84:87], v[152:155]
s_waitcnt lgkmcnt(0)
v_exp_f32 v127, v255
v_mfma_f32_16x16x32_bf16 v[156:159], a[184:187], v[80:83], v[156:159]
buffer_load_dwordx4 v5, s[60:63], s4 offen offset:3072 sc1 lds
v_mfma_f32_16x16x32_bf16 v[156:159], a[188:191], v[84:87], v[156:159]
s_waitcnt vmcnt(16) lgkmcnt(0)
v_cvt_pk_bf16_f32 v94, v124, v125
v_cvt_pk_bf16_f32 v95, v126, v127
v_mfma_f32_16x16x32_bf16 v[60:63], v[28:31], v[88:91], v[36:39]
s_barrier
v_mfma_f32_16x16x32_bf16 v[60:63], v[28:31], v[92:95], v[60:63]
v_exp_f32 v96, v192
v_mfma_f32_16x16x32_bf16 v[208:211], a[192:195], a[48:51], v[44:47]
ds_read_b128 a[192:195], v4 offset:16384
v_mfma_f32_16x16x32_bf16 v[208:211], a[196:199], a[52:55], v[208:211]
v_exp_f32 v97, v193
v_mfma_f32_16x16x32_bf16 v[208:211], a[200:203], a[56:59], v[208:211]
s_add_u32 s7, s7, 0x8000
ds_read_b128 a[196:199], v4 offset:17408
v_cvt_pk_bf16_f32 v80, v96, v97
v_mfma_f32_16x16x32_bf16 v[208:211], a[204:207], a[60:63], v[208:211]
v_exp_f32 v98, v194
v_mfma_f32_16x16x32_bf16 v[212:215], a[208:211], a[48:51], v[44:47]
s_and_b32 s7, s7, 0x1ffff
ds_read_b128 a[200:203], v4 offset:18432
ds_read_b128 a[204:207], v4 offset:19456
v_mfma_f32_16x16x32_bf16 v[212:215], a[212:215], a[52:55], v[212:215]
v_exp_f32 v99, v195
v_mfma_f32_16x16x32_bf16 v[212:215], a[216:219], a[56:59], v[212:215]
s_add_u32 s4, s4, 0x8000
ds_read_b128 a[208:211], v4 offset:20480
v_cmp_lt_f32 vcc, s10, v60
v_mfma_f32_16x16x32_bf16 v[212:215], a[220:223], a[60:63], v[212:215]
v_exp_f32 v100, v196
v_mfma_f32_16x16x32_bf16 v[216:219], a[224:227], a[48:51], v[44:47]
s_cmp_eq_u32 s4, s5
ds_read_b128 a[212:215], v4 offset:21504
ds_read_b128 a[216:219], v4 offset:22528
v_mfma_f32_16x16x32_bf16 v[216:219], a[228:231], a[52:55], v[216:219]
v_exp_f32 v101, v197
v_mfma_f32_16x16x32_bf16 v[216:219], a[232:235], a[56:59], v[216:219]
s_cselect_b32 s4, s6, s4
ds_read_b128 a[220:223], v4 offset:23552
v_cvt_pk_bf16_f32 v81, v98, v99
v_mfma_f32_16x16x32_bf16 v[216:219], a[236:239], a[60:63], v[216:219]
v_exp_f32 v102, v198
v_mfma_f32_16x16x32_bf16 v[220:223], a[240:243], a[48:51], v[44:47]
ds_read_b128 a[224:227], v4 offset:24576
v_cvt_pk_bf16_f32 v82, v100, v101
v_mfma_f32_16x16x32_bf16 v[220:223], a[244:247], a[52:55], v[220:223]
v_exp_f32 v103, v199
v_mfma_f32_16x16x32_bf16 v[220:223], a[248:251], a[56:59], v[220:223]
ds_read_b128 a[228:231], v4 offset:25600
ds_read_b128 a[232:235], v4 offset:26624
v_mfma_f32_16x16x32_bf16 v[220:223], a[252:255], a[60:63], v[220:223]
s_cbranch_vccnz Lstub30
Lret31:
v_exp_f32 v104, v200
v_mfma_f32_16x16x32_bf16 v[160:163], a[128:131], v[88:91], v[160:163]
ds_read_b128 a[236:239], v4 offset:27648
ds_read_b128 a[240:243], v4 offset:28672
v_mfma_f32_16x16x32_bf16 v[160:163], a[132:135], v[92:95], v[160:163]
v_exp_f32 v105, v201
v_mfma_f32_16x16x32_bf16 v[164:167], a[136:139], v[88:91], v[164:167]
ds_read_b128 a[244:247], v4 offset:29696
ds_read_b128 a[248:251], v4 offset:30720
v_mfma_f32_16x16x32_bf16 v[164:167], a[140:143], v[92:95], v[164:167]
v_exp_f32 v106, v202
v_mfma_f32_16x16x32_bf16 v[168:171], a[144:147], v[88:91], v[168:171]
ds_read_b128 a[252:255], v4 offset:31744
ds_read_b128 a[128:131], v4 offset:0
v_mfma_f32_16x16x32_bf16 v[168:171], a[148:151], v[92:95], v[168:171]
v_exp_f32 v107, v203
v_mfma_f32_16x16x32_bf16 v[172:175], a[152:155], v[88:91], v[172:175]
ds_read_b128 a[132:135], v4 offset:1024
v_cvt_pk_bf16_f32 v83, v102, v103
v_mfma_f32_16x16x32_bf16 v[172:175], a[156:159], v[92:95], v[172:175]
v_exp_f32 v108, v204
v_mfma_f32_16x16x32_bf16 v[176:179], a[160:163], v[88:91], v[176:179]
ds_read_b128 a[136:139], v4 offset:2048
v_cvt_pk_bf16_f32 v84, v104, v105
v_mfma_f32_16x16x32_bf16 v[176:179], a[164:167], v[92:95], v[176:179]
v_exp_f32 v109, v205
v_mfma_f32_16x16x32_bf16 v[180:183], a[168:171], v[88:91], v[180:183]
s_sub_u32 s88, s88, 1
ds_read_b128 a[140:143], v4 offset:3072
v_cvt_pk_bf16_f32 v85, v106, v107
v_mfma_f32_16x16x32_bf16 v[180:183], a[172:175], v[92:95], v[180:183]
v_exp_f32 v110, v206
v_mfma_f32_16x16x32_bf16 v[184:187], a[176:179], v[88:91], v[184:187]
s_cmp_lg_u32 s88, 0
ds_read_b128 a[144:147], v4 offset:4096
v_cvt_pk_bf16_f32 v86, v108, v109
v_mfma_f32_16x16x32_bf16 v[184:187], a[180:183], v[92:95], v[184:187]
v_exp_f32 v111, v207
v_mfma_f32_16x16x32_bf16 v[188:191], a[184:187], v[88:91], v[188:191]
ds_read_b128 a[148:151], v4 offset:5120
v_cvt_pk_bf16_f32 v87, v110, v111
v_mfma_f32_16x16x32_bf16 v[188:191], a[188:191], v[92:95], v[188:191]
s_cbranch_scc1 L_loop2
L_lastb:
v_mfma_f32_16x16x32_bf16 v[32:35], v[28:31], v[80:83], v[24:27]
ds_read_b128 a[152:155], v4 offset:6144
ds_read_b128 a[156:159], v4 offset:7168
v_mfma_f32_16x16x32_bf16 v[32:35], v[28:31], v[84:87], v[32:35]
s_waitcnt lgkmcnt(5)
v_exp_f32 v112, v208
v_mfma_f32_16x16x32_bf16 v[224:227], a[192:195], a[32:35], v[40:43]
ds_read_b128 a[160:163], v4 offset:8192
ds_read_b128 a[164:167], v4 offset:9216
v_mfma_f32_16x16x32_bf16 v[224:227], a[196:199], a[36:39], v[224:227]
s_mov_b32 m0, s7
v_exp_f32 v113, v209
v_mfma_f32_16x16x32_bf16 v[224:227], a[200:203], a[40:43], v[224:227]
buffer_load_dwordx4 v2, s[60:63], s4 offen offset:0 sc1 lds
v_mfma_f32_16x16x32_bf16 v[224:227], a[204:207], a[44:47], v[224:227]
v_exp_f32 v114, v210
v_mfma_f32_16x16x32_bf16 v[228:231], a[208:211], a[32:35], v[40:43]
ds_read_b128 a[168:171], v4 offset:10240
ds_read_b128 a[172:175], v4 offset:11264
v_mfma_f32_16x16x32_bf16 v[228:231], a[212:215], a[36:39], v[228:231]
v_exp_f32 v115, v211
v_mfma_f32_16x16x32_bf16 v[228:231], a[216:219], a[40:43], v[228:231]
buffer_load_dwordx4 v2, s[60:63], s4 offen offset:1024 sc1 lds
v_mfma_f32_16x16x32_bf16 v[228:231], a[220:223], a[44:47], v[228:231]
v_exp_f32 v116, v212
v_mfma_f32_16x16x32_bf16 v[232:235], a[224:227], a[32:35], v[40:43]
ds_read_b128 a[176:179], v4 offset:12288
v_cmp_lt_f32 vcc, s10, v32
v_mfma_f32_16x16x32_bf16 v[232:235], a[228:231], a[36:39], v[232:235]
v_exp_f32 v117, v213
v_mfma_f32_16x16x32_bf16 v[232:235], a[232:235], a[40:43], v[232:235]
buffer_load_dwordx4 v2, s[60:63], s4 offen offset:2048 sc1 lds
v_mfma_f32_16x16x32_bf16 v[232:235], a[236:239], a[44:47], v[232:235]
v_exp_f32 v118, v214
v_mfma_f32_16x16x32_bf16 v[236:239], a[240:243], a[32:35], v[40:43]
ds_read_b128 a[180:183], v4 offset:13312
ds_read_b128 a[184:187], v4 offset:14336
v_mfma_f32_16x16x32_bf16 v[236:239], a[244:247], a[36:39], v[236:239]
v_exp_f32 v119, v215
v_mfma_f32_16x16x32_bf16 v[236:239], a[248:251], a[40:43], v[236:239]
buffer_load_dwordx4 v2, s[60:63], s4 offen offset:3072 sc1 lds
v_mfma_f32_16x16x32_bf16 v[236:239], a[252:255], a[44:47], v[236:239]
s_cbranch_vccnz Lstub105
Lret106:
v_exp_f32 v120, v216
v_mfma_f32_16x16x32_bf16 v[128:131], a[128:131], v[80:83], v[128:131]
s_waitcnt lgkmcnt(2)
ds_read_b128 a[188:191], v4 offset:15360
v_cvt_pk_bf16_f32 v88, v112, v113
v_mfma_f32_16x16x32_bf16 v[128:131], a[132:135], v[84:87], v[128:131]
s_add_u32 m0, s7, 4096
v_exp_f32 v121, v217
v_mfma_f32_16x16x32_bf16 v[132:135], a[136:139], v[80:83], v[132:135]
buffer_load_dwordx4 v5, s[60:63], s4 offen offset:0 sc1 lds
v_mfma_f32_16x16x32_bf16 v[132:135], a[140:143], v[84:87], v[132:135]
v_exp_f32 v122, v218
v_mfma_f32_16x16x32_bf16 v[136:139], a[144:147], v[80:83], v[136:139]
v_cvt_pk_bf16_f32 v89, v114, v115
v_fma_f32 v64, v8, s14, v40
v_mfma_f32_16x16x32_bf16 v[136:139], a[148:151], v[84:87], v[136:139]
v_exp_f32 v123, v219
v_mfma_f32_16x16x32_bf16 v[140:143], a[152:155], v[80:83], v[140:143]
buffer_load_dwordx4 v5, s[60:63], s4 offen offset:1024 sc1 lds
v_mfma_f32_16x16x32_bf16 v[140:143], a[156:159], v[84:87], v[140:143]
v_exp_f32 v124, v220
v_mfma_f32_16x16x32_bf16 v[144:147], a[160:163], v[80:83], v[144:147]
v_cvt_pk_bf16_f32 v90, v116, v117
v_cvt_pk_bf16_f32 v91, v118, v119
v_mfma_f32_16x16x32_bf16 v[144:147], a[164:167], v[84:87], v[144:147]
v_exp_f32 v125, v221
v_mfma_f32_16x16x32_bf16 v[148:151], a[168:171], v[80:83], v[148:151]
buffer_load_dwordx4 v5, s[60:63], s4 offen offset:2048 sc1 lds
v_mfma_f32_16x16x32_bf16 v[148:151], a[172:175], v[84:87], v[148:151]
v_exp_f32 v126, v222
v_mfma_f32_16x16x32_bf16 v[152:155], a[176:179], v[80:83], v[152:155]
s_waitcnt lgkmcnt(0)
v_cvt_pk_bf16_f32 v92, v120, v121
v_cvt_pk_bf16_f32 v93, v122, v123
v_mfma_f32_16x16x32_bf16 v[152:155], a[180:183], v[84:87], v[152:155]
v_exp_f32 v127, v223
v_mfma_f32_16x16x32_bf16 v[156:159], a[184:187], v[80:83], v[156:159]
buffer_load_dwordx4 v5, s[60:63], s4 offen offset:3072 sc1 lds
v_mfma_f32_16x16x32_bf16 v[156:159], a[188:191], v[84:87], v[156:159]
s_waitcnt vmcnt(16) lgkmcnt(0)
v_cvt_pk_bf16_f32 v94, v124, v125
v_cvt_pk_bf16_f32 v95, v126, v127
v_mfma_f32_16x16x32_bf16 v[36:39], v[28:31], v[88:91], v[60:63]
s_barrier
v_mfma_f32_16x16x32_bf16 v[36:39], v[28:31], v[92:95], v[36:39]
v_exp_f32 v96, v224
v_mfma_f32_16x16x32_bf16 v[240:243], a[192:195], a[48:51], v[44:47]
ds_read_b128 a[192:195], v4 offset:49152
v_fma_f32 v65, v9, s14, v40
v_fma_f32 v66, v10, s14, v40
v_mfma_f32_16x16x32_bf16 v[240:243], a[196:199], a[52:55], v[240:243]
v_exp_f32 v97, v225
v_mfma_f32_16x16x32_bf16 v[240:243], a[200:203], a[56:59], v[240:243]
s_add_u32 s7, s7, 0x8000
ds_read_b128 a[196:199], v4 offset:50176
v_cvt_pk_bf16_f32 v80, v96, v97
v_fma_f32 v67, v11, s14, v40
v_mfma_f32_16x16x32_bf16 v[240:243], a[204:207], a[60:63], v[240:243]
v_exp_f32 v98, v226
v_mfma_f32_16x16x32_bf16 v[244:247], a[208:211], a[48:51], v[44:47]
s_and_b32 s7, s7, 0x1ffff
ds_read_b128 a[200:203], v4 offset:51200
ds_read_b128 a[204:207], v4 offset:52224
v_fma_f32 v68, v12, s14, v40
v_mfma_f32_16x16x32_bf16 v[244:247], a[212:215], a[52:55], v[244:247]
v_exp_f32 v99, v227
v_mfma_f32_16x16x32_bf16 v[244:247], a[216:219], a[56:59], v[244:247]
s_add_u32 s4, s4, 0x8000
ds_read_b128 a[208:211], v4 offset:53248
v_cmp_lt_f32 vcc, s10, v36
v_fma_f32 v69, v13, s14, v40
v_mfma_f32_16x16x32_bf16 v[244:247], a[220:223], a[60:63], v[244:247]
v_exp_f32 v100, v228
v_mfma_f32_16x16x32_bf16 v[248:251], a[224:227], a[48:51], v[44:47]
s_cmp_eq_u32 s4, s5
ds_read_b128 a[212:215], v4 offset:54272
ds_read_b128 a[216:219], v4 offset:55296
v_fma_f32 v70, v14, s14, v40
v_mfma_f32_16x16x32_bf16 v[248:251], a[228:231], a[52:55], v[248:251]
v_exp_f32 v101, v229
v_mfma_f32_16x16x32_bf16 v[248:251], a[232:235], a[56:59], v[248:251]
s_cselect_b32 s4, s6, s4
ds_read_b128 a[220:223], v4 offset:56320
v_cvt_pk_bf16_f32 v81, v98, v99
v_fma_f32 v71, v15, s14, v40
v_mfma_f32_16x16x32_bf16 v[248:251], a[236:239], a[60:63], v[248:251]
v_exp_f32 v102, v230
v_mfma_f32_16x16x32_bf16 v[252:255], a[240:243], a[48:51], v[44:47]
ds_read_b128 a[224:227], v4 offset:57344
v_cvt_pk_bf16_f32 v82, v100, v101
v_fma_f32 v72, v16, s14, v40
v_mfma_f32_16x16x32_bf16 v[252:255], a[244:247], a[52:55], v[252:255]
v_exp_f32 v103, v231
v_mfma_f32_16x16x32_bf16 v[252:255], a[248:251], a[56:59], v[252:255]
ds_read_b128 a[228:231], v4 offset:58368
v_cvt_pk_bf16_f32 v83, v102, v103
v_fma_f32 v73, v17, s14, v40
v_mfma_f32_16x16x32_bf16 v[252:255], a[252:255], a[60:63], v[252:255]
s_cbranch_vccnz Lstub107
Lret108:
v_exp_f32 v104, v232
v_mfma_f32_16x16x32_bf16 v[160:163], a[128:131], v[88:91], v[160:163]
ds_read_b128 a[232:235], v4 offset:59392
ds_read_b128 a[236:239], v4 offset:60416
v_fma_f32 v74, v18, s14, v40
v_mfma_f32_16x16x32_bf16 v[160:163], a[132:135], v[92:95], v[160:163]
v_exp_f32 v105, v233
v_mfma_f32_16x16x32_bf16 v[164:167], a[136:139], v[88:91], v[164:167]
ds_read_b128 a[240:243], v4 offset:61440
ds_read_b128 a[244:247], v4 offset:62464
v_fma_f32 v75, v19, s14, v40
v_mfma_f32_16x16x32_bf16 v[164:167], a[140:143], v[92:95], v[164:167]
v_exp_f32 v106, v234
v_mfma_f32_16x16x32_bf16 v[168:171], a[144:147], v[88:91], v[168:171]
ds_read_b128 a[248:251], v4 offset:63488
ds_read_b128 a[252:255], v4 offset:64512
v_fma_f32 v76, v20, s14, v40
v_mfma_f32_16x16x32_bf16 v[168:171], a[148:151], v[92:95], v[168:171]
v_exp_f32 v107, v235
v_mfma_f32_16x16x32_bf16 v[172:175], a[152:155], v[88:91], v[172:175]
ds_read_b128 a[128:131], v4 offset:32768
ds_read_b128 a[132:135], v4 offset:33792
v_fma_f32 v77, v21, s14, v40
v_mfma_f32_16x16x32_bf16 v[172:175], a[156:159], v[92:95], v[172:175]
v_exp_f32 v108, v236
v_mfma_f32_16x16x32_bf16 v[176:179], a[160:163], v[88:91], v[176:179]
ds_read_b128 a[136:139], v4 offset:34816
ds_read_b128 a[140:143], v4 offset:35840
v_fma_f32 v78, v22, s14, v40
v_mfma_f32_16x16x32_bf16 v[176:179], a[164:167], v[92:95], v[176:179]
v_exp_f32 v109, v237
v_mfma_f32_16x16x32_bf16 v[180:183], a[168:171], v[88:91], v[180:183]
ds_read_b128 a[144:147], v4 offset:36864
v_cvt_pk_bf16_f32 v84, v104, v105
v_fma_f32 v79, v23, s14, v40
v_mfma_f32_16x16x32_bf16 v[180:183], a[172:175], v[92:95], v[180:183]
v_exp_f32 v110, v238
v_mfma_f32_16x16x32_bf16 v[184:187], a[176:179], v[88:91], v[184:187]
ds_read_b128 a[148:151], v4 offset:37888
v_cvt_pk_bf16_f32 v85, v106, v107
v_mfma_f32_16x16x32_bf16 v[184:187], a[180:183], v[92:95], v[184:187]
v_exp_f32 v111, v239
v_mfma_f32_16x16x32_bf16 v[188:191], a[184:187], v[88:91], v[188:191]
ds_read_b128 a[152:155], v4 offset:38912
v_cvt_pk_bf16_f32 v86, v108, v109
v_mfma_f32_16x16x32_bf16 v[188:191], a[188:191], v[92:95], v[188:191]
ds_read_b128 a[156:159], v4 offset:39936
v_cvt_pk_bf16_f32 v87, v110, v111
v_mfma_f32_16x16x32_bf16 v[24:27], v[28:31], v[80:83], v[32:35]
ds_read_b128 a[160:163], v4 offset:40960
ds_read_b128 a[164:167], v4 offset:41984
v_mfma_f32_16x16x32_bf16 v[24:27], v[28:31], v[84:87], v[24:27]
s_waitcnt lgkmcnt(6)
v_exp_f32 v112, v240
v_mfma_f32_16x16x32_bf16 v[192:195], a[192:195], a[32:35], v[64:67]
ds_read_b128 a[168:171], v4 offset:43008
ds_read_b128 a[172:175], v4 offset:44032
v_mfma_f32_16x16x32_bf16 v[192:195], a[196:199], a[36:39], v[192:195]
s_add_u32 m0, s86, 65536
v_exp_f32 v113, v241
v_mfma_f32_16x16x32_bf16 v[192:195], a[200:203], a[40:43], v[192:195]
buffer_load_dwordx4 v2, s[60:63], s94 offen offset:0 sc1 lds
v_mfma_f32_16x16x32_bf16 v[192:195], a[204:207], a[44:47], v[192:195]
v_exp_f32 v114, v242
v_mfma_f32_16x16x32_bf16 v[196:199], a[208:211], a[32:35], v[68:71]
ds_read_b128 a[176:179], v4 offset:45056
ds_read_b128 a[180:183], v4 offset:46080
v_mfma_f32_16x16x32_bf16 v[196:199], a[212:215], a[36:39], v[196:199]
v_exp_f32 v115, v243
v_mfma_f32_16x16x32_bf16 v[196:199], a[216:219], a[40:43], v[196:199]
buffer_load_dwordx4 v2, s[60:63], s94 offen offset:1024 sc1 lds
v_mfma_f32_16x16x32_bf16 v[196:199], a[220:223], a[44:47], v[196:199]
v_exp_f32 v116, v244
v_mfma_f32_16x16x32_bf16 v[200:203], a[224:227], a[32:35], v[72:75]
v_cvt_pk_bf16_f32 v88, v112, v113
v_cmp_lt_f32 vcc, s10, v24
v_mfma_f32_16x16x32_bf16 v[200:203], a[228:231], a[36:39], v[200:203]
v_exp_f32 v117, v245
v_mfma_f32_16x16x32_bf16 v[200:203], a[232:235], a[40:43], v[200:203]
buffer_load_dwordx4 v2, s[60:63], s94 offen offset:2048 sc1 lds
v_mfma_f32_16x16x32_bf16 v[200:203], a[236:239], a[44:47], v[200:203]
v_exp_f32 v118, v246
v_mfma_f32_16x16x32_bf16 v[204:207], a[240:243], a[32:35], v[76:79]
ds_read_b128 a[184:187], v4 offset:47104
v_cvt_pk_bf16_f32 v89, v114, v115
v_mfma_f32_16x16x32_bf16 v[204:207], a[244:247], a[36:39], v[204:207]
v_exp_f32 v119, v247
v_mfma_f32_16x16x32_bf16 v[204:207], a[248:251], a[40:43], v[204:207]
buffer_load_dwordx4 v2, s[60:63], s94 offen offset:3072 sc1 lds
v_mfma_f32_16x16x32_bf16 v[204:207], a[252:255], a[44:47], v[204:207]
s_cbranch_vccnz Lstub109
Lret110:
v_exp_f32 v120, v248
v_mfma_f32_16x16x32_bf16 v[128:131], a[128:131], v[80:83], v[128:131]
ds_read_b128 a[188:191], v4 offset:48128
v_cvt_pk_bf16_f32 v90, v116, v117
v_mfma_f32_16x16x32_bf16 v[128:131], a[132:135], v[84:87], v[128:131]
s_add_u32 m0, s86, 69632
v_exp_f32 v121, v249
v_mfma_f32_16x16x32_bf16 v[132:135], a[136:139], v[80:83], v[132:135]
buffer_load_dwordx4 v5, s[60:63], s94 offen offset:0 sc1 lds
v_mfma_f32_16x16x32_bf16 v[132:135], a[140:143], v[84:87], v[132:135]
s_waitcnt lgkmcnt(2)
v_exp_f32 v122, v250
v_mfma_f32_16x16x32_bf16 v[136:139], a[144:147], v[80:83], v[136:139]
v_cvt_pk_bf16_f32 v91, v118, v119
v_cvt_pk_bf16_f32 v92, v120, v121
v_mfma_f32_16x16x32_bf16 v[136:139], a[148:151], v[84:87], v[136:139]
v_exp_f32 v123, v251
v_mfma_f32_16x16x32_bf16 v[140:143], a[152:155], v[80:83], v[140:143]
buffer_load_dwordx4 v5, s[60:63], s94 offen offset:1024 sc1 lds
v_mfma_f32_16x16x32_bf16 v[140:143], a[156:159], v[84:87], v[140:143]
v_exp_f32 v124, v252
v_mfma_f32_16x16x32_bf16 v[144:147], a[160:163], v[80:83], v[144:147]
v_cvt_pk_bf16_f32 v93, v122, v123
v_mfma_f32_16x16x32_bf16 v[144:147], a[164:167], v[84:87], v[144:147]
v_exp_f32 v125, v253
v_mfma_f32_16x16x32_bf16 v[148:151], a[168:171], v[80:83], v[148:151]
buffer_load_dwordx4 v5, s[60:63], s94 offen offset:2048 sc1 lds
v_mfma_f32_16x16x32_bf16 v[148:151], a[172:175], v[84:87], v[148:151]
v_exp_f32 v126, v254
v_mfma_f32_16x16x32_bf16 v[152:155], a[176:179], v[80:83], v[152:155]
v_xor_b32 v4, 0x10000, v4
v_mfma_f32_16x16x32_bf16 v[152:155], a[180:183], v[84:87], v[152:155]
s_waitcnt lgkmcnt(0)
v_exp_f32 v127, v255
v_mfma_f32_16x16x32_bf16 v[156:159], a[184:187], v[80:83], v[156:159]
buffer_load_dwordx4 v5, s[60:63], s94 offen offset:3072 sc1 lds
v_mfma_f32_16x16x32_bf16 v[156:159], a[188:191], v[84:87], v[156:159]
s_waitcnt vmcnt(16) lgkmcnt(0)
v_cvt_pk_bf16_f32 v94, v124, v125
v_cvt_pk_bf16_f32 v95, v126, v127
v_mfma_f32_16x16x32_bf16 v[60:63], v[28:31], v[88:91], v[36:39]
s_barrier
v_mfma_f32_16x16x32_bf16 v[60:63], v[28:31], v[92:95], v[60:63]
v_exp_f32 v96, v192
v_mfma_f32_16x16x32_bf16 v[208:211], a[192:195], a[48:51], v[44:47]
ds_read_b128 a[192:195], v4 offset:16384
v_mfma_f32_16x16x32_bf16 v[208:211], a[196:199], a[52:55], v[208:211]
v_exp_f32 v97, v193
v_mfma_f32_16x16x32_bf16 v[208:211], a[200:203], a[56:59], v[208:211]
s_add_u32 s7, s7, 0x8000
ds_read_b128 a[196:199], v4 offset:17408
v_cvt_pk_bf16_f32 v80, v96, v97
v_mfma_f32_16x16x32_bf16 v[208:211], a[204:207], a[60:63], v[208:211]
v_exp_f32 v98, v194
v_mfma_f32_16x16x32_bf16 v[212:215], a[208:211], a[48:51], v[44:47]
s_and_b32 s7, s7, 0x1ffff
ds_read_b128 a[200:203], v4 offset:18432
ds_read_b128 a[204:207], v4 offset:19456
v_mfma_f32_16x16x32_bf16 v[212:215], a[212:215], a[52:55], v[212:215]
v_exp_f32 v99, v195
v_mfma_f32_16x16x32_bf16 v[212:215], a[216:219], a[56:59], v[212:215]
s_add_u32 s4, s4, 0x8000
ds_read_b128 a[208:211], v4 offset:20480
v_cmp_lt_f32 vcc, s10, v60
v_mfma_f32_16x16x32_bf16 v[212:215], a[220:223], a[60:63], v[212:215]
v_exp_f32 v100, v196
v_mfma_f32_16x16x32_bf16 v[216:219], a[224:227], a[48:51], v[44:47]
s_cmp_eq_u32 s4, s5
ds_read_b128 a[212:215], v4 offset:21504
ds_read_b128 a[216:219], v4 offset:22528
v_mfma_f32_16x16x32_bf16 v[216:219], a[228:231], a[52:55], v[216:219]
v_exp_f32 v101, v197
v_mfma_f32_16x16x32_bf16 v[216:219], a[232:235], a[56:59], v[216:219]
s_cselect_b32 s4, s6, s4
ds_read_b128 a[220:223], v4 offset:23552
v_cvt_pk_bf16_f32 v81, v98, v99
v_mfma_f32_16x16x32_bf16 v[216:219], a[236:239], a[60:63], v[216:219]
v_exp_f32 v102, v198
v_mfma_f32_16x16x32_bf16 v[220:223], a[240:243], a[48:51], v[44:47]
ds_read_b128 a[224:227], v4 offset:24576
v_cvt_pk_bf16_f32 v82, v100, v101
v_mfma_f32_16x16x32_bf16 v[220:223], a[244:247], a[52:55], v[220:223]
v_exp_f32 v103, v199
v_mfma_f32_16x16x32_bf16 v[220:223], a[248:251], a[56:59], v[220:223]
ds_read_b128 a[228:231], v4 offset:25600
ds_read_b128 a[232:235], v4 offset:26624
v_mfma_f32_16x16x32_bf16 v[220:223], a[252:255], a[60:63], v[220:223]
s_cbranch_vccnz Lstub111
Lret112:
v_exp_f32 v104, v200
v_mfma_f32_16x16x32_bf16 v[160:163], a[128:131], v[88:91], v[160:163]
ds_read_b128 a[236:239], v4 offset:27648
ds_read_b128 a[240:243], v4 offset:28672
v_mfma_f32_16x16x32_bf16 v[160:163], a[132:135], v[92:95], v[160:163]
v_exp_f32 v105, v201
v_mfma_f32_16x16x32_bf16 v[164:167], a[136:139], v[88:91], v[164:167]
ds_read_b128 a[244:247], v4 offset:29696
ds_read_b128 a[248:251], v4 offset:30720
v_mfma_f32_16x16x32_bf16 v[164:167], a[140:143], v[92:95], v[164:167]
v_exp_f32 v106, v202
v_mfma_f32_16x16x32_bf16 v[168:171], a[144:147], v[88:91], v[168:171]
ds_read_b128 a[252:255], v4 offset:31744
ds_read_b128 a[128:131], v4 offset:0
v_mfma_f32_16x16x32_bf16 v[168:171], a[148:151], v[92:95], v[168:171]
v_exp_f32 v107, v203
v_mfma_f32_16x16x32_bf16 v[172:175], a[152:155], v[88:91], v[172:175]
ds_read_b128 a[132:135], v4 offset:1024
v_cvt_pk_bf16_f32 v83, v102, v103
v_mfma_f32_16x16x32_bf16 v[172:175], a[156:159], v[92:95], v[172:175]
v_exp_f32 v108, v204
v_mfma_f32_16x16x32_bf16 v[176:179], a[160:163], v[88:91], v[176:179]
ds_read_b128 a[136:139], v4 offset:2048
v_cvt_pk_bf16_f32 v84, v104, v105
v_mfma_f32_16x16x32_bf16 v[176:179], a[164:167], v[92:95], v[176:179]
v_exp_f32 v109, v205
v_mfma_f32_16x16x32_bf16 v[180:183], a[168:171], v[88:91], v[180:183]
ds_read_b128 a[140:143], v4 offset:3072
v_cvt_pk_bf16_f32 v85, v106, v107
v_mfma_f32_16x16x32_bf16 v[180:183], a[172:175], v[92:95], v[180:183]
v_exp_f32 v110, v206
v_mfma_f32_16x16x32_bf16 v[184:187], a[176:179], v[88:91], v[184:187]
ds_read_b128 a[144:147], v4 offset:4096
v_cvt_pk_bf16_f32 v86, v108, v109
v_mfma_f32_16x16x32_bf16 v[184:187], a[180:183], v[92:95], v[184:187]
v_exp_f32 v111, v207
v_mfma_f32_16x16x32_bf16 v[188:191], a[184:187], v[88:91], v[188:191]
ds_read_b128 a[148:151], v4 offset:5120
v_cvt_pk_bf16_f32 v87, v110, v111
v_mfma_f32_16x16x32_bf16 v[188:191], a[188:191], v[92:95], v[188:191]
L_last:
v_fma_f32 v64, v8, s14, v44
v_fma_f32 v65, v9, s14, v44
v_fma_f32 v66, v10, s14, v44
v_fma_f32 v67, v11, s14, v44
v_fma_f32 v68, v12, s14, v44
v_fma_f32 v69, v13, s14, v44
v_fma_f32 v70, v14, s14, v44
v_fma_f32 v71, v15, s14, v44
v_fma_f32 v72, v16, s14, v44
v_fma_f32 v73, v17, s14, v44
v_fma_f32 v74, v18, s14, v44
v_fma_f32 v75, v19, s14, v44
v_fma_f32 v76, v20, s14, v44
v_fma_f32 v77, v21, s14, v44
v_fma_f32 v78, v22, s14, v44
v_fma_f32 v79, v23, s14, v44
s_waitcnt lgkmcnt(0)
v_mfma_f32_16x16x32_bf16 v[32:35], v[28:31], v[80:83], v[24:27]
Lcp84:
s_add_u32 s9, s95, Lcp84-L_pc+4096
ds_read_b128 a[152:155], v4 offset:6144
ds_read_b128 a[156:159], v4 offset:7168
v_mfma_f32_16x16x32_bf16 v[32:35], v[28:31], v[84:87], v[32:35]
buffer_load_dword v51, off, s[64:67], s9
v_exp_f32 v112, v208
v_mfma_f32_16x16x32_bf16 v[240:243], a[192:195], a[48:51], v[64:67]
ds_read_b128 a[160:163], v4 offset:8192
ds_read_b128 a[164:167], v4 offset:9216
v_mfma_f32_16x16x32_bf16 v[240:243], a[196:199], a[52:55], v[240:243]
s_add_u32 m0, s86, 98304
v_exp_f32 v113, v209
v_mfma_f32_16x16x32_bf16 v[240:243], a[200:203], a[56:59], v[240:243]
buffer_load_dwordx4 v2, s[60:63], s1 offen offset:0 sc1 lds
v_mfma_f32_16x16x32_bf16 v[240:243], a[204:207], a[60:63], v[240:243]
v_exp_f32 v114, v210
v_mfma_f32_16x16x32_bf16 v[244:247], a[208:211], a[48:51], v[68:71]
ds_read_b128 a[168:171], v4 offset:10240
ds_read_b128 a[172:175], v4 offset:11264
v_mfma_f32_16x16x32_bf16 v[244:247], a[212:215], a[52:55], v[244:247]
v_exp_f32 v115, v211
v_mfma_f32_16x16x32_bf16 v[244:247], a[216:219], a[56:59], v[244:247]
buffer_load_dwordx4 v2, s[60:63], s1 offen offset:1024 sc1 lds
v_mfma_f32_16x16x32_bf16 v[244:247], a[220:223], a[60:63], v[244:247]
v_exp_f32 v116, v212
v_mfma_f32_16x16x32_bf16 v[248:251], a[224:227], a[48:51], v[72:75]
ds_read_b128 a[176:179], v4 offset:12288
v_cmp_lt_f32 vcc, s10, v32
v_mfma_f32_16x16x32_bf16 v[248:251], a[228:231], a[52:55], v[248:251]
v_exp_f32 v117, v213
v_mfma_f32_16x16x32_bf16 v[248:251], a[232:235], a[56:59], v[248:251]
buffer_load_dwordx4 v2, s[60:63], s1 offen offset:2048 sc1 lds
v_mfma_f32_16x16x32_bf16 v[248:251], a[236:239], a[60:63], v[248:251]
v_exp_f32 v118, v214
v_mfma_f32_16x16x32_bf16 v[252:255], a[240:243], a[48:51], v[76:79]
ds_read_b128 a[180:183], v4 offset:13312
ds_read_b128 a[184:187], v4 offset:14336
v_mfma_f32_16x16x32_bf16 v[252:255], a[244:247], a[52:55], v[252:255]
v_exp_f32 v119, v215
v_mfma_f32_16x16x32_bf16 v[252:255], a[248:251], a[56:59], v[252:255]
buffer_load_dwordx4 v2, s[60:63], s1 offen offset:3072 sc1 lds
v_mfma_f32_16x16x32_bf16 v[252:255], a[252:255], a[60:63], v[252:255]
s_cbranch_vccnz Lstub82
Lret83:
v_exp_f32 v120, v216
v_mfma_f32_16x16x32_bf16 v[128:131], a[128:131], v[80:83], v[128:131]
ds_read_b128 a[188:191], v4 offset:15360
v_cvt_pk_bf16_f32 v88, v112, v113
v_mfma_f32_16x16x32_bf16 v[128:131], a[132:135], v[84:87], v[128:131]
s_add_u32 m0, s86, 102400
v_exp_f32 v121, v217
v_mfma_f32_16x16x32_bf16 v[132:135], a[136:139], v[80:83], v[132:135]
buffer_load_dwordx4 v5, s[60:63], s1 offen offset:0 sc1 lds
v_mfma_f32_16x16x32_bf16 v[132:135], a[140:143], v[84:87], v[132:135]
v_exp_f32 v122, v218
v_mfma_f32_16x16x32_bf16 v[136:139], a[144:147], v[80:83], v[136:139]
v_cvt_pk_bf16_f32 v89, v114, v115
v_mfma_f32_16x16x32_bf16 v[136:139], a[148:151], v[84:87], v[136:139]
s_waitcnt lgkmcnt(0)
v_exp_f32 v123, v219
v_mfma_f32_16x16x32_bf16 v[140:143], a[152:155], v[80:83], v[140:143]
buffer_load_dwordx4 v5, s[60:63], s1 offen offset:1024 sc1 lds
v_mfma_f32_16x16x32_bf16 v[140:143], a[156:159], v[84:87], v[140:143]
v_exp_f32 v124, v220
v_mfma_f32_16x16x32_bf16 v[144:147], a[160:163], v[80:83], v[144:147]
v_cvt_pk_bf16_f32 v90, v116, v117
v_cvt_pk_bf16_f32 v91, v118, v119
v_mfma_f32_16x16x32_bf16 v[144:147], a[164:167], v[84:87], v[144:147]
v_exp_f32 v125, v221
v_mfma_f32_16x16x32_bf16 v[148:151], a[168:171], v[80:83], v[148:151]
buffer_load_dwordx4 v5, s[60:63], s1 offen offset:2048 sc1 lds
v_mfma_f32_16x16x32_bf16 v[148:151], a[172:175], v[84:87], v[148:151]
v_exp_f32 v126, v222
v_mfma_f32_16x16x32_bf16 v[152:155], a[176:179], v[80:83], v[152:155]
v_cvt_pk_bf16_f32 v92, v120, v121
v_cvt_pk_bf16_f32 v93, v122, v123
v_mfma_f32_16x16x32_bf16 v[152:155], a[180:183], v[84:87], v[152:155]
v_exp_f32 v127, v223
v_mfma_f32_16x16x32_bf16 v[156:159], a[184:187], v[80:83], v[156:159]
buffer_load_dwordx4 v5, s[60:63], s1 offen offset:3072 sc1 lds
v_mfma_f32_16x16x32_bf16 v[156:159], a[188:191], v[84:87], v[156:159]
v_cvt_pk_bf16_f32 v94, v124, v125
v_cvt_pk_bf16_f32 v95, v126, v127
v_mfma_f32_16x16x32_bf16 v[36:39], v[28:31], v[88:91], v[60:63]
s_nop 0
v_mfma_f32_16x16x32_bf16 v[36:39], v[28:31], v[92:95], v[36:39]
s_waitcnt vmcnt(11) lgkmcnt(0)
s_barrier
v_rcp_f32 v54, v32
s_add_u32 s80, s11, 0
v_mul_f32 v55, 0x25800000, v54
v_mul_f32 v54, 0x25800000, v54
v_pk_mul_f32 v[128:129], v[128:129], v[54:55]
v_pk_mul_f32 v[130:131], v[130:131], v[54:55]
v_cmp_lt_f32 vcc, s10, v36
s_cmp_lg_u32 s3, 0
s_cbranch_scc1 Lpub85
v_mov_b32 v56, 1
s_mov_b64 exec, 1
buffer_atomic_add v56, off, s[60:63], s0 sc1
s_mov_b64 exec, -1
Lpub85:
v_pk_mul_f32 v[132:133], v[132:133], v[54:55]
v_pk_mul_f32 v[134:135], v[134:135], v[54:55]
v_cvt_pk_bf16_f32 v128, v128, v129
v_cvt_pk_bf16_f32 v129, v130, v131
v_cvt_pk_bf16_f32 v130, v132, v133
v_cvt_pk_bf16_f32 v131, v134, v135
buffer_store_dwordx4 v[128:131], v2, s[60:63], s80 offen sc1
s_add_u32 s80, s80, 4096
v_pk_mul_f32 v[136:137], v[136:137], v[54:55]
v_pk_mul_f32 v[138:139], v[138:139], v[54:55]
v_pk_mul_f32 v[140:141], v[140:141], v[54:55]
v_pk_mul_f32 v[142:143], v[142:143], v[54:55]
v_cvt_pk_bf16_f32 v136, v136, v137
v_cvt_pk_bf16_f32 v137, v138, v139
v_cvt_pk_bf16_f32 v138, v140, v141
v_cvt_pk_bf16_f32 v139, v142, v143
buffer_store_dwordx4 v[136:139], v2, s[60:63], s80 offen sc1
s_add_u32 s80, s80, 4096
s_cbranch_vccnz Lstub86
Lret87:
v_mfma_f32_16x16x32_bf16 v[160:163], a[128:131], v[88:91], v[160:163]
ds_read_b128 a[128:131], v4 offset:32768
v_exp_f32 v112, v240
v_mfma_f32_16x16x32_bf16 v[160:163], a[132:135], v[92:95], v[160:163]
ds_read_b128 a[132:135], v4 offset:33792
v_exp_f32 v113, v241
v_mfma_f32_16x16x32_bf16 v[164:167], a[136:139], v[88:91], v[164:167]
ds_read_b128 a[136:139], v4 offset:34816
v_exp_f32 v114, v242
v_cvt_pk_bf16_f32 v224, v112, v113
v_mfma_f32_16x16x32_bf16 v[164:167], a[140:143], v[92:95], v[164:167]
ds_read_b128 a[140:143], v4 offset:35840
v_exp_f32 v115, v243
v_mfma_f32_16x16x32_bf16 v[168:171], a[144:147], v[88:91], v[168:171]
ds_read_b128 a[144:147], v4 offset:36864
v_exp_f32 v116, v244
v_cvt_pk_bf16_f32 v225, v114, v115
v_mfma_f32_16x16x32_bf16 v[168:171], a[148:151], v[92:95], v[168:171]
ds_read_b128 a[148:151], v4 offset:37888
v_exp_f32 v117, v245
v_mfma_f32_16x16x32_bf16 v[172:175], a[152:155], v[88:91], v[172:175]
ds_read_b128 a[152:155], v4 offset:38912
v_exp_f32 v118, v246
v_cvt_pk_bf16_f32 v226, v116, v117
v_mfma_f32_16x16x32_bf16 v[172:175], a[156:159], v[92:95], v[172:175]
ds_read_b128 a[156:159], v4 offset:39936
v_exp_f32 v119, v247
v_mfma_f32_16x16x32_bf16 v[176:179], a[160:163], v[88:91], v[176:179]
ds_read_b128 a[160:163], v4 offset:40960
v_exp_f32 v120, v248
v_cvt_pk_bf16_f32 v227, v118, v119
v_mfma_f32_16x16x32_bf16 v[176:179], a[164:167], v[92:95], v[176:179]
ds_read_b128 a[164:167], v4 offset:41984
v_exp_f32 v121, v249
v_mfma_f32_16x16x32_bf16 v[180:183], a[168:171], v[88:91], v[180:183]
ds_read_b128 a[168:171], v4 offset:43008
v_exp_f32 v122, v250
v_cvt_pk_bf16_f32 v228, v120, v121
v_mfma_f32_16x16x32_bf16 v[180:183], a[172:175], v[92:95], v[180:183]
ds_read_b128 a[172:175], v4 offset:44032
v_exp_f32 v123, v251
v_mfma_f32_16x16x32_bf16 v[184:187], a[176:179], v[88:91], v[184:187]
ds_read_b128 a[176:179], v4 offset:45056
v_exp_f32 v124, v252
v_cvt_pk_bf16_f32 v229, v122, v123
v_mfma_f32_16x16x32_bf16 v[184:187], a[180:183], v[92:95], v[184:187]
ds_read_b128 a[180:183], v4 offset:46080
v_exp_f32 v125, v253
v_mfma_f32_16x16x32_bf16 v[188:191], a[184:187], v[88:91], v[188:191]
ds_read_b128 a[184:187], v4 offset:47104
v_exp_f32 v126, v254
v_cvt_pk_bf16_f32 v230, v124, v125
v_mfma_f32_16x16x32_bf16 v[188:191], a[188:191], v[92:95], v[188:191]
ds_read_b128 a[188:191], v4 offset:48128
v_exp_f32 v127, v255
s_nop 0
v_cvt_pk_bf16_f32 v231, v126, v127
v_mfma_f32_16x16x32_bf16 v[60:63], v[28:31], v[224:227], v[36:39]
s_nop 0
v_mfma_f32_16x16x32_bf16 v[60:63], v[28:31], v[228:231], v[60:63]
v_pk_mul_f32 v[144:145], v[144:145], v[54:55]
v_pk_mul_f32 v[146:147], v[146:147], v[54:55]
v_pk_mul_f32 v[148:149], v[148:149], v[54:55]
v_pk_mul_f32 v[150:151], v[150:151], v[54:55]
v_cvt_pk_bf16_f32 v144, v144, v145
v_cvt_pk_bf16_f32 v145, v146, v147
v_cvt_pk_bf16_f32 v146, v148, v149
v_cvt_pk_bf16_f32 v147, v150, v151
buffer_store_dwordx4 v[144:147], v2, s[60:63], s80 offen sc1
v_cmp_lt_f32 vcc, s10, v60
s_add_u32 s80, s80, 4096
v_pk_mul_f32 v[152:153], v[152:153], v[54:55]
v_pk_mul_f32 v[154:155], v[154:155], v[54:55]
v_pk_mul_f32 v[156:157], v[156:157], v[54:55]
v_pk_mul_f32 v[158:159], v[158:159], v[54:55]
v_cvt_pk_bf16_f32 v152, v152, v153
v_cvt_pk_bf16_f32 v153, v154, v155
v_cvt_pk_bf16_f32 v154, v156, v157
v_cvt_pk_bf16_f32 v155, v158, v159
buffer_store_dwordx4 v[152:155], v2, s[60:63], s80 offen sc1
s_cbranch_vccnz Lstub88
Lret89:
s_waitcnt lgkmcnt(0)
v_mfma_f32_16x16x32_bf16 v[160:163], a[128:131], v[224:227], v[160:163]
v_rcp_f32 v54, v60
v_mfma_f32_16x16x32_bf16 v[160:163], a[132:135], v[228:231], v[160:163]
s_add_u32 s80, s11, 524288
v_mul_f32 v55, 0x25800000, v54
v_mul_f32 v54, 0x25800000, v54
v_mfma_f32_16x16x32_bf16 v[164:167], a[136:139], v[224:227], v[164:167]
v_mfma_f32_16x16x32_bf16 v[164:167], a[140:143], v[228:231], v[164:167]
v_mfma_f32_16x16x32_bf16 v[168:171], a[144:147], v[224:227], v[168:171]
v_mfma_f32_16x16x32_bf16 v[168:171], a[148:151], v[228:231], v[168:171]
v_mfma_f32_16x16x32_bf16 v[172:175], a[152:155], v[224:227], v[172:175]
v_mul_f32 v160, v160, v54
v_mul_f32 v161, v161, v54
v_mfma_f32_16x16x32_bf16 v[172:175], a[156:159], v[228:231], v[172:175]
v_mul_f32 v162, v162, v54
v_mul_f32 v163, v163, v54
v_mfma_f32_16x16x32_bf16 v[176:179], a[160:163], v[224:227], v[176:179]
v_mul_f32 v164, v164, v54
v_mul_f32 v165, v165, v54
v_mfma_f32_16x16x32_bf16 v[176:179], a[164:167], v[228:231], v[176:179]
v_mul_f32 v166, v166, v54
v_mul_f32 v167, v167, v54
v_mfma_f32_16x16x32_bf16 v[180:183], a[168:171], v[224:227], v[180:183]
v_cvt_pk_bf16_f32 v160, v160, v161
v_cvt_pk_bf16_f32 v161, v162, v163
v_mfma_f32_16x16x32_bf16 v[180:183], a[172:175], v[228:231], v[180:183]
v_cvt_pk_bf16_f32 v162, v164, v165
v_cvt_pk_bf16_f32 v163, v166, v167
v_mfma_f32_16x16x32_bf16 v[184:187], a[176:179], v[224:227], v[184:187]
buffer_store_dwordx4 v[160:163], v2, s[60:63], s80 offen sc1
v_mfma_f32_16x16x32_bf16 v[184:187], a[180:183], v[228:231], v[184:187]
s_add_u32 s80, s80, 4096
v_mul_f32 v168, v168, v54
v_mul_f32 v169, v169, v54
v_mfma_f32_16x16x32_bf16 v[188:191], a[184:187], v[224:227], v[188:191]
v_mul_f32 v170, v170, v54
v_mul_f32 v171, v171, v54
v_mfma_f32_16x16x32_bf16 v[188:191], a[188:191], v[228:231], v[188:191]
v_mul_f32 v172, v172, v54
v_mul_f32 v173, v173, v54
v_mul_f32 v174, v174, v54
v_mul_f32 v175, v175, v54
v_cvt_pk_bf16_f32 v168, v168, v169
v_cvt_pk_bf16_f32 v169, v170, v171
v_cvt_pk_bf16_f32 v170, v172, v173
v_cvt_pk_bf16_f32 v171, v174, v175
buffer_store_dwordx4 v[168:171], v2, s[60:63], s80 offen sc1
s_add_u32 s80, s80, 4096
v_mul_f32 v176, v176, v54
v_mul_f32 v177, v177, v54
v_mul_f32 v178, v178, v54
v_mul_f32 v179, v179, v54
v_mul_f32 v180, v180, v54
v_mul_f32 v181, v181, v54
v_mul_f32 v182, v182, v54
v_mul_f32 v183, v183, v54
v_cvt_pk_bf16_f32 v176, v176, v177
v_cvt_pk_bf16_f32 v177, v178, v179
v_cvt_pk_bf16_f32 v178, v180, v181
v_cvt_pk_bf16_f32 v179, v182, v183
buffer_store_dwordx4 v[176:179], v2, s[60:63], s80 offen sc1
s_add_u32 s80, s80, 4096
v_mul_f32 v184, v184, v54
v_mul_f32 v185, v185, v54
v_mul_f32 v186, v186, v54
v_mul_f32 v187, v187, v54
v_mul_f32 v188, v188, v54
v_mul_f32 v189, v189, v54
v_mul_f32 v190, v190, v54
v_mul_f32 v191, v191, v54
v_cvt_pk_bf16_f32 v184, v184, v185
v_cvt_pk_bf16_f32 v185, v186, v187
v_cvt_pk_bf16_f32 v186, v188, v189
v_cvt_pk_bf16_f32 v187, v190, v191
buffer_store_dwordx4 v[184:187], v2, s[60:63], s80 offen sc1
v_mfma_f32_16x16x32_bf16 v[192:195], a[64:67], a[80:83], 0
buffer_load_dwordx4 a[224:227], v2, s[60:63], s84 offen offset:0 sc1
v_mfma_f32_16x16x32_bf16 v[196:199], a[68:71], a[80:83], 0
v_mfma_f32_16x16x32_bf16 v[200:203], a[72:75], a[80:83], 0
buffer_load_dwordx4 a[228:231], v2, s[60:63], s84 offen offset:1024 sc1
v_mfma_f32_16x16x32_bf16 v[204:207], a[76:79], a[80:83], 0
v_mfma_f32_16x16x32_bf16 v[208:211], a[64:67], a[84:87], 0
buffer_load_dwordx4 a[232:235], v2, s[60:63], s84 offen offset:2048 sc1
v_mfma_f32_16x16x32_bf16 v[212:215], a[68:71], a[84:87], 0
v_mfma_f32_16x16x32_bf16 v[216:219], a[72:75], a[84:87], 0
buffer_load_dwordx4 a[236:239], v2, s[60:63], s84 offen offset:3072 sc1
v_mfma_f32_16x16x32_bf16 v[220:223], a[76:79], a[84:87], 0
s_add_u32 s84, s84, 4096
v_mfma_f32_16x16x32_bf16 v[224:227], a[64:67], a[88:91], 0
buffer_load_dwordx4 a[240:243], v2, s[60:63], s85 offen offset:0 sc1
v_mfma_f32_16x16x32_bf16 v[228:231], a[68:71], a[88:91], 0
v_mfma_f32_16x16x32_bf16 v[232:235], a[72:75], a[88:91], 0
buffer_load_dwordx4 a[244:247], v2, s[60:63], s85 offen offset:1024 sc1
v_mfma_f32_16x16x32_bf16 v[236:239], a[76:79], a[88:91], 0
v_mfma_f32_16x16x32_bf16 v[240:243], a[64:67], a[92:95], 0
buffer_load_dwordx4 a[248:251], v2, s[60:63], s85 offen offset:2048 sc1
v_mfma_f32_16x16x32_bf16 v[244:247], a[68:71], a[92:95], 0
v_mfma_f32_16x16x32_bf16 v[248:251], a[72:75], a[92:95], 0
buffer_load_dwordx4 a[252:255], v2, s[60:63], s85 offen offset:3072 sc1
v_mfma_f32_16x16x32_bf16 v[252:255], a[76:79], a[92:95], 0
s_add_u32 s85, s85, 4096
s_add_u32 s81, s86, 0x10000
v_add_u32 v27, s81, v2
v_mfma_f32_16x16x32_bf16 v[192:195], a[96:99], a[112:115], v[192:195]
s_waitcnt vmcnt(16)
s_lshr_b32 s6, s76, 3
ds_read_b128 a[32:35], v27 offset:0
v_mfma_f32_16x16x32_bf16 v[196:199], a[100:103], a[112:115], v[196:199]
s_add_u32 s0, s0, 4096
ds_read_b128 a[36:39], v27 offset:1024
s_and_b32 s82, s3, 1
v_mfma_f32_16x16x32_bf16 v[200:203], a[104:107], a[112:115], v[200:203]
ds_read_b128 a[40:43], v27 offset:2048
s_lshr_b32 s83, s3, 1
ds_read_b128 a[44:47], v27 offset:3072
v_mfma_f32_16x16x32_bf16 v[204:207], a[108:111], a[112:115], v[204:207]
s_lshl_b32 s4, s82, 13
ds_read_b128 a[48:51], v27 offset:32768
s_lshl_b32 s81, s83, 12
v_mfma_f32_16x16x32_bf16 v[208:211], a[96:99], a[116:119], v[208:211]
ds_read_b128 a[52:55], v27 offset:33792
s_add_u32 s4, s4, s81
ds_read_b128 a[56:59], v27 offset:34816
v_mfma_f32_16x16x32_bf16 v[212:215], a[100:103], a[116:119], v[212:215]
s_lshl_b32 s81, s83, 13
ds_read_b128 a[60:63], v27 offset:35840
v_add_u32 v23, s81, v2
v_mfma_f32_16x16x32_bf16 v[216:219], a[104:107], a[116:119], v[216:219]
ds_read_b128 a[192:195], v27 offset:4096
s_xor_b32 s81, s6, 0
ds_read_b128 a[196:199], v27 offset:5120
v_mfma_f32_16x16x32_bf16 v[220:223], a[108:111], a[116:119], v[220:223]
s_add_u32 s81, s81, 4
ds_read_b128 a[200:203], v27 offset:6144
s_lshl_b32 s81, s81, 10
v_mfma_f32_16x16x32_bf16 v[224:227], a[96:99], a[120:123], v[224:227]
ds_read_b128 a[204:207], v27 offset:7168
v_add_u32 v16, s81, v2
v_mfma_f32_16x16x32_bf16 v[228:231], a[100:103], a[120:123], v[228:231]
ds_read_b128 a[208:211], v27 offset:36864
s_xor_b32 s81, s6, 1
ds_read_b128 a[212:215], v27 offset:37888
v_mfma_f32_16x16x32_bf16 v[232:235], a[104:107], a[120:123], v[232:235]
s_add_u32 s81, s81, 3
ds_read_b128 a[216:219], v27 offset:38912
s_lshl_b32 s81, s81, 10
v_mfma_f32_16x16x32_bf16 v[236:239], a[108:111], a[120:123], v[236:239]
ds_read_b128 a[220:223], v27 offset:39936
v_add_u32 v17, s81, v2
v_mfma_f32_16x16x32_bf16 v[240:243], a[96:99], a[124:127], v[240:243]
s_xor_b32 s81, s6, 2
s_add_u32 s81, s81, 2
s_lshl_b32 s81, s81, 10
v_mfma_f32_16x16x32_bf16 v[244:247], a[100:103], a[124:127], v[244:247]
v_add_u32 v18, s81, v2
s_xor_b32 s81, s6, 3
s_add_u32 s81, s81, 1
v_mfma_f32_16x16x32_bf16 v[248:251], a[104:107], a[124:127], v[248:251]
s_lshl_b32 s81, s81, 10
v_add_u32 v19, s81, v2
s_sub_u32 s80, 15, s93
v_mfma_f32_16x16x32_bf16 v[252:255], a[108:111], a[124:127], v[252:255]
s_min_u32 s80, s80, s93
s_lshl_b32 s80, s80, 7
s_lshl_b32 s19, s6, 10
s_waitcnt vmcnt(25)
s_waitcnt vmcnt(8)
s_barrier
s_cmp_lg_u32 s3, 0
s_cbranch_scc1 Lpub94
v_mov_b32 v12, 1
s_mov_b64 exec, 1
buffer_atomic_add v12, off, s[60:63], s0 sc1
s_mov_b64 exec, -1
Lpub94:
v_mfma_f32_16x16x32_bf16 v[192:195], a[0:3], a[16:19], v[192:195]
s_add_u32 s19, s19, s80
s_add_u32 s19, s19, 59850752
s_lshr_b32 s80, s93, 3
v_mfma_f32_16x16x32_bf16 v[196:199], a[4:7], a[16:19], v[196:199]
s_lshl_b32 s80, s80, 12
s_sub_u32 s19, s19, s80
s_lshl_b32 s7, s93, 1
v_mfma_f32_16x16x32_bf16 v[200:203], a[8:11], a[16:19], v[200:203]
s_add_u32 s7, s7, s83
s_lshl_b32 s7, s7, 2
s_add_u32 s7, s7, s6
v_mfma_f32_16x16x32_bf16 v[204:207], a[12:15], a[16:19], v[204:207]
s_lshl_b32 s7, s7, 16
s_and_b32 s81, s77, 3
s_lshl_b32 s81, s81, 1
v_mfma_f32_16x16x32_bf16 v[208:211], a[0:3], a[20:23], v[208:211]
s_add_u32 s81, s81, s82
s_lshl_b32 s81, s81, 8
s_add_u32 s7, s7, s81
v_mfma_f32_16x16x32_bf16 v[212:215], a[4:7], a[20:23], v[212:215]
s_and_b32 s5, s76, 7
s_lshl_b32 s5, s5, 3
s_add_u32 s5, s5, s77
v_mfma_f32_16x16x32_bf16 v[216:219], a[8:11], a[20:23], v[216:219]
s_lshl_b32 s5, s5, 6
s_add_u32 s5, s5, s3
s_lshl_b32 s5, s5, 11
v_mfma_f32_16x16x32_bf16 v[220:223], a[12:15], a[20:23], v[220:223]
s_add_u32 s5, s5, 60817408
v_and_b32 v113, 15, v1
v_lshlrev_b32 v112, 1, v3
v_mfma_f32_16x16x32_bf16 v[224:227], a[0:3], a[24:27], v[224:227]
v_xor_b32 v112, v112, v113
v_lshlrev_b32 v112, 4, v112
v_mfma_f32_16x16x32_bf16 v[228:231], a[4:7], a[24:27], v[228:231]
v_lshl_add_u32 v112, v3, 10, v112
v_xor_b32 v113, 128, v112
v_mfma_f32_16x16x32_bf16 v[232:235], a[8:11], a[24:27], v[232:235]
v_add_u32 v114, 6144, v112
v_add_u32 v115, 9216, v113
v_mfma_f32_16x16x32_bf16 v[236:239], a[12:15], a[24:27], v[236:239]
v_add_u32 v113, 3072, v113
v_mfma_f32_16x16x32_bf16 v[240:243], a[0:3], a[28:31], v[240:243]
v_mfma_f32_16x16x32_bf16 v[244:247], a[4:7], a[28:31], v[244:247]
v_mfma_f32_16x16x32_bf16 v[248:251], a[8:11], a[28:31], v[248:251]
v_mfma_f32_16x16x32_bf16 v[252:255], a[12:15], a[28:31], v[252:255]
s_waitcnt lgkmcnt(0)
v_mfma_f32_16x16x32_bf16 v[192:195], a[32:35], a[48:51], v[192:195]
s_cmp_lg_u32 s3, 0
s_cbranch_scc1 Lrd90
v_mov_b32 v48, 0
s_mov_b64 exec, 1
buffer_atomic_add v48, off, s[60:63], s19 sc0 sc1
s_mov_b64 exec, -1
Lrd90:
v_mfma_f32_16x16x32_bf16 v[196:199], a[36:39], a[48:51], v[196:199]
s_add_u32 m0, s86, 65536
v_mfma_f32_16x16x32_bf16 v[200:203], a[40:43], a[48:51], v[200:203]
buffer_load_dwordx4 v112, s[52:55], s89 offen offset:0 lds
v_mfma_f32_16x16x32_bf16 v[204:207], a[44:47], a[48:51], v[204:207]
v_mfma_f32_16x16x32_bf16 v[208:211], a[32:35], a[52:55], v[208:211]
buffer_load_dwordx4 v113, s[52:55], s89 offen offset:1024 lds
v_mfma_f32_16x16x32_bf16 v[212:215], a[36:39], a[52:55], v[212:215]
v_mfma_f32_16x16x32_bf16 v[216:219], a[40:43], a[52:55], v[216:219]
buffer_load_dwordx4 v114, s[52:55], s89 offen offset:2048 lds
v_mfma_f32_16x16x32_bf16 v[220:223], a[44:47], a[52:55], v[220:223]
v_mfma_f32_16x16x32_bf16 v[224:227], a[32:35], a[56:59], v[224:227]
buffer_load_dwordx4 v115, s[52:55], s89 offen offset:3072 lds
v_mfma_f32_16x16x32_bf16 v[228:231], a[36:39], a[56:59], v[228:231]
s_add_u32 m0, s86, 69632
s_add_u32 s89, s89, 16384
v_mfma_f32_16x16x32_bf16 v[232:235], a[40:43], a[56:59], v[232:235]
buffer_load_dwordx4 v112, s[52:55], s89 offen offset:0 lds
v_mfma_f32_16x16x32_bf16 v[236:239], a[44:47], a[56:59], v[236:239]
v_mfma_f32_16x16x32_bf16 v[240:243], a[32:35], a[60:63], v[240:243]
buffer_load_dwordx4 v113, s[52:55], s89 offen offset:1024 lds
v_mfma_f32_16x16x32_bf16 v[244:247], a[36:39], a[60:63], v[244:247]
v_mfma_f32_16x16x32_bf16 v[248:251], a[40:43], a[60:63], v[248:251]
buffer_load_dwordx4 v114, s[52:55], s89 offen offset:2048 lds
v_mfma_f32_16x16x32_bf16 v[252:255], a[44:47], a[60:63], v[252:255]
v_mfma_f32_16x16x32_bf16 v[192:195], a[192:195], a[208:211], v[192:195]
buffer_load_dwordx4 v115, s[52:55], s89 offen offset:3072 lds
v_mfma_f32_16x16x32_bf16 v[196:199], a[196:199], a[208:211], v[196:199]
s_add_u32 s89, s89, 114688
v_lshrrev_b32 v116, 2, v1
v_and_b32 v117, 7, v116
v_mfma_f32_16x16x32_bf16 v[200:203], a[200:203], a[208:211], v[200:203]
v_lshlrev_b32 v116, 8, v116
v_lshl_add_u32 v116, v117, 5, v116
v_mfma_f32_16x16x32_bf16 v[204:207], a[204:207], a[208:211], v[204:207]
v_and_b32 v117, 3, v1
v_lshl_add_u32 v116, v117, 3, v116
v_mfma_f32_16x16x32_bf16 v[208:211], a[192:195], a[212:215], v[208:211]
s_and_b32 s81, s3, 1
s_lshl_b32 s81, s81, 7
s_add_u32 s81, s81, 0x10000
v_mfma_f32_16x16x32_bf16 v[212:215], a[196:199], a[212:215], v[212:215]
v_xor_b32 v116, s81, v116
v_xor_b32 v117, 0x20, v116
v_mfma_f32_16x16x32_bf16 v[216:219], a[200:203], a[212:215], v[216:219]
v_xor_b32 v118, 0x40, v116
v_xor_b32 v119, 0x60, v116
v_mfma_f32_16x16x32_bf16 v[220:223], a[204:207], a[212:215], v[220:223]
v_xor_b32 v120, 0x30000, v116
v_xor_b32 v121, 0x30020, v116
v_mfma_f32_16x16x32_bf16 v[224:227], a[192:195], a[216:219], v[224:227]
v_xor_b32 v122, 0x30040, v116
v_xor_b32 v123, 0x30060, v116
v_mfma_f32_16x16x32_bf16 v[228:231], a[196:199], a[216:219], v[228:231]
v_mfma_f32_16x16x32_bf16 v[232:235], a[200:203], a[216:219], v[232:235]
v_mfma_f32_16x16x32_bf16 v[236:239], a[204:207], a[216:219], v[236:239]
v_mfma_f32_16x16x32_bf16 v[240:243], a[192:195], a[220:223], v[240:243]
v_mfma_f32_16x16x32_bf16 v[244:247], a[196:199], a[220:223], v[244:247]
v_mfma_f32_16x16x32_bf16 v[248:251], a[200:203], a[220:223], v[248:251]
v_mfma_f32_16x16x32_bf16 v[252:255], a[204:207], a[220:223], v[252:255]
s_waitcnt vmcnt(8)
v_mfma_f32_16x16x32_bf16 v[192:195], a[224:227], a[240:243], v[192:195]
s_cmp_lg_u32 s3, 0
s_cbranch_scc1 Lone91
s_mov_b32 s83, 0x20000
s_mov_b64 exec, 1
s_waitcnt vmcnt(8)
Lsp92:
v_cmp_gt_u32 vcc, 4, v48
s_sub_u32 s83, s83, 1
s_cbranch_vccz Ldn93
s_cbranch_scc1 Ldn93
v_mov_b32 v48, 0
buffer_atomic_add v48, off, s[60:63], s19 sc0 sc1
s_waitcnt vmcnt(0)
s_branch Lsp92
Ldn93:
s_mov_b64 exec, -1
Lone91:
s_barrier
v_mfma_f32_16x16x32_bf16 v[196:199], a[228:231], a[240:243], v[196:199]
s_add_u32 m0, s4, 0
v_mfma_f32_16x16x32_bf16 v[200:203], a[232:235], a[240:243], v[200:203]
buffer_load_dwordx4 v16, s[60:63], s90 offen offset:0 sc1 lds
v_mfma_f32_16x16x32_bf16 v[204:207], a[236:239], a[240:243], v[204:207]
v_mfma_f32_16x16x32_bf16 v[208:211], a[224:227], a[244:247], v[208:211]
buffer_load_dwordx4 v17, s[60:63], s90 offen offset:1024 sc1 lds
v_mfma_f32_16x16x32_bf16 v[212:215], a[228:231], a[244:247], v[212:215]
v_mfma_f32_16x16x32_bf16 v[216:219], a[232:235], a[244:247], v[216:219]
buffer_load_dwordx4 v18, s[60:63], s90 offen offset:2048 sc1 lds
v_mfma_f32_16x16x32_bf16 v[220:223], a[236:239], a[244:247], v[220:223]
v_mfma_f32_16x16x32_bf16 v[224:227], a[224:227], a[248:251], v[224:227]
buffer_load_dwordx4 v19, s[60:63], s90 offen offset:3072 sc1 lds
v_mfma_f32_16x16x32_bf16 v[228:231], a[228:231], a[248:251], v[228:231]
s_add_u32 s90, s90, 8192
s_add_u32 m0, s4, 16384
v_mfma_f32_16x16x32_bf16 v[232:235], a[232:235], a[248:251], v[232:235]
buffer_load_dwordx4 v16, s[60:63], s90 offen offset:0 sc1 lds
v_mfma_f32_16x16x32_bf16 v[236:239], a[236:239], a[248:251], v[236:239]
v_mfma_f32_16x16x32_bf16 v[240:243], a[224:227], a[252:255], v[240:243]
buffer_load_dwordx4 v17, s[60:63], s90 offen offset:1024 sc1 lds
v_mfma_f32_16x16x32_bf16 v[244:247], a[228:231], a[252:255], v[244:247]
v_mfma_f32_16x16x32_bf16 v[248:251], a[232:235], a[252:255], v[248:251]
buffer_load_dwordx4 v18, s[60:63], s90 offen offset:2048 sc1 lds
v_mfma_f32_16x16x32_bf16 v[252:255], a[236:239], a[252:255], v[252:255]
buffer_load_dwordx4 v19, s[60:63], s90 offen offset:3072 sc1 lds
s_add_u32 s90, s90, 8192
s_add_u32 m0, s4, 32768
s_nop 0
buffer_load_dwordx4 v16, s[60:63], s90 offen offset:0 sc1 lds
buffer_load_dwordx4 v17, s[60:63], s90 offen offset:1024 sc1 lds
buffer_load_dwordx4 v18, s[60:63], s90 offen offset:2048 sc1 lds
buffer_load_dwordx4 v19, s[60:63], s90 offen offset:3072 sc1 lds
s_add_u32 s90, s90, 8192
s_waitcnt vmcnt(8)
s_barrier
ds_read_b64_tr_b16 a[64:65], v120 offset:0
ds_read_b64_tr_b16 a[66:67], v120 offset:4096
ds_read_b64_tr_b16 a[68:69], v120 offset:8192
ds_read_b64_tr_b16 a[70:71], v120 offset:12288
ds_read_b64_tr_b16 a[72:73], v121 offset:0
ds_read_b64_tr_b16 a[74:75], v121 offset:4096
ds_read_b64_tr_b16 a[76:77], v121 offset:8192
ds_read_b64_tr_b16 a[78:79], v121 offset:12288
ds_read_b128 a[80:83], v23 offset:1024
ds_read_b128 a[84:87], v23 offset:5120
ds_read_b128 a[88:91], v23 offset:2048
ds_read_b128 a[92:95], v23 offset:6144
s_add_u32 m0, s4, 49152
s_nop 0
buffer_load_dwordx4 v16, s[60:63], s90 offen offset:0 sc1 lds
buffer_load_dwordx4 v17, s[60:63], s90 offen offset:1024 sc1 lds
buffer_load_dwordx4 v18, s[60:63], s90 offen offset:2048 sc1 lds
buffer_load_dwordx4 v19, s[60:63], s90 offen offset:3072 sc1 lds
s_add_u32 s90, s90, 8192
s_waitcnt lgkmcnt(2)
v_mfma_f32_16x16x32_bf16 v[144:147], a[64:67], a[80:83], 0
ds_read_b128 a[112:115], v23 offset:3072
v_mfma_f32_16x16x32_bf16 v[144:147], a[68:71], a[84:87], v[144:147]
s_waitcnt lgkmcnt(1)
ds_read_b128 a[116:119], v23 offset:7168
v_mfma_f32_16x16x32_bf16 v[148:151], a[72:75], a[80:83], 0
s_add_u32 m0, s86, 98304
ds_read_b128 a[120:123], v23 offset:0
v_mfma_f32_16x16x32_bf16 v[148:151], a[76:79], a[84:87], v[148:151]
buffer_load_dwordx4 v112, s[52:55], s89 offen offset:0 lds
v_mfma_f32_16x16x32_bf16 v[160:163], a[64:67], a[88:91], 0
ds_read_b128 a[124:127], v23 offset:4096
v_mfma_f32_16x16x32_bf16 v[160:163], a[68:71], a[92:95], v[160:163]
ds_read_b64_tr_b16 a[96:97], v122 offset:0
ds_read_b64_tr_b16 a[98:99], v122 offset:4096
v_mfma_f32_16x16x32_bf16 v[164:167], a[72:75], a[88:91], 0
s_waitcnt lgkmcnt(3)
ds_read_b64_tr_b16 a[100:101], v122 offset:8192
ds_read_b64_tr_b16 a[102:103], v122 offset:12288
v_mfma_f32_16x16x32_bf16 v[164:167], a[76:79], a[92:95], v[164:167]
buffer_load_dwordx4 v113, s[52:55], s89 offen offset:1024 lds
v_mfma_f32_16x16x32_bf16 v[176:179], a[64:67], a[112:115], 0
ds_read_b64_tr_b16 a[104:105], v123 offset:0
ds_read_b64_tr_b16 a[106:107], v123 offset:4096
v_mfma_f32_16x16x32_bf16 v[176:179], a[68:71], a[116:119], v[176:179]
ds_read_b64_tr_b16 a[108:109], v123 offset:8192
ds_read_b64_tr_b16 a[110:111], v123 offset:12288
v_mfma_f32_16x16x32_bf16 v[180:183], a[72:75], a[112:115], 0
buffer_load_dwordx4 v114, s[52:55], s89 offen offset:2048 lds
v_mfma_f32_16x16x32_bf16 v[180:183], a[76:79], a[116:119], v[180:183]
s_waitcnt lgkmcnt(4)
v_mfma_f32_16x16x32_bf16 v[128:131], a[64:67], a[120:123], 0
buffer_load_dwordx4 v115, s[52:55], s89 offen offset:3072 lds
v_mfma_f32_16x16x32_bf16 v[128:131], a[68:71], a[124:127], v[128:131]
v_mfma_f32_16x16x32_bf16 v[132:135], a[72:75], a[120:123], 0
s_waitcnt vmcnt(12) lgkmcnt(0)
v_mfma_f32_16x16x32_bf16 v[132:135], a[76:79], a[124:127], v[132:135]
s_barrier
v_mfma_f32_16x16x32_bf16 v[152:155], a[96:99], a[80:83], 0
ds_read_b64_tr_b16 a[64:65], v120 offset:16384
ds_read_b64_tr_b16 a[66:67], v120 offset:20480
v_mfma_f32_16x16x32_bf16 v[152:155], a[100:103], a[84:87], v[152:155]
ds_read_b64_tr_b16 a[68:69], v120 offset:24576
ds_read_b64_tr_b16 a[70:71], v120 offset:28672
v_mfma_f32_16x16x32_bf16 v[156:159], a[104:107], a[80:83], 0
s_add_u32 m0, s4, 0
ds_read_b64_tr_b16 a[72:73], v121 offset:16384
ds_read_b64_tr_b16 a[74:75], v121 offset:20480
v_mfma_f32_16x16x32_bf16 v[156:159], a[108:111], a[84:87], v[156:159]
buffer_load_dwordx4 v16, s[60:63], s90 offen offset:0 sc1 lds
v_mfma_f32_16x16x32_bf16 v[168:171], a[96:99], a[88:91], 0
ds_read_b64_tr_b16 a[76:77], v121 offset:24576
ds_read_b64_tr_b16 a[78:79], v121 offset:28672
v_mfma_f32_16x16x32_bf16 v[168:171], a[100:103], a[92:95], v[168:171]
ds_read_b128 a[80:83], v23 offset:17408
v_mfma_f32_16x16x32_bf16 v[172:175], a[104:107], a[88:91], 0
ds_read_b128 a[84:87], v23 offset:21504
v_mfma_f32_16x16x32_bf16 v[172:175], a[108:111], a[92:95], v[172:175]
buffer_load_dwordx4 v17, s[60:63], s90 offen offset:1024 sc1 lds
v_mfma_f32_16x16x32_bf16 v[184:187], a[96:99], a[112:115], 0
ds_read_b128 a[88:91], v23 offset:18432
v_mfma_f32_16x16x32_bf16 v[184:187], a[100:103], a[116:119], v[184:187]
ds_read_b128 a[92:95], v23 offset:22528
v_mfma_f32_16x16x32_bf16 v[188:191], a[104:107], a[112:115], 0
v_mfma_f32_16x16x32_bf16 v[188:191], a[108:111], a[116:119], v[188:191]
buffer_load_dwordx4 v18, s[60:63], s90 offen offset:2048 sc1 lds
v_mfma_f32_16x16x32_bf16 v[136:139], a[96:99], a[120:123], 0
v_mfma_f32_16x16x32_bf16 v[136:139], a[100:103], a[124:127], v[136:139]
s_waitcnt lgkmcnt(0)
v_mfma_f32_16x16x32_bf16 v[140:143], a[104:107], a[120:123], 0
buffer_load_dwordx4 v19, s[60:63], s90 offen offset:3072 sc1 lds
v_mfma_f32_16x16x32_bf16 v[140:143], a[108:111], a[124:127], v[140:143]
s_add_u32 s90, s90, 8192
v_mfma_f32_16x16x32_bf16 v[144:147], a[64:67], a[80:83], v[144:147]
ds_read_b128 a[112:115], v23 offset:19456
v_mfma_f32_16x16x32_bf16 v[144:147], a[68:71], a[84:87], v[144:147]
ds_read_b128 a[116:119], v23 offset:23552
v_mfma_f32_16x16x32_bf16 v[148:151], a[72:75], a[80:83], v[148:151]
s_add_u32 m0, s86, 102400
s_add_u32 s89, s89, 16384
ds_read_b128 a[120:123], v23 offset:16384
v_mfma_f32_16x16x32_bf16 v[148:151], a[76:79], a[84:87], v[148:151]
buffer_load_dwordx4 v112, s[52:55], s89 offen offset:0 lds
v_mfma_f32_16x16x32_bf16 v[160:163], a[64:67], a[88:91], v[160:163]
ds_read_b128 a[124:127], v23 offset:20480
v_mfma_f32_16x16x32_bf16 v[160:163], a[68:71], a[92:95], v[160:163]
ds_read_b64_tr_b16 a[96:97], v122 offset:16384
ds_read_b64_tr_b16 a[98:99], v122 offset:20480
v_mfma_f32_16x16x32_bf16 v[164:167], a[72:75], a[88:91], v[164:167]
s_waitcnt lgkmcnt(3)
ds_read_b64_tr_b16 a[100:101], v122 offset:24576
ds_read_b64_tr_b16 a[102:103], v122 offset:28672
v_mfma_f32_16x16x32_bf16 v[164:167], a[76:79], a[92:95], v[164:167]
buffer_load_dwordx4 v113, s[52:55], s89 offen offset:1024 lds
v_mfma_f32_16x16x32_bf16 v[176:179], a[64:67], a[112:115], v[176:179]
ds_read_b64_tr_b16 a[104:105], v123 offset:16384
ds_read_b64_tr_b16 a[106:107], v123 offset:20480
v_mfma_f32_16x16x32_bf16 v[176:179], a[68:71], a[116:119], v[176:179]
ds_read_b64_tr_b16 a[108:109], v123 offset:24576
ds_read_b64_tr_b16 a[110:111], v123 offset:28672
v_mfma_f32_16x16x32_bf16 v[180:183], a[72:75], a[112:115], v[180:183]
buffer_load_dwordx4 v114, s[52:55], s89 offen offset:2048 lds
v_mfma_f32_16x16x32_bf16 v[180:183], a[76:79], a[116:119], v[180:183]
s_waitcnt lgkmcnt(4)
v_mfma_f32_16x16x32_bf16 v[128:131], a[64:67], a[120:123], v[128:131]
buffer_load_dwordx4 v115, s[52:55], s89 offen offset:3072 lds
v_mfma_f32_16x16x32_bf16 v[128:131], a[68:71], a[124:127], v[128:131]
s_add_u32 s89, s89, 114688
v_mfma_f32_16x16x32_bf16 v[132:135], a[72:75], a[120:123], v[132:135]
s_waitcnt vmcnt(16) lgkmcnt(0)
v_mfma_f32_16x16x32_bf16 v[132:135], a[76:79], a[124:127], v[132:135]
s_barrier
v_mfma_f32_16x16x32_bf16 v[152:155], a[96:99], a[80:83], v[152:155]
ds_read_b64_tr_b16 a[64:65], v116 offset:0
ds_read_b64_tr_b16 a[66:67], v116 offset:4096
v_mfma_f32_16x16x32_bf16 v[152:155], a[100:103], a[84:87], v[152:155]
ds_read_b64_tr_b16 a[68:69], v116 offset:8192
ds_read_b64_tr_b16 a[70:71], v116 offset:12288
v_mfma_f32_16x16x32_bf16 v[156:159], a[104:107], a[80:83], v[156:159]
s_add_u32 m0, s4, 16384
ds_read_b64_tr_b16 a[72:73], v117 offset:0
ds_read_b64_tr_b16 a[74:75], v117 offset:4096
v_mfma_f32_16x16x32_bf16 v[156:159], a[108:111], a[84:87], v[156:159]
buffer_load_dwordx4 v16, s[60:63], s90 offen offset:0 sc1 lds
v_mfma_f32_16x16x32_bf16 v[168:171], a[96:99], a[88:91], v[168:171]
ds_read_b64_tr_b16 a[76:77], v117 offset:8192
ds_read_b64_tr_b16 a[78:79], v117 offset:12288
v_mfma_f32_16x16x32_bf16 v[168:171], a[100:103], a[92:95], v[168:171]
ds_read_b128 a[80:83], v23 offset:33792
v_mfma_f32_16x16x32_bf16 v[172:175], a[104:107], a[88:91], v[172:175]
ds_read_b128 a[84:87], v23 offset:37888
v_mfma_f32_16x16x32_bf16 v[172:175], a[108:111], a[92:95], v[172:175]
buffer_load_dwordx4 v17, s[60:63], s90 offen offset:1024 sc1 lds
v_mfma_f32_16x16x32_bf16 v[184:187], a[96:99], a[112:115], v[184:187]
ds_read_b128 a[88:91], v23 offset:34816
v_mfma_f32_16x16x32_bf16 v[184:187], a[100:103], a[116:119], v[184:187]
ds_read_b128 a[92:95], v23 offset:38912
v_mfma_f32_16x16x32_bf16 v[188:191], a[104:107], a[112:115], v[188:191]
v_mfma_f32_16x16x32_bf16 v[188:191], a[108:111], a[116:119], v[188:191]
buffer_load_dwordx4 v18, s[60:63], s90 offen offset:2048 sc1 lds
v_mfma_f32_16x16x32_bf16 v[136:139], a[96:99], a[120:123], v[136:139]
v_mfma_f32_16x16x32_bf16 v[136:139], a[100:103], a[124:127], v[136:139]
s_waitcnt lgkmcnt(0)
v_mfma_f32_16x16x32_bf16 v[140:143], a[104:107], a[120:123], v[140:143]
buffer_load_dwordx4 v19, s[60:63], s90 offen offset:3072 sc1 lds
v_mfma_f32_16x16x32_bf16 v[140:143], a[108:111], a[124:127], v[140:143]
s_add_u32 s90, s90, 8192
v_mfma_f32_16x16x32_bf16 v[144:147], a[64:67], a[80:83], v[144:147]
ds_read_b128 a[112:115], v23 offset:35840
v_mfma_f32_16x16x32_bf16 v[144:147], a[68:71], a[84:87], v[144:147]
ds_read_b128 a[116:119], v23 offset:39936
v_mfma_f32_16x16x32_bf16 v[148:151], a[72:75], a[80:83], v[148:151]
s_add_u32 m0, s86, 131072
ds_read_b128 a[120:123], v23 offset:32768
v_mfma_f32_16x16x32_bf16 v[148:151], a[76:79], a[84:87], v[148:151]
buffer_load_dwordx4 v112, s[52:55], s89 offen offset:0 lds
v_mfma_f32_16x16x32_bf16 v[160:163], a[64:67], a[88:91], v[160:163]
ds_read_b128 a[124:127], v23 offset:36864
v_mfma_f32_16x16x32_bf16 v[160:163], a[68:71], a[92:95], v[160:163]
ds_read_b64_tr_b16 a[96:97], v118 offset:0
ds_read_b64_tr_b16 a[98:99], v118 offset:4096
v_mfma_f32_16x16x32_bf16 v[164:167], a[72:75], a[88:91], v[164:167]
s_waitcnt lgkmcnt(3)
ds_read_b64_tr_b16 a[100:101], v118 offset:8192
ds_read_b64_tr_b16 a[102:103], v118 offset:12288
v_mfma_f32_16x16x32_bf16 v[164:167], a[76:79], a[92:95], v[164:167]
buffer_load_dwordx4 v113, s[52:55], s89 offen offset:1024 lds
v_mfma_f32_16x16x32_bf16 v[176:179], a[64:67], a[112:115], v[176:179]
ds_read_b64_tr_b16 a[104:105], v119 offset:0
ds_read_b64_tr_b16 a[106:107], v119 offset:4096
v_mfma_f32_16x16x32_bf16 v[176:179], a[68:71], a[116:119], v[176:179]
ds_read_b64_tr_b16 a[108:109], v119 offset:8192
ds_read_b64_tr_b16 a[110:111], v119 offset:12288
v_mfma_f32_16x16x32_bf16 v[180:183], a[72:75], a[112:115], v[180:183]
buffer_load_dwordx4 v114, s[52:55], s89 offen offset:2048 lds
v_mfma_f32_16x16x32_bf16 v[180:183], a[76:79], a[116:119], v[180:183]
s_waitcnt lgkmcnt(4)
v_mfma_f32_16x16x32_bf16 v[128:131], a[64:67], a[120:123], v[128:131]
buffer_load_dwordx4 v115, s[52:55], s89 offen offset:3072 lds
v_mfma_f32_16x16x32_bf16 v[128:131], a[68:71], a[124:127], v[128:131]
v_mfma_f32_16x16x32_bf16 v[132:135], a[72:75], a[120:123], v[132:135]
s_waitcnt vmcnt(20) lgkmcnt(0)
v_mfma_f32_16x16x32_bf16 v[132:135], a[76:79], a[124:127], v[132:135]
s_barrier
v_mfma_f32_16x16x32_bf16 v[152:155], a[96:99], a[80:83], v[152:155]
ds_read_b64_tr_b16 a[64:65], v116 offset:16384
ds_read_b64_tr_b16 a[66:67], v116 offset:20480
v_mfma_f32_16x16x32_bf16 v[152:155], a[100:103], a[84:87], v[152:155]
ds_read_b64_tr_b16 a[68:69], v116 offset:24576
ds_read_b64_tr_b16 a[70:71], v116 offset:28672
v_mfma_f32_16x16x32_bf16 v[156:159], a[104:107], a[80:83], v[156:159]
s_add_u32 m0, s4, 32768
ds_read_b64_tr_b16 a[72:73], v117 offset:16384
ds_read_b64_tr_b16 a[74:75], v117 offset:20480
v_mfma_f32_16x16x32_bf16 v[156:159], a[108:111], a[84:87], v[156:159]
buffer_load_dwordx4 v16, s[60:63], s90 offen offset:0 sc1 lds
v_mfma_f32_16x16x32_bf16 v[168:171], a[96:99], a[88:91], v[168:171]
ds_read_b64_tr_b16 a[76:77], v117 offset:24576
ds_read_b64_tr_b16 a[78:79], v117 offset:28672
v_mfma_f32_16x16x32_bf16 v[168:171], a[100:103], a[92:95], v[168:171]
ds_read_b128 a[80:83], v23 offset:50176
v_mfma_f32_16x16x32_bf16 v[172:175], a[104:107], a[88:91], v[172:175]
ds_read_b128 a[84:87], v23 offset:54272
v_mfma_f32_16x16x32_bf16 v[172:175], a[108:111], a[92:95], v[172:175]
buffer_load_dwordx4 v17, s[60:63], s90 offen offset:1024 sc1 lds
v_mfma_f32_16x16x32_bf16 v[184:187], a[96:99], a[112:115], v[184:187]
ds_read_b128 a[88:91], v23 offset:51200
v_mfma_f32_16x16x32_bf16 v[184:187], a[100:103], a[116:119], v[184:187]
ds_read_b128 a[92:95], v23 offset:55296
v_mfma_f32_16x16x32_bf16 v[188:191], a[104:107], a[112:115], v[188:191]
v_mfma_f32_16x16x32_bf16 v[188:191], a[108:111], a[116:119], v[188:191]
buffer_load_dwordx4 v18, s[60:63], s90 offen offset:2048 sc1 lds
v_mfma_f32_16x16x32_bf16 v[136:139], a[96:99], a[120:123], v[136:139]
v_mfma_f32_16x16x32_bf16 v[136:139], a[100:103], a[124:127], v[136:139]
s_waitcnt lgkmcnt(0)
v_mfma_f32_16x16x32_bf16 v[140:143], a[104:107], a[120:123], v[140:143]
buffer_load_dwordx4 v19, s[60:63], s90 offen offset:3072 sc1 lds
v_mfma_f32_16x16x32_bf16 v[140:143], a[108:111], a[124:127], v[140:143]
s_add_u32 s90, s90, 8192
v_mfma_f32_16x16x32_bf16 v[144:147], a[64:67], a[80:83], v[144:147]
ds_read_b128 a[112:115], v23 offset:52224
v_mfma_f32_16x16x32_bf16 v[144:147], a[68:71], a[84:87], v[144:147]
ds_read_b128 a[116:119], v23 offset:56320
v_mfma_f32_16x16x32_bf16 v[148:151], a[72:75], a[80:83], v[148:151]
s_add_u32 m0, s86, 135168
s_add_u32 s89, s89, 16384
ds_read_b128 a[120:123], v23 offset:49152
v_mfma_f32_16x16x32_bf16 v[148:151], a[76:79], a[84:87], v[148:151]
buffer_load_dwordx4 v112, s[52:55], s89 offen offset:0 lds
v_mfma_f32_16x16x32_bf16 v[160:163], a[64:67], a[88:91], v[160:163]
ds_read_b128 a[124:127], v23 offset:53248
v_mfma_f32_16x16x32_bf16 v[160:163], a[68:71], a[92:95], v[160:163]
ds_read_b64_tr_b16 a[96:97], v118 offset:16384
ds_read_b64_tr_b16 a[98:99], v118 offset:20480
v_mfma_f32_16x16x32_bf16 v[164:167], a[72:75], a[88:91], v[164:167]
s_waitcnt lgkmcnt(3)
ds_read_b64_tr_b16 a[100:101], v118 offset:24576
ds_read_b64_tr_b16 a[102:103], v118 offset:28672
v_mfma_f32_16x16x32_bf16 v[164:167], a[76:79], a[92:95], v[164:167]
buffer_load_dwordx4 v113, s[52:55], s89 offen offset:1024 lds
v_mfma_f32_16x16x32_bf16 v[176:179], a[64:67], a[112:115], v[176:179]
ds_read_b64_tr_b16 a[104:105], v119 offset:16384
ds_read_b64_tr_b16 a[106:107], v119 offset:20480
v_mfma_f32_16x16x32_bf16 v[176:179], a[68:71], a[116:119], v[176:179]
ds_read_b64_tr_b16 a[108:109], v119 offset:24576
ds_read_b64_tr_b16 a[110:111], v119 offset:28672
v_mfma_f32_16x16x32_bf16 v[180:183], a[72:75], a[112:115], v[180:183]
buffer_load_dwordx4 v114, s[52:55], s89 offen offset:2048 lds
v_mfma_f32_16x16x32_bf16 v[180:183], a[76:79], a[116:119], v[180:183]
s_waitcnt lgkmcnt(4)
v_mfma_f32_16x16x32_bf16 v[128:131], a[64:67], a[120:123], v[128:131]
buffer_load_dwordx4 v115, s[52:55], s89 offen offset:3072 lds
v_mfma_f32_16x16x32_bf16 v[128:131], a[68:71], a[124:127], v[128:131]
s_add_u32 s89, s89, 114688
s_add_u32 s19, s19, 4
s_cmp_lg_u32 s3, 0
s_cbranch_scc1 Lrd95
v_mov_b32 v48, 0
s_mov_b64 exec, 1
buffer_atomic_add v48, off, s[60:63], s19 sc0 sc1
s_mov_b64 exec, -1
Lrd95:
v_mfma_f32_16x16x32_bf16 v[132:135], a[72:75], a[120:123], v[132:135]
s_waitcnt vmcnt(16) lgkmcnt(0)
v_mfma_f32_16x16x32_bf16 v[132:135], a[76:79], a[124:127], v[132:135]
s_barrier
v_mfma_f32_16x16x32_bf16 v[152:155], a[96:99], a[80:83], v[152:155]
ds_read_b64_tr_b16 a[64:65], v116 offset:32768
ds_read_b64_tr_b16 a[66:67], v116 offset:36864
v_mfma_f32_16x16x32_bf16 v[152:155], a[100:103], a[84:87], v[152:155]
ds_read_b64_tr_b16 a[68:69], v116 offset:40960
ds_read_b64_tr_b16 a[70:71], v116 offset:45056
v_mfma_f32_16x16x32_bf16 v[156:159], a[104:107], a[80:83], v[156:159]
s_add_u32 m0, s4, 49152
ds_read_b64_tr_b16 a[72:73], v117 offset:32768
ds_read_b64_tr_b16 a[74:75], v117 offset:36864
v_mfma_f32_16x16x32_bf16 v[156:159], a[108:111], a[84:87], v[156:159]
buffer_load_dwordx4 v16, s[60:63], s90 offen offset:0 sc1 lds
v_mfma_f32_16x16x32_bf16 v[168:171], a[96:99], a[88:91], v[168:171]
ds_read_b64_tr_b16 a[76:77], v117 offset:40960
ds_read_b64_tr_b16 a[78:79], v117 offset:45056
v_mfma_f32_16x16x32_bf16 v[168:171], a[100:103], a[92:95], v[168:171]
ds_read_b128 a[80:83], v23 offset:1024
v_mfma_f32_16x16x32_bf16 v[172:175], a[104:107], a[88:91], v[172:175]
ds_read_b128 a[84:87], v23 offset:5120
v_mfma_f32_16x16x32_bf16 v[172:175], a[108:111], a[92:95], v[172:175]
buffer_load_dwordx4 v17, s[60:63], s90 offen offset:1024 sc1 lds
v_mfma_f32_16x16x32_bf16 v[184:187], a[96:99], a[112:115], v[184:187]
ds_read_b128 a[88:91], v23 offset:2048
v_mfma_f32_16x16x32_bf16 v[184:187], a[100:103], a[116:119], v[184:187]
ds_read_b128 a[92:95], v23 offset:6144
v_mfma_f32_16x16x32_bf16 v[188:191], a[104:107], a[112:115], v[188:191]
v_mfma_f32_16x16x32_bf16 v[188:191], a[108:111], a[116:119], v[188:191]
buffer_load_dwordx4 v18, s[60:63], s90 offen offset:2048 sc1 lds
v_mfma_f32_16x16x32_bf16 v[136:139], a[96:99], a[120:123], v[136:139]
v_mfma_f32_16x16x32_bf16 v[136:139], a[100:103], a[124:127], v[136:139]
s_waitcnt lgkmcnt(0)
v_mfma_f32_16x16x32_bf16 v[140:143], a[104:107], a[120:123], v[140:143]
buffer_load_dwordx4 v19, s[60:63], s90 offen offset:3072 sc1 lds
v_mfma_f32_16x16x32_bf16 v[140:143], a[108:111], a[124:127], v[140:143]
s_add_u32 s90, s90, 8192
v_mfma_f32_16x16x32_bf16 v[144:147], a[64:67], a[80:83], v[144:147]
ds_read_b128 a[112:115], v23 offset:3072
v_mfma_f32_16x16x32_bf16 v[144:147], a[68:71], a[84:87], v[144:147]
ds_read_b128 a[116:119], v23 offset:7168
v_mfma_f32_16x16x32_bf16 v[148:151], a[72:75], a[80:83], v[148:151]
s_add_u32 m0, s86, 65536
ds_read_b128 a[120:123], v23 offset:0
v_mfma_f32_16x16x32_bf16 v[148:151], a[76:79], a[84:87], v[148:151]
buffer_load_dwordx4 v112, s[52:55], s89 offen offset:0 lds
v_mfma_f32_16x16x32_bf16 v[160:163], a[64:67], a[88:91], v[160:163]
ds_read_b128 a[124:127], v23 offset:4096
v_mfma_f32_16x16x32_bf16 v[160:163], a[68:71], a[92:95], v[160:163]
ds_read_b64_tr_b16 a[96:97], v118 offset:32768
ds_read_b64_tr_b16 a[98:99], v118 offset:36864
v_mfma_f32_16x16x32_bf16 v[164:167], a[72:75], a[88:91], v[164:167]
s_waitcnt lgkmcnt(3)
ds_read_b64_tr_b16 a[100:101], v118 offset:40960
ds_read_b64_tr_b16 a[102:103], v118 offset:45056
v_mfma_f32_16x16x32_bf16 v[164:167], a[76:79], a[92:95], v[164:167]
buffer_load_dwordx4 v113, s[52:55], s89 offen offset:1024 lds
v_mfma_f32_16x16x32_bf16 v[176:179], a[64:67], a[112:115], v[176:179]
ds_read_b64_tr_b16 a[104:105], v119 offset:32768
ds_read_b64_tr_b16 a[106:107], v119 offset:36864
v_mfma_f32_16x16x32_bf16 v[176:179], a[68:71], a[116:119], v[176:179]
ds_read_b64_tr_b16 a[108:109], v119 offset:40960
ds_read_b64_tr_b16 a[110:111], v119 offset:45056
v_mfma_f32_16x16x32_bf16 v[180:183], a[72:75], a[112:115], v[180:183]
buffer_load_dwordx4 v114, s[52:55], s89 offen offset:2048 lds
v_mfma_f32_16x16x32_bf16 v[180:183], a[76:79], a[116:119], v[180:183]
s_waitcnt lgkmcnt(4)
v_mfma_f32_16x16x32_bf16 v[128:131], a[64:67], a[120:123], v[128:131]
buffer_load_dwordx4 v115, s[52:55], s89 offen offset:3072 lds
v_mfma_f32_16x16x32_bf16 v[128:131], a[68:71], a[124:127], v[128:131]
s_cmp_lg_u32 s3, 0
s_cbranch_scc1 Lone96
s_mov_b32 s83, 0x20000
s_mov_b64 exec, 1
s_waitcnt vmcnt(8)
Lsp97:
v_cmp_gt_u32 vcc, 4, v48
s_sub_u32 s83, s83, 1
s_cbranch_vccz Ldn98
s_cbranch_scc1 Ldn98
v_mov_b32 v48, 0
buffer_atomic_add v48, off, s[60:63], s19 sc0 sc1
s_waitcnt vmcnt(0)
s_branch Lsp97
Ldn98:
s_mov_b64 exec, -1
Lone96:
v_mfma_f32_16x16x32_bf16 v[132:135], a[72:75], a[120:123], v[132:135]
s_waitcnt vmcnt(20) lgkmcnt(0)
v_mfma_f32_16x16x32_bf16 v[132:135], a[76:79], a[124:127], v[132:135]
s_barrier
v_mfma_f32_16x16x32_bf16 v[152:155], a[96:99], a[80:83], v[152:155]
ds_read_b64_tr_b16 a[64:65], v116 offset:49152
ds_read_b64_tr_b16 a[66:67], v116 offset:53248
v_mfma_f32_16x16x32_bf16 v[152:155], a[100:103], a[84:87], v[152:155]
ds_read_b64_tr_b16 a[68:69], v116 offset:57344
ds_read_b64_tr_b16 a[70:71], v116 offset:61440
v_mfma_f32_16x16x32_bf16 v[156:159], a[104:107], a[80:83], v[156:159]
s_add_u32 m0, s4, 0
ds_read_b64_tr_b16 a[72:73], v117 offset:49152
ds_read_b64_tr_b16 a[74:75], v117 offset:53248
v_mfma_f32_16x16x32_bf16 v[156:159], a[108:111], a[84:87], v[156:159]
buffer_load_dwordx4 v16, s[60:63], s90 offen offset:0 sc1 lds
v_mfma_f32_16x16x32_bf16 v[168:171], a[96:99], a[88:91], v[168:171]
ds_read_b64_tr_b16 a[76:77], v117 offset:57344
ds_read_b64_tr_b16 a[78:79], v117 offset:61440
v_mfma_f32_16x16x32_bf16 v[168:171], a[100:103], a[92:95], v[168:171]
ds_read_b128 a[80:83], v23 offset:17408
v_and_b32 v10, 15, v1
v_mfma_f32_16x16x32_bf16 v[172:175], a[104:107], a[88:91], v[172:175]
ds_read_b128 a[84:87], v23 offset:21504
v_xor_b32 v8, v10, v3
v_mfma_f32_16x16x32_bf16 v[172:175], a[108:111], a[92:95], v[172:175]
buffer_load_dwordx4 v17, s[60:63], s90 offen offset:1024 sc1 lds
v_mfma_f32_16x16x32_bf16 v[184:187], a[96:99], a[112:115], v[184:187]
ds_read_b128 a[88:91], v23 offset:18432
v_lshlrev_b32 v8, 4, v8
v_mfma_f32_16x16x32_bf16 v[184:187], a[100:103], a[116:119], v[184:187]
ds_read_b128 a[92:95], v23 offset:22528
v_add_u32 v8, 98304, v8
v_mfma_f32_16x16x32_bf16 v[188:191], a[104:107], a[112:115], v[188:191]
v_lshl_add_u32 v9, v10, 8, v8
s_lshl_b32 s82, s3, 14
v_mfma_f32_16x16x32_bf16 v[188:191], a[108:111], a[116:119], v[188:191]
buffer_load_dwordx4 v18, s[60:63], s90 offen offset:2048 sc1 lds
v_mfma_f32_16x16x32_bf16 v[136:139], a[96:99], a[120:123], v[136:139]
v_add_u32 v9, s82, v9
v_xor_b32 v28, 0, v9
v_mfma_f32_16x16x32_bf16 v[136:139], a[100:103], a[124:127], v[136:139]
s_waitcnt lgkmcnt(0)
v_xor_b32 v29, 64, v9
v_xor_b32 v30, 128, v9
v_mfma_f32_16x16x32_bf16 v[140:143], a[104:107], a[120:123], v[140:143]
buffer_load_dwordx4 v19, s[60:63], s90 offen offset:3072 sc1 lds
v_mfma_f32_16x16x32_bf16 v[140:143], a[108:111], a[124:127], v[140:143]
s_add_u32 s90, s90, 8192
v_xor_b32 v31, 192, v9
v_lshl_add_u32 v9, v3, 8, v8
v_mfma_f32_16x16x32_bf16 v[144:147], a[64:67], a[80:83], v[144:147]
ds_read_b128 a[112:115], v23 offset:19456
v_add_u32 v9, s87, v9
v_mfma_f32_16x16x32_bf16 v[144:147], a[68:71], a[84:87], v[144:147]
ds_read_b128 a[116:119], v23 offset:23552
v_xor_b32 v32, 0, v9
v_mfma_f32_16x16x32_bf16 v[148:151], a[72:75], a[80:83], v[148:151]
s_add_u32 m0, s86, 69632
s_add_u32 s89, s89, 16384
ds_read_b128 a[120:123], v23 offset:16384
v_add_u32 v32, 0, v32
v_mfma_f32_16x16x32_bf16 v[148:151], a[76:79], a[84:87], v[148:151]
buffer_load_dwordx4 v112, s[52:55], s89 offen offset:0 lds
v_mfma_f32_16x16x32_bf16 v[160:163], a[64:67], a[88:91], v[160:163]
ds_read_b128 a[124:127], v23 offset:20480
v_xor_b32 v33, 64, v9
v_mfma_f32_16x16x32_bf16 v[160:163], a[68:71], a[92:95], v[160:163]
ds_read_b64_tr_b16 a[96:97], v118 offset:49152
ds_read_b64_tr_b16 a[98:99], v118 offset:53248
v_mfma_f32_16x16x32_bf16 v[164:167], a[72:75], a[88:91], v[164:167]
s_waitcnt lgkmcnt(3)
ds_read_b64_tr_b16 a[100:101], v118 offset:57344
ds_read_b64_tr_b16 a[102:103], v118 offset:61440
v_mfma_f32_16x16x32_bf16 v[164:167], a[76:79], a[92:95], v[164:167]
buffer_load_dwordx4 v113, s[52:55], s89 offen offset:1024 lds
v_mfma_f32_16x16x32_bf16 v[176:179], a[64:67], a[112:115], v[176:179]
ds_read_b64_tr_b16 a[104:105], v119 offset:49152
ds_read_b64_tr_b16 a[106:107], v119 offset:53248
v_mfma_f32_16x16x32_bf16 v[176:179], a[68:71], a[116:119], v[176:179]
ds_read_b64_tr_b16 a[108:109], v119 offset:57344
ds_read_b64_tr_b16 a[110:111], v119 offset:61440
v_mfma_f32_16x16x32_bf16 v[180:183], a[72:75], a[112:115], v[180:183]
buffer_load_dwordx4 v114, s[52:55], s89 offen offset:2048 lds
v_mfma_f32_16x16x32_bf16 v[180:183], a[76:79], a[116:119], v[180:183]
s_waitcnt lgkmcnt(4)
v_add_u32 v33, 1024, v33
v_xor_b32 v34, 128, v9
v_mfma_f32_16x16x32_bf16 v[128:131], a[64:67], a[120:123], v[128:131]
buffer_load_dwordx4 v115, s[52:55], s89 offen offset:3072 lds
v_mfma_f32_16x16x32_bf16 v[128:131], a[68:71], a[124:127], v[128:131]
s_add_u32 s89, s89, 114688
v_add_u32 v34, 2048, v34
v_xor_b32 v35, 192, v9
v_mfma_f32_16x16x32_bf16 v[132:135], a[72:75], a[120:123], v[132:135]
s_waitcnt vmcnt(16) lgkmcnt(0)
v_add_u32 v35, 3072, v35
v_lshlrev_b32 v36, 12, v3
v_mfma_f32_16x16x32_bf16 v[132:135], a[76:79], a[124:127], v[132:135]
s_barrier
v_mfma_f32_16x16x32_bf16 v[152:155], a[96:99], a[80:83], v[152:155]
ds_read_b64_tr_b16 a[64:65], v120 offset:0
ds_read_b64_tr_b16 a[66:67], v120 offset:4096
v_mfma_f32_16x16x32_bf16 v[152:155], a[100:103], a[84:87], v[152:155]
ds_read_b64_tr_b16 a[68:69], v120 offset:8192
ds_read_b64_tr_b16 a[70:71], v120 offset:12288
v_mfma_f32_16x16x32_bf16 v[156:159], a[104:107], a[80:83], v[156:159]
s_add_u32 m0, s4, 16384
ds_read_b64_tr_b16 a[72:73], v121 offset:0
ds_read_b64_tr_b16 a[74:75], v121 offset:4096
v_mfma_f32_16x16x32_bf16 v[156:159], a[108:111], a[84:87], v[156:159]
buffer_load_dwordx4 v16, s[60:63], s90 offen offset:0 sc1 lds
v_mfma_f32_16x16x32_bf16 v[168:171], a[96:99], a[88:91], v[168:171]
ds_read_b64_tr_b16 a[76:77], v121 offset:8192
ds_read_b64_tr_b16 a[78:79], v121 offset:12288
v_mfma_f32_16x16x32_bf16 v[168:171], a[100:103], a[92:95], v[168:171]
ds_read_b128 a[80:83], v23 offset:33792
v_lshl_add_u32 v36, v10, 4, v36
v_mfma_f32_16x16x32_bf16 v[172:175], a[104:107], a[88:91], v[172:175]
ds_read_b128 a[84:87], v23 offset:37888
v_lshlrev_b32 v37, 10, v3
v_mfma_f32_16x16x32_bf16 v[172:175], a[108:111], a[92:95], v[172:175]
buffer_load_dwordx4 v17, s[60:63], s90 offen offset:1024 sc1 lds
v_mfma_f32_16x16x32_bf16 v[184:187], a[96:99], a[112:115], v[184:187]
ds_read_b128 a[88:91], v23 offset:34816
v_lshl_add_u32 v37, v10, 3, v37
v_mfma_f32_16x16x32_bf16 v[184:187], a[100:103], a[116:119], v[184:187]
s_lshl_b32 s82, s78, 2
ds_read_b128 a[92:95], v23 offset:38912
s_add_u32 s82, s82, s3
v_mfma_f32_16x16x32_bf16 v[188:191], a[104:107], a[112:115], v[188:191]
s_lshl_b32 s91, s82, 16
s_lshl_b32 s83, s77, 8
s_add_u32 s91, s91, s83
v_mfma_f32_16x16x32_bf16 v[188:191], a[108:111], a[116:119], v[188:191]
buffer_load_dwordx4 v18, s[60:63], s90 offen offset:2048 sc1 lds
v_mfma_f32_16x16x32_bf16 v[136:139], a[96:99], a[120:123], v[136:139]
s_lshl_b32 s92, s82, 14
s_lshl_b32 s83, s77, 7
s_add_u32 s92, s92, s83
v_mfma_f32_16x16x32_bf16 v[136:139], a[100:103], a[124:127], v[136:139]
s_waitcnt lgkmcnt(0)
v_lshlrev_b32 v8, 3, v10
v_add_u32 v8, s83, v8
v_mfma_f32_16x16x32_bf16 v[140:143], a[104:107], a[120:123], v[140:143]
buffer_load_dwordx4 v19, s[60:63], s90 offen offset:3072 sc1 lds
v_mfma_f32_16x16x32_bf16 v[140:143], a[108:111], a[124:127], v[140:143]
s_add_u32 s90, s90, 8192
s_mov_b32 s48, s34
s_and_b32 s49, s35, 0xffff
v_mfma_f32_16x16x32_bf16 v[144:147], a[64:67], a[80:83], v[144:147]
s_mov_b32 s50, 0x800000
ds_read_b128 a[112:115], v23 offset:35840
s_mov_b32 s51, 0x20000
v_mfma_f32_16x16x32_bf16 v[144:147], a[68:71], a[84:87], v[144:147]
ds_read_b128 a[116:119], v23 offset:39936
v_mfma_f32_16x16x32_bf16 v[148:151], a[72:75], a[80:83], v[148:151]
s_add_u32 m0, s86, 98304
ds_read_b128 a[120:123], v23 offset:32768
v_mfma_f32_16x16x32_bf16 v[148:151], a[76:79], a[84:87], v[148:151]
buffer_load_dwordx4 v112, s[52:55], s89 offen offset:0 lds
v_mfma_f32_16x16x32_bf16 v[160:163], a[64:67], a[88:91], v[160:163]
ds_read_b128 a[124:127], v23 offset:36864
v_mfma_f32_16x16x32_bf16 v[160:163], a[68:71], a[92:95], v[160:163]
ds_read_b64_tr_b16 a[96:97], v122 offset:0
ds_read_b64_tr_b16 a[98:99], v122 offset:4096
v_mfma_f32_16x16x32_bf16 v[164:167], a[72:75], a[88:91], v[164:167]
s_waitcnt lgkmcnt(3)
ds_read_b64_tr_b16 a[100:101], v122 offset:8192
ds_read_b64_tr_b16 a[102:103], v122 offset:12288
v_mfma_f32_16x16x32_bf16 v[164:167], a[76:79], a[92:95], v[164:167]
buffer_load_dwordx4 v113, s[52:55], s89 offen offset:1024 lds
v_mfma_f32_16x16x32_bf16 v[176:179], a[64:67], a[112:115], v[176:179]
ds_read_b64_tr_b16 a[104:105], v123 offset:0
ds_read_b64_tr_b16 a[106:107], v123 offset:4096
v_mfma_f32_16x16x32_bf16 v[176:179], a[68:71], a[116:119], v[176:179]
ds_read_b64_tr_b16 a[108:109], v123 offset:8192
ds_read_b64_tr_b16 a[110:111], v123 offset:12288
v_mfma_f32_16x16x32_bf16 v[180:183], a[72:75], a[112:115], v[180:183]
buffer_load_dwordx4 v114, s[52:55], s89 offen offset:2048 lds
v_mfma_f32_16x16x32_bf16 v[180:183], a[76:79], a[116:119], v[180:183]
global_load_dwordx2 v[56:57], v8, s[20:21]
v_mfma_f32_16x16x32_bf16 v[128:131], a[64:67], a[120:123], v[128:131]
buffer_load_dwordx4 v115, s[52:55], s89 offen offset:3072 lds
s_waitcnt lgkmcnt(2)
v_mfma_f32_16x16x32_bf16 v[128:131], a[68:71], a[124:127], v[128:131]
buffer_load_dwordx2 v[40:41], v37, s[40:43], s92 offen
v_mfma_f32_16x16x32_bf16 v[132:135], a[72:75], a[120:123], v[132:135]
s_waitcnt vmcnt(22) lgkmcnt(0)
s_add_u32 s92, s92, 4096
v_mfma_f32_16x16x32_bf16 v[132:135], a[76:79], a[124:127], v[132:135]
s_barrier
v_mfma_f32_16x16x32_bf16 v[152:155], a[96:99], a[80:83], v[152:155]
ds_read_b64_tr_b16 a[64:65], v120 offset:16384
ds_read_b64_tr_b16 a[66:67], v120 offset:20480
v_mfma_f32_16x16x32_bf16 v[152:155], a[100:103], a[84:87], v[152:155]
ds_read_b64_tr_b16 a[68:69], v120 offset:24576
ds_read_b64_tr_b16 a[70:71], v120 offset:28672
v_mfma_f32_16x16x32_bf16 v[156:159], a[104:107], a[80:83], v[156:159]
s_add_u32 m0, s4, 32768
ds_read_b64_tr_b16 a[72:73], v121 offset:16384
ds_read_b64_tr_b16 a[74:75], v121 offset:20480
v_mfma_f32_16x16x32_bf16 v[156:159], a[108:111], a[84:87], v[156:159]
buffer_load_dwordx4 v16, s[60:63], s90 offen offset:0 sc1 lds
v_mfma_f32_16x16x32_bf16 v[168:171], a[96:99], a[88:91], v[168:171]
Lcp99:
s_add_u32 s9, s95, Lcp99-L_pc+3072
ds_read_b64_tr_b16 a[76:77], v121 offset:24576
ds_read_b64_tr_b16 a[78:79], v121 offset:28672
v_mfma_f32_16x16x32_bf16 v[168:171], a[100:103], a[92:95], v[168:171]
buffer_load_dword v15, off, s[64:67], s9
ds_read_b128 a[80:83], v23 offset:50176
v_mfma_f32_16x16x32_bf16 v[172:175], a[104:107], a[88:91], v[172:175]
ds_read_b128 a[84:87], v23 offset:54272
v_mfma_f32_16x16x32_bf16 v[172:175], a[108:111], a[92:95], v[172:175]
buffer_load_dwordx4 v17, s[60:63], s90 offen offset:1024 sc1 lds
v_mfma_f32_16x16x32_bf16 v[184:187], a[96:99], a[112:115], v[184:187]
ds_read_b128 a[88:91], v23 offset:51200
v_mfma_f32_16x16x32_bf16 v[184:187], a[100:103], a[116:119], v[184:187]
ds_read_b128 a[92:95], v23 offset:55296
v_mfma_f32_16x16x32_bf16 v[188:191], a[104:107], a[112:115], v[188:191]
buffer_load_dwordx2 v[42:43], v37, s[40:43], s92 offen
v_mfma_f32_16x16x32_bf16 v[188:191], a[108:111], a[116:119], v[188:191]
buffer_load_dwordx4 v18, s[60:63], s90 offen offset:2048 sc1 lds
v_mfma_f32_16x16x32_bf16 v[136:139], a[96:99], a[120:123], v[136:139]
s_add_u32 s92, s92, 4096
v_mfma_f32_16x16x32_bf16 v[136:139], a[100:103], a[124:127], v[136:139]
buffer_load_dwordx2 v[44:45], v37, s[40:43], s92 offen
v_mfma_f32_16x16x32_bf16 v[140:143], a[104:107], a[120:123], v[140:143]
buffer_load_dwordx4 v19, s[60:63], s90 offen offset:3072 sc1 lds
v_mfma_f32_16x16x32_bf16 v[140:143], a[108:111], a[124:127], v[140:143]
s_add_u32 s90, s90, 8192
s_add_u32 s92, s92, 4096
s_waitcnt lgkmcnt(0)
v_mfma_f32_16x16x32_bf16 v[144:147], a[64:67], a[80:83], v[144:147]
ds_read_b128 a[112:115], v23 offset:52224
v_mfma_f32_16x16x32_bf16 v[144:147], a[68:71], a[84:87], v[144:147]
ds_read_b128 a[116:119], v23 offset:56320
v_mfma_f32_16x16x32_bf16 v[148:151], a[72:75], a[80:83], v[148:151]
s_add_u32 m0, s86, 102400
s_add_u32 s89, s89, 16384
ds_read_b128 a[120:123], v23 offset:49152
v_mfma_f32_16x16x32_bf16 v[148:151], a[76:79], a[84:87], v[148:151]
buffer_load_dwordx4 v112, s[52:55], s89 offen offset:0 lds
v_mfma_f32_16x16x32_bf16 v[160:163], a[64:67], a[88:91], v[160:163]
ds_read_b128 a[124:127], v23 offset:53248
v_mfma_f32_16x16x32_bf16 v[160:163], a[68:71], a[92:95], v[160:163]
ds_read_b64_tr_b16 a[96:97], v122 offset:16384
ds_read_b64_tr_b16 a[98:99], v122 offset:20480
v_mfma_f32_16x16x32_bf16 v[164:167], a[72:75], a[88:91], v[164:167]
s_waitcnt lgkmcnt(3)
ds_read_b64_tr_b16 a[100:101], v122 offset:24576
ds_read_b64_tr_b16 a[102:103], v122 offset:28672
v_mfma_f32_16x16x32_bf16 v[164:167], a[76:79], a[92:95], v[164:167]
buffer_load_dwordx4 v113, s[52:55], s89 offen offset:1024 lds
v_mfma_f32_16x16x32_bf16 v[176:179], a[64:67], a[112:115], v[176:179]
ds_read_b64_tr_b16 a[104:105], v123 offset:16384
ds_read_b64_tr_b16 a[106:107], v123 offset:20480
v_mfma_f32_16x16x32_bf16 v[176:179], a[68:71], a[116:119], v[176:179]
ds_read_b64_tr_b16 a[108:109], v123 offset:24576
ds_read_b64_tr_b16 a[110:111], v123 offset:28672
v_mfma_f32_16x16x32_bf16 v[180:183], a[72:75], a[112:115], v[180:183]
buffer_load_dwordx4 v114, s[52:55], s89 offen offset:2048 lds
v_mfma_f32_16x16x32_bf16 v[180:183], a[76:79], a[116:119], v[180:183]
buffer_load_dwordx2 v[46:47], v37, s[40:43], s92 offen
v_mfma_f32_16x16x32_bf16 v[128:131], a[64:67], a[120:123], v[128:131]
buffer_load_dwordx4 v115, s[52:55], s89 offen offset:3072 lds
s_waitcnt lgkmcnt(2)
v_mfma_f32_16x16x32_bf16 v[128:131], a[68:71], a[124:127], v[128:131]
s_add_u32 s89, s89, 114688
v_mfma_f32_16x16x32_bf16 v[132:135], a[72:75], a[120:123], v[132:135]
s_waitcnt vmcnt(22) lgkmcnt(0)
v_mfma_f32_16x16x32_bf16 v[132:135], a[76:79], a[124:127], v[132:135]
s_barrier
v_mfma_f32_16x16x32_bf16 v[152:155], a[96:99], a[80:83], v[152:155]
ds_read_b64_tr_b16 a[64:65], v116 offset:0
ds_read_b64_tr_b16 a[66:67], v116 offset:4096
v_mfma_f32_16x16x32_bf16 v[152:155], a[100:103], a[84:87], v[152:155]
ds_read_b64_tr_b16 a[68:69], v116 offset:8192
ds_read_b64_tr_b16 a[70:71], v116 offset:12288
v_mfma_f32_16x16x32_bf16 v[156:159], a[104:107], a[80:83], v[156:159]
s_add_u32 m0, s4, 49152
ds_read_b64_tr_b16 a[72:73], v117 offset:0
ds_read_b64_tr_b16 a[74:75], v117 offset:4096
v_mfma_f32_16x16x32_bf16 v[156:159], a[108:111], a[84:87], v[156:159]
buffer_load_dwordx4 v16, s[60:63], s90 offen offset:0 sc1 lds
v_mfma_f32_16x16x32_bf16 v[168:171], a[96:99], a[88:91], v[168:171]
ds_read_b64_tr_b16 a[76:77], v117 offset:8192
ds_read_b64_tr_b16 a[78:79], v117 offset:12288
v_mfma_f32_16x16x32_bf16 v[168:171], a[100:103], a[92:95], v[168:171]
ds_read_b128 a[80:83], v23 offset:1024
v_mfma_f32_16x16x32_bf16 v[172:175], a[104:107], a[88:91], v[172:175]
ds_read_b128 a[84:87], v23 offset:5120
v_mfma_f32_16x16x32_bf16 v[172:175], a[108:111], a[92:95], v[172:175]
buffer_load_dwordx4 v17, s[60:63], s90 offen offset:1024 sc1 lds
v_mfma_f32_16x16x32_bf16 v[184:187], a[96:99], a[112:115], v[184:187]
ds_read_b128 a[88:91], v23 offset:2048
v_mfma_f32_16x16x32_bf16 v[184:187], a[100:103], a[116:119], v[184:187]
ds_read_b128 a[92:95], v23 offset:6144
v_mfma_f32_16x16x32_bf16 v[188:191], a[104:107], a[112:115], v[188:191]
v_mfma_f32_16x16x32_bf16 v[188:191], a[108:111], a[116:119], v[188:191]
buffer_load_dwordx4 v18, s[60:63], s90 offen offset:2048 sc1 lds
v_mfma_f32_16x16x32_bf16 v[136:139], a[96:99], a[120:123], v[136:139]
v_mfma_f32_16x16x32_bf16 v[136:139], a[100:103], a[124:127], v[136:139]
s_waitcnt lgkmcnt(0)
v_mfma_f32_16x16x32_bf16 v[140:143], a[104:107], a[120:123], v[140:143]
buffer_load_dwordx4 v19, s[60:63], s90 offen offset:3072 sc1 lds
v_mfma_f32_16x16x32_bf16 v[140:143], a[108:111], a[124:127], v[140:143]
s_add_u32 s90, s90, 8192
v_mfma_f32_16x16x32_bf16 v[144:147], a[64:67], a[80:83], v[144:147]
ds_read_b128 a[112:115], v23 offset:3072
v_mfma_f32_16x16x32_bf16 v[144:147], a[68:71], a[84:87], v[144:147]
ds_read_b128 a[116:119], v23 offset:7168
v_mfma_f32_16x16x32_bf16 v[148:151], a[72:75], a[80:83], v[148:151]
s_add_u32 m0, s86, 131072
ds_read_b128 a[120:123], v23 offset:0
v_mfma_f32_16x16x32_bf16 v[148:151], a[76:79], a[84:87], v[148:151]
buffer_load_dwordx4 v112, s[52:55], s89 offen offset:0 lds
v_mfma_f32_16x16x32_bf16 v[160:163], a[64:67], a[88:91], v[160:163]
ds_read_b128 a[124:127], v23 offset:4096
v_mfma_f32_16x16x32_bf16 v[160:163], a[68:71], a[92:95], v[160:163]
ds_read_b64_tr_b16 a[96:97], v118 offset:0
ds_read_b64_tr_b16 a[98:99], v118 offset:4096
v_mfma_f32_16x16x32_bf16 v[164:167], a[72:75], a[88:91], v[164:167]
s_waitcnt lgkmcnt(3)
ds_read_b64_tr_b16 a[100:101], v118 offset:8192
ds_read_b64_tr_b16 a[102:103], v118 offset:12288
v_mfma_f32_16x16x32_bf16 v[164:167], a[76:79], a[92:95], v[164:167]
buffer_load_dwordx4 v113, s[52:55], s89 offen offset:1024 lds
v_mfma_f32_16x16x32_bf16 v[176:179], a[64:67], a[112:115], v[176:179]
ds_read_b64_tr_b16 a[104:105], v119 offset:0
ds_read_b64_tr_b16 a[106:107], v119 offset:4096
v_mfma_f32_16x16x32_bf16 v[176:179], a[68:71], a[116:119], v[176:179]
ds_read_b64_tr_b16 a[108:109], v119 offset:8192
ds_read_b64_tr_b16 a[110:111], v119 offset:12288
v_mfma_f32_16x16x32_bf16 v[180:183], a[72:75], a[112:115], v[180:183]
buffer_load_dwordx4 v114, s[52:55], s89 offen offset:2048 lds
v_mfma_f32_16x16x32_bf16 v[180:183], a[76:79], a[116:119], v[180:183]
s_waitcnt lgkmcnt(4)
v_mfma_f32_16x16x32_bf16 v[128:131], a[64:67], a[120:123], v[128:131]
buffer_load_dwordx4 v115, s[52:55], s89 offen offset:3072 lds
v_mfma_f32_16x16x32_bf16 v[128:131], a[68:71], a[124:127], v[128:131]
v_mfma_f32_16x16x32_bf16 v[132:135], a[72:75], a[120:123], v[132:135]
s_waitcnt vmcnt(26) lgkmcnt(0)
v_mfma_f32_16x16x32_bf16 v[132:135], a[76:79], a[124:127], v[132:135]
s_barrier
v_mfma_f32_16x16x32_bf16 v[152:155], a[96:99], a[80:83], v[152:155]
ds_read_b64_tr_b16 a[64:65], v116 offset:16384
ds_read_b64_tr_b16 a[66:67], v116 offset:20480
v_mfma_f32_16x16x32_bf16 v[152:155], a[100:103], a[84:87], v[152:155]
ds_read_b64_tr_b16 a[68:69], v116 offset:24576
ds_read_b64_tr_b16 a[70:71], v116 offset:28672
v_mfma_f32_16x16x32_bf16 v[156:159], a[104:107], a[80:83], v[156:159]
s_add_u32 m0, s4, 0
ds_read_b64_tr_b16 a[72:73], v117 offset:16384
ds_read_b64_tr_b16 a[74:75], v117 offset:20480
v_mfma_f32_16x16x32_bf16 v[156:159], a[108:111], a[84:87], v[156:159]
buffer_load_dwordx4 v16, s[60:63], s90 offen offset:0 sc1 lds
v_mfma_f32_16x16x32_bf16 v[168:171], a[96:99], a[88:91], v[168:171]
ds_read_b64_tr_b16 a[76:77], v117 offset:24576
ds_read_b64_tr_b16 a[78:79], v117 offset:28672
v_mfma_f32_16x16x32_bf16 v[168:171], a[100:103], a[92:95], v[168:171]
ds_read_b128 a[80:83], v23 offset:17408
v_mfma_f32_16x16x32_bf16 v[172:175], a[104:107], a[88:91], v[172:175]
ds_read_b128 a[84:87], v23 offset:21504
v_mfma_f32_16x16x32_bf16 v[172:175], a[108:111], a[92:95], v[172:175]
buffer_load_dwordx4 v17, s[60:63], s90 offen offset:1024 sc1 lds
v_mfma_f32_16x16x32_bf16 v[184:187], a[96:99], a[112:115], v[184:187]
ds_read_b128 a[88:91], v23 offset:18432
v_mfma_f32_16x16x32_bf16 v[184:187], a[100:103], a[116:119], v[184:187]
ds_read_b128 a[92:95], v23 offset:22528
v_mfma_f32_16x16x32_bf16 v[188:191], a[104:107], a[112:115], v[188:191]
v_mfma_f32_16x16x32_bf16 v[188:191], a[108:111], a[116:119], v[188:191]
buffer_load_dwordx4 v18, s[60:63], s90 offen offset:2048 sc1 lds
v_mfma_f32_16x16x32_bf16 v[136:139], a[96:99], a[120:123], v[136:139]
v_mfma_f32_16x16x32_bf16 v[136:139], a[100:103], a[124:127], v[136:139]
s_waitcnt lgkmcnt(0)
v_mfma_f32_16x16x32_bf16 v[140:143], a[104:107], a[120:123], v[140:143]
buffer_load_dwordx4 v19, s[60:63], s90 offen offset:3072 sc1 lds
v_mfma_f32_16x16x32_bf16 v[140:143], a[108:111], a[124:127], v[140:143]
s_add_u32 s90, s90, 8192
v_mfma_f32_16x16x32_bf16 v[144:147], a[64:67], a[80:83], v[144:147]
ds_read_b128 a[112:115], v23 offset:19456
v_mfma_f32_16x16x32_bf16 v[144:147], a[68:71], a[84:87], v[144:147]
ds_read_b128 a[116:119], v23 offset:23552
v_mfma_f32_16x16x32_bf16 v[148:151], a[72:75], a[80:83], v[148:151]
s_add_u32 m0, s86, 135168
s_add_u32 s89, s89, 16384
ds_read_b128 a[120:123], v23 offset:16384
v_mfma_f32_16x16x32_bf16 v[148:151], a[76:79], a[84:87], v[148:151]
buffer_load_dwordx4 v112, s[52:55], s89 offen offset:0 lds
v_mfma_f32_16x16x32_bf16 v[160:163], a[64:67], a[88:91], v[160:163]
ds_read_b128 a[124:127], v23 offset:20480
v_mfma_f32_16x16x32_bf16 v[160:163], a[68:71], a[92:95], v[160:163]
ds_read_b64_tr_b16 a[96:97], v118 offset:16384
ds_read_b64_tr_b16 a[98:99], v118 offset:20480
v_mfma_f32_16x16x32_bf16 v[164:167], a[72:75], a[88:91], v[164:167]
s_waitcnt lgkmcnt(3)
ds_read_b64_tr_b16 a[100:101], v118 offset:24576
ds_read_b64_tr_b16 a[102:103], v118 offset:28672
v_mfma_f32_16x16x32_bf16 v[164:167], a[76:79], a[92:95], v[164:167]
buffer_load_dwordx4 v113, s[52:55], s89 offen offset:1024 lds
v_mfma_f32_16x16x32_bf16 v[176:179], a[64:67], a[112:115], v[176:179]
ds_read_b64_tr_b16 a[104:105], v119 offset:16384
ds_read_b64_tr_b16 a[106:107], v119 offset:20480
v_mfma_f32_16x16x32_bf16 v[176:179], a[68:71], a[116:119], v[176:179]
ds_read_b64_tr_b16 a[108:109], v119 offset:24576
ds_read_b64_tr_b16 a[110:111], v119 offset:28672
v_mfma_f32_16x16x32_bf16 v[180:183], a[72:75], a[112:115], v[180:183]
buffer_load_dwordx4 v114, s[52:55], s89 offen offset:2048 lds
v_mfma_f32_16x16x32_bf16 v[180:183], a[76:79], a[116:119], v[180:183]
s_waitcnt lgkmcnt(4)
v_mfma_f32_16x16x32_bf16 v[128:131], a[64:67], a[120:123], v[128:131]
buffer_load_dwordx4 v115, s[52:55], s89 offen offset:3072 lds
v_mfma_f32_16x16x32_bf16 v[128:131], a[68:71], a[124:127], v[128:131]
s_add_u32 s89, s89, 114688
s_waitcnt vmcnt(17)
v_lshlrev_b32 v58, 16, v56
v_mfma_f32_16x16x32_bf16 v[132:135], a[72:75], a[120:123], v[132:135]
s_waitcnt vmcnt(16) lgkmcnt(0)
v_and_b32 v59, 0xffff0000, v56
v_lshlrev_b32 v60, 16, v57
v_mfma_f32_16x16x32_bf16 v[132:135], a[76:79], a[124:127], v[132:135]
s_barrier
v_mfma_f32_16x16x32_bf16 v[152:155], a[96:99], a[80:83], v[152:155]
ds_read_b64_tr_b16 a[64:65], v116 offset:32768
ds_read_b64_tr_b16 a[66:67], v116 offset:36864
v_mfma_f32_16x16x32_bf16 v[152:155], a[100:103], a[84:87], v[152:155]
ds_read_b64_tr_b16 a[68:69], v116 offset:40960
ds_read_b64_tr_b16 a[70:71], v116 offset:45056
v_mfma_f32_16x16x32_bf16 v[156:159], a[104:107], a[80:83], v[156:159]
s_add_u32 m0, s4, 16384
ds_read_b64_tr_b16 a[72:73], v117 offset:32768
ds_read_b64_tr_b16 a[74:75], v117 offset:36864
v_mfma_f32_16x16x32_bf16 v[156:159], a[108:111], a[84:87], v[156:159]
buffer_load_dwordx4 v16, s[60:63], s90 offen offset:0 sc1 lds
v_mfma_f32_16x16x32_bf16 v[168:171], a[96:99], a[88:91], v[168:171]
ds_read_b64_tr_b16 a[76:77], v117 offset:40960
ds_read_b64_tr_b16 a[78:79], v117 offset:45056
v_mfma_f32_16x16x32_bf16 v[168:171], a[100:103], a[92:95], v[168:171]
ds_read_b128 a[80:83], v23 offset:33792
v_and_b32 v61, 0xffff0000, v57
v_mfma_f32_16x16x32_bf16 v[172:175], a[104:107], a[88:91], v[172:175]
ds_read_b128 a[84:87], v23 offset:37888
v_lshlrev_b32 v8, 16, v40
v_mfma_f32_16x16x32_bf16 v[172:175], a[108:111], a[92:95], v[172:175]
buffer_load_dwordx4 v17, s[60:63], s90 offen offset:1024 sc1 lds
v_mfma_f32_16x16x32_bf16 v[184:187], a[96:99], a[112:115], v[184:187]
ds_read_b128 a[88:91], v23 offset:34816
v_and_b32 v9, 0xffff0000, v40
v_mfma_f32_16x16x32_bf16 v[184:187], a[100:103], a[116:119], v[184:187]
ds_read_b128 a[92:95], v23 offset:38912
v_lshlrev_b32 v10, 16, v41
v_mfma_f32_16x16x32_bf16 v[188:191], a[104:107], a[112:115], v[188:191]
v_and_b32 v11, 0xffff0000, v41
v_mul_f32 v8, v8, v58
v_mfma_f32_16x16x32_bf16 v[188:191], a[108:111], a[116:119], v[188:191]
buffer_load_dwordx4 v18, s[60:63], s90 offen offset:2048 sc1 lds
v_mfma_f32_16x16x32_bf16 v[136:139], a[96:99], a[120:123], v[136:139]
v_mul_f32 v9, v9, v59
v_mul_f32 v10, v10, v60
v_mfma_f32_16x16x32_bf16 v[136:139], a[100:103], a[124:127], v[136:139]
s_waitcnt lgkmcnt(0)
v_mul_f32 v11, v11, v61
v_cvt_pk_bf16_f32 v40, v8, v9
v_mfma_f32_16x16x32_bf16 v[140:143], a[104:107], a[120:123], v[140:143]
buffer_load_dwordx4 v19, s[60:63], s90 offen offset:3072 sc1 lds
v_mfma_f32_16x16x32_bf16 v[140:143], a[108:111], a[124:127], v[140:143]
s_add_u32 s90, s90, 8192
v_cvt_pk_bf16_f32 v41, v10, v11
v_lshlrev_b32 v8, 16, v42
v_mfma_f32_16x16x32_bf16 v[144:147], a[64:67], a[80:83], v[144:147]
ds_read_b128 a[112:115], v23 offset:35840
v_and_b32 v9, 0xffff0000, v42
v_mfma_f32_16x16x32_bf16 v[144:147], a[68:71], a[84:87], v[144:147]
ds_read_b128 a[116:119], v23 offset:39936
v_lshlrev_b32 v10, 16, v43
v_mfma_f32_16x16x32_bf16 v[148:151], a[72:75], a[80:83], v[148:151]
s_add_u32 m0, s86, 65536
ds_read_b128 a[120:123], v23 offset:32768
v_and_b32 v11, 0xffff0000, v43
v_mfma_f32_16x16x32_bf16 v[148:151], a[76:79], a[84:87], v[148:151]
buffer_load_dwordx4 v112, s[52:55], s89 offen offset:0 lds
v_mfma_f32_16x16x32_bf16 v[160:163], a[64:67], a[88:91], v[160:163]
ds_read_b128 a[124:127], v23 offset:36864
v_mul_f32 v8, v8, v58
v_mfma_f32_16x16x32_bf16 v[160:163], a[68:71], a[92:95], v[160:163]
ds_read_b64_tr_b16 a[96:97], v118 offset:32768
ds_read_b64_tr_b16 a[98:99], v118 offset:36864
v_mfma_f32_16x16x32_bf16 v[164:167], a[72:75], a[88:91], v[164:167]
s_waitcnt lgkmcnt(3)
ds_read_b64_tr_b16 a[100:101], v118 offset:40960
ds_read_b64_tr_b16 a[102:103], v118 offset:45056
v_mfma_f32_16x16x32_bf16 v[164:167], a[76:79], a[92:95], v[164:167]
buffer_load_dwordx4 v113, s[52:55], s89 offen offset:1024 lds
v_mfma_f32_16x16x32_bf16 v[176:179], a[64:67], a[112:115], v[176:179]
ds_read_b64_tr_b16 a[104:105], v119 offset:32768
ds_read_b64_tr_b16 a[106:107], v119 offset:36864
v_mfma_f32_16x16x32_bf16 v[176:179], a[68:71], a[116:119], v[176:179]
ds_read_b64_tr_b16 a[108:109], v119 offset:40960
ds_read_b64_tr_b16 a[110:111], v119 offset:45056
v_mfma_f32_16x16x32_bf16 v[180:183], a[72:75], a[112:115], v[180:183]
buffer_load_dwordx4 v114, s[52:55], s89 offen offset:2048 lds
v_mfma_f32_16x16x32_bf16 v[180:183], a[76:79], a[116:119], v[180:183]
s_waitcnt lgkmcnt(4)
v_mul_f32 v9, v9, v59
v_mul_f32 v10, v10, v60
v_mfma_f32_16x16x32_bf16 v[128:131], a[64:67], a[120:123], v[128:131]
buffer_load_dwordx4 v115, s[52:55], s89 offen offset:3072 lds
v_mfma_f32_16x16x32_bf16 v[128:131], a[68:71], a[124:127], v[128:131]
v_mul_f32 v11, v11, v61
v_cvt_pk_bf16_f32 v42, v8, v9
v_mfma_f32_16x16x32_bf16 v[132:135], a[72:75], a[120:123], v[132:135]
s_waitcnt vmcnt(20) lgkmcnt(0)
v_cvt_pk_bf16_f32 v43, v10, v11
v_lshlrev_b32 v8, 16, v44
v_mfma_f32_16x16x32_bf16 v[132:135], a[76:79], a[124:127], v[132:135]
s_barrier
v_mfma_f32_16x16x32_bf16 v[152:155], a[96:99], a[80:83], v[152:155]
ds_read_b64_tr_b16 a[64:65], v116 offset:49152
ds_read_b64_tr_b16 a[66:67], v116 offset:53248
v_mfma_f32_16x16x32_bf16 v[152:155], a[100:103], a[84:87], v[152:155]
ds_read_b64_tr_b16 a[68:69], v116 offset:57344
ds_read_b64_tr_b16 a[70:71], v116 offset:61440
v_mfma_f32_16x16x32_bf16 v[156:159], a[104:107], a[80:83], v[156:159]
s_add_u32 m0, s4, 32768
ds_read_b64_tr_b16 a[72:73], v117 offset:49152
ds_read_b64_tr_b16 a[74:75], v117 offset:53248
v_mfma_f32_16x16x32_bf16 v[156:159], a[108:111], a[84:87], v[156:159]
buffer_load_dwordx4 v16, s[60:63], s90 offen offset:0 sc1 lds
v_mfma_f32_16x16x32_bf16 v[168:171], a[96:99], a[88:91], v[168:171]
ds_read_b64_tr_b16 a[76:77], v117 offset:57344
ds_read_b64_tr_b16 a[78:79], v117 offset:61440
v_mfma_f32_16x16x32_bf16 v[168:171], a[100:103], a[92:95], v[168:171]
ds_read_b128 a[80:83], v23 offset:50176
v_and_b32 v9, 0xffff0000, v44
v_mfma_f32_16x16x32_bf16 v[172:175], a[104:107], a[88:91], v[172:175]
ds_read_b128 a[84:87], v23 offset:54272
v_lshlrev_b32 v10, 16, v45
v_mfma_f32_16x16x32_bf16 v[172:175], a[108:111], a[92:95], v[172:175]
buffer_load_dwordx4 v17, s[60:63], s90 offen offset:1024 sc1 lds
v_mfma_f32_16x16x32_bf16 v[184:187], a[96:99], a[112:115], v[184:187]
ds_read_b128 a[88:91], v23 offset:51200
v_and_b32 v11, 0xffff0000, v45
v_mfma_f32_16x16x32_bf16 v[184:187], a[100:103], a[116:119], v[184:187]
ds_read_b128 a[92:95], v23 offset:55296
v_mul_f32 v8, v8, v58
v_mfma_f32_16x16x32_bf16 v[188:191], a[104:107], a[112:115], v[188:191]
v_mul_f32 v9, v9, v59
v_mul_f32 v10, v10, v60
v_mfma_f32_16x16x32_bf16 v[188:191], a[108:111], a[116:119], v[188:191]
buffer_load_dwordx4 v18, s[60:63], s90 offen offset:2048 sc1 lds
v_mfma_f32_16x16x32_bf16 v[136:139], a[96:99], a[120:123], v[136:139]
v_mul_f32 v11, v11, v61
v_cvt_pk_bf16_f32 v44, v8, v9
v_mfma_f32_16x16x32_bf16 v[136:139], a[100:103], a[124:127], v[136:139]
s_waitcnt lgkmcnt(0)
v_cvt_pk_bf16_f32 v45, v10, v11
v_lshlrev_b32 v8, 16, v46
v_mfma_f32_16x16x32_bf16 v[140:143], a[104:107], a[120:123], v[140:143]
buffer_load_dwordx4 v19, s[60:63], s90 offen offset:3072 sc1 lds
v_mfma_f32_16x16x32_bf16 v[140:143], a[108:111], a[124:127], v[140:143]
s_add_u32 s90, s90, 8192
v_and_b32 v9, 0xffff0000, v46
v_lshlrev_b32 v10, 16, v47
v_mfma_f32_16x16x32_bf16 v[144:147], a[64:67], a[80:83], v[144:147]
ds_read_b128 a[112:115], v23 offset:52224
v_and_b32 v11, 0xffff0000, v47
v_mfma_f32_16x16x32_bf16 v[144:147], a[68:71], a[84:87], v[144:147]
ds_read_b128 a[116:119], v23 offset:56320
v_mul_f32 v8, v8, v58
v_mfma_f32_16x16x32_bf16 v[148:151], a[72:75], a[80:83], v[148:151]
s_add_u32 m0, s86, 69632
s_add_u32 s89, s89, 16384
ds_read_b128 a[120:123], v23 offset:49152
v_mul_f32 v9, v9, v59
v_mfma_f32_16x16x32_bf16 v[148:151], a[76:79], a[84:87], v[148:151]
buffer_load_dwordx4 v112, s[52:55], s89 offen offset:0 lds
v_mfma_f32_16x16x32_bf16 v[160:163], a[64:67], a[88:91], v[160:163]
ds_read_b128 a[124:127], v23 offset:53248
v_mul_f32 v10, v10, v60
v_mfma_f32_16x16x32_bf16 v[160:163], a[68:71], a[92:95], v[160:163]
ds_read_b64_tr_b16 a[96:97], v118 offset:49152
ds_read_b64_tr_b16 a[98:99], v118 offset:53248
v_mfma_f32_16x16x32_bf16 v[164:167], a[72:75], a[88:91], v[164:167]
s_waitcnt lgkmcnt(3)
ds_read_b64_tr_b16 a[100:101], v118 offset:57344
ds_read_b64_tr_b16 a[102:103], v118 offset:61440
v_mfma_f32_16x16x32_bf16 v[164:167], a[76:79], a[92:95], v[164:167]
buffer_load_dwordx4 v113, s[52:55], s89 offen offset:1024 lds
v_mfma_f32_16x16x32_bf16 v[176:179], a[64:67], a[112:115], v[176:179]
ds_read_b64_tr_b16 a[104:105], v119 offset:49152
ds_read_b64_tr_b16 a[106:107], v119 offset:53248
v_mfma_f32_16x16x32_bf16 v[176:179], a[68:71], a[116:119], v[176:179]
ds_read_b64_tr_b16 a[108:109], v119 offset:57344
ds_read_b64_tr_b16 a[110:111], v119 offset:61440
v_mfma_f32_16x16x32_bf16 v[180:183], a[72:75], a[112:115], v[180:183]
buffer_load_dwordx4 v114, s[52:55], s89 offen offset:2048 lds
v_mfma_f32_16x16x32_bf16 v[180:183], a[76:79], a[116:119], v[180:183]
buffer_load_dwordx4 a[128:131], v2, s[60:63], s84 offen offset:0 sc1
v_mfma_f32_16x16x32_bf16 v[128:131], a[64:67], a[120:123], v[128:131]
buffer_load_dwordx4 v115, s[52:55], s89 offen offset:3072 lds
s_waitcnt lgkmcnt(2)
v_mfma_f32_16x16x32_bf16 v[128:131], a[68:71], a[124:127], v[128:131]
s_add_u32 s89, s89, 114688
v_mul_f32 v11, v11, v61
v_cvt_pk_bf16_f32 v46, v8, v9
v_mfma_f32_16x16x32_bf16 v[132:135], a[72:75], a[120:123], v[132:135]
s_waitcnt vmcnt(17) lgkmcnt(0)
v_cvt_pk_bf16_f32 v47, v10, v11
v_mfma_f32_16x16x32_bf16 v[132:135], a[76:79], a[124:127], v[132:135]
s_barrier
v_mfma_f32_16x16x32_bf16 v[152:155], a[96:99], a[80:83], v[152:155]
ds_read_b64_tr_b16 a[64:65], v120 offset:0
ds_read_b64_tr_b16 a[66:67], v120 offset:4096
v_mfma_f32_16x16x32_bf16 v[152:155], a[100:103], a[84:87], v[152:155]
ds_read_b64_tr_b16 a[68:69], v120 offset:8192
ds_read_b64_tr_b16 a[70:71], v120 offset:12288
v_mfma_f32_16x16x32_bf16 v[156:159], a[104:107], a[80:83], v[156:159]
s_add_u32 m0, s4, 49152
ds_read_b64_tr_b16 a[72:73], v121 offset:0
ds_read_b64_tr_b16 a[74:75], v121 offset:4096
v_mfma_f32_16x16x32_bf16 v[156:159], a[108:111], a[84:87], v[156:159]
buffer_load_dwordx4 v16, s[60:63], s90 offen offset:0 sc1 lds
v_mfma_f32_16x16x32_bf16 v[168:171], a[96:99], a[88:91], v[168:171]
ds_read_b64_tr_b16 a[76:77], v121 offset:8192
ds_read_b64_tr_b16 a[78:79], v121 offset:12288
v_mfma_f32_16x16x32_bf16 v[168:171], a[100:103], a[92:95], v[168:171]
ds_read_b128 a[80:83], v23 offset:1024
v_mfma_f32_16x16x32_bf16 v[172:175], a[104:107], a[88:91], v[172:175]
ds_read_b128 a[84:87], v23 offset:5120
v_mfma_f32_16x16x32_bf16 v[172:175], a[108:111], a[92:95], v[172:175]
buffer_load_dwordx4 v17, s[60:63], s90 offen offset:1024 sc1 lds
v_mfma_f32_16x16x32_bf16 v[184:187], a[96:99], a[112:115], v[184:187]
ds_read_b128 a[88:91], v23 offset:2048
v_mfma_f32_16x16x32_bf16 v[184:187], a[100:103], a[116:119], v[184:187]
ds_read_b128 a[92:95], v23 offset:6144
v_mfma_f32_16x16x32_bf16 v[188:191], a[104:107], a[112:115], v[188:191]
buffer_load_dwordx4 a[132:135], v2, s[60:63], s84 offen offset:1024 sc1
v_mfma_f32_16x16x32_bf16 v[188:191], a[108:111], a[116:119], v[188:191]
buffer_load_dwordx4 v18, s[60:63], s90 offen offset:2048 sc1 lds
v_mfma_f32_16x16x32_bf16 v[136:139], a[96:99], a[120:123], v[136:139]
buffer_load_dwordx4 a[136:139], v2, s[60:63], s84 offen offset:2048 sc1
v_mfma_f32_16x16x32_bf16 v[136:139], a[100:103], a[124:127], v[136:139]
s_waitcnt lgkmcnt(0)
v_mfma_f32_16x16x32_bf16 v[140:143], a[104:107], a[120:123], v[140:143]
buffer_load_dwordx4 v19, s[60:63], s90 offen offset:3072 sc1 lds
v_mfma_f32_16x16x32_bf16 v[140:143], a[108:111], a[124:127], v[140:143]
s_add_u32 s90, s90, 8192
v_mfma_f32_16x16x32_bf16 v[144:147], a[64:67], a[80:83], v[144:147]
ds_read_b128 a[112:115], v23 offset:3072
v_mfma_f32_16x16x32_bf16 v[144:147], a[68:71], a[84:87], v[144:147]
ds_read_b128 a[116:119], v23 offset:7168
v_mfma_f32_16x16x32_bf16 v[148:151], a[72:75], a[80:83], v[148:151]
s_xor_b32 s81, s6, 1
ds_read_b128 a[120:123], v23 offset:0
s_lshl_b32 s81, s81, 2
v_mfma_f32_16x16x32_bf16 v[148:151], a[76:79], a[84:87], v[148:151]
buffer_load_dwordx4 a[140:143], v2, s[60:63], s84 offen offset:3072 sc1
v_mfma_f32_16x16x32_bf16 v[160:163], a[64:67], a[88:91], v[160:163]
s_add_u32 s81, s81, s6
ds_read_b128 a[124:127], v23 offset:4096
s_lshl_b32 s81, s81, 13
v_mfma_f32_16x16x32_bf16 v[160:163], a[68:71], a[92:95], v[160:163]
s_add_u32 s84, s84, 4096
ds_read_b64_tr_b16 a[96:97], v122 offset:0
ds_read_b64_tr_b16 a[98:99], v122 offset:4096
v_mfma_f32_16x16x32_bf16 v[164:167], a[72:75], a[88:91], v[164:167]
s_add_u32 s94, s81, s5
ds_read_b64_tr_b16 a[100:101], v122 offset:8192
ds_read_b64_tr_b16 a[102:103], v122 offset:12288
v_mfma_f32_16x16x32_bf16 v[164:167], a[76:79], a[92:95], v[164:167]
buffer_load_dwordx4 a[144:147], v2, s[60:63], s85 offen offset:0 sc1
s_waitcnt lgkmcnt(5)
v_mfma_f32_16x16x32_bf16 v[176:179], a[64:67], a[112:115], v[176:179]
s_xor_b32 s81, s6, 2
ds_read_b64_tr_b16 a[104:105], v123 offset:0
ds_read_b64_tr_b16 a[106:107], v123 offset:4096
v_mfma_f32_16x16x32_bf16 v[176:179], a[68:71], a[116:119], v[176:179]
s_lshl_b32 s81, s81, 2
ds_read_b64_tr_b16 a[108:109], v123 offset:8192
ds_read_b64_tr_b16 a[110:111], v123 offset:12288
v_mfma_f32_16x16x32_bf16 v[180:183], a[72:75], a[112:115], v[180:183]
buffer_load_dwordx4 a[148:151], v2, s[60:63], s85 offen offset:1024 sc1
v_mfma_f32_16x16x32_bf16 v[180:183], a[76:79], a[116:119], v[180:183]
s_add_u32 s81, s81, s6
s_lshl_b32 s81, s81, 13
s_add_u32 s1, s81, s5
v_mfma_f32_16x16x32_bf16 v[128:131], a[64:67], a[120:123], v[128:131]
buffer_load_dwordx4 a[152:155], v2, s[60:63], s85 offen offset:2048 sc1
s_waitcnt lgkmcnt(2)
v_mfma_f32_16x16x32_bf16 v[128:131], a[68:71], a[124:127], v[128:131]
s_xor_b32 s81, s6, 3
s_lshl_b32 s81, s81, 2
s_add_u32 s81, s81, s6
v_mfma_f32_16x16x32_bf16 v[132:135], a[72:75], a[120:123], v[132:135]
s_waitcnt vmcnt(23) lgkmcnt(0)
s_lshl_b32 s81, s81, 13
s_add_u32 s89, s81, s5
v_mfma_f32_16x16x32_bf16 v[132:135], a[76:79], a[124:127], v[132:135]
s_barrier
v_mfma_f32_16x16x32_bf16 v[152:155], a[96:99], a[80:83], v[152:155]
s_and_b32 s19, s76, 7
ds_read_b64_tr_b16 a[0:1], v120 offset:16384
ds_read_b64_tr_b16 a[2:3], v120 offset:20480
v_mfma_f32_16x16x32_bf16 v[152:155], a[100:103], a[84:87], v[152:155]
s_lshl_b32 s19, s19, 3
ds_read_b64_tr_b16 a[4:5], v120 offset:24576
ds_read_b64_tr_b16 a[6:7], v120 offset:28672
v_mfma_f32_16x16x32_bf16 v[156:159], a[104:107], a[80:83], v[156:159]
s_add_u32 s19, s19, s77
ds_read_b64_tr_b16 a[8:9], v121 offset:16384
ds_read_b64_tr_b16 a[10:11], v121 offset:20480
v_mfma_f32_16x16x32_bf16 v[156:159], a[108:111], a[84:87], v[156:159]
buffer_load_dwordx4 a[156:159], v2, s[60:63], s85 offen offset:3072 sc1
v_mfma_f32_16x16x32_bf16 v[168:171], a[96:99], a[88:91], v[168:171]
s_lshl_b32 s19, s19, 7
ds_read_b64_tr_b16 a[12:13], v121 offset:24576
ds_read_b64_tr_b16 a[14:15], v121 offset:28672
v_mfma_f32_16x16x32_bf16 v[168:171], a[100:103], a[92:95], v[168:171]
s_add_u32 s85, s85, 4096
ds_read_b128 a[80:83], v23 offset:17408
s_add_u32 s19, s19, 59854848
v_mfma_f32_16x16x32_bf16 v[172:175], a[104:107], a[88:91], v[172:175]
s_mov_b32 s0, s19
ds_read_b128 a[84:87], v23 offset:21504
v_and_b32 v26, 3, v1
v_mfma_f32_16x16x32_bf16 v[172:175], a[108:111], a[92:95], v[172:175]
buffer_load_dwordx4 a[160:163], v2, s[60:63], s84 offen offset:0 sc1
v_mfma_f32_16x16x32_bf16 v[184:187], a[96:99], a[112:115], v[184:187]
ds_read_b128 a[88:91], v23 offset:18432
v_max_u32 v26, 1, v26
v_mfma_f32_16x16x32_bf16 v[184:187], a[100:103], a[116:119], v[184:187]
ds_read_b128 a[92:95], v23 offset:22528
v_xor_b32 v26, s6, v26
v_mfma_f32_16x16x32_bf16 v[188:191], a[104:107], a[112:115], v[188:191]
buffer_load_dwordx4 a[164:167], v2, s[60:63], s84 offen offset:1024 sc1
v_mfma_f32_16x16x32_bf16 v[188:191], a[108:111], a[116:119], v[188:191]
v_lshlrev_b32 v26, 2, v26
v_mfma_f32_16x16x32_bf16 v[136:139], a[96:99], a[120:123], v[136:139]
buffer_load_dwordx4 a[168:171], v2, s[60:63], s84 offen offset:2048 sc1
v_mfma_f32_16x16x32_bf16 v[136:139], a[100:103], a[124:127], v[136:139]
v_mfma_f32_16x16x32_bf16 v[140:143], a[104:107], a[120:123], v[140:143]
buffer_load_dwordx4 a[172:175], v2, s[60:63], s84 offen offset:3072 sc1
v_mfma_f32_16x16x32_bf16 v[140:143], a[108:111], a[124:127], v[140:143]
s_waitcnt lgkmcnt(0)
v_mfma_f32_16x16x32_bf16 v[144:147], a[0:3], a[80:83], v[144:147]
s_add_u32 s84, s84, 4096
ds_read_b128 a[112:115], v23 offset:19456
v_mfma_f32_16x16x32_bf16 v[144:147], a[4:7], a[84:87], v[144:147]
ds_read_b128 a[116:119], v23 offset:23552
v_mfma_f32_16x16x32_bf16 v[148:151], a[8:11], a[80:83], v[148:151]
ds_read_b64_tr_b16 a[16:17], v122 offset:16384
ds_read_b64_tr_b16 a[18:19], v122 offset:20480
v_mfma_f32_16x16x32_bf16 v[148:151], a[12:15], a[84:87], v[148:151]
ds_read_b64_tr_b16 a[20:21], v122 offset:24576
ds_read_b64_tr_b16 a[22:23], v122 offset:28672
v_mfma_f32_16x16x32_bf16 v[160:163], a[0:3], a[88:91], v[160:163]
ds_read_b64_tr_b16 a[24:25], v123 offset:16384
ds_read_b64_tr_b16 a[26:27], v123 offset:20480
v_mfma_f32_16x16x32_bf16 v[160:163], a[4:7], a[92:95], v[160:163]
ds_read_b64_tr_b16 a[28:29], v123 offset:24576
ds_read_b64_tr_b16 a[30:31], v123 offset:28672
v_mfma_f32_16x16x32_bf16 v[164:167], a[8:11], a[88:91], v[164:167]
ds_read_b128 a[40:43], v23 offset:16384
v_mfma_f32_16x16x32_bf16 v[164:167], a[12:15], a[92:95], v[164:167]
s_waitcnt lgkmcnt(5)
ds_read_b128 a[44:47], v23 offset:20480
v_mfma_f32_16x16x32_bf16 v[176:179], a[0:3], a[112:115], v[176:179]
buffer_load_dwordx4 a[176:179], v2, s[60:63], s85 offen offset:0 sc1
v_mfma_f32_16x16x32_bf16 v[176:179], a[4:7], a[116:119], v[176:179]
v_mfma_f32_16x16x32_bf16 v[180:183], a[8:11], a[112:115], v[180:183]
s_waitcnt vmcnt(16)
v_mfma_f32_16x16x32_bf16 v[180:183], a[12:15], a[116:119], v[180:183]
s_barrier
v_mfma_f32_16x16x32_bf16 v[152:155], a[16:19], a[80:83], v[152:155]
ds_read_b64_tr_b16 a[192:193], v116 offset:0
ds_read_b64_tr_b16 a[194:195], v116 offset:4096
v_mfma_f32_16x16x32_bf16 v[152:155], a[20:23], a[84:87], v[152:155]
s_waitcnt lgkmcnt(2)
ds_read_b64_tr_b16 a[196:197], v116 offset:8192
ds_read_b64_tr_b16 a[198:199], v116 offset:12288
v_mfma_f32_16x16x32_bf16 v[156:159], a[24:27], a[80:83], v[156:159]
ds_read_b64_tr_b16 a[200:201], v117 offset:0
ds_read_b64_tr_b16 a[202:203], v117 offset:4096
v_mfma_f32_16x16x32_bf16 v[156:159], a[28:31], a[84:87], v[156:159]
ds_read_b64_tr_b16 a[204:205], v117 offset:8192
ds_read_b64_tr_b16 a[206:207], v117 offset:12288
v_mfma_f32_16x16x32_bf16 v[168:171], a[16:19], a[88:91], v[168:171]
ds_read_b128 a[80:83], v23 offset:33792
v_mfma_f32_16x16x32_bf16 v[168:171], a[20:23], a[92:95], v[168:171]
ds_read_b128 a[84:87], v23 offset:37888
v_mfma_f32_16x16x32_bf16 v[172:175], a[24:27], a[88:91], v[172:175]
buffer_load_dwordx4 a[180:183], v2, s[60:63], s85 offen offset:1024 sc1
v_mfma_f32_16x16x32_bf16 v[172:175], a[28:31], a[92:95], v[172:175]
ds_read_b128 a[88:91], v23 offset:34816
v_mfma_f32_16x16x32_bf16 v[184:187], a[16:19], a[112:115], v[184:187]
ds_read_b128 a[92:95], v23 offset:38912
v_mfma_f32_16x16x32_bf16 v[184:187], a[20:23], a[116:119], v[184:187]
buffer_load_dwordx4 a[184:187], v2, s[60:63], s85 offen offset:2048 sc1
v_mfma_f32_16x16x32_bf16 v[188:191], a[24:27], a[112:115], v[188:191]
s_waitcnt lgkmcnt(2)
v_mfma_f32_16x16x32_bf16 v[188:191], a[28:31], a[116:119], v[188:191]
buffer_load_dwordx4 a[188:191], v2, s[60:63], s85 offen offset:3072 sc1
v_mfma_f32_16x16x32_bf16 v[144:147], a[192:195], a[80:83], v[144:147]
ds_read_b128 a[112:115], v23 offset:35840
v_mfma_f32_16x16x32_bf16 v[144:147], a[196:199], a[84:87], v[144:147]
s_add_u32 s85, s85, 4096
ds_read_b128 a[116:119], v23 offset:39936
v_mfma_f32_16x16x32_bf16 v[148:151], a[200:203], a[80:83], v[148:151]
ds_read_b64_tr_b16 a[208:209], v118 offset:0
ds_read_b64_tr_b16 a[210:211], v118 offset:4096
v_mfma_f32_16x16x32_bf16 v[148:151], a[204:207], a[84:87], v[148:151]
s_waitcnt lgkmcnt(4)
ds_read_b64_tr_b16 a[212:213], v118 offset:8192
ds_read_b64_tr_b16 a[214:215], v118 offset:12288
v_mfma_f32_16x16x32_bf16 v[160:163], a[192:195], a[88:91], v[160:163]
ds_read_b64_tr_b16 a[216:217], v119 offset:0
ds_read_b64_tr_b16 a[218:219], v119 offset:4096
v_mfma_f32_16x16x32_bf16 v[160:163], a[196:199], a[92:95], v[160:163]
ds_read_b64_tr_b16 a[220:221], v119 offset:8192
ds_read_b64_tr_b16 a[222:223], v119 offset:12288
v_mfma_f32_16x16x32_bf16 v[164:167], a[200:203], a[88:91], v[164:167]
ds_read_b128 a[48:51], v23 offset:32768
v_mfma_f32_16x16x32_bf16 v[164:167], a[204:207], a[92:95], v[164:167]
s_waitcnt lgkmcnt(5)
ds_read_b128 a[52:55], v23 offset:36864
v_mfma_f32_16x16x32_bf16 v[176:179], a[192:195], a[112:115], v[176:179]
v_mfma_f32_16x16x32_bf16 v[176:179], a[196:199], a[116:119], v[176:179]
v_mfma_f32_16x16x32_bf16 v[180:183], a[200:203], a[112:115], v[180:183]
s_waitcnt vmcnt(13)
v_mfma_f32_16x16x32_bf16 v[180:183], a[204:207], a[116:119], v[180:183]
s_barrier
v_mfma_f32_16x16x32_bf16 v[152:155], a[208:211], a[80:83], v[152:155]
ds_read_b64_tr_b16 a[64:65], v116 offset:16384
ds_read_b64_tr_b16 a[66:67], v116 offset:20480
v_mfma_f32_16x16x32_bf16 v[152:155], a[212:215], a[84:87], v[152:155]
s_waitcnt lgkmcnt(2)
ds_read_b64_tr_b16 a[68:69], v116 offset:24576
ds_read_b64_tr_b16 a[70:71], v116 offset:28672
v_mfma_f32_16x16x32_bf16 v[156:159], a[216:219], a[80:83], v[156:159]
ds_read_b64_tr_b16 a[72:73], v117 offset:16384
ds_read_b64_tr_b16 a[74:75], v117 offset:20480
v_mfma_f32_16x16x32_bf16 v[156:159], a[220:223], a[84:87], v[156:159]
ds_read_b64_tr_b16 a[76:77], v117 offset:24576
ds_read_b64_tr_b16 a[78:79], v117 offset:28672
v_mfma_f32_16x16x32_bf16 v[168:171], a[208:211], a[88:91], v[168:171]
ds_read_b128 a[80:83], v23 offset:50176
v_mfma_f32_16x16x32_bf16 v[168:171], a[212:215], a[92:95], v[168:171]
ds_read_b128 a[84:87], v23 offset:54272
v_mfma_f32_16x16x32_bf16 v[172:175], a[216:219], a[88:91], v[172:175]
v_mfma_f32_16x16x32_bf16 v[172:175], a[220:223], a[92:95], v[172:175]
ds_read_b128 a[88:91], v23 offset:51200
v_mfma_f32_16x16x32_bf16 v[184:187], a[208:211], a[112:115], v[184:187]
ds_read_b128 a[92:95], v23 offset:55296
v_mfma_f32_16x16x32_bf16 v[184:187], a[212:215], a[116:119], v[184:187]
v_mfma_f32_16x16x32_bf16 v[188:191], a[216:219], a[112:115], v[188:191]
v_mfma_f32_16x16x32_bf16 v[188:191], a[220:223], a[116:119], v[188:191]
s_waitcnt lgkmcnt(1)
v_mfma_f32_16x16x32_bf16 v[144:147], a[64:67], a[80:83], v[144:147]
ds_read_b128 a[112:115], v23 offset:52224
v_mfma_f32_16x16x32_bf16 v[144:147], a[68:71], a[84:87], v[144:147]
ds_read_b128 a[116:119], v23 offset:56320
v_mfma_f32_16x16x32_bf16 v[148:151], a[72:75], a[80:83], v[148:151]
ds_read_b64_tr_b16 a[96:97], v118 offset:16384
ds_read_b64_tr_b16 a[98:99], v118 offset:20480
v_mfma_f32_16x16x32_bf16 v[148:151], a[76:79], a[84:87], v[148:151]
ds_read_b64_tr_b16 a[100:101], v118 offset:24576
ds_read_b64_tr_b16 a[102:103], v118 offset:28672
v_mfma_f32_16x16x32_bf16 v[160:163], a[64:67], a[88:91], v[160:163]
s_waitcnt lgkmcnt(5)
ds_read_b64_tr_b16 a[104:105], v119 offset:16384
ds_read_b64_tr_b16 a[106:107], v119 offset:20480
v_mfma_f32_16x16x32_bf16 v[160:163], a[68:71], a[92:95], v[160:163]
ds_read_b64_tr_b16 a[108:109], v119 offset:24576
ds_read_b64_tr_b16 a[110:111], v119 offset:28672
v_mfma_f32_16x16x32_bf16 v[164:167], a[72:75], a[88:91], v[164:167]
ds_read_b128 a[120:123], v23 offset:49152
v_mfma_f32_16x16x32_bf16 v[164:167], a[76:79], a[92:95], v[164:167]
ds_read_b128 a[124:127], v23 offset:53248
v_cvt_pk_bf16_f32 v144, v144, v145
v_mfma_f32_16x16x32_bf16 v[176:179], a[64:67], a[112:115], v[176:179]
s_waitcnt lgkmcnt(4)
v_cvt_pk_bf16_f32 v145, v146, v147
v_cvt_pk_bf16_f32 v146, v148, v149
v_mfma_f32_16x16x32_bf16 v[176:179], a[68:71], a[116:119], v[176:179]
v_cvt_pk_bf16_f32 v147, v150, v151
v_mfma_f32_16x16x32_bf16 v[180:183], a[72:75], a[112:115], v[180:183]
buffer_store_dwordx4 v[144:147], v2, s[60:63], s94 offen offset:0 sc1
v_mfma_f32_16x16x32_bf16 v[180:183], a[76:79], a[116:119], v[180:183]
v_cvt_pk_bf16_f32 v160, v160, v161
v_cvt_pk_bf16_f32 v161, v162, v163
v_mfma_f32_16x16x32_bf16 v[152:155], a[96:99], a[80:83], v[152:155]
v_cvt_pk_bf16_f32 v162, v164, v165
v_cvt_pk_bf16_f32 v163, v166, v167
v_mfma_f32_16x16x32_bf16 v[152:155], a[100:103], a[84:87], v[152:155]
buffer_store_dwordx4 v[160:163], v2, s[60:63], s1 offen offset:0 sc1
v_mfma_f32_16x16x32_bf16 v[156:159], a[104:107], a[80:83], v[156:159]
s_waitcnt lgkmcnt(0)
v_mfma_f32_16x16x32_bf16 v[156:159], a[108:111], a[84:87], v[156:159]
v_cvt_pk_bf16_f32 v176, v176, v177
v_cvt_pk_bf16_f32 v177, v178, v179
v_mfma_f32_16x16x32_bf16 v[168:171], a[96:99], a[88:91], v[168:171]
v_cvt_pk_bf16_f32 v178, v180, v181
v_cvt_pk_bf16_f32 v179, v182, v183
v_mfma_f32_16x16x32_bf16 v[168:171], a[100:103], a[92:95], v[168:171]
buffer_store_dwordx4 v[176:179], v2, s[60:63], s89 offen offset:0 sc1
v_mfma_f32_16x16x32_bf16 v[172:175], a[104:107], a[88:91], v[172:175]
v_mfma_f32_16x16x32_bf16 v[172:175], a[108:111], a[92:95], v[172:175]
v_cvt_pk_bf16_f32 v152, v152, v153
v_cvt_pk_bf16_f32 v153, v154, v155
v_mfma_f32_16x16x32_bf16 v[184:187], a[96:99], a[112:115], v[184:187]
v_cvt_pk_bf16_f32 v154, v156, v157
v_cvt_pk_bf16_f32 v155, v158, v159
v_mfma_f32_16x16x32_bf16 v[184:187], a[100:103], a[116:119], v[184:187]
buffer_store_dwordx4 v[152:155], v2, s[60:63], s94 offen offset:1024 sc1
v_mfma_f32_16x16x32_bf16 v[188:191], a[104:107], a[112:115], v[188:191]
v_mfma_f32_16x16x32_bf16 v[188:191], a[108:111], a[116:119], v[188:191]
v_cvt_pk_bf16_f32 v168, v168, v169
v_cvt_pk_bf16_f32 v169, v170, v171
v_mfma_f32_16x16x32_bf16 v[128:131], a[0:3], a[40:43], v[128:131]
v_cvt_pk_bf16_f32 v170, v172, v173
v_cvt_pk_bf16_f32 v171, v174, v175
v_mfma_f32_16x16x32_bf16 v[128:131], a[4:7], a[44:47], v[128:131]
buffer_store_dwordx4 v[168:171], v2, s[60:63], s1 offen offset:1024 sc1
v_mfma_f32_16x16x32_bf16 v[128:131], a[192:195], a[48:51], v[128:131]
v_mfma_f32_16x16x32_bf16 v[128:131], a[196:199], a[52:55], v[128:131]
v_cvt_pk_bf16_f32 v184, v184, v185
v_cvt_pk_bf16_f32 v185, v186, v187
v_mfma_f32_16x16x32_bf16 v[128:131], a[64:67], a[120:123], v[128:131]
v_cvt_pk_bf16_f32 v186, v188, v189
v_cvt_pk_bf16_f32 v187, v190, v191
v_mfma_f32_16x16x32_bf16 v[128:131], a[68:71], a[124:127], v[128:131]
buffer_store_dwordx4 v[184:187], v2, s[60:63], s89 offen offset:1024 sc1
v_mfma_f32_16x16x32_bf16 v[132:135], a[8:11], a[40:43], v[132:135]
v_mfma_f32_16x16x32_bf16 v[132:135], a[12:15], a[44:47], v[132:135]
v_mfma_f32_16x16x32_bf16 v[132:135], a[200:203], a[48:51], v[132:135]
v_mfma_f32_16x16x32_bf16 v[132:135], a[204:207], a[52:55], v[132:135]
v_mfma_f32_16x16x32_bf16 v[132:135], a[72:75], a[120:123], v[132:135]
v_mfma_f32_16x16x32_bf16 v[132:135], a[76:79], a[124:127], v[132:135]
v_mfma_f32_16x16x32_bf16 v[136:139], a[16:19], a[40:43], v[136:139]
v_mfma_f32_16x16x32_bf16 v[136:139], a[20:23], a[44:47], v[136:139]
v_mfma_f32_16x16x32_bf16 v[136:139], a[208:211], a[48:51], v[136:139]
v_mfma_f32_16x16x32_bf16 v[136:139], a[212:215], a[52:55], v[136:139]
v_mfma_f32_16x16x32_bf16 v[136:139], a[96:99], a[120:123], v[136:139]
v_mfma_f32_16x16x32_bf16 v[136:139], a[100:103], a[124:127], v[136:139]
v_mfma_f32_16x16x32_bf16 v[140:143], a[24:27], a[40:43], v[140:143]
v_mfma_f32_16x16x32_bf16 v[140:143], a[28:31], a[44:47], v[140:143]
v_mfma_f32_16x16x32_bf16 v[140:143], a[216:219], a[48:51], v[140:143]
v_mfma_f32_16x16x32_bf16 v[140:143], a[220:223], a[52:55], v[140:143]
v_mfma_f32_16x16x32_bf16 v[140:143], a[104:107], a[120:123], v[140:143]
v_mfma_f32_16x16x32_bf16 v[140:143], a[108:111], a[124:127], v[140:143]
s_waitcnt vmcnt(6)
v_mfma_f32_16x16x32_bf16 v[192:195], a[128:131], a[144:147], v[192:195]
v_mfma_f32_16x16x32_bf16 v[192:195], a[160:163], a[176:179], v[192:195]
v_mfma_f32_16x16x32_bf16 v[196:199], a[132:135], a[144:147], v[196:199]
v_mfma_f32_16x16x32_bf16 v[196:199], a[164:167], a[176:179], v[196:199]
v_mfma_f32_16x16x32_bf16 v[200:203], a[136:139], a[144:147], v[200:203]
v_mfma_f32_16x16x32_bf16 v[200:203], a[168:171], a[176:179], v[200:203]
v_mfma_f32_16x16x32_bf16 v[204:207], a[140:143], a[144:147], v[204:207]
v_mfma_f32_16x16x32_bf16 v[204:207], a[172:175], a[176:179], v[204:207]
v_mfma_f32_16x16x32_bf16 v[208:211], a[128:131], a[148:151], v[208:211]
s_nop 0
ds_write_b128 v28, v[192:195] offset:0
v_mfma_f32_16x16x32_bf16 v[208:211], a[160:163], a[180:183], v[208:211]
v_mfma_f32_16x16x32_bf16 v[212:215], a[132:135], a[148:151], v[212:215]
ds_write_b128 v29, v[196:199] offset:0
v_mfma_f32_16x16x32_bf16 v[212:215], a[164:167], a[180:183], v[212:215]
v_mfma_f32_16x16x32_bf16 v[216:219], a[136:139], a[148:151], v[216:219]
ds_write_b128 v30, v[200:203] offset:0
v_mfma_f32_16x16x32_bf16 v[216:219], a[168:171], a[180:183], v[216:219]
v_mfma_f32_16x16x32_bf16 v[220:223], a[140:143], a[148:151], v[220:223]
ds_write_b128 v31, v[204:207] offset:0
v_mfma_f32_16x16x32_bf16 v[220:223], a[172:175], a[180:183], v[220:223]
v_mfma_f32_16x16x32_bf16 v[224:227], a[128:131], a[152:155], v[224:227]
ds_write_b128 v28, v[208:211] offset:4096
v_mfma_f32_16x16x32_bf16 v[224:227], a[160:163], a[184:187], v[224:227]
v_mfma_f32_16x16x32_bf16 v[228:231], a[132:135], a[152:155], v[228:231]
ds_write_b128 v29, v[212:215] offset:4096
v_mfma_f32_16x16x32_bf16 v[228:231], a[164:167], a[184:187], v[228:231]
v_mfma_f32_16x16x32_bf16 v[232:235], a[136:139], a[152:155], v[232:235]
ds_write_b128 v30, v[216:219] offset:4096
v_mfma_f32_16x16x32_bf16 v[232:235], a[168:171], a[184:187], v[232:235]
v_mfma_f32_16x16x32_bf16 v[236:239], a[140:143], a[152:155], v[236:239]
ds_write_b128 v31, v[220:223] offset:4096
v_mfma_f32_16x16x32_bf16 v[236:239], a[172:175], a[184:187], v[236:239]
v_mfma_f32_16x16x32_bf16 v[240:243], a[128:131], a[156:159], v[240:243]
ds_write_b128 v28, v[224:227] offset:8192
v_mfma_f32_16x16x32_bf16 v[240:243], a[160:163], a[188:191], v[240:243]
v_mfma_f32_16x16x32_bf16 v[244:247], a[132:135], a[156:159], v[244:247]
ds_write_b128 v29, v[228:231] offset:8192
v_mfma_f32_16x16x32_bf16 v[244:247], a[164:167], a[188:191], v[244:247]
v_mfma_f32_16x16x32_bf16 v[248:251], a[136:139], a[156:159], v[248:251]
ds_write_b128 v30, v[232:235] offset:8192
v_mfma_f32_16x16x32_bf16 v[248:251], a[168:171], a[188:191], v[248:251]
v_mfma_f32_16x16x32_bf16 v[252:255], a[140:143], a[156:159], v[252:255]
ds_write_b128 v31, v[236:239] offset:8192
v_mfma_f32_16x16x32_bf16 v[252:255], a[172:175], a[188:191], v[252:255]
ds_write_b128 v28, v[240:243] offset:12288
s_nop 0
ds_write_b128 v29, v[244:247] offset:12288
s_nop 1
ds_write_b128 v30, v[248:251] offset:12288
s_nop 1
ds_write_b128 v31, v[252:255] offset:12288
s_waitcnt vmcnt(0) lgkmcnt(0)
s_barrier
s_cmp_lg_u32 s3, 0
s_cbranch_scc1 Lpub100
v_mov_b32 v12, 1
s_mov_b64 exec, 1
buffer_atomic_add v12, off, s[60:63], s0 sc1
s_mov_b64 exec, -1
Lpub100:
ds_read_b128 v[64:67], v32 offset:0
ds_read_b128 v[68:71], v32 offset:16384
ds_read_b128 v[72:75], v32 offset:32768
ds_read_b128 v[76:79], v32 offset:49152
ds_read_b128 v[80:83], v33 offset:0
ds_read_b128 v[84:87], v33 offset:16384
ds_read_b128 v[88:91], v33 offset:32768
ds_read_b128 v[92:95], v33 offset:49152
ds_read_b128 v[96:99], v34 offset:0
ds_read_b128 v[100:103], v34 offset:16384
ds_read_b128 v[104:107], v34 offset:32768
ds_read_b128 v[108:111], v34 offset:49152
ds_read_b128 v[112:115], v35 offset:0
ds_read_b128 v[116:119], v35 offset:16384
ds_read_b128 v[120:123], v35 offset:32768
ds_read_b128 v[124:127], v35 offset:49152
s_mul_i32 s81, s3, 4294955008
s_sub_u32 s81, s81, 98304
v_add_u32 v28, s81, v28
v_add_u32 v29, s81, v29
v_add_u32 v30, s81, v30
v_add_u32 v31, s81, v31
v_subrev_u32 v32, 98304, v32
v_subrev_u32 v33, 98304, v33
v_subrev_u32 v34, 98304, v34
v_subrev_u32 v35, 98304, v35
s_xor_b32 s81, s6, 1
s_lshl_b32 s82, s6, 2
s_add_u32 s81, s81, s82
s_lshl_b32 s81, s81, 13
s_add_u32 s94, s81, s5
s_xor_b32 s81, s6, 2
s_lshl_b32 s82, s6, 2
s_add_u32 s81, s81, s82
s_lshl_b32 s81, s81, 13
s_add_u32 s1, s81, s5
s_xor_b32 s81, s6, 3
s_lshl_b32 s82, s6, 2
s_add_u32 s81, s81, s82
s_lshl_b32 s81, s81, 13
s_add_u32 s89, s81, s5
s_cmp_lg_u32 s3, 0
s_cbranch_scc1 Lrd101
v_mov_b32 v48, 0
s_mov_b64 exec, 1
buffer_atomic_add v48, off, s[60:63], s19 sc0 sc1
s_mov_b64 exec, -1
Lrd101:
v_lshlrev_b32 v8, 16, v40
v_and_b32 v9, 0xffff0000, v40
v_lshlrev_b32 v10, 16, v41
v_and_b32 v11, 0xffff0000, v41
s_waitcnt lgkmcnt(12)
v_pk_add_f32 v[64:65], v[64:65], v[68:69]
v_pk_add_f32 v[72:73], v[72:73], v[76:77]
v_pk_add_f32 v[66:67], v[66:67], v[70:71]
v_pk_add_f32 v[74:75], v[74:75], v[78:79]
v_pk_add_f32 v[64:65], v[64:65], v[8:9]
v_pk_add_f32 v[66:67], v[66:67], v[10:11]
v_pk_add_f32 v[64:65], v[64:65], v[72:73]
v_pk_add_f32 v[66:67], v[66:67], v[74:75]
s_add_u32 s80, s91, 0
buffer_store_dwordx4 v[64:67], v36, s[48:51], s80 offen sc1
v_lshlrev_b32 v8, 16, v42
v_and_b32 v9, 0xffff0000, v42
v_lshlrev_b32 v10, 16, v43
v_and_b32 v11, 0xffff0000, v43
s_waitcnt lgkmcnt(8)
v_pk_add_f32 v[80:81], v[80:81], v[84:85]
v_pk_add_f32 v[88:89], v[88:89], v[92:93]
v_pk_add_f32 v[82:83], v[82:83], v[86:87]
v_pk_add_f32 v[90:91], v[90:91], v[94:95]
v_pk_add_f32 v[80:81], v[80:81], v[8:9]
v_pk_add_f32 v[82:83], v[82:83], v[10:11]
v_pk_add_f32 v[80:81], v[80:81], v[88:89]
v_pk_add_f32 v[82:83], v[82:83], v[90:91]
s_add_u32 s80, s91, 16384
buffer_store_dwordx4 v[80:83], v36, s[48:51], s80 offen sc1
v_lshlrev_b32 v8, 16, v44
v_and_b32 v9, 0xffff0000, v44
v_lshlrev_b32 v10, 16, v45
v_and_b32 v11, 0xffff0000, v45
s_waitcnt lgkmcnt(4)
v_pk_add_f32 v[96:97], v[96:97], v[100:101]
v_pk_add_f32 v[104:105], v[104:105], v[108:109]
v_pk_add_f32 v[98:99], v[98:99], v[102:103]
v_pk_add_f32 v[106:107], v[106:107], v[110:111]
v_pk_add_f32 v[96:97], v[96:97], v[8:9]
v_pk_add_f32 v[98:99], v[98:99], v[10:11]
v_pk_add_f32 v[96:97], v[96:97], v[104:105]
v_pk_add_f32 v[98:99], v[98:99], v[106:107]
s_add_u32 s80, s91, 32768
buffer_store_dwordx4 v[96:99], v36, s[48:51], s80 offen sc1
v_lshlrev_b32 v8, 16, v46
v_and_b32 v9, 0xffff0000, v46
v_lshlrev_b32 v10, 16, v47
v_and_b32 v11, 0xffff0000, v47
s_waitcnt lgkmcnt(0)
v_pk_add_f32 v[112:113], v[112:113], v[116:117]
v_pk_add_f32 v[120:121], v[120:121], v[124:125]
v_pk_add_f32 v[114:115], v[114:115], v[118:119]
v_pk_add_f32 v[122:123], v[122:123], v[126:127]
v_pk_add_f32 v[112:113], v[112:113], v[8:9]
v_pk_add_f32 v[114:115], v[114:115], v[10:11]
v_pk_add_f32 v[112:113], v[112:113], v[120:121]
v_pk_add_f32 v[114:115], v[114:115], v[122:123]
s_add_u32 s80, s91, 49152
buffer_store_dwordx4 v[112:115], v36, s[48:51], s80 offen sc1
s_cmp_lg_u32 s3, 0
s_cbranch_scc1 Lone102
s_mov_b32 s83, 0x20000
s_mov_b64 exec, 1
s_waitcnt vmcnt(4)
Lsp103:
v_cmp_gt_u32 vcc, 4, v48
s_sub_u32 s83, s83, 1
s_cbranch_vccz Ldn104
s_cbranch_scc1 Ldn104
v_mov_b32 v48, 0
buffer_atomic_add v48, off, s[60:63], s19 sc0 sc1
s_waitcnt vmcnt(0)
s_branch Lsp103
Ldn104:
s_mov_b64 exec, -1
Lone102:
s_barrier
buffer_load_dwordx4 v[208:211], v2, s[60:63], s94 offen offset:0 sc1
buffer_load_dwordx4 v[212:215], v2, s[60:63], s94 offen offset:1024 sc1
buffer_load_dwordx4 v[224:227], v2, s[60:63], s1 offen offset:0 sc1
buffer_load_dwordx4 v[228:231], v2, s[60:63], s1 offen offset:1024 sc1
buffer_load_dwordx4 v[240:243], v2, s[60:63], s89 offen offset:0 sc1
buffer_load_dwordx4 v[244:247], v2, s[60:63], s89 offen offset:1024 sc1
s_waitcnt vmcnt(4)
v_lshlrev_b32 v192, 16, v208
v_and_b32 v193, 0xffff0000, v208
v_lshlrev_b32 v194, 16, v209
v_and_b32 v195, 0xffff0000, v209
v_lshlrev_b32 v196, 16, v210
v_and_b32 v197, 0xffff0000, v210
v_lshlrev_b32 v198, 16, v211
v_and_b32 v199, 0xffff0000, v211
v_lshlrev_b32 v200, 16, v212
v_and_b32 v201, 0xffff0000, v212
v_lshlrev_b32 v202, 16, v213
v_and_b32 v203, 0xffff0000, v213
v_lshlrev_b32 v204, 16, v214
v_and_b32 v205, 0xffff0000, v214
v_lshlrev_b32 v206, 16, v215
v_and_b32 v207, 0xffff0000, v215
v_pk_add_f32 v[128:129], v[128:129], v[192:193]
v_pk_add_f32 v[130:131], v[130:131], v[194:195]
v_pk_add_f32 v[132:133], v[132:133], v[196:197]
v_pk_add_f32 v[134:135], v[134:135], v[198:199]
v_pk_add_f32 v[136:137], v[136:137], v[200:201]
v_pk_add_f32 v[138:139], v[138:139], v[202:203]
v_pk_add_f32 v[140:141], v[140:141], v[204:205]
v_pk_add_f32 v[142:143], v[142:143], v[206:207]
s_waitcnt vmcnt(2)
v_lshlrev_b32 v192, 16, v224
v_and_b32 v193, 0xffff0000, v224
v_lshlrev_b32 v194, 16, v225
v_and_b32 v195, 0xffff0000, v225
v_lshlrev_b32 v196, 16, v226
v_and_b32 v197, 0xffff0000, v226
v_lshlrev_b32 v198, 16, v227
v_and_b32 v199, 0xffff0000, v227
v_lshlrev_b32 v200, 16, v228
v_and_b32 v201, 0xffff0000, v228
v_lshlrev_b32 v202, 16, v229
v_and_b32 v203, 0xffff0000, v229
v_lshlrev_b32 v204, 16, v230
v_and_b32 v205, 0xffff0000, v230
v_lshlrev_b32 v206, 16, v231
v_and_b32 v207, 0xffff0000, v231
v_pk_add_f32 v[128:129], v[128:129], v[192:193]
v_pk_add_f32 v[130:131], v[130:131], v[194:195]
v_pk_add_f32 v[132:133], v[132:133], v[196:197]
v_pk_add_f32 v[134:135], v[134:135], v[198:199]
v_pk_add_f32 v[136:137], v[136:137], v[200:201]
v_pk_add_f32 v[138:139], v[138:139], v[202:203]
v_pk_add_f32 v[140:141], v[140:141], v[204:205]
v_pk_add_f32 v[142:143], v[142:143], v[206:207]
s_waitcnt vmcnt(0)
v_lshlrev_b32 v192, 16, v240
v_and_b32 v193, 0xffff0000, v240
v_lshlrev_b32 v194, 16, v241
v_and_b32 v195, 0xffff0000, v241
v_lshlrev_b32 v196, 16, v242
v_and_b32 v197, 0xffff0000, v242
v_lshlrev_b32 v198, 16, v243
v_and_b32 v199, 0xffff0000, v243
v_lshlrev_b32 v200, 16, v244
v_and_b32 v201, 0xffff0000, v244
v_lshlrev_b32 v202, 16, v245
v_and_b32 v203, 0xffff0000, v245
v_lshlrev_b32 v204, 16, v246
v_and_b32 v205, 0xffff0000, v246
v_lshlrev_b32 v206, 16, v247
v_and_b32 v207, 0xffff0000, v247
v_pk_add_f32 v[128:129], v[128:129], v[192:193]
v_pk_add_f32 v[130:131], v[130:131], v[194:195]
v_pk_add_f32 v[132:133], v[132:133], v[196:197]
v_pk_add_f32 v[134:135], v[134:135], v[198:199]
v_pk_add_f32 v[136:137], v[136:137], v[200:201]
v_pk_add_f32 v[138:139], v[138:139], v[202:203]
v_pk_add_f32 v[140:141], v[140:141], v[204:205]
v_pk_add_f32 v[142:143], v[142:143], v[206:207]
ds_write_b128 v28, v[128:131] offset:0
ds_write_b128 v29, v[132:135] offset:0
ds_write_b128 v30, v[136:139] offset:0
ds_write_b128 v31, v[140:143] offset:0
s_waitcnt lgkmcnt(0)
ds_read_b128 v[64:67], v32
ds_read_b128 v[68:71], v33
ds_read_b128 v[72:75], v34
ds_read_b128 v[76:79], v35
s_add_u32 s80, s7, 0
s_waitcnt lgkmcnt(3)
buffer_store_dwordx4 v[64:67], v36, s[48:51], s80 offen offset:2048 sc1
s_add_u32 s80, s7, 16384
s_waitcnt lgkmcnt(2)
buffer_store_dwordx4 v[68:71], v36, s[48:51], s80 offen offset:2048 sc1
s_add_u32 s80, s7, 32768
s_waitcnt lgkmcnt(1)
buffer_store_dwordx4 v[72:75], v36, s[48:51], s80 offen offset:2048 sc1
s_add_u32 s80, s7, 49152
s_waitcnt lgkmcnt(0)
buffer_store_dwordx4 v[76:79], v36, s[48:51], s80 offen offset:2048 sc1
L_end:
s_endpgm
L_spinI:
s_mov_b32 s83, 0x20000
L_spI:
s_sleep 2
global_load_dword v13, v10, s[36:37] sc1
s_sub_u32 s83, s83, 1
s_waitcnt vmcnt(0)
v_cmp_eq_u32 vcc, 0, v13
s_cmp_eq_u32 s83, 0
s_cbranch_scc1 L_goI
s_cbranch_vccnz L_spI
s_branch L_goI
Lspin2:
s_mov_b32 s83, 0x20000
Lsp4:
s_sleep 2
buffer_load_dword v13, v10, s[60:63], s19 offen sc1
s_sub_u32 s83, s83, 1
s_waitcnt vmcnt(0)
v_cmp_gt_u32 vcc, 256, v13
s_cmp_eq_u32 s83, 0
s_cbranch_scc1 Lgo3
s_cbranch_vccnz Lsp4
s_branch Lgo3
Lwb6:
buffer_wbl2 sc1
s_waitcnt vmcnt(0)
s_branch Lwbd7
Lspin8:
s_mov_b32 s83, 0x20000
Lsp10:
s_sleep 2
buffer_load_dword v42, v7, s[60:63], s19 offen sc1
s_sub_u32 s83, s83, 1
s_waitcnt vmcnt(0)
v_cmp_gt_u32 vcc, 512, v42
s_cmp_eq_u32 s83, 0
s_cbranch_scc1 Lgo9
s_cbranch_vccnz Lsp10
s_branch Lgo9
Lstub15:
s_call_b64 s[12:13], L_rare00
s_branch Lret16
Lstub17:
s_call_b64 s[12:13], L_rare10
s_branch Lret18
Lstub19:
s_call_b64 s[12:13], L_rare01
s_branch Lret20
Lstub21:
s_call_b64 s[12:13], L_rare11
s_branch Lret22
Lstub24:
s_call_b64 s[12:13], L_rare00
s_branch Lret25
Lstub26:
s_call_b64 s[12:13], L_rare10
s_branch Lret27
Lstub28:
s_call_b64 s[12:13], L_rare01
s_branch Lret29
Lstub30:
s_call_b64 s[12:13], L_rare11
s_branch Lret31
Lstub33:
s_call_b64 s[12:13], L_rare00
s_branch Lret34
Lstub35:
s_call_b64 s[12:13], L_rare10
s_branch Lret36
Lstub37:
s_call_b64 s[12:13], L_rare01
s_branch Lret38
Lstub39:
s_call_b64 s[12:13], L_rare11
s_branch Lret40
Lwb42:
buffer_wbl2 sc1
s_waitcnt vmcnt(0)
s_branch Lwbd43
Lstub44:
s_call_b64 s[12:13], L_rare00
s_branch Lret45
Lstub46:
s_call_b64 s[12:13], L_rare10
s_branch Lret47
Lstub48:
s_call_b64 s[12:13], L_rare01
s_branch Lret49
Lstub50:
s_call_b64 s[12:13], L_rare11
s_branch Lret51
Lspin52:
s_mov_b32 s83, 0x20000
Lsp54:
s_sleep 2
buffer_load_dword v59, v7, s[60:63], s19 offen sc1
s_sub_u32 s83, s83, 1
s_waitcnt vmcnt(0)
v_cmp_gt_u32 vcc, 768, v59
s_cmp_eq_u32 s83, 0
s_cbranch_scc1 Lgo53
s_cbranch_vccnz Lsp54
s_branch Lgo53
Lstub56:
s_call_b64 s[12:13], L_rare00
s_branch Lret57
Lstub58:
s_call_b64 s[12:13], L_rare10
s_branch Lret59
Lstub60:
s_call_b64 s[12:13], L_rare01
s_branch Lret61
Lstub62:
s_call_b64 s[12:13], L_rare11
s_branch Lret63
Lspin64:
s_mov_b32 s83, 0x20000
Lsp66:
s_sleep 2
buffer_load_dwordx4 v[56:59], v0, s[60:63], s19 offen sc1
s_sub_u32 s83, s83, 1
s_waitcnt vmcnt(0)
v_min3_u32 v56, v56, v57, v58
v_min_u32 v56, v56, v59
v_cmp_gt_u32 vcc, 768, v56
s_cmp_eq_u32 s83, 0
s_cbranch_scc1 Lgo65
s_cbranch_vccnz Lsp66
s_branch Lgo65
Lstub67:
s_call_b64 s[12:13], L_rare00
s_branch Lret68
Lstub69:
s_call_b64 s[12:13], L_rare10
s_branch Lret70
Lstub71:
s_call_b64 s[12:13], L_rare01
s_branch Lret72
Lstub73:
s_call_b64 s[12:13], L_rare11
s_branch Lret74
Lstub76:
s_call_b64 s[12:13], L_rare00
s_branch Lret77
Lstub78:
s_call_b64 s[12:13], L_rare10
s_branch Lret79
Lstub80:
s_call_b64 s[12:13], L_rare11x
s_branch Lret81
L_cbm:
s_nop 3
v_fma_f32 v192, v8, s14, v192
v_fma_f32 v193, v9, s14, v193
v_fma_f32 v194, v10, s14, v194
v_fma_f32 v195, v11, s14, v195
v_fma_f32 v196, v12, s14, v196
v_fma_f32 v197, v13, s14, v197
v_fma_f32 v198, v14, s14, v198
v_fma_f32 v199, v15, s14, v199
v_fma_f32 v200, v16, s14, v200
v_fma_f32 v201, v17, s14, v201
v_fma_f32 v202, v18, s14, v202
v_fma_f32 v203, v19, s14, v203
v_fma_f32 v204, v20, s14, v204
v_fma_f32 v205, v21, s14, v205
v_fma_f32 v206, v22, s14, v206
v_fma_f32 v207, v23, s14, v207
s_branch L_cbd
Lstub82:
s_call_b64 s[12:13], L_rare00
s_branch Lret83
Lstub86:
s_call_b64 s[12:13], L_rare10
s_branch Lret87
Lstub88:
s_call_b64 s[12:13], L_rare11x
s_branch Lret89
Lstub105:
s_call_b64 s[12:13], L_rare00
s_branch Lret106
Lstub107:
s_call_b64 s[12:13], L_rare10
s_branch Lret108
Lstub109:
s_call_b64 s[12:13], L_rare01
s_branch Lret110
Lstub111:
s_call_b64 s[12:13], L_rare11
s_branch Lret112
L_rare00:
s_nop 7
v_max3_f32 v52, v192, v193, v194
v_max3_f32 v52, v52, v195, v196
v_max3_f32 v52, v52, v197, v198
v_max3_f32 v52, v52, v199, v200
v_max3_f32 v52, v52, v201, v202
v_max3_f32 v52, v52, v203, v204
v_max3_f32 v52, v52, v205, v206
v_max_f32 v52, v52, v207
v_mov_b32 v53, v52
s_nop 1
v_permlane32_swap_b32 v52, v53
v_max_f32 v52, v52, v53
v_mov_b32 v53, v52
s_nop 1
v_permlane16_swap_b32 v52, v53
v_max_f32 v52, v52, v53
v_log_f32 v53, v24
s_nop 0
v_max_f32 v52, v52, v53
v_add_f32 v52, 0x42ca0000, v52
v_max_f32 v52, 0, v52
v_exp_f32 v53, -v52
s_nop 0
v_mul_f32 v24, v24, v53
v_mul_f32 v25, v25, v53
v_mul_f32 v26, v26, v53
v_mul_f32 v27, v27, v53
v_sub_f32 v192, v192, v52
v_sub_f32 v193, v193, v52
v_sub_f32 v194, v194, v52
v_sub_f32 v195, v195, v52
v_sub_f32 v196, v196, v52
v_sub_f32 v197, v197, v52
v_sub_f32 v198, v198, v52
v_sub_f32 v199, v199, v52
v_sub_f32 v200, v200, v52
v_sub_f32 v201, v201, v52
v_sub_f32 v202, v202, v52
v_sub_f32 v203, v203, v52
v_sub_f32 v204, v204, v52
v_sub_f32 v205, v205, v52
v_sub_f32 v206, v206, v52
v_sub_f32 v207, v207, v52
v_exp_f32 v192, v192
v_exp_f32 v193, v193
v_exp_f32 v194, v194
v_exp_f32 v195, v195
v_exp_f32 v196, v196
v_exp_f32 v197, v197
v_exp_f32 v198, v198
v_exp_f32 v199, v199
v_exp_f32 v200, v200
v_exp_f32 v201, v201
v_exp_f32 v202, v202
v_exp_f32 v203, v203
v_exp_f32 v204, v204
v_exp_f32 v205, v205
v_exp_f32 v206, v206
v_exp_f32 v207, v207
v_sub_f32 v224, v224, v52
v_sub_f32 v225, v225, v52
v_sub_f32 v226, v226, v52
v_sub_f32 v227, v227, v52
v_sub_f32 v228, v228, v52
v_sub_f32 v229, v229, v52
v_sub_f32 v230, v230, v52
v_sub_f32 v231, v231, v52
v_sub_f32 v232, v232, v52
v_sub_f32 v233, v233, v52
v_sub_f32 v234, v234, v52
v_sub_f32 v235, v235, v52
v_sub_f32 v236, v236, v52
v_sub_f32 v237, v237, v52
v_sub_f32 v238, v238, v52
v_sub_f32 v239, v239, v52
v_cvt_pk_bf16_f32 v80, v192, v193
v_cvt_pk_bf16_f32 v81, v194, v195
v_cvt_pk_bf16_f32 v82, v196, v197
v_cvt_pk_bf16_f32 v83, v198, v199
v_cvt_pk_bf16_f32 v84, v200, v201
v_cvt_pk_bf16_f32 v85, v202, v203
v_cvt_pk_bf16_f32 v86, v204, v205
v_cvt_pk_bf16_f32 v87, v206, v207
v_sub_f32 v40, v40, v52
v_sub_f32 v41, v41, v52
v_sub_f32 v42, v42, v52
v_sub_f32 v43, v43, v52
v_mfma_f32_16x16x32_bf16 v[32:35], v[28:31], v[80:83], v[24:27]
v_mfma_f32_16x16x32_bf16 v[32:35], v[28:31], v[84:87], v[32:35]
v_mul_f32 v128, v128, v53
v_mul_f32 v129, v129, v53
v_mul_f32 v130, v130, v53
v_mul_f32 v131, v131, v53
v_mul_f32 v132, v132, v53
v_mul_f32 v133, v133, v53
v_mul_f32 v134, v134, v53
v_mul_f32 v135, v135, v53
v_mul_f32 v136, v136, v53
v_mul_f32 v137, v137, v53
v_mul_f32 v138, v138, v53
v_mul_f32 v139, v139, v53
v_mul_f32 v140, v140, v53
v_mul_f32 v141, v141, v53
v_mul_f32 v142, v142, v53
v_mul_f32 v143, v143, v53
v_mul_f32 v144, v144, v53
v_mul_f32 v145, v145, v53
v_mul_f32 v146, v146, v53
v_mul_f32 v147, v147, v53
v_mul_f32 v148, v148, v53
v_mul_f32 v149, v149, v53
v_mul_f32 v150, v150, v53
v_mul_f32 v151, v151, v53
v_mul_f32 v152, v152, v53
v_mul_f32 v153, v153, v53
v_mul_f32 v154, v154, v53
v_mul_f32 v155, v155, v53
v_mul_f32 v156, v156, v53
v_mul_f32 v157, v157, v53
v_mul_f32 v158, v158, v53
v_mul_f32 v159, v159, v53
s_nop 1
s_setpc_b64 s[12:13]
L_rare01:
s_nop 7
v_max3_f32 v52, v224, v225, v226
v_max3_f32 v52, v52, v227, v228
v_max3_f32 v52, v52, v229, v230
v_max3_f32 v52, v52, v231, v232
v_max3_f32 v52, v52, v233, v234
v_max3_f32 v52, v52, v235, v236
v_max3_f32 v52, v52, v237, v238
v_max_f32 v52, v52, v239
v_mov_b32 v53, v52
s_nop 1
v_permlane32_swap_b32 v52, v53
v_max_f32 v52, v52, v53
v_mov_b32 v53, v52
s_nop 1
v_permlane16_swap_b32 v52, v53
v_max_f32 v52, v52, v53
v_log_f32 v53, v32
s_nop 0
v_max_f32 v52, v52, v53
v_add_f32 v52, 0x42ca0000, v52
v_max_f32 v52, 0, v52
v_exp_f32 v53, -v52
s_nop 0
v_mul_f32 v32, v32, v53
v_mul_f32 v33, v33, v53
v_mul_f32 v34, v34, v53
v_mul_f32 v35, v35, v53
v_sub_f32 v224, v224, v52
v_sub_f32 v225, v225, v52
v_sub_f32 v226, v226, v52
v_sub_f32 v227, v227, v52
v_sub_f32 v228, v228, v52
v_sub_f32 v229, v229, v52
v_sub_f32 v230, v230, v52
v_sub_f32 v231, v231, v52
v_sub_f32 v232, v232, v52
v_sub_f32 v233, v233, v52
v_sub_f32 v234, v234, v52
v_sub_f32 v235, v235, v52
v_sub_f32 v236, v236, v52
v_sub_f32 v237, v237, v52
v_sub_f32 v238, v238, v52
v_sub_f32 v239, v239, v52
v_exp_f32 v224, v224
v_exp_f32 v225, v225
v_exp_f32 v226, v226
v_exp_f32 v227, v227
v_exp_f32 v228, v228
v_exp_f32 v229, v229
v_exp_f32 v230, v230
v_exp_f32 v231, v231
v_exp_f32 v232, v232
v_exp_f32 v233, v233
v_exp_f32 v234, v234
v_exp_f32 v235, v235
v_exp_f32 v236, v236
v_exp_f32 v237, v237
v_exp_f32 v238, v238
v_exp_f32 v239, v239
v_sub_f32 v192, v192, v52
v_sub_f32 v193, v193, v52
v_sub_f32 v194, v194, v52
v_sub_f32 v195, v195, v52
v_sub_f32 v196, v196, v52
v_sub_f32 v197, v197, v52
v_sub_f32 v198, v198, v52
v_sub_f32 v199, v199, v52
v_sub_f32 v200, v200, v52
v_sub_f32 v201, v201, v52
v_sub_f32 v202, v202, v52
v_sub_f32 v203, v203, v52
v_sub_f32 v204, v204, v52
v_sub_f32 v205, v205, v52
v_sub_f32 v206, v206, v52
v_sub_f32 v207, v207, v52
v_cvt_pk_bf16_f32 v80, v224, v225
v_cvt_pk_bf16_f32 v81, v226, v227
v_cvt_pk_bf16_f32 v82, v228, v229
v_cvt_pk_bf16_f32 v83, v230, v231
v_cvt_pk_bf16_f32 v84, v232, v233
v_cvt_pk_bf16_f32 v85, v234, v235
v_cvt_pk_bf16_f32 v86, v236, v237
v_cvt_pk_bf16_f32 v87, v238, v239
v_sub_f32 v40, v40, v52
v_sub_f32 v41, v41, v52
v_sub_f32 v42, v42, v52
v_sub_f32 v43, v43, v52
v_mfma_f32_16x16x32_bf16 v[24:27], v[28:31], v[80:83], v[32:35]
v_mfma_f32_16x16x32_bf16 v[24:27], v[28:31], v[84:87], v[24:27]
v_mul_f32 v128, v128, v53
v_mul_f32 v129, v129, v53
v_mul_f32 v130, v130, v53
v_mul_f32 v131, v131, v53
v_mul_f32 v132, v132, v53
v_mul_f32 v133, v133, v53
v_mul_f32 v134, v134, v53
v_mul_f32 v135, v135, v53
v_mul_f32 v136, v136, v53
v_mul_f32 v137, v137, v53
v_mul_f32 v138, v138, v53
v_mul_f32 v139, v139, v53
v_mul_f32 v140, v140, v53
v_mul_f32 v141, v141, v53
v_mul_f32 v142, v142, v53
v_mul_f32 v143, v143, v53
v_mul_f32 v144, v144, v53
v_mul_f32 v145, v145, v53
v_mul_f32 v146, v146, v53
v_mul_f32 v147, v147, v53
v_mul_f32 v148, v148, v53
v_mul_f32 v149, v149, v53
v_mul_f32 v150, v150, v53
v_mul_f32 v151, v151, v53
v_mul_f32 v152, v152, v53
v_mul_f32 v153, v153, v53
v_mul_f32 v154, v154, v53
v_mul_f32 v155, v155, v53
v_mul_f32 v156, v156, v53
v_mul_f32 v157, v157, v53
v_mul_f32 v158, v158, v53
v_mul_f32 v159, v159, v53
s_nop 1
s_setpc_b64 s[12:13]
L_rare10:
s_nop 7
v_max3_f32 v52, v208, v209, v210
v_max3_f32 v52, v52, v211, v212
v_max3_f32 v52, v52, v213, v214
v_max3_f32 v52, v52, v215, v216
v_max3_f32 v52, v52, v217, v218
v_max3_f32 v52, v52, v219, v220
v_max3_f32 v52, v52, v221, v222
v_max_f32 v52, v52, v223
v_mov_b32 v53, v52
s_nop 1
v_permlane32_swap_b32 v52, v53
v_max_f32 v52, v52, v53
v_mov_b32 v53, v52
s_nop 1
v_permlane16_swap_b32 v52, v53
v_max_f32 v52, v52, v53
v_log_f32 v53, v60
s_nop 0
v_max_f32 v52, v52, v53
v_add_f32 v52, 0x42ca0000, v52
v_max_f32 v52, 0, v52
v_exp_f32 v53, -v52
s_nop 0
v_mul_f32 v60, v60, v53
v_mul_f32 v61, v61, v53
v_mul_f32 v62, v62, v53
v_mul_f32 v63, v63, v53
v_sub_f32 v208, v208, v52
v_sub_f32 v209, v209, v52
v_sub_f32 v210, v210, v52
v_sub_f32 v211, v211, v52
v_sub_f32 v212, v212, v52
v_sub_f32 v213, v213, v52
v_sub_f32 v214, v214, v52
v_sub_f32 v215, v215, v52
v_sub_f32 v216, v216, v52
v_sub_f32 v217, v217, v52
v_sub_f32 v218, v218, v52
v_sub_f32 v219, v219, v52
v_sub_f32 v220, v220, v52
v_sub_f32 v221, v221, v52
v_sub_f32 v222, v222, v52
v_sub_f32 v223, v223, v52
v_exp_f32 v208, v208
v_exp_f32 v209, v209
v_exp_f32 v210, v210
v_exp_f32 v211, v211
v_exp_f32 v212, v212
v_exp_f32 v213, v213
v_exp_f32 v214, v214
v_exp_f32 v215, v215
v_exp_f32 v216, v216
v_exp_f32 v217, v217
v_exp_f32 v218, v218
v_exp_f32 v219, v219
v_exp_f32 v220, v220
v_exp_f32 v221, v221
v_exp_f32 v222, v222
v_exp_f32 v223, v223
v_sub_f32 v240, v240, v52
v_sub_f32 v241, v241, v52
v_sub_f32 v242, v242, v52
v_sub_f32 v243, v243, v52
v_sub_f32 v244, v244, v52
v_sub_f32 v245, v245, v52
v_sub_f32 v246, v246, v52
v_sub_f32 v247, v247, v52
v_sub_f32 v248, v248, v52
v_sub_f32 v249, v249, v52
v_sub_f32 v250, v250, v52
v_sub_f32 v251, v251, v52
v_sub_f32 v252, v252, v52
v_sub_f32 v253, v253, v52
v_sub_f32 v254, v254, v52
v_sub_f32 v255, v255, v52
v_cvt_pk_bf16_f32 v88, v208, v209
v_cvt_pk_bf16_f32 v89, v210, v211
v_cvt_pk_bf16_f32 v90, v212, v213
v_cvt_pk_bf16_f32 v91, v214, v215
v_cvt_pk_bf16_f32 v92, v216, v217
v_cvt_pk_bf16_f32 v93, v218, v219
v_cvt_pk_bf16_f32 v94, v220, v221
v_cvt_pk_bf16_f32 v95, v222, v223
v_sub_f32 v44, v44, v52
v_sub_f32 v45, v45, v52
v_sub_f32 v46, v46, v52
v_sub_f32 v47, v47, v52
v_mfma_f32_16x16x32_bf16 v[36:39], v[28:31], v[88:91], v[60:63]
v_mfma_f32_16x16x32_bf16 v[36:39], v[28:31], v[92:95], v[36:39]
v_mul_f32 v160, v160, v53
v_mul_f32 v161, v161, v53
v_mul_f32 v162, v162, v53
v_mul_f32 v163, v163, v53
v_mul_f32 v164, v164, v53
v_mul_f32 v165, v165, v53
v_mul_f32 v166, v166, v53
v_mul_f32 v167, v167, v53
v_mul_f32 v168, v168, v53
v_mul_f32 v169, v169, v53
v_mul_f32 v170, v170, v53
v_mul_f32 v171, v171, v53
v_mul_f32 v172, v172, v53
v_mul_f32 v173, v173, v53
v_mul_f32 v174, v174, v53
v_mul_f32 v175, v175, v53
v_mul_f32 v176, v176, v53
v_mul_f32 v177, v177, v53
v_mul_f32 v178, v178, v53
v_mul_f32 v179, v179, v53
v_mul_f32 v180, v180, v53
v_mul_f32 v181, v181, v53
v_mul_f32 v182, v182, v53
v_mul_f32 v183, v183, v53
v_mul_f32 v184, v184, v53
v_mul_f32 v185, v185, v53
v_mul_f32 v186, v186, v53
v_mul_f32 v187, v187, v53
v_mul_f32 v188, v188, v53
v_mul_f32 v189, v189, v53
v_mul_f32 v190, v190, v53
v_mul_f32 v191, v191, v53
s_nop 1
s_setpc_b64 s[12:13]
L_rare11:
s_nop 7
v_max3_f32 v52, v240, v241, v242
v_max3_f32 v52, v52, v243, v244
v_max3_f32 v52, v52, v245, v246
v_max3_f32 v52, v52, v247, v248
v_max3_f32 v52, v52, v249, v250
v_max3_f32 v52, v52, v251, v252
v_max3_f32 v52, v52, v253, v254
v_max_f32 v52, v52, v255
v_mov_b32 v53, v52
s_nop 1
v_permlane32_swap_b32 v52, v53
v_max_f32 v52, v52, v53
v_mov_b32 v53, v52
s_nop 1
v_permlane16_swap_b32 v52, v53
v_max_f32 v52, v52, v53
v_log_f32 v53, v36
s_nop 0
v_max_f32 v52, v52, v53
v_add_f32 v52, 0x42ca0000, v52
v_max_f32 v52, 0, v52
v_exp_f32 v53, -v52
s_nop 0
v_mul_f32 v36, v36, v53
v_mul_f32 v37, v37, v53
v_mul_f32 v38, v38, v53
v_mul_f32 v39, v39, v53
v_sub_f32 v240, v240, v52
v_sub_f32 v241, v241, v52
v_sub_f32 v242, v242, v52
v_sub_f32 v243, v243, v52
v_sub_f32 v244, v244, v52
v_sub_f32 v245, v245, v52
v_sub_f32 v246, v246, v52
v_sub_f32 v247, v247, v52
v_sub_f32 v248, v248, v52
v_sub_f32 v249, v249, v52
v_sub_f32 v250, v250, v52
v_sub_f32 v251, v251, v52
v_sub_f32 v252, v252, v52
v_sub_f32 v253, v253, v52
v_sub_f32 v254, v254, v52
v_sub_f32 v255, v255, v52
v_exp_f32 v240, v240
v_exp_f32 v241, v241
v_exp_f32 v242, v242
v_exp_f32 v243, v243
v_exp_f32 v244, v244
v_exp_f32 v245, v245
v_exp_f32 v246, v246
v_exp_f32 v247, v247
v_exp_f32 v248, v248
v_exp_f32 v249, v249
v_exp_f32 v250, v250
v_exp_f32 v251, v251
v_exp_f32 v252, v252
v_exp_f32 v253, v253
v_exp_f32 v254, v254
v_exp_f32 v255, v255
v_sub_f32 v208, v208, v52
v_sub_f32 v209, v209, v52
v_sub_f32 v210, v210, v52
v_sub_f32 v211, v211, v52
v_sub_f32 v212, v212, v52
v_sub_f32 v213, v213, v52
v_sub_f32 v214, v214, v52
v_sub_f32 v215, v215, v52
v_sub_f32 v216, v216, v52
v_sub_f32 v217, v217, v52
v_sub_f32 v218, v218, v52
v_sub_f32 v219, v219, v52
v_sub_f32 v220, v220, v52
v_sub_f32 v221, v221, v52
v_sub_f32 v222, v222, v52
v_sub_f32 v223, v223, v52
v_cvt_pk_bf16_f32 v88, v240, v241
v_cvt_pk_bf16_f32 v89, v242, v243
v_cvt_pk_bf16_f32 v90, v244, v245
v_cvt_pk_bf16_f32 v91, v246, v247
v_cvt_pk_bf16_f32 v92, v248, v249
v_cvt_pk_bf16_f32 v93, v250, v251
v_cvt_pk_bf16_f32 v94, v252, v253
v_cvt_pk_bf16_f32 v95, v254, v255
v_sub_f32 v44, v44, v52
v_sub_f32 v45, v45, v52
v_sub_f32 v46, v46, v52
v_sub_f32 v47, v47, v52
v_mfma_f32_16x16x32_bf16 v[60:63], v[28:31], v[88:91], v[36:39]
v_mfma_f32_16x16x32_bf16 v[60:63], v[28:31], v[92:95], v[60:63]
v_mul_f32 v160, v160, v53
v_mul_f32 v161, v161, v53
v_mul_f32 v162, v162, v53
v_mul_f32 v163, v163, v53
v_mul_f32 v164, v164, v53
v_mul_f32 v165, v165, v53
v_mul_f32 v166, v166, v53
v_mul_f32 v167, v167, v53
v_mul_f32 v168, v168, v53
v_mul_f32 v169, v169, v53
v_mul_f32 v170, v170, v53
v_mul_f32 v171, v171, v53
v_mul_f32 v172, v172, v53
v_mul_f32 v173, v173, v53
v_mul_f32 v174, v174, v53
v_mul_f32 v175, v175, v53
v_mul_f32 v176, v176, v53
v_mul_f32 v177, v177, v53
v_mul_f32 v178, v178, v53
v_mul_f32 v179, v179, v53
v_mul_f32 v180, v180, v53
v_mul_f32 v181, v181, v53
v_mul_f32 v182, v182, v53
v_mul_f32 v183, v183, v53
v_mul_f32 v184, v184, v53
v_mul_f32 v185, v185, v53
v_mul_f32 v186, v186, v53
v_mul_f32 v187, v187, v53
v_mul_f32 v188, v188, v53
v_mul_f32 v189, v189, v53
v_mul_f32 v190, v190, v53
v_mul_f32 v191, v191, v53
s_nop 1
s_setpc_b64 s[12:13]
L_rare11x:
s_nop 7
v_max3_f32 v52, v240, v241, v242
v_max3_f32 v52, v52, v243, v244
v_max3_f32 v52, v52, v245, v246
v_max3_f32 v52, v52, v247, v248
v_max3_f32 v52, v52, v249, v250
v_max3_f32 v52, v52, v251, v252
v_max3_f32 v52, v52, v253, v254
v_max_f32 v52, v52, v255
v_mov_b32 v53, v52
s_nop 1
v_permlane32_swap_b32 v52, v53
v_max_f32 v52, v52, v53
v_mov_b32 v53, v52
s_nop 1
v_permlane16_swap_b32 v52, v53
v_max_f32 v52, v52, v53
v_log_f32 v53, v36
s_nop 0
v_max_f32 v52, v52, v53
v_add_f32 v52, 0x42ca0000, v52
v_max_f32 v52, 0, v52
v_exp_f32 v53, -v52
s_nop 0
v_mul_f32 v36, v36, v53
v_mul_f32 v37, v37, v53
v_mul_f32 v38, v38, v53
v_mul_f32 v39, v39, v53
v_sub_f32 v240, v240, v52
v_sub_f32 v241, v241, v52
v_sub_f32 v242, v242, v52
v_sub_f32 v243, v243, v52
v_sub_f32 v244, v244, v52
v_sub_f32 v245, v245, v52
v_sub_f32 v246, v246, v52
v_sub_f32 v247, v247, v52
v_sub_f32 v248, v248, v52
v_sub_f32 v249, v249, v52
v_sub_f32 v250, v250, v52
v_sub_f32 v251, v251, v52
v_sub_f32 v252, v252, v52
v_sub_f32 v253, v253, v52
v_sub_f32 v254, v254, v52
v_sub_f32 v255, v255, v52
v_exp_f32 v240, v240
v_exp_f32 v241, v241
v_exp_f32 v242, v242
v_exp_f32 v243, v243
v_exp_f32 v244, v244
v_exp_f32 v245, v245
v_exp_f32 v246, v246
v_exp_f32 v247, v247
v_exp_f32 v248, v248
v_exp_f32 v249, v249
v_exp_f32 v250, v250
v_exp_f32 v251, v251
v_exp_f32 v252, v252
v_exp_f32 v253, v253
v_exp_f32 v254, v254
v_exp_f32 v255, v255
v_cvt_pk_bf16_f32 v224, v240, v241
v_cvt_pk_bf16_f32 v225, v242, v243
v_cvt_pk_bf16_f32 v226, v244, v245
v_cvt_pk_bf16_f32 v227, v246, v247
v_cvt_pk_bf16_f32 v228, v248, v249
v_cvt_pk_bf16_f32 v229, v250, v251
v_cvt_pk_bf16_f32 v230, v252, v253
v_cvt_pk_bf16_f32 v231, v254, v255
v_sub_f32 v44, v44, v52
v_sub_f32 v45, v45, v52
v_sub_f32 v46, v46, v52
v_sub_f32 v47, v47, v52
v_mfma_f32_16x16x32_bf16 v[60:63], v[28:31], v[224:227], v[36:39]
v_mfma_f32_16x16x32_bf16 v[60:63], v[28:31], v[228:231], v[60:63]
v_mul_f32 v160, v160, v53
v_mul_f32 v161, v161, v53
v_mul_f32 v162, v162, v53
v_mul_f32 v163, v163, v53
v_mul_f32 v164, v164, v53
v_mul_f32 v165, v165, v53
v_mul_f32 v166, v166, v53
v_mul_f32 v167, v167, v53
v_mul_f32 v168, v168, v53
v_mul_f32 v169, v169, v53
v_mul_f32 v170, v170, v53
v_mul_f32 v171, v171, v53
v_mul_f32 v172, v172, v53
v_mul_f32 v173, v173, v53
v_mul_f32 v174, v174, v53
v_mul_f32 v175, v175, v53
v_mul_f32 v176, v176, v53
v_mul_f32 v177, v177, v53
v_mul_f32 v178, v178, v53
v_mul_f32 v179, v179, v53
v_mul_f32 v180, v180, v53
v_mul_f32 v181, v181, v53
v_mul_f32 v182, v182, v53
v_mul_f32 v183, v183, v53
v_mul_f32 v184, v184, v53
v_mul_f32 v185, v185, v53
v_mul_f32 v186, v186, v53
v_mul_f32 v187, v187, v53
v_mul_f32 v188, v188, v53
v_mul_f32 v189, v189, v53
v_mul_f32 v190, v190, v53
v_mul_f32 v191, v191, v53
s_nop 1
s_setpc_b64 s[12:13]
.section .rodata,"a"
.p2align 6
.amdhsa_kernel concat_heads__ssm_conv_s5__compressed_kv_cla__prompt_kernel
  .amdhsa_next_free_vgpr 512
  .amdhsa_next_free_sgpr 102
  .amdhsa_accum_offset 256
  .amdhsa_group_segment_fixed_size 0
  .amdhsa_kernarg_size 144
  .amdhsa_user_sgpr_count 2
  .amdhsa_user_sgpr_kernarg_segment_ptr 1
  .amdhsa_system_sgpr_workgroup_id_x 1
.end_amdhsa_kernel
.text
s_endpgm
L_text_end:
```
